```python
import torch

def _softmax(x, axis=-1):
    return torch.softmax(x, dim=axis)
def _gelu(x):
    return torch.nn.functional.gelu(x, approximate="tanh")
def _silu(x):
    return torch.nn.functional.silu(x)
def _sigmoid(x):
    return torch.sigmoid(x)
def _layernorm(x, axis=-1, eps=1e-5):
    m = x.mean(dim=axis, keepdim=True)
    v = x.var(dim=axis, keepdim=True, unbiased=False)
    return (x - m) / torch.sqrt(v + eps)
def _scatter_add(tgt, idx, src, axis=0):
    return tgt.clone().index_add_(axis, idx, src)
def _segment_sum(src, seg, n):
    out = torch.zeros((n,) + src.shape[1:], dtype=src.dtype)
    return out.index_add_(0, seg, src)
def _pad(x, pw):
    flat = tuple(v for pair in reversed(pw) for v in pair)
    return torch.nn.functional.pad(x, flat)

kernel_name = 'recurrent_scan__sliding_block_cached__swiglu_ffn__prompt'

def setup_inputs():

    _w = (lambda a: (lambda t: t.to(torch.bfloat16) if t.is_floating_point() else t)(torch.as_tensor(a)))
    def _A_setup():
        B, Sq, D = 1, 2048, 640
        Hq, Hkv, Sk, Dh = 32, 32, 2048, 192
        assert Hq % Hkv == 0, (Hq, Hkv)
        return {
            "x": _w((lambda *s: torch.randn(*s, dtype=torch.bfloat16) * 0.05)(B, Sq, D)),
            "k_cache": _w((lambda *s: torch.randn(*s, dtype=torch.bfloat16) * 0.8)(B, Hkv, Sk, Dh)),
            "v_cache": _w((lambda *s: torch.randn(*s, dtype=torch.bfloat16) * 0.2)(B, Hkv, Sk, Dh)),
            "wq": _w((lambda *s: torch.randn(*s, dtype=torch.bfloat16) * 0.8)(D, Hq * Dh) * (D ** -0.5)),
            "wo": _w((lambda *s: torch.randn(*s, dtype=torch.bfloat16) * 0.2)(Hq * Dh, D) * ((Hq * Dh) ** -0.5)),
        }
    _A_in = _A_setup()

    def _B_setup():
        B, S, D, F = 1, 2048, 640, 1536
        return {
            "x": _w((lambda *s: torch.randn(*s, dtype=torch.bfloat16) * 0.05)(B, S, D)),
            "w_gate": _w((lambda *s: torch.randn(*s, dtype=torch.bfloat16) * 0.1)(D, F)),
            "w_up": _w((lambda *s: torch.randn(*s, dtype=torch.bfloat16) * 0.1)(D, F)),
            "w_down": _w((lambda *s: torch.randn(*s, dtype=torch.bfloat16) * 0.1)(F, D)),
        }
    _B_in = _B_setup()

    return {
        "A_x": _A_in["x"],
        "A_k_cache": _A_in["k_cache"],
        "A_v_cache": _A_in["v_cache"],
        "A_wq": _A_in["wq"],
        "A_wo": _A_in["wo"],
        "B_x": _B_in["x"],
        "B_w_gate": _B_in["w_gate"],
        "B_w_up": _B_in["w_up"],
        "B_w_down": _B_in["w_down"],
    }

def reference(A_x, A_k_cache, A_v_cache, A_wq, A_wo, B_x, B_w_gate, B_w_up, B_w_down):
    def _A_ref(x, k_cache, v_cache, wq, wo):
        B, Sq, D = x.shape
        Hq, Dh = 32, 192
        Hkv, Sk = k_cache.shape[1], k_cache.shape[2]
        W = min(4096, max(256, Sk // 4))
        rep = Hq // Hkv
        q = (lambda x, *d: x.permute(*d))((x @ wq).reshape(B, Sq, Hq, Dh), 0, 2, 1, 3)
        k = (lambda x, n, axis: torch.repeat_interleave(x, n, dim=axis))(k_cache[:, :, Sk - W:, :], rep, axis=1)
        v = (lambda x, n, axis: torch.repeat_interleave(x, n, dim=axis))(v_cache[:, :, Sk - W:, :], rep, axis=1)
        scores = torch.einsum("bhqd,bhkd->bhqk", q, k) * (Dh ** -0.5)
        p = _softmax(scores, axis=-1)
        o = torch.einsum("bhqk,bhkd->bhqd", p, v)
        return (lambda x, *d: x.permute(*d))(o, 0, 2, 1, 3).reshape(B, Sq, Hq * Dh) @ wo

    def _B_ref(x, w_gate, w_up, w_down):
        g = _silu(x @ w_gate)
        u = x @ w_up
        return (g * u) @ w_down

    x = A_x
    xn = _layernorm(x, axis=-1)
    s = _A_ref(xn, A_k_cache, A_v_cache, A_wq, A_wo)
    g = _silu(_B_ref(xn, B_w_gate, B_w_up, B_w_down))
    return x + s * g
```

```asm
; @launch grid=(256,1,1) block=(256,1,1) lds=163840
.amdgcn_target "amdgcn-amd-amdhsa--gfx950"
.text
.globl recurrent_scan__sliding_block_cached__swiglu_ffn__prompt_kernel
.p2align 12
.fill 832, 4, 0xBF810000
.p2align 8
.type recurrent_scan__sliding_block_cached__swiglu_ffn__prompt_kernel,@function
recurrent_scan__sliding_block_cached__swiglu_ffn__prompt_kernel:
  s_cmpk_ge_u32 s2, 256
  s_cbranch_scc1 L_end
  s_load_dwordx2 s[32:33], s[0:1], 0
  s_load_dwordx2 s[4:5], s[0:1], 88
  s_getpc_b64 s[48:49]
  v_lshlrev_b32 v121, 5, v0
  global_load_dword a255, v121, s[48:49]
  s_mul_i32 s50, s2, 10240
  v_lshrrev_b32 v50, 5, v0
  v_lshlrev_b32 v52, 3, v0
  v_lshl_add_u32 v52, v50, 10, v52
  s_mov_b32 s34, 2621440
  s_mov_b32 s35, 0x20000
  s_waitcnt lgkmcnt(0)
  buffer_load_dwordx2 v[60:61], v52, s[32:35], s50 offen offset:0
  buffer_load_dwordx2 v[62:63], v52, s[32:35], s50 offen offset:256
  buffer_load_dwordx2 v[64:65], v52, s[32:35], s50 offen offset:512
  buffer_load_dwordx2 v[66:67], v52, s[32:35], s50 offen offset:768
  buffer_load_dwordx2 v[68:69], v52, s[32:35], s50 offen offset:1024
  s_and_b32 s44, s2, 7
  s_bfe_u32 s45, s2, 0x20003
  s_lshl2_add_u32 s47, s44, s45
  s_load_dwordx2 s[8:9], s[0:1], 24
  s_load_dwordx4 s[12:15], s[0:1], 48
  s_mov_b32 s6, 268435456
  s_mov_b32 s7, 0x20000
  s_mov_b32 s10, 7864320
  s_mov_b32 s11, 0x20000
  s_lshr_b32 s46, s2, 5
  s_lshl_b32 s52, s46, 7
  s_add_u32 s52, s52, 3178496
  v_lshrrev_b32 v48, 6, v0
  v_lshlrev_b32 v54, 4, v0
  v_and_b32 v37, 0x3f0, v54
  s_lshr_b32 s51, s2, 3
  v_readfirstlane_b32 s72, v48
  s_and_b32 s98, s44, 1
  s_bitcmp1_b32 s72, 0
  s_waitcnt lgkmcnt(0)
  s_cselect_b64 s[12:13], s[14:15], s[12:13]
  s_load_dword s40, s[4:5], s52
  s_mov_b32 s14, 1966080
  s_mov_b32 s15, 0x20000
  s_lshl2_add_u32 s51, s51, s72
  s_lshl3_add_u32 s53, s51, s44
  s_mul_i32 s53, s53, 1536
  v_lshl_add_u32 v55, v37, 3, s53
  v_cmp_gt_u32 vcc, 192, v37
  v_mov_b32 v57, 2.0
  s_lshr_b32 s53, s51, 1
  v_cndmask_b32 v44, v57, v55, vcc
  s_lshl4_add_u32 s53, s53, s44
  s_mul_i32 s53, s53, 384
  v_lshl_add_u32 v55, v37, 2, s53
  v_and_b32 v58, 16, v37
  v_cmp_gt_u32 vcc, 96, v37
  v_mul_u32_u24 v58, 188, v58
  v_add_u32 v55, v55, v58
  v_cndmask_b32 v45, v57, v55, vcc
  s_lshl_b32 s51, s51, 7
  s_add_u32 s51, s51, 8192
  v_lshrrev_b32 v121, 7, v37
  v_min_u32 v121, 4, v121
  v_lshl_add_u32 v121, v121, 14, s51
  s_lshl2_add_u32 s73, s46, s72
  s_mul_i32 s75, s73, 90240
  s_lshl_b32 s3, s73, 10
  s_add_u32 s3, s3, 3145728
  v_and_b32 v39, 0x380, v37
  s_mov_b32 s50, 786432
  buffer_load_dword a255, v44, s[8:11], s50 offen
  s_mov_b32 s51, 0
  buffer_load_dword a255, v45, s[12:15], s51 offen
  global_load_dword a255, v121, s[48:49]
  s_load_dwordx2 s[16:17], s[0:1], 8
  s_load_dwordx2 s[20:21], s[0:1], 16
  s_load_dwordx2 s[24:25], s[0:1], 32
  s_load_dwordx2 s[28:29], s[0:1], 64
  s_load_dwordx2 s[36:37], s[0:1], 72
  s_mul_i32 s74, s72, 3072
  s_lshl_b32 s53, s72, 8
  s_add_u32 s53, s53, s47
  s_mul_i32 s53, s53, 384
  v_add_u32 v58, s53, v37
  s_and_b32 s53, s72, 2
  s_lshl_b32 s53, s53, 9
  s_add_u32 s53, s53, s47
  s_mul_i32 s53, s53, 96
  v_add_u32 v59, s53, v37
  s_movk_i32 s53, 0x60
  s_movk_i32 s54, 2976
  s_movk_i32 s55, 11904
  v_mul_u32_u24 v70, 683, v37
  v_lshrrev_b32 v71, 14, v70
  v_bitop3_b32 v22, v58, v71, s53 bitop3:0x78
  v_lshrrev_b32 v71, 18, v70
  v_mad_u32_u24 v22, v71, s55, v22
  v_lshrrev_b32 v71, 16, v70
  v_mad_u32_u24 v25, v71, s54, v59
  v_add_u32 v70, 699392, v70
  v_lshrrev_b32 v71, 14, v70
  v_bitop3_b32 v23, v58, v71, s53 bitop3:0x78
  v_lshrrev_b32 v71, 18, v70
  v_mad_u32_u24 v23, v71, s55, v23
  v_lshrrev_b32 v71, 16, v70
  v_mad_u32_u24 v26, v71, s54, v59
  v_add_u32 v70, 699392, v70
  v_lshrrev_b32 v71, 14, v70
  v_bitop3_b32 v24, v58, v71, s53 bitop3:0x78
  v_lshrrev_b32 v71, 18, v70
  v_mad_u32_u24 v24, v71, s55, v24
  v_lshrrev_b32 v71, 16, v70
  v_mad_u32_u24 v27, v71, s54, v59
  v_lshrrev_b32 v58, 6, v37
  v_mul_u32_u24 v58, 320, v58
  v_add_u32 v58, v58, v37
  v_lshrrev_b32 v59, 2, v37
  v_bitop3_b32 v1, v58, v59, s53 bitop3:0x78
  v_xor_b32 v2, 64, v1
  v_lshrrev_b32 v56, 3, v0
  v_lshl_add_u32 v134, v56, 7, v54
  v_mul_u32_u24 v57, 3072, v50
  v_add_u32 v134, v134, v57
  s_lshr_b32 s53, s2, 3
  s_mul_i32 s101, s53, 86144
  s_and_b32 s53, s2, 1
  s_mul_i32 s53, s53, -384
  s_lshl_b32 s100, s2, 7
  s_lshl2_add_u32 s53, s100, s53
  s_add_u32 s101, s101, s53
  v_lshlrev_b32 v53, 4, v50
  v_and_b32 v55, 24, v0
  v_lshl_add_u32 v53, v55, 6, v53
  v_and_b32 v55, 3, v0
  v_lshl_add_u32 v53, v55, 7, v53
  v_and_b32 v55, 4, v0
  v_lshl_add_u32 v53, v55, 1, v53
  s_movk_i32 s53, 0x70
  v_lshrrev_b32 v55, 4, v53
  v_bitop3_b32 v53, v53, v55, s53 bitop3:0x78
  v_bitop3_b32 v54, v54, v0, s53 bitop3:0x78
  v_lshrrev_b32 v56, 7, v0
  v_lshl_add_u32 v56, v56, 30, v134
  v_min_u32 v223, 1, v0
  v_lshlrev_b32 v223, 30, v223
  v_lshlrev_b32 v55, 12, v48
  v_sub_u32 v55, v134, v55
  v_and_b32 v140, 0xa0, v0
  v_lshl_add_u32 v140, v140, 23, v55
  v_min_u32 v0, 1, v37
  v_lshlrev_b32 v0, 30, v0
  s_add_u32 s84, s101, 81920
  s_add_u32 s82, s101, 16384
  s_add_u32 s83, s101, 49152
  s_and_b32 s53, s44, 6
  s_lshl_b32 s53, s53, 9
  v_add_u32 v42, s53, v37
  v_xor_b32 v43, 1024, v42
  v_xor_b32 v46, 2048, v42
  v_xor_b32 v47, 3072, v42
  v_mov_b32 v72, 0
  v_mov_b32 v74, 0
  v_add_u32 v53, 147456, v53
  v_add_u32 v54, 147456, v54
  v_lshrrev_b32 v38, 1, v37
  v_lshrrev_b32 v14, 6, v37
  v_lshl_add_u32 v13, v14, 6, v38
  v_add_u32 v14, 49152, v13
  v_add_u32 v15, 98304, v13
  v_add_u32 v5, 49152, v1
  v_add_u32 v6, 49152, v2
  v_add_u32 v9, 98304, v1
  v_add_u32 v10, 98304, v2
  s_mov_b32 s18, 25165824
  s_mov_b32 s19, 0x20000
  s_mov_b32 s22, 25165824
  s_mov_b32 s23, 0x20000
  s_mov_b32 s26, 7864320
  s_mov_b32 s27, 0x20000
  s_mov_b32 s30, 1966080
  s_mov_b32 s31, 0x20000
  s_mov_b32 s38, 2621440
  s_mov_b32 s39, 0x20000
  s_lshl_b32 s48, s44, 5
  s_add_u32 s48, s48, s73
  s_mul_i32 s85, s48, 106496
  s_add_u32 s85, s85, 33554432
  s_lshl_b32 s48, s48, 9
  s_add_u32 s78, s48, 3407872
  s_lshr_b32 s49, s2, 3
  s_lshl2_add_u32 s49, s49, s72
  s_mul_i32 s49, s49, 3072
  s_add_u32 s79, s49, 4194304
  s_mul_i32 s99, s44, 245760
  s_and_b32 s87, s72, 2
  s_mul_i32 s87, s87, 20480
  s_add_u32 s87, s99, s87
  s_mov_b32 s80, 0xc15db3d7
  s_mov_b32 s81, 0x3c319c33
  s_lshl_b32 s41, s45, 7
  s_add_u32 s41, s78, s41
  s_lshl_b32 s42, s44, 7
  s_add_u32 s42, s79, s42
  s_mul_i32 s88, s45, 26624
  s_add_u32 s88, s85, s88
  s_add_u32 s89, s45, 1
  s_and_b32 s89, s89, 3
  s_mul_i32 s89, s89, 26624
  s_add_u32 s89, s85, s89
  s_add_u32 s90, s45, 2
  s_and_b32 s90, s90, 3
  s_mul_i32 s90, s90, 26624
  s_add_u32 s90, s85, s90
  s_add_u32 s91, s45, 3
  s_and_b32 s91, s91, 3
  s_mul_i32 s91, s91, 26624
  s_add_u32 s91, s85, s91
  s_add_u32 s77, s88, 24576
  s_add_u32 s76, s88, 20480
  s_mul_i32 s92, s47, 245760
  s_mul_i32 s52, s44, 96
  s_add_u32 s52, s52, s72
  s_lshl_b32 s52, s52, 5
  s_add_u32 s52, s52, s45
  s_mul_i32 s52, s52, 320
  s_andn2_b32 s53, 1, s45
  s_lshl_b32 s53, s53, 6
  s_lshl2_add_u32 s95, s53, s52
  s_xor_b32 s53, s53, 64
  s_add_u32 s52, s52, s53
  s_lshl_b32 s53, s98, 7
  s_add_u32 s93, s52, s53
  s_xor_b32 s53, s53, 128
  s_add_u32 s94, s52, s53
  s_branch L_near
L_tagx0:
  s_mov_b32 s84, 0x40000
L_tgx0:
  s_add_u32 s100, s75, 81920
  buffer_load_dwordx3 v[224:226], v42, s[4:7], s100 offen offset:0 sc1
  buffer_load_dwordx3 v[228:230], v43, s[4:7], s100 offen offset:0 sc1
  buffer_load_dwordx3 v[232:234], v46, s[4:7], s100 offen offset:0 sc1
  buffer_load_dwordx3 v[236:238], v47, s[4:7], s100 offen offset:0 sc1
  s_add_u32 s100, s75, 0
  buffer_load_dwordx4 a[80:83], v42, s[4:7], s100 offen offset:0 sc1
  buffer_load_dwordx4 a[84:87], v43, s[4:7], s100 offen offset:0 sc1
  buffer_load_dwordx4 a[88:91], v46, s[4:7], s100 offen offset:0 sc1
  buffer_load_dwordx4 a[92:95], v47, s[4:7], s100 offen offset:0 sc1
  s_add_u32 s100, s75, 4096
  buffer_load_dwordx4 a[96:99], v42, s[4:7], s100 offen offset:0 sc1
  buffer_load_dwordx4 a[100:103], v43, s[4:7], s100 offen offset:0 sc1
  buffer_load_dwordx4 a[104:107], v46, s[4:7], s100 offen offset:0 sc1
  buffer_load_dwordx4 a[108:111], v47, s[4:7], s100 offen offset:0 sc1
  s_waitcnt vmcnt(0)
  v_accvgpr_read_b32 v227, a83
  v_accvgpr_write_b32 a83, v224
  v_accvgpr_read_b32 v231, a87
  v_accvgpr_write_b32 a87, v228
  v_add3_u32 v226, v226, v227, v231
  v_accvgpr_read_b32 v235, a91
  v_accvgpr_write_b32 a91, v232
  v_accvgpr_read_b32 v239, a95
  v_accvgpr_write_b32 a95, v236
  v_add3_u32 v234, v234, v235, v239
  v_add3_u32 v226, v226, v230, v238
  v_subrev_u32 v226, s43, v226
  v_accvgpr_read_b32 v227, a99
  v_accvgpr_write_b32 a99, v225
  v_accvgpr_read_b32 v231, a103
  v_accvgpr_write_b32 a103, v229
  v_add3_u32 v226, v226, v227, v231
  v_accvgpr_read_b32 v235, a107
  v_accvgpr_write_b32 a107, v233
  v_accvgpr_read_b32 v239, a111
  v_accvgpr_write_b32 a111, v237
  v_add3_u32 v234, v234, v235, v239
  v_add_u32 v226, v226, v234
  v_cmp_ne_u32 vcc, 0, v226
  s_nop 1
  s_cbranch_vccz L_tagxok0
  s_sub_u32 s84, s84, 1
  s_cmp_lg_u32 s84, 0
  s_cbranch_scc1 L_tgx0
  s_branch L_tagxok0
L_tagx1:
  s_mov_b32 s84, 0x40000
L_tgx1:
  s_add_u32 s100, s75, 86016
  buffer_load_dwordx3 v[224:226], v42, s[4:7], s100 offen offset:0 sc1
  buffer_load_dwordx3 v[228:230], v43, s[4:7], s100 offen offset:0 sc1
  buffer_load_dwordx3 v[232:234], v46, s[4:7], s100 offen offset:0 sc1
  buffer_load_dwordx3 v[236:238], v47, s[4:7], s100 offen offset:0 sc1
  s_add_u32 s100, s75, 8192
  buffer_load_dwordx4 a[112:115], v42, s[4:7], s100 offen offset:0 sc1
  buffer_load_dwordx4 a[116:119], v43, s[4:7], s100 offen offset:0 sc1
  buffer_load_dwordx4 a[120:123], v46, s[4:7], s100 offen offset:0 sc1
  buffer_load_dwordx4 a[124:127], v47, s[4:7], s100 offen offset:0 sc1
  s_add_u32 s100, s75, 12288
  buffer_load_dwordx4 a[128:131], v42, s[4:7], s100 offen offset:0 sc1
  buffer_load_dwordx4 a[132:135], v43, s[4:7], s100 offen offset:0 sc1
  buffer_load_dwordx4 a[136:139], v46, s[4:7], s100 offen offset:0 sc1
  buffer_load_dwordx4 a[140:143], v47, s[4:7], s100 offen offset:0 sc1
  s_waitcnt vmcnt(0)
  v_accvgpr_read_b32 v227, a115
  v_accvgpr_write_b32 a115, v224
  v_accvgpr_read_b32 v231, a119
  v_accvgpr_write_b32 a119, v228
  v_add3_u32 v226, v226, v227, v231
  v_accvgpr_read_b32 v235, a123
  v_accvgpr_write_b32 a123, v232
  v_accvgpr_read_b32 v239, a127
  v_accvgpr_write_b32 a127, v236
  v_add3_u32 v234, v234, v235, v239
  v_add3_u32 v226, v226, v230, v238
  v_subrev_u32 v226, s43, v226
  v_accvgpr_read_b32 v227, a131
  v_accvgpr_write_b32 a131, v225
  v_accvgpr_read_b32 v231, a135
  v_accvgpr_write_b32 a135, v229
  v_add3_u32 v226, v226, v227, v231
  v_accvgpr_read_b32 v235, a139
  v_accvgpr_write_b32 a139, v233
  v_accvgpr_read_b32 v239, a143
  v_accvgpr_write_b32 a143, v237
  v_add3_u32 v234, v234, v235, v239
  v_add_u32 v226, v226, v234
  v_cmp_ne_u32 vcc, 0, v226
  s_nop 1
  s_cbranch_vccz L_tagxok1
  s_sub_u32 s84, s84, 1
  s_cmp_lg_u32 s84, 0
  s_cbranch_scc1 L_tgx1
  s_branch L_tagxok1
L_near:
  s_mov_b32 s54, 0
  s_add_u32 m0, s74, 0
  s_nop 0
  buffer_load_dwordx4 v22, s[8:11], s54 offen offset:0  lds
  buffer_load_dwordx4 v23, s[8:11], s54 offen offset:1024  lds
  buffer_load_dwordx4 v24, s[8:11], s54 offen offset:2048  lds
  s_mov_b32 s55, 393216
  s_add_u32 m0, s74, 12288
  s_nop 0
  buffer_load_dwordx4 v22, s[8:11], s55 offen offset:0  lds
  buffer_load_dwordx4 v23, s[8:11], s55 offen offset:1024  lds
  buffer_load_dwordx4 v24, s[8:11], s55 offen offset:2048  lds
  s_mov_b32 s53, 0x3f803f80
  s_waitcnt vmcnt(13)
  v_dot2c_f32_bf16 v72, s53, v60
  v_dot2c_f32_bf16 v74, v60, v60
  v_dot2c_f32_bf16 v72, s53, v61
  v_dot2c_f32_bf16 v74, v61, v61
  s_waitcnt vmcnt(12)
  v_dot2c_f32_bf16 v72, s53, v62
  v_dot2c_f32_bf16 v74, v62, v62
  v_dot2c_f32_bf16 v72, s53, v63
  v_dot2c_f32_bf16 v74, v63, v63
  s_waitcnt vmcnt(11)
  v_dot2c_f32_bf16 v72, s53, v64
  v_dot2c_f32_bf16 v74, v64, v64
  v_dot2c_f32_bf16 v72, s53, v65
  v_dot2c_f32_bf16 v74, v65, v65
  s_waitcnt vmcnt(10)
  v_dot2c_f32_bf16 v72, s53, v66
  v_dot2c_f32_bf16 v74, v66, v66
  v_dot2c_f32_bf16 v72, s53, v67
  v_dot2c_f32_bf16 v74, v67, v67
  s_waitcnt vmcnt(9)
  v_dot2c_f32_bf16 v72, s53, v68
  v_dot2c_f32_bf16 v74, v68, v68
  v_dot2c_f32_bf16 v72, s53, v69
  v_dot2c_f32_bf16 v74, v69, v69
  v_lshlrev_b32 v80, 16, v60
  v_and_b32 v81, 0xffff0000, v60
  v_add_f32_dpp v72, v72, v72 quad_perm:[1,0,3,2] row_mask:0xf bank_mask:0xf
  v_add_f32_dpp v74, v74, v74 quad_perm:[1,0,3,2] row_mask:0xf bank_mask:0xf
  v_lshlrev_b32 v82, 16, v61
  v_add_f32_dpp v72, v72, v72 quad_perm:[2,3,0,1] row_mask:0xf bank_mask:0xf
  v_add_f32_dpp v74, v74, v74 quad_perm:[2,3,0,1] row_mask:0xf bank_mask:0xf
  v_and_b32 v83, 0xffff0000, v61
  v_add_f32_dpp v72, v72, v72 row_half_mirror row_mask:0xf bank_mask:0xf
  v_add_f32_dpp v74, v74, v74 row_half_mirror row_mask:0xf bank_mask:0xf
  v_lshlrev_b32 v84, 16, v62
  v_add_f32_dpp v72, v72, v72 row_mirror row_mask:0xf bank_mask:0xf
  v_add_f32_dpp v74, v74, v74 row_mirror row_mask:0xf bank_mask:0xf
  v_and_b32 v85, 0xffff0000, v62
  v_mov_b32 v78, v72
  v_mov_b32 v79, v74
  v_lshlrev_b32 v86, 16, v63
  v_permlane16_swap_b32 v78, v72
  v_permlane16_swap_b32 v79, v74
  v_add_f32 v72, v78, v72
  v_add_f32 v74, v79, v74
  v_mul_f32 v72, 0xbacccccd, v72
  v_mul_f32 v74, 0x3acccccd, v74
  v_and_b32 v87, 0xffff0000, v63
  v_fma_f32 v74, -v72, v72, v74
  v_lshlrev_b32 v88, 16, v64
  v_max_f32 v74, 0, v74
  v_and_b32 v89, 0xffff0000, v64
  v_cvt_pk_bf16_f32 v74, v74, v74
  v_lshlrev_b32 v90, 16, v65
  v_and_b32 v74, 0xffff0000, v74
  v_and_b32 v91, 0xffff0000, v65
  v_add_f32 v74, 0x3727c5ac, v74
  v_lshlrev_b32 v92, 16, v66
  v_cvt_pk_bf16_f32 v74, v74, v74
  v_and_b32 v93, 0xffff0000, v66
  v_and_b32 v74, 0xffff0000, v74
  v_lshlrev_b32 v94, 16, v67
  v_sqrt_f32 v74, v74
  v_and_b32 v95, 0xffff0000, v67
  v_cvt_pk_bf16_f32 v74, v74, v74
  v_lshlrev_b32 v96, 16, v68
  v_and_b32 v74, 0xffff0000, v74
  v_and_b32 v97, 0xffff0000, v68
  v_rcp_f32 v74, v74
  v_cvt_pk_bf16_f32 v72, v72, v72
  v_and_b32 v72, 0xffff0000, v72
  v_mul_f32 v74, 0x3dd53b95, v74
  v_lshlrev_b32 v98, 16, v69
  v_mul_f32 v72, v72, v74
  v_and_b32 v99, 0xffff0000, v69
  s_waitcnt lgkmcnt(0)
  s_add_u32 s40, s40, 0x9e3779b1
  v_mov_b32 v138, s40
  v_mov_b32 v139, s40
  v_pk_fma_f32 v[80:81], v[80:81], v[74:75], v[72:73] op_sel_hi:[1,0,0]
  v_pk_fma_f32 v[82:83], v[82:83], v[74:75], v[72:73] op_sel_hi:[1,0,0]
  v_cvt_pk_bf16_f32 v60, v80, v81
  v_cvt_pk_bf16_f32 v61, v82, v83
  ds_write_b64 v53, v[60:61] offset:0
  v_pk_fma_f32 v[84:85], v[84:85], v[74:75], v[72:73] op_sel_hi:[1,0,0]
  v_pk_fma_f32 v[86:87], v[86:87], v[74:75], v[72:73] op_sel_hi:[1,0,0]
  v_cvt_pk_bf16_f32 v62, v84, v85
  v_cvt_pk_bf16_f32 v63, v86, v87
  ds_write_b64 v53, v[62:63] offset:2048
  v_pk_fma_f32 v[88:89], v[88:89], v[74:75], v[72:73] op_sel_hi:[1,0,0]
  v_pk_fma_f32 v[90:91], v[90:91], v[74:75], v[72:73] op_sel_hi:[1,0,0]
  v_cvt_pk_bf16_f32 v64, v88, v89
  v_cvt_pk_bf16_f32 v65, v90, v91
  ds_write_b64 v53, v[64:65] offset:4096
  v_pk_fma_f32 v[92:93], v[92:93], v[74:75], v[72:73] op_sel_hi:[1,0,0]
  v_pk_fma_f32 v[94:95], v[94:95], v[74:75], v[72:73] op_sel_hi:[1,0,0]
  v_cvt_pk_bf16_f32 v66, v92, v93
  v_cvt_pk_bf16_f32 v67, v94, v95
  ds_write_b64 v53, v[66:67] offset:6144
  v_pk_fma_f32 v[96:97], v[96:97], v[74:75], v[72:73] op_sel_hi:[1,0,0]
  v_pk_fma_f32 v[98:99], v[98:99], v[74:75], v[72:73] op_sel_hi:[1,0,0]
  v_cvt_pk_bf16_f32 v68, v96, v97
  v_cvt_pk_bf16_f32 v69, v98, v99
  ds_write_b64 v53, v[68:69] offset:8192
  s_waitcnt lgkmcnt(0)
  s_barrier
  ds_read_b128 v[60:63], v54 offset:0
  ds_read_b128 v[64:67], v54 offset:2048
  ds_read_b128 v[68:71], v54 offset:6144
  s_waitcnt lgkmcnt(2)
  v_mov_b32 v136, v63
  v_mov_b32 v137, v63
  v_mov_b32 v63, v138
  buffer_store_dwordx4 v[60:63], v56, s[4:7], s101 offen sc1
  v_permlane32_swap_b32 v136, v137
  buffer_store_dwordx4 v[136:139], v140, s[4:7], s84 offen sc1
  s_waitcnt lgkmcnt(1)
  buffer_store_dwordx4 v[64:67], v134, s[4:7], s82 offen sc1
  s_waitcnt lgkmcnt(0)
  buffer_store_dwordx4 v[68:71], v134, s[4:7], s83 offen sc1
  s_mov_b32 s56, 0
  s_add_u32 m0, s74, 24576
  s_nop 0
  buffer_load_dwordx4 v25, s[12:15], s56 offen offset:0  lds
  buffer_load_dwordx4 v26, s[12:15], s56 offen offset:1024  lds
  buffer_load_dwordx4 v27, s[12:15], s56 offen offset:2048  lds
  s_mov_b32 s57, 786432
  s_add_u32 m0, s74, 36864
  s_nop 0
  buffer_load_dwordx4 v22, s[8:11], s57 offen offset:0  lds
  buffer_load_dwordx4 v23, s[8:11], s57 offen offset:1024  lds
  buffer_load_dwordx4 v24, s[8:11], s57 offen offset:2048  lds
  s_mov_b32 s58, 1179648
  s_add_u32 m0, s74, 49152
  s_nop 0
  buffer_load_dwordx4 v22, s[8:11], s58 offen offset:0  lds
  buffer_load_dwordx4 v23, s[8:11], s58 offen offset:1024  lds
  buffer_load_dwordx4 v24, s[8:11], s58 offen offset:2048  lds
  s_mul_i32 s59, s47, 786432
  s_add_u32 s59, s59, s74
  s_add_u32 s59, s59, 589824
  s_movk_i32 s60, 0x60
  v_add_u32 v20, s59, v37
  v_mul_u32_u24 v19, 683, v37
  v_lshrrev_b32 v16, 18, v19
  v_lshrrev_b32 v21, 14, v19
  v_bitop3_b32 v31, v20, v21, s60 bitop3:0x78
  v_add_u32 v19, 699392, v19
  v_lshrrev_b32 v17, 18, v19
  v_lshrrev_b32 v21, 14, v19
  v_bitop3_b32 v32, v20, v21, s60 bitop3:0x78
  v_add_u32 v19, 699392, v19
  v_lshrrev_b32 v18, 18, v19
  v_lshrrev_b32 v21, 14, v19
  v_bitop3_b32 v33, v20, v21, s60 bitop3:0x78
  s_and_b32 s61, s45, 1
  s_mul_i32 s62, s61, -46976
  s_mul_i32 s63, s98, -1920
  s_add_u32 s62, s62, s63
  s_add_u32 s62, s62, 67584
  s_lshl_b32 s63, s72, 5
  s_add_u32 s63, s63, s45
  s_mul_i32 s63, s63, 5
  s_sub_u32 s63, s63, s61
  s_lshl_b32 s63, s63, 6
  s_add_u32 s61, s45, 1
  s_mov_b32 s64, 245760
  s_movk_i32 s65, 639
  s_movk_i32 s66, 0x1c0
  v_lshrrev_b32 v3, 7, v37
  v_add_u32 v12, 159744, v37
  v_mad_i32_i24 v19, v16, -3, v3
  v_mul_u32_u24 v4, 1280, v16
  v_and_b32 v21, 0x70, v31
  v_add_u32 v20, s61, v19
  v_and_b32 v20, 3, v20
  v_add_u32 v7, v4, v21
  v_mad_u32_u24 v28, v20, s64, v7
  v_and_b32 v7, 64, v21
  v_mad_u32_u24 v8, v7, s65, v28
  ds_write_b32 v12, v8 offset:1024
  v_lshlrev_b32 v19, 2, v19
  v_lshrrev_b32 v19, v19, s62
  v_bitop3_b32 v19, v21, v19, s66 bitop3:0x78
  v_add3_u32 v34, v19, v4, s63
  v_mad_i32_i24 v19, v17, -3, v3
  v_mul_u32_u24 v4, 1280, v17
  v_and_b32 v21, 0x70, v32
  v_subrev_u32 v4, 1024, v4
  v_add_u32 v20, s61, v19
  v_and_b32 v20, 3, v20
  v_add_u32 v7, v4, v21
  v_mad_u32_u24 v29, v20, s64, v7
  v_and_b32 v7, 64, v21
  v_mad_u32_u24 v8, v7, s65, v29
  ds_write_b32 v12, v8 offset:1028
  v_lshlrev_b32 v19, 2, v19
  v_lshrrev_b32 v19, v19, s62
  v_bitop3_b32 v19, v21, v19, s66 bitop3:0x78
  v_add3_u32 v35, v19, v4, s63
  v_mad_i32_i24 v19, v18, -3, v3
  v_mul_u32_u24 v4, 1280, v18
  v_and_b32 v21, 0x70, v33
  v_subrev_u32 v4, 2048, v4
  v_add_u32 v20, s61, v19
  v_and_b32 v20, 3, v20
  v_add_u32 v7, v4, v21
  v_mad_u32_u24 v30, v20, s64, v7
  v_and_b32 v7, 64, v21
  v_mad_u32_u24 v8, v7, s65, v30
  ds_write_b32 v12, v8 offset:1032
  v_lshlrev_b32 v19, 2, v19
  v_lshrrev_b32 v19, v19, s62
  v_bitop3_b32 v19, v21, v19, s66 bitop3:0x78
  v_add3_u32 v36, v19, v4, s63
  ds_write_b96 v12, v[28:30] offset:2048
  v_and_b32 v20, 0xf0, v37
  v_mul_u32_u24 v20, 80, v20
  v_lshrrev_b32 v19, 8, v37
  v_lshl_add_u32 v21, v19, 3, v20
  v_and_b32 v3, 1, v19
  v_lshl_add_u32 v20, v3, 5, v20
  v_lshrrev_b32 v19, 1, v19
  v_lshl_add_u32 v20, v19, 4, v20
  ds_write_b64 v12, v[20:21] offset:3072
  s_and_b32 s67, s72, 1
  s_mul_i32 s67, s67, 0x60
  v_bfe_i32 v19, v16, 1, 1
  v_bitop3_b32 v28, v31, v19, 48 bitop3:0x78
  v_xor_b32 v28, s67, v28
  v_bfe_i32 v19, v17, 1, 1
  v_bitop3_b32 v29, v32, v19, 48 bitop3:0x78
  v_xor_b32 v29, s67, v29
  v_bfe_i32 v19, v18, 1, 1
  v_bitop3_b32 v30, v33, v19, 48 bitop3:0x78
  v_xor_b32 v30, s67, v30
  s_movk_i32 s50, 0x60
  v_and_b32 v16, 0xf0, v37
  v_mul_u32_u24 v16, 24, v16
  v_bitop3_b32 v16, v16, v38, 16 bitop3:0x78
  v_bitop3_b32 v16, v16, v37, 64 bitop3:0x78
  v_bfe_i32 v17, v37, 7, 1
  v_bitop3_b32 v16, v16, v17, s50 bitop3:0x78
  v_lshrrev_b32 v17, 4, v37
  v_bitop3_b32 v16, v16, v17, 48 bitop3:0x78
  v_xor_b32 v17, 64, v16
  v_lshrrev_b32 v3, 6, v37
  v_mul_u32_u24 v3, 352, v3
  v_add_u32 v3, v3, v38
  v_lshrrev_b32 v4, 2, v37
  v_bitop3_b32 v3, v3, v4, s50 bitop3:0x78
  v_xor_b32 v4, s50, v3
  v_xor_b32 v3, 64, v3
  v_add_u32 v18, 49152, v16
  v_add_u32 v19, 49152, v17
  v_add_u32 v7, 49152, v3
  v_add_u32 v8, 49152, v4
  v_add_u32 v20, 98304, v16
  v_add_u32 v21, 98304, v17
  v_add_u32 v11, 98304, v3
  v_add_u32 v12, 98304, v4
  s_add_u32 s51, s75, 81920
  buffer_load_dwordx3 v[224:226], v42, s[4:7], s51 offen offset:0 sc1
  buffer_load_dwordx3 v[228:230], v43, s[4:7], s51 offen offset:0 sc1
  buffer_load_dwordx3 v[232:234], v46, s[4:7], s51 offen offset:0 sc1
  buffer_load_dwordx3 v[236:238], v47, s[4:7], s51 offen offset:0 sc1
  s_add_u32 s48, s75, 0
  buffer_load_dwordx4 a[80:83], v42, s[4:7], s48 offen offset:0 sc1
  buffer_load_dwordx4 a[84:87], v43, s[4:7], s48 offen offset:0 sc1
  buffer_load_dwordx4 a[88:91], v46, s[4:7], s48 offen offset:0 sc1
  buffer_load_dwordx4 a[92:95], v47, s[4:7], s48 offen offset:0 sc1
  s_add_u32 s49, s75, 4096
  buffer_load_dwordx4 a[96:99], v42, s[4:7], s49 offen offset:0 sc1
  buffer_load_dwordx4 a[100:103], v43, s[4:7], s49 offen offset:0 sc1
  buffer_load_dwordx4 a[104:107], v46, s[4:7], s49 offen offset:0 sc1
  buffer_load_dwordx4 a[108:111], v47, s[4:7], s49 offen offset:0 sc1
  s_mov_b64 exec, 0
  s_cmp_eq_u32 s72, 0
  s_cbranch_scc1 L_pg1
  s_cmp_eq_u32 s72, 1
  s_cbranch_scc1 L_pg2
  s_cmp_eq_u32 s72, 2
  s_cbranch_scc1 L_pg3
  s_branch L_pg4
L_hop0:
  s_mov_b64 exec, -1
  s_getreg_b32 s53, hwreg(HW_REG_XCC_ID, 0, 3)
  s_add_u32 s53, s53, s40
  v_mov_b32 v41, s53
  s_mul_i32 s43, s40, 12
  s_waitcnt vmcnt(18)
  s_barrier
  s_add_u32 s101, s100, 3145728
  buffer_store_dword v41, v223, s[4:7], s101 offen sc1
  ds_read_b64_tr_b16 a[208:209], v1 offset:0
  ds_read_b64_tr_b16 a[210:211], v1 offset:6144
  ds_read_b64_tr_b16 a[212:213], v1 offset:12288
  ds_read_b64_tr_b16 a[214:215], v1 offset:18432
  s_waitcnt vmcnt(8)
  v_accvgpr_read_b32 v227, a83
  v_accvgpr_write_b32 a83, v224
  s_waitcnt vmcnt(7)
  v_accvgpr_read_b32 v231, a87
  v_accvgpr_write_b32 a87, v228
  v_add3_u32 v226, v226, v227, v231
  s_waitcnt vmcnt(6)
  v_accvgpr_read_b32 v235, a91
L_pg1:
  s_cbranch_execz L_hop0
  v_accvgpr_write_b32 a91, v232
  s_waitcnt vmcnt(5)
  v_accvgpr_read_b32 v239, a95
  v_accvgpr_write_b32 a95, v236
  v_add3_u32 v234, v234, v235, v239
  v_add3_u32 v226, v226, v230, v238
  v_subrev_u32 v226, s43, v226
  s_waitcnt vmcnt(4)
  v_accvgpr_read_b32 v227, a99
  v_accvgpr_write_b32 a99, v225
  s_waitcnt vmcnt(3)
  v_accvgpr_read_b32 v231, a103
  v_accvgpr_write_b32 a103, v229
  v_add3_u32 v226, v226, v227, v231
  s_waitcnt vmcnt(2)
  v_accvgpr_read_b32 v235, a107
  v_accvgpr_write_b32 a107, v233
  s_waitcnt vmcnt(1)
  v_accvgpr_read_b32 v239, a111
  v_accvgpr_write_b32 a111, v237
  v_add3_u32 v234, v234, v235, v239
  v_add_u32 v226, v226, v234
  v_cmp_ne_u32 vcc, 0, v226
  s_nop 0
  s_cbranch_vccnz L_tagx0
L_tagxok0:
  ds_read_b64_tr_b16 a[216:217], v1 offset:8
  ds_read_b64_tr_b16 a[218:219], v1 offset:6152
  ds_read_b64_tr_b16 a[220:221], v1 offset:12296
  ds_read_b64_tr_b16 a[222:223], v1 offset:18440
  s_waitcnt lgkmcnt(6)
  v_mfma_f32_16x16x32_bf16 v[48:51], a[208:211], a[80:83], 0
  s_waitcnt lgkmcnt(4)
  ds_read_b64_tr_b16 a[224:225], v2 offset:0
  v_mfma_f32_16x16x32_bf16 v[48:51], a[212:215], a[96:99], v[48:51]
  s_add_u32 s52, s75, 86016
  ds_read_b64_tr_b16 a[226:227], v2 offset:6144
  v_mfma_f32_16x16x32_bf16 v[52:55], a[212:215], a[100:103], 0
  ds_read_b64_tr_b16 a[228:229], v2 offset:12288
  v_mfma_f32_16x16x32_bf16 v[52:55], a[208:211], a[84:87], v[52:55]
  ds_read_b64_tr_b16 a[230:231], v2 offset:18432
  v_mfma_f32_16x16x32_bf16 v[56:59], a[208:211], a[88:91], 0
  buffer_load_dwordx3 v[224:226], v42, s[4:7], s52 offen offset:0 sc1
  v_mfma_f32_16x16x32_bf16 v[56:59], a[212:215], a[104:107], v[56:59]
  v_mfma_f32_16x16x32_bf16 v[60:63], a[212:215], a[108:111], 0
  buffer_load_dwordx3 v[228:230], v43, s[4:7], s52 offen offset:0 sc1
  v_mfma_f32_16x16x32_bf16 v[60:63], a[208:211], a[92:95], v[60:63]
  s_waitcnt lgkmcnt(6)
  v_mfma_f32_16x16x32_bf16 a[12:15], a[216:219], a[92:95], 0
  s_waitcnt lgkmcnt(4)
  ds_read_b64_tr_b16 a[208:209], v2 offset:8
  v_mfma_f32_16x16x32_bf16 a[12:15], a[220:223], a[108:111], a[12:15]
  ds_read_b64_tr_b16 a[210:211], v2 offset:6152
  v_mfma_f32_16x16x32_bf16 a[8:11], a[220:223], a[104:107], 0
  ds_read_b64_tr_b16 a[212:213], v2 offset:12296
  v_mfma_f32_16x16x32_bf16 a[8:11], a[216:219], a[88:91], a[8:11]
  ds_read_b64_tr_b16 a[214:215], v2 offset:18440
  v_mfma_f32_16x16x32_bf16 a[4:7], a[216:219], a[84:87], 0
  buffer_load_dwordx3 v[232:234], v46, s[4:7], s52 offen offset:0 sc1
  v_mfma_f32_16x16x32_bf16 a[4:7], a[220:223], a[100:103], a[4:7]
  v_mfma_f32_16x16x32_bf16 a[0:3], a[220:223], a[96:99], 0
  v_mfma_f32_16x16x32_bf16 a[0:3], a[216:219], a[80:83], a[0:3]
  s_waitcnt lgkmcnt(6)
  v_mfma_f32_16x16x32_bf16 v[64:67], a[224:227], a[80:83], 0
  s_waitcnt lgkmcnt(4)
  ds_read_b64_tr_b16 a[216:217], v1 offset:128
  v_mfma_f32_16x16x32_bf16 v[64:67], a[228:231], a[96:99], v[64:67]
  ds_read_b64_tr_b16 a[218:219], v1 offset:6272
  v_mfma_f32_16x16x32_bf16 v[68:71], a[228:231], a[100:103], 0
  ds_read_b64_tr_b16 a[220:221], v1 offset:12416
  v_mfma_f32_16x16x32_bf16 v[68:71], a[224:227], a[84:87], v[68:71]
  ds_read_b64_tr_b16 a[222:223], v1 offset:18560
  v_mfma_f32_16x16x32_bf16 v[72:75], a[224:227], a[88:91], 0
  buffer_load_dwordx3 v[236:238], v47, s[4:7], s52 offen offset:0 sc1
  v_mfma_f32_16x16x32_bf16 v[72:75], a[228:231], a[104:107], v[72:75]
  s_add_u32 s53, s75, 8192
  v_mfma_f32_16x16x32_bf16 v[76:79], a[228:231], a[108:111], 0
  buffer_load_dwordx4 a[112:115], v42, s[4:7], s53 offen offset:0 sc1
  v_mfma_f32_16x16x32_bf16 v[76:79], a[224:227], a[92:95], v[76:79]
  s_waitcnt lgkmcnt(6)
  v_mfma_f32_16x16x32_bf16 a[28:31], a[208:211], a[92:95], 0
  s_waitcnt lgkmcnt(4)
  ds_read_b64_tr_b16 a[224:225], v1 offset:136
  v_mfma_f32_16x16x32_bf16 a[28:31], a[212:215], a[108:111], a[28:31]
  ds_read_b64_tr_b16 a[226:227], v1 offset:6280
  v_mfma_f32_16x16x32_bf16 a[24:27], a[212:215], a[104:107], 0
  ds_read_b64_tr_b16 a[228:229], v1 offset:12424
  v_mfma_f32_16x16x32_bf16 a[24:27], a[208:211], a[88:91], a[24:27]
  ds_read_b64_tr_b16 a[230:231], v1 offset:18568
  v_mfma_f32_16x16x32_bf16 a[20:23], a[208:211], a[84:87], 0
  buffer_load_dwordx4 a[116:119], v43, s[4:7], s53 offen offset:0 sc1
  v_mfma_f32_16x16x32_bf16 a[20:23], a[212:215], a[100:103], a[20:23]
  v_mfma_f32_16x16x32_bf16 a[16:19], a[212:215], a[96:99], 0
  buffer_load_dwordx4 a[120:123], v46, s[4:7], s53 offen offset:0 sc1
  v_mfma_f32_16x16x32_bf16 a[16:19], a[208:211], a[80:83], a[16:19]
  s_waitcnt lgkmcnt(6)
  v_mfma_f32_16x16x32_bf16 v[80:83], a[216:219], a[80:83], 0
  s_waitcnt lgkmcnt(4)
  ds_read_b64_tr_b16 a[208:209], v2 offset:128
  v_mfma_f32_16x16x32_bf16 v[80:83], a[220:223], a[96:99], v[80:83]
  ds_read_b64_tr_b16 a[210:211], v2 offset:6272
  v_mfma_f32_16x16x32_bf16 v[84:87], a[220:223], a[100:103], 0
  ds_read_b64_tr_b16 a[212:213], v2 offset:12416
  v_mfma_f32_16x16x32_bf16 v[84:87], a[216:219], a[84:87], v[84:87]
  ds_read_b64_tr_b16 a[214:215], v2 offset:18560
  v_mfma_f32_16x16x32_bf16 v[88:91], a[216:219], a[88:91], 0
  buffer_load_dwordx4 a[124:127], v47, s[4:7], s53 offen offset:0 sc1
  v_mfma_f32_16x16x32_bf16 v[88:91], a[220:223], a[104:107], v[88:91]
  v_mfma_f32_16x16x32_bf16 v[92:95], a[220:223], a[108:111], 0
  s_waitcnt lgkmcnt(6)
  v_mfma_f32_16x16x32_bf16 v[92:95], a[216:219], a[92:95], v[92:95]
  s_add_u32 s54, s75, 12288
  v_mfma_f32_16x16x32_bf16 a[44:47], a[224:227], a[92:95], 0
  s_mov_b64 exec, 0
  s_cmp_eq_u32 s72, 0
  s_cbranch_scc1 L_pg5
  s_cmp_eq_u32 s72, 1
  s_cbranch_scc1 L_pg6
  s_cmp_eq_u32 s72, 2
  s_cbranch_scc1 L_pg7
  s_branch L_pg8
L_hop1:
  s_mov_b64 exec, -1
  ds_read_b64_tr_b16 a[216:217], v2 offset:136
  s_waitcnt lgkmcnt(5)
  v_mfma_f32_16x16x32_bf16 a[44:47], a[228:231], a[108:111], a[44:47]
  ds_read_b64_tr_b16 a[218:219], v2 offset:6280
  v_mfma_f32_16x16x32_bf16 a[40:43], a[228:231], a[104:107], 0
  ds_read_b64_tr_b16 a[220:221], v2 offset:12424
  v_mfma_f32_16x16x32_bf16 a[40:43], a[224:227], a[88:91], a[40:43]
  ds_read_b64_tr_b16 a[222:223], v2 offset:18568
  v_mfma_f32_16x16x32_bf16 a[36:39], a[224:227], a[84:87], 0
  buffer_load_dwordx4 a[128:131], v42, s[4:7], s54 offen offset:0 sc1
  v_mfma_f32_16x16x32_bf16 a[36:39], a[228:231], a[100:103], a[36:39]
  buffer_load_dwordx4 a[132:135], v43, s[4:7], s54 offen offset:0 sc1
  v_mfma_f32_16x16x32_bf16 a[32:35], a[228:231], a[96:99], 0
  v_mfma_f32_16x16x32_bf16 a[32:35], a[224:227], a[80:83], a[32:35]
  s_waitcnt lgkmcnt(6)
  v_mfma_f32_16x16x32_bf16 v[96:99], a[208:211], a[80:83], 0
  s_waitcnt lgkmcnt(4)
  ds_read_b64_tr_b16 a[224:225], v1 offset:256
  v_mfma_f32_16x16x32_bf16 v[96:99], a[212:215], a[96:99], v[96:99]
  ds_read_b64_tr_b16 a[226:227], v1 offset:6400
  v_mfma_f32_16x16x32_bf16 v[100:103], a[212:215], a[100:103], 0
  ds_read_b64_tr_b16 a[228:229], v1 offset:12544
  v_mfma_f32_16x16x32_bf16 v[100:103], a[208:211], a[84:87], v[100:103]
  ds_read_b64_tr_b16 a[230:231], v1 offset:18688
  v_mfma_f32_16x16x32_bf16 v[104:107], a[208:211], a[88:91], 0
  buffer_load_dwordx4 a[136:139], v46, s[4:7], s54 offen offset:0 sc1
  v_mfma_f32_16x16x32_bf16 v[104:107], a[212:215], a[104:107], v[104:107]
  v_mfma_f32_16x16x32_bf16 v[108:111], a[212:215], a[108:111], 0
  buffer_load_dwordx4 a[140:143], v47, s[4:7], s54 offen offset:0 sc1
  v_mfma_f32_16x16x32_bf16 v[108:111], a[208:211], a[92:95], v[108:111]
  s_waitcnt lgkmcnt(6)
  v_mfma_f32_16x16x32_bf16 a[60:63], a[216:219], a[92:95], 0
  s_waitcnt lgkmcnt(4)
  ds_read_b64_tr_b16 a[208:209], v1 offset:264
  v_mfma_f32_16x16x32_bf16 a[60:63], a[220:223], a[108:111], a[60:63]
  ds_read_b64_tr_b16 a[210:211], v1 offset:6408
  v_mfma_f32_16x16x32_bf16 a[56:59], a[220:223], a[104:107], 0
  s_add_u32 m0, s74, 61440
  ds_read_b64_tr_b16 a[212:213], v1 offset:12552
  v_mfma_f32_16x16x32_bf16 a[56:59], a[216:219], a[88:91], a[56:59]
  s_mov_b32 s55, 196608
  ds_read_b64_tr_b16 a[214:215], v1 offset:18696
  v_mfma_f32_16x16x32_bf16 a[52:55], a[216:219], a[84:87], 0
  buffer_load_dwordx4 v25, s[12:15], s55 offen offset:0  lds
  v_mfma_f32_16x16x32_bf16 a[52:55], a[220:223], a[100:103], a[52:55]
  v_mfma_f32_16x16x32_bf16 a[48:51], a[220:223], a[96:99], 0
  v_mfma_f32_16x16x32_bf16 a[48:51], a[216:219], a[80:83], a[48:51]
  s_waitcnt lgkmcnt(6)
  v_mfma_f32_16x16x32_bf16 v[112:115], a[224:227], a[80:83], 0
  s_waitcnt lgkmcnt(4)
  ds_read_b64_tr_b16 a[216:217], v2 offset:256
  v_mfma_f32_16x16x32_bf16 v[112:115], a[228:231], a[96:99], v[112:115]
  ds_read_b64_tr_b16 a[218:219], v2 offset:6400
  v_mfma_f32_16x16x32_bf16 v[116:119], a[228:231], a[100:103], 0
  ds_read_b64_tr_b16 a[220:221], v2 offset:12544
  v_mfma_f32_16x16x32_bf16 v[116:119], a[224:227], a[84:87], v[116:119]
  ds_read_b64_tr_b16 a[222:223], v2 offset:18688
  v_mfma_f32_16x16x32_bf16 v[120:123], a[224:227], a[88:91], 0
  v_mfma_f32_16x16x32_bf16 v[120:123], a[228:231], a[104:107], v[120:123]
  v_mfma_f32_16x16x32_bf16 v[124:127], a[228:231], a[108:111], 0
  v_mfma_f32_16x16x32_bf16 v[124:127], a[224:227], a[92:95], v[124:127]
  s_waitcnt lgkmcnt(6)
  v_mfma_f32_16x16x32_bf16 a[76:79], a[208:211], a[92:95], 0
  s_waitcnt lgkmcnt(4)
  ds_read_b64_tr_b16 a[224:225], v2 offset:264
  v_mfma_f32_16x16x32_bf16 a[76:79], a[212:215], a[108:111], a[76:79]
  ds_read_b64_tr_b16 a[226:227], v2 offset:6408
  v_mfma_f32_16x16x32_bf16 a[72:75], a[212:215], a[104:107], 0
  ds_read_b64_tr_b16 a[228:229], v2 offset:12552
  v_mfma_f32_16x16x32_bf16 a[72:75], a[208:211], a[88:91], a[72:75]
  ds_read_b64_tr_b16 a[230:231], v2 offset:18696
  v_mfma_f32_16x16x32_bf16 a[68:71], a[208:211], a[84:87], 0
  buffer_load_dwordx4 v26, s[12:15], s55 offen offset:1024  lds
  v_mfma_f32_16x16x32_bf16 a[68:71], a[212:215], a[100:103], a[68:71]
  buffer_load_dword v40, v39, s[4:7], s3 offen offset:0 sc1
  v_mfma_f32_16x16x32_bf16 a[64:67], a[212:215], a[96:99], 0
  v_mfma_f32_16x16x32_bf16 a[64:67], a[208:211], a[80:83], a[64:67]
  s_waitcnt lgkmcnt(6)
  v_mfma_f32_16x16x32_bf16 v[128:131], a[216:219], a[80:83], 0
  s_waitcnt lgkmcnt(4)
  ds_read_b64_tr_b16 a[208:209], v13 offset:24576
  v_mfma_f32_16x16x32_bf16 v[128:131], a[220:223], a[96:99], v[128:131]
  ds_read_b64_tr_b16 a[210:211], v13 offset:26112
  v_mfma_f32_16x16x32_bf16 v[132:135], a[220:223], a[100:103], 0
  ds_read_b64_tr_b16 a[212:213], v13 offset:30720
  v_mfma_f32_16x16x32_bf16 v[132:135], a[216:219], a[84:87], v[132:135]
  ds_read_b64_tr_b16 a[214:215], v13 offset:32256
  v_mfma_f32_16x16x32_bf16 v[136:139], a[216:219], a[88:91], 0
  v_mfma_f32_16x16x32_bf16 v[136:139], a[220:223], a[104:107], v[136:139]
  buffer_load_dwordx4 v27, s[12:15], s55 offen offset:2048  lds
  v_mfma_f32_16x16x32_bf16 v[140:143], a[220:223], a[108:111], 0
  v_mfma_f32_16x16x32_bf16 v[140:143], a[216:219], a[92:95], v[140:143]
  s_waitcnt lgkmcnt(6)
  v_mfma_f32_16x16x32_bf16 v[252:255], a[224:227], a[92:95], 0
  s_waitcnt lgkmcnt(4)
  ds_read_b64_tr_b16 a[216:217], v13 offset:27648
  v_mfma_f32_16x16x32_bf16 v[252:255], a[228:231], a[108:111], v[252:255]
  ds_read_b64_tr_b16 a[218:219], v13 offset:29184
  v_mfma_f32_16x16x32_bf16 v[248:251], a[228:231], a[104:107], 0
  ds_read_b64_tr_b16 a[220:221], v13 offset:33792
  v_mfma_f32_16x16x32_bf16 v[248:251], a[224:227], a[88:91], v[248:251]
  ds_read_b64_tr_b16 a[222:223], v13 offset:35328
  v_mfma_f32_16x16x32_bf16 v[244:247], a[224:227], a[84:87], 0
  v_mfma_f32_16x16x32_bf16 v[244:247], a[228:231], a[100:103], v[244:247]
  v_mfma_f32_16x16x32_bf16 v[240:243], a[228:231], a[96:99], 0
  v_mfma_f32_16x16x32_bf16 v[240:243], a[224:227], a[80:83], v[240:243]
  s_waitcnt lgkmcnt(6)
  v_mfma_f32_16x16x32_bf16 v[192:195], a[208:211], a[80:83], 0
  s_waitcnt lgkmcnt(4)
  ds_read_b64_tr_b16 a[224:225], v13 offset:24608
  v_mfma_f32_16x16x32_bf16 v[192:195], a[212:215], a[96:99], v[192:195]
  s_mov_b32 s56, 2359296
  ds_read_b64_tr_b16 a[226:227], v13 offset:26144
  v_mfma_f32_16x16x32_bf16 v[196:199], a[212:215], a[100:103], 0
  ds_read_b64_tr_b16 a[228:229], v13 offset:30752
  v_mfma_f32_16x16x32_bf16 v[196:199], a[208:211], a[84:87], v[196:199]
  s_waitcnt vmcnt(11)
  ds_read_b64_tr_b16 a[230:231], v13 offset:32288
  v_accvgpr_read_b32 v227, a115
  v_mfma_f32_16x16x32_bf16 v[200:203], a[208:211], a[88:91], 0
  buffer_load_dword a255, v44, s[8:11], s56 offen
  v_mfma_f32_16x16x32_bf16 v[200:203], a[212:215], a[104:107], v[200:203]
  s_waitcnt vmcnt(11)
  s_mov_b32 s57, 393216
  v_accvgpr_write_b32 a115, v224
  v_accvgpr_read_b32 v231, a119
  v_mfma_f32_16x16x32_bf16 v[204:207], a[212:215], a[108:111], 0
  buffer_load_dword a255, v45, s[12:15], s57 offen
  v_mfma_f32_16x16x32_bf16 v[204:207], a[208:211], a[92:95], v[204:207]
  s_waitcnt lgkmcnt(6)
  v_accvgpr_write_b32 a119, v228
  v_add3_u32 v226, v226, v227, v231
  v_mfma_f32_16x16x32_bf16 v[156:159], a[216:219], a[92:95], 0
  s_waitcnt vmcnt(11) lgkmcnt(4)
  ds_read_b64_tr_b16 a[208:209], v13 offset:27680
  v_accvgpr_read_b32 v235, a123
  v_mfma_f32_16x16x32_bf16 v[156:159], a[220:223], a[108:111], v[156:159]
  ds_read_b64_tr_b16 a[210:211], v13 offset:29216
  v_accvgpr_write_b32 a123, v232
  v_mfma_f32_16x16x32_bf16 v[152:155], a[220:223], a[104:107], 0
  s_waitcnt vmcnt(10)
  ds_read_b64_tr_b16 a[212:213], v13 offset:33824
  v_accvgpr_read_b32 v239, a127
  v_mfma_f32_16x16x32_bf16 v[152:155], a[216:219], a[88:91], v[152:155]
  s_add_u32 m0, s74, 73728
  ds_read_b64_tr_b16 a[214:215], v13 offset:35360
  v_accvgpr_write_b32 a127, v236
  v_mfma_f32_16x16x32_bf16 v[148:151], a[216:219], a[84:87], 0
  s_mov_b32 s58, 1572864
  v_add3_u32 v234, v234, v235, v239
  v_add3_u32 v226, v226, v230, v238
  v_mfma_f32_16x16x32_bf16 v[148:151], a[220:223], a[100:103], v[148:151]
  buffer_load_dwordx4 v22, s[8:11], s58 offen offset:0  lds
  v_mfma_f32_16x16x32_bf16 v[144:147], a[220:223], a[96:99], 0
  s_waitcnt vmcnt(10)
  v_subrev_u32 v226, s43, v226
  v_accvgpr_read_b32 v227, a131
  v_mfma_f32_16x16x32_bf16 v[144:147], a[216:219], a[80:83], v[144:147]
  s_waitcnt vmcnt(9) lgkmcnt(6)
  v_accvgpr_write_b32 a131, v225
  v_accvgpr_read_b32 v231, a135
  v_mfma_f32_16x16x32_bf16 v[160:163], a[224:227], a[80:83], 0
  s_waitcnt lgkmcnt(4)
  ds_read_b64_tr_b16 a[216:217], v13 offset:24640
  v_accvgpr_write_b32 a135, v229
  v_mfma_f32_16x16x32_bf16 v[160:163], a[228:231], a[96:99], v[160:163]
  ds_read_b64_tr_b16 a[220:221], v13 offset:30784
  v_add3_u32 v226, v226, v227, v231
  v_mfma_f32_16x16x32_bf16 v[164:167], a[228:231], a[100:103], 0
  s_waitcnt vmcnt(8)
  ds_read_b64_tr_b16 a[222:223], v13 offset:32320
  v_accvgpr_read_b32 v235, a139
  v_mfma_f32_16x16x32_bf16 v[164:167], a[224:227], a[84:87], v[164:167]
  ds_read_b64_tr_b16 a[218:219], v13 offset:26176
  v_accvgpr_write_b32 a139, v233
  v_mfma_f32_16x16x32_bf16 v[168:171], a[224:227], a[88:91], 0
  buffer_load_dwordx4 v23, s[8:11], s58 offen offset:1024  lds
  v_mfma_f32_16x16x32_bf16 v[168:171], a[228:231], a[104:107], v[168:171]
  buffer_load_dwordx4 v24, s[8:11], s58 offen offset:2048  lds
  v_mfma_f32_16x16x32_bf16 v[172:175], a[228:231], a[108:111], 0
  s_waitcnt vmcnt(9)
  ds_read_b64_tr_b16 a[228:229], v13 offset:33856
  v_accvgpr_read_b32 v239, a143
  v_mfma_f32_16x16x32_bf16 v[172:175], a[224:227], a[92:95], v[172:175]
  s_waitcnt lgkmcnt(7)
  ds_read_b64_tr_b16 a[230:231], v13 offset:35392
  v_accvgpr_write_b32 a143, v237
  v_mfma_f32_16x16x32_bf16 v[188:191], a[208:211], a[92:95], 0
  s_mov_b64 exec, 0
  s_cmp_eq_u32 s72, 0
  s_cbranch_scc1 L_pg9
  s_cmp_eq_u32 s72, 1
  s_cbranch_scc1 L_pg10
  s_cmp_eq_u32 s72, 2
  s_cbranch_scc1 L_pg11
  s_branch L_pg12
L_hop2:
  s_mov_b64 exec, -1
  ds_read_b64_tr_b16 a[224:225], v13 offset:27712
  v_add3_u32 v234, v234, v235, v239
  s_waitcnt lgkmcnt(7)
  v_mfma_f32_16x16x32_bf16 v[188:191], a[212:215], a[108:111], v[188:191]
  s_add_u32 m0, s74, 86016
  ds_read_b64_tr_b16 a[226:227], v13 offset:29248
  v_add_u32 v226, v226, v234
  v_mfma_f32_16x16x32_bf16 v[184:187], a[212:215], a[104:107], 0
  s_mov_b32 s59, 1966080
  v_cmp_ne_u32 vcc, 0, v226
  v_mfma_f32_16x16x32_bf16 v[184:187], a[208:211], a[88:91], v[184:187]
  buffer_load_dwordx4 v22, s[8:11], s59 offen offset:0  lds
  v_mfma_f32_16x16x32_bf16 v[180:183], a[208:211], a[84:87], 0
  s_cbranch_vccnz L_tagx1
L_tagxok1:
  v_lshrrev_b32 v41, 3, v39
  v_mfma_f32_16x16x32_bf16 v[180:183], a[212:215], a[100:103], v[180:183]
  s_waitcnt vmcnt(7)
  v_subrev_u32 v40, s40, v40
  v_lshl_add_u32 v41, s72, 2, v41
  v_mfma_f32_16x16x32_bf16 v[176:179], a[212:215], a[96:99], 0
  v_cmp_lt_u32 vcc, 7, v40
  v_add_u32 v41, 159744, v41
  v_mfma_f32_16x16x32_bf16 v[176:179], a[208:211], a[80:83], v[176:179]
  s_waitcnt lgkmcnt(0)
  s_barrier
  v_mfma_f32_16x16x32_bf16 v[208:211], a[216:219], a[80:83], 0
  s_cbranch_vccnz L_spin0
L_ret0:
  ds_read_b64_tr_b16 a[208:209], v1 offset:36864
  v_mfma_f32_16x16x32_bf16 v[208:211], a[220:223], a[96:99], v[208:211]
  ds_write_b32 v41, v40
  ds_read_b64_tr_b16 a[210:211], v1 offset:43008
  v_mfma_f32_16x16x32_bf16 v[212:215], a[220:223], a[100:103], 0
  ds_read_b64_tr_b16 a[212:213], v5 offset:0
  v_mfma_f32_16x16x32_bf16 v[212:215], a[216:219], a[84:87], v[212:215]
  buffer_load_dwordx4 v23, s[8:11], s59 offen offset:1024  lds
  v_mfma_f32_16x16x32_bf16 v[216:219], a[216:219], a[88:91], 0
  ds_read_b64_tr_b16 a[214:215], v5 offset:6144
  v_mfma_f32_16x16x32_bf16 v[216:219], a[220:223], a[104:107], v[216:219]
  buffer_load_dwordx4 v24, s[8:11], s59 offen offset:2048  lds
  v_mfma_f32_16x16x32_bf16 v[220:223], a[220:223], a[108:111], 0
  v_mfma_f32_16x16x32_bf16 v[220:223], a[216:219], a[92:95], v[220:223]
  v_mfma_f32_16x16x32_bf16 v[236:239], a[224:227], a[92:95], 0
  s_add_u32 m0, s74, 98304
  ds_read_b64_tr_b16 a[216:217], v1 offset:36872
  v_mfma_f32_16x16x32_bf16 v[236:239], a[228:231], a[108:111], v[236:239]
  s_mov_b32 s3, 393216
  ds_read_b64_tr_b16 a[218:219], v1 offset:43016
  v_mfma_f32_16x16x32_bf16 v[232:235], a[228:231], a[104:107], 0
  ds_read_b64_tr_b16 a[220:221], v5 offset:8
  v_mfma_f32_16x16x32_bf16 v[232:235], a[224:227], a[88:91], v[232:235]
  ds_read_b64_tr_b16 a[222:223], v5 offset:6152
  v_mfma_f32_16x16x32_bf16 v[228:231], a[224:227], a[84:87], 0
  buffer_load_dwordx4 v25, s[12:15], s3 offen offset:0  lds
  v_mfma_f32_16x16x32_bf16 v[228:231], a[228:231], a[100:103], v[228:231]
  v_mfma_f32_16x16x32_bf16 v[224:227], a[228:231], a[96:99], 0
  v_mfma_f32_16x16x32_bf16 v[224:227], a[224:227], a[80:83], v[224:227]
  s_waitcnt lgkmcnt(6)
  v_mfma_f32_16x16x32_bf16 v[48:51], a[208:211], a[112:115], v[48:51]
  s_waitcnt lgkmcnt(4)
  ds_read_b64_tr_b16 a[224:225], v2 offset:36864
  v_mfma_f32_16x16x32_bf16 v[48:51], a[212:215], a[128:131], v[48:51]
  ds_read_b64_tr_b16 a[226:227], v2 offset:43008
  v_mfma_f32_16x16x32_bf16 v[52:55], a[212:215], a[132:135], v[52:55]
  ds_read_b64_tr_b16 a[228:229], v6 offset:0
  v_mfma_f32_16x16x32_bf16 v[52:55], a[208:211], a[116:119], v[52:55]
  ds_read_b64_tr_b16 a[230:231], v6 offset:6144
  v_mfma_f32_16x16x32_bf16 v[56:59], a[208:211], a[120:123], v[56:59]
  v_mfma_f32_16x16x32_bf16 v[56:59], a[212:215], a[136:139], v[56:59]
  s_add_u32 s60, s75, 16384
  v_mfma_f32_16x16x32_bf16 v[60:63], a[212:215], a[140:143], v[60:63]
  buffer_load_dwordx4 a[144:147], v42, s[4:7], s60 offen offset:0 sc1
  v_mfma_f32_16x16x32_bf16 v[60:63], a[208:211], a[124:127], v[60:63]
  s_waitcnt lgkmcnt(6)
  v_mfma_f32_16x16x32_bf16 a[12:15], a[216:219], a[124:127], a[12:15]
  s_waitcnt lgkmcnt(4)
  ds_read_b64_tr_b16 a[208:209], v2 offset:36872
  v_mfma_f32_16x16x32_bf16 a[12:15], a[220:223], a[140:143], a[12:15]
  ds_read_b64_tr_b16 a[210:211], v2 offset:43016
  v_mfma_f32_16x16x32_bf16 a[8:11], a[220:223], a[136:139], a[8:11]
  ds_read_b64_tr_b16 a[212:213], v6 offset:8
  v_mfma_f32_16x16x32_bf16 a[8:11], a[216:219], a[120:123], a[8:11]
  ds_read_b64_tr_b16 a[214:215], v6 offset:6152
  v_mfma_f32_16x16x32_bf16 a[4:7], a[216:219], a[116:119], a[4:7]
  buffer_load_dwordx4 a[148:151], v43, s[4:7], s60 offen offset:0 sc1
  v_mfma_f32_16x16x32_bf16 a[4:7], a[220:223], a[132:135], a[4:7]
  v_mfma_f32_16x16x32_bf16 a[0:3], a[220:223], a[128:131], a[0:3]
  s_waitcnt lgkmcnt(6)
  v_mfma_f32_16x16x32_bf16 a[0:3], a[216:219], a[112:115], a[0:3]
  buffer_load_dwordx4 v26, s[12:15], s3 offen offset:1024  lds
  v_mfma_f32_16x16x32_bf16 v[64:67], a[224:227], a[112:115], v[64:67]
  s_waitcnt lgkmcnt(4)
  ds_read_b64_tr_b16 a[216:217], v1 offset:36992
  v_mfma_f32_16x16x32_bf16 v[64:67], a[228:231], a[128:131], v[64:67]
  ds_read_b64_tr_b16 a[218:219], v1 offset:43136
  v_mfma_f32_16x16x32_bf16 v[68:71], a[228:231], a[132:135], v[68:71]
  ds_read_b64_tr_b16 a[220:221], v5 offset:128
  v_mfma_f32_16x16x32_bf16 v[68:71], a[224:227], a[116:119], v[68:71]
  ds_read_b64_tr_b16 a[222:223], v5 offset:6272
  v_mfma_f32_16x16x32_bf16 v[72:75], a[224:227], a[120:123], v[72:75]
  v_mfma_f32_16x16x32_bf16 v[72:75], a[228:231], a[136:139], v[72:75]
  v_mfma_f32_16x16x32_bf16 v[76:79], a[228:231], a[140:143], v[76:79]
  v_mfma_f32_16x16x32_bf16 v[76:79], a[224:227], a[124:127], v[76:79]
  s_waitcnt lgkmcnt(6)
  v_mfma_f32_16x16x32_bf16 a[28:31], a[208:211], a[124:127], a[28:31]
  s_waitcnt lgkmcnt(4)
  ds_read_b64_tr_b16 a[224:225], v1 offset:37000
  v_mfma_f32_16x16x32_bf16 a[28:31], a[212:215], a[140:143], a[28:31]
  ds_read_b64_tr_b16 a[226:227], v1 offset:43144
  v_mfma_f32_16x16x32_bf16 a[24:27], a[212:215], a[136:139], a[24:27]
  ds_read_b64_tr_b16 a[228:229], v5 offset:136
  v_mfma_f32_16x16x32_bf16 a[24:27], a[208:211], a[120:123], a[24:27]
  ds_read_b64_tr_b16 a[230:231], v5 offset:6280
  v_mfma_f32_16x16x32_bf16 a[20:23], a[208:211], a[116:119], a[20:23]
  buffer_load_dwordx4 a[152:155], v46, s[4:7], s60 offen offset:0 sc1
  v_mfma_f32_16x16x32_bf16 a[20:23], a[212:215], a[132:135], a[20:23]
  v_mfma_f32_16x16x32_bf16 a[16:19], a[212:215], a[128:131], a[16:19]
  v_mfma_f32_16x16x32_bf16 a[16:19], a[208:211], a[112:115], a[16:19]
  s_waitcnt lgkmcnt(6)
  v_mfma_f32_16x16x32_bf16 v[80:83], a[216:219], a[112:115], v[80:83]
  s_waitcnt lgkmcnt(4)
  ds_read_b64_tr_b16 a[208:209], v2 offset:36992
  v_mfma_f32_16x16x32_bf16 v[80:83], a[220:223], a[128:131], v[80:83]
  ds_read_b64_tr_b16 a[210:211], v2 offset:43136
  v_mfma_f32_16x16x32_bf16 v[84:87], a[220:223], a[132:135], v[84:87]
  ds_read_b64_tr_b16 a[212:213], v6 offset:128
  v_mfma_f32_16x16x32_bf16 v[84:87], a[216:219], a[116:119], v[84:87]
  ds_read_b64_tr_b16 a[214:215], v6 offset:6272
  v_mfma_f32_16x16x32_bf16 v[88:91], a[216:219], a[120:123], v[88:91]
  buffer_load_dwordx4 a[156:159], v47, s[4:7], s60 offen offset:0 sc1
  v_mfma_f32_16x16x32_bf16 v[88:91], a[220:223], a[136:139], v[88:91]
  s_add_u32 s61, s75, 20480
  v_mfma_f32_16x16x32_bf16 v[92:95], a[220:223], a[140:143], v[92:95]
  buffer_load_dwordx4 a[160:163], v42, s[4:7], s61 offen offset:0 sc1
  v_mfma_f32_16x16x32_bf16 v[92:95], a[216:219], a[124:127], v[92:95]
  s_waitcnt lgkmcnt(6)
  v_mfma_f32_16x16x32_bf16 a[44:47], a[224:227], a[124:127], a[44:47]
  s_waitcnt lgkmcnt(4)
  ds_read_b64_tr_b16 a[216:217], v2 offset:37000
  v_mfma_f32_16x16x32_bf16 a[44:47], a[228:231], a[140:143], a[44:47]
  ds_read_b64_tr_b16 a[218:219], v2 offset:43144
  v_mfma_f32_16x16x32_bf16 a[40:43], a[228:231], a[136:139], a[40:43]
  ds_read_b64_tr_b16 a[220:221], v6 offset:136
  v_mfma_f32_16x16x32_bf16 a[40:43], a[224:227], a[120:123], a[40:43]
  ds_read_b64_tr_b16 a[222:223], v6 offset:6280
  v_mfma_f32_16x16x32_bf16 a[36:39], a[224:227], a[116:119], a[36:39]
  buffer_load_dwordx4 v27, s[12:15], s3 offen offset:2048  lds
  v_mfma_f32_16x16x32_bf16 a[36:39], a[228:231], a[132:135], a[36:39]
  v_mfma_f32_16x16x32_bf16 a[32:35], a[228:231], a[128:131], a[32:35]
  v_mfma_f32_16x16x32_bf16 a[32:35], a[224:227], a[112:115], a[32:35]
  s_waitcnt lgkmcnt(6)
  v_mfma_f32_16x16x32_bf16 v[96:99], a[208:211], a[112:115], v[96:99]
  s_waitcnt lgkmcnt(4)
  ds_read_b64_tr_b16 a[224:225], v1 offset:37120
  v_mfma_f32_16x16x32_bf16 v[96:99], a[212:215], a[128:131], v[96:99]
  ds_read_b64_tr_b16 a[226:227], v1 offset:43264
  v_mfma_f32_16x16x32_bf16 v[100:103], a[212:215], a[132:135], v[100:103]
  ds_read_b64_tr_b16 a[228:229], v5 offset:256
  v_mfma_f32_16x16x32_bf16 v[100:103], a[208:211], a[116:119], v[100:103]
  ds_read_b64_tr_b16 a[230:231], v5 offset:6400
  v_mfma_f32_16x16x32_bf16 v[104:107], a[208:211], a[120:123], v[104:107]
  v_mfma_f32_16x16x32_bf16 v[104:107], a[212:215], a[136:139], v[104:107]
  v_mfma_f32_16x16x32_bf16 v[108:111], a[212:215], a[140:143], v[108:111]
  v_mfma_f32_16x16x32_bf16 v[108:111], a[208:211], a[124:127], v[108:111]
  s_waitcnt lgkmcnt(6)
  v_mfma_f32_16x16x32_bf16 a[60:63], a[216:219], a[124:127], a[60:63]
  s_waitcnt lgkmcnt(4)
  ds_read_b64_tr_b16 a[208:209], v1 offset:37128
  v_mfma_f32_16x16x32_bf16 a[60:63], a[220:223], a[140:143], a[60:63]
  ds_read_b64_tr_b16 a[210:211], v1 offset:43272
  v_mfma_f32_16x16x32_bf16 a[56:59], a[220:223], a[136:139], a[56:59]
  ds_read_b64_tr_b16 a[212:213], v5 offset:264
  v_mfma_f32_16x16x32_bf16 a[56:59], a[216:219], a[120:123], a[56:59]
  ds_read_b64_tr_b16 a[214:215], v5 offset:6408
  v_mfma_f32_16x16x32_bf16 a[52:55], a[216:219], a[116:119], a[52:55]
  buffer_load_dwordx4 a[164:167], v43, s[4:7], s61 offen offset:0 sc1
  v_mfma_f32_16x16x32_bf16 a[52:55], a[220:223], a[132:135], a[52:55]
  buffer_load_dwordx4 a[168:171], v46, s[4:7], s61 offen offset:0 sc1
  v_mfma_f32_16x16x32_bf16 a[48:51], a[220:223], a[128:131], a[48:51]
  v_mfma_f32_16x16x32_bf16 a[48:51], a[216:219], a[112:115], a[48:51]
  s_waitcnt lgkmcnt(6)
  v_mfma_f32_16x16x32_bf16 v[112:115], a[224:227], a[112:115], v[112:115]
  s_waitcnt lgkmcnt(4)
  ds_read_b64_tr_b16 a[216:217], v2 offset:37120
  v_mfma_f32_16x16x32_bf16 v[112:115], a[228:231], a[128:131], v[112:115]
  ds_read_b64_tr_b16 a[218:219], v2 offset:43264
  v_mfma_f32_16x16x32_bf16 v[116:119], a[228:231], a[132:135], v[116:119]
  ds_read_b64_tr_b16 a[220:221], v6 offset:256
  v_mfma_f32_16x16x32_bf16 v[116:119], a[224:227], a[116:119], v[116:119]
  ds_read_b64_tr_b16 a[222:223], v6 offset:6400
  v_mfma_f32_16x16x32_bf16 v[120:123], a[224:227], a[120:123], v[120:123]
  buffer_load_dwordx4 a[172:175], v47, s[4:7], s61 offen offset:0 sc1
  v_mfma_f32_16x16x32_bf16 v[120:123], a[228:231], a[136:139], v[120:123]
  s_mov_b32 s64, 3932160
  v_mfma_f32_16x16x32_bf16 v[124:127], a[228:231], a[140:143], v[124:127]
  buffer_load_dword a255, v44, s[8:11], s64 offen
  v_mfma_f32_16x16x32_bf16 v[124:127], a[224:227], a[124:127], v[124:127]
  s_waitcnt lgkmcnt(6)
  s_mov_b32 s65, 786432
  v_mfma_f32_16x16x32_bf16 a[76:79], a[208:211], a[124:127], a[76:79]
  s_waitcnt lgkmcnt(4)
  ds_read_b64_tr_b16 a[224:225], v2 offset:37128
  v_mfma_f32_16x16x32_bf16 a[76:79], a[212:215], a[140:143], a[76:79]
  ds_read_b64_tr_b16 a[226:227], v2 offset:43272
  v_mfma_f32_16x16x32_bf16 a[72:75], a[212:215], a[136:139], a[72:75]
  ds_read_b64_tr_b16 a[228:229], v6 offset:264
  v_mfma_f32_16x16x32_bf16 a[72:75], a[208:211], a[120:123], a[72:75]
  buffer_load_dword a255, v45, s[12:15], s65 offen
  v_mfma_f32_16x16x32_bf16 a[68:71], a[208:211], a[116:119], a[68:71]
  ds_read_b64_tr_b16 a[230:231], v6 offset:6408
  v_mfma_f32_16x16x32_bf16 a[68:71], a[212:215], a[132:135], a[68:71]
  v_mfma_f32_16x16x32_bf16 a[64:67], a[212:215], a[128:131], a[64:67]
  v_mfma_f32_16x16x32_bf16 a[64:67], a[208:211], a[112:115], a[64:67]
  s_waitcnt vmcnt(21)
  s_barrier
  s_waitcnt lgkmcnt(6)
  v_mfma_f32_16x16x32_bf16 v[128:131], a[216:219], a[112:115], v[128:131]
  s_waitcnt lgkmcnt(4)
  s_add_u32 m0, s74, 110592
  ds_read_b64_tr_b16 a[208:209], v14 offset:12288
  v_mfma_f32_16x16x32_bf16 v[128:131], a[220:223], a[128:131], v[128:131]
  s_mov_b32 s62, 2359296
  ds_read_b64_tr_b16 a[210:211], v14 offset:13824
  v_mfma_f32_16x16x32_bf16 v[132:135], a[220:223], a[132:135], v[132:135]
  ds_read_b64_tr_b16 a[212:213], v14 offset:18432
  v_mfma_f32_16x16x32_bf16 v[132:135], a[216:219], a[116:119], v[132:135]
  ds_read_b64_tr_b16 a[214:215], v14 offset:19968
  v_mfma_f32_16x16x32_bf16 v[136:139], a[216:219], a[120:123], v[136:139]
  buffer_load_dwordx4 v22, s[8:11], s62 offen offset:0  lds
  v_mfma_f32_16x16x32_bf16 v[136:139], a[220:223], a[136:139], v[136:139]
  buffer_load_dwordx4 v23, s[8:11], s62 offen offset:1024  lds
  v_mfma_f32_16x16x32_bf16 v[140:143], a[220:223], a[140:143], v[140:143]
  v_mfma_f32_16x16x32_bf16 v[140:143], a[216:219], a[124:127], v[140:143]
  s_waitcnt lgkmcnt(6)
  v_mfma_f32_16x16x32_bf16 v[252:255], a[224:227], a[124:127], v[252:255]
  s_waitcnt lgkmcnt(4)
  ds_read_b64_tr_b16 a[216:217], v14 offset:15360
  v_mfma_f32_16x16x32_bf16 v[252:255], a[228:231], a[140:143], v[252:255]
  ds_read_b64_tr_b16 a[218:219], v14 offset:16896
  v_mfma_f32_16x16x32_bf16 v[248:251], a[228:231], a[136:139], v[248:251]
  ds_read_b64_tr_b16 a[220:221], v14 offset:21504
  v_mfma_f32_16x16x32_bf16 v[248:251], a[224:227], a[120:123], v[248:251]
  ds_read_b64_tr_b16 a[222:223], v14 offset:23040
  v_mfma_f32_16x16x32_bf16 v[244:247], a[224:227], a[116:119], v[244:247]
  buffer_load_dwordx4 v24, s[8:11], s62 offen offset:2048  lds
  v_mfma_f32_16x16x32_bf16 v[244:247], a[228:231], a[132:135], v[244:247]
L_pg2:
  s_cbranch_execz L_hop0
  s_add_u32 m0, s74, 122880
  v_mfma_f32_16x16x32_bf16 v[240:243], a[228:231], a[128:131], v[240:243]
  s_mov_b32 s66, 2752512
  v_mfma_f32_16x16x32_bf16 v[240:243], a[224:227], a[112:115], v[240:243]
  s_waitcnt lgkmcnt(6)
  buffer_load_dwordx4 v22, s[8:11], s66 offen offset:0  lds
  v_mfma_f32_16x16x32_bf16 v[192:195], a[208:211], a[112:115], v[192:195]
  s_waitcnt lgkmcnt(4)
  ds_read_b64_tr_b16 a[224:225], v14 offset:12320
  v_mfma_f32_16x16x32_bf16 v[192:195], a[212:215], a[128:131], v[192:195]
  ds_read_b64_tr_b16 a[226:227], v14 offset:13856
  v_mfma_f32_16x16x32_bf16 v[196:199], a[212:215], a[132:135], v[196:199]
  ds_read_b64_tr_b16 a[228:229], v14 offset:18464
  v_mfma_f32_16x16x32_bf16 v[196:199], a[208:211], a[116:119], v[196:199]
  ds_read_b64_tr_b16 a[230:231], v14 offset:20000
  v_mfma_f32_16x16x32_bf16 v[200:203], a[208:211], a[120:123], v[200:203]
  buffer_load_dwordx4 v23, s[8:11], s66 offen offset:1024  lds
  v_mfma_f32_16x16x32_bf16 v[200:203], a[212:215], a[136:139], v[200:203]
  v_mfma_f32_16x16x32_bf16 v[204:207], a[212:215], a[140:143], v[204:207]
  v_mfma_f32_16x16x32_bf16 v[204:207], a[208:211], a[124:127], v[204:207]
  s_waitcnt lgkmcnt(6)
  v_mfma_f32_16x16x32_bf16 v[156:159], a[216:219], a[124:127], v[156:159]
  s_waitcnt lgkmcnt(4)
  ds_read_b64_tr_b16 a[208:209], v14 offset:15392
  v_mfma_f32_16x16x32_bf16 v[156:159], a[220:223], a[140:143], v[156:159]
  ds_read_b64_tr_b16 a[210:211], v14 offset:16928
  v_mfma_f32_16x16x32_bf16 v[152:155], a[220:223], a[136:139], v[152:155]
  ds_read_b64_tr_b16 a[212:213], v14 offset:21536
  v_mfma_f32_16x16x32_bf16 v[152:155], a[216:219], a[120:123], v[152:155]
  ds_read_b64_tr_b16 a[214:215], v14 offset:23072
  v_mfma_f32_16x16x32_bf16 v[148:151], a[216:219], a[116:119], v[148:151]
  buffer_load_dwordx4 v24, s[8:11], s66 offen offset:2048  lds
  v_mfma_f32_16x16x32_bf16 v[148:151], a[220:223], a[132:135], v[148:151]
  s_add_u32 m0, s74, 135168
  v_mfma_f32_16x16x32_bf16 v[144:147], a[220:223], a[128:131], v[144:147]
  s_mov_b32 s63, 589824
  v_mfma_f32_16x16x32_bf16 v[144:147], a[216:219], a[112:115], v[144:147]
  s_waitcnt lgkmcnt(6)
  buffer_load_dwordx4 v25, s[12:15], s63 offen offset:0  lds
  v_mfma_f32_16x16x32_bf16 v[160:163], a[224:227], a[112:115], v[160:163]
  s_waitcnt lgkmcnt(4)
  ds_read_b64_tr_b16 a[220:221], v14 offset:18496
  v_mfma_f32_16x16x32_bf16 v[160:163], a[228:231], a[128:131], v[160:163]
  ds_read_b64_tr_b16 a[222:223], v14 offset:20032
  v_mfma_f32_16x16x32_bf16 v[164:167], a[228:231], a[132:135], v[164:167]
  ds_read_b64_tr_b16 a[216:217], v14 offset:12352
  v_mfma_f32_16x16x32_bf16 v[164:167], a[224:227], a[116:119], v[164:167]
  ds_read_b64_tr_b16 a[218:219], v14 offset:13888
  v_mfma_f32_16x16x32_bf16 v[168:171], a[224:227], a[120:123], v[168:171]
  v_mfma_f32_16x16x32_bf16 v[168:171], a[228:231], a[136:139], v[168:171]
  v_mfma_f32_16x16x32_bf16 v[172:175], a[228:231], a[140:143], v[172:175]
  ds_read_b64_tr_b16 a[228:229], v14 offset:21568
  v_mfma_f32_16x16x32_bf16 v[172:175], a[224:227], a[124:127], v[172:175]
  s_waitcnt lgkmcnt(5)
  ds_read_b64_tr_b16 a[230:231], v14 offset:23104
  v_mfma_f32_16x16x32_bf16 v[188:191], a[208:211], a[124:127], v[188:191]
  s_add_u32 s67, s75, 24576
  ds_read_b64_tr_b16 a[224:225], v14 offset:15424
  v_mfma_f32_16x16x32_bf16 v[188:191], a[212:215], a[140:143], v[188:191]
  ds_read_b64_tr_b16 a[226:227], v14 offset:16960
  v_mfma_f32_16x16x32_bf16 v[184:187], a[212:215], a[136:139], v[184:187]
  buffer_load_dwordx4 a[176:179], v42, s[4:7], s67 offen offset:0 sc1
  v_mfma_f32_16x16x32_bf16 v[184:187], a[208:211], a[120:123], v[184:187]
  v_mfma_f32_16x16x32_bf16 v[180:183], a[208:211], a[116:119], v[180:183]
  v_mfma_f32_16x16x32_bf16 v[180:183], a[212:215], a[132:135], v[180:183]
  v_mfma_f32_16x16x32_bf16 v[176:179], a[212:215], a[128:131], v[176:179]
  buffer_load_dwordx4 a[180:183], v43, s[4:7], s67 offen offset:0 sc1
  v_mfma_f32_16x16x32_bf16 v[176:179], a[208:211], a[112:115], v[176:179]
  s_waitcnt vmcnt(14) lgkmcnt(0)
  s_barrier
  v_mfma_f32_16x16x32_bf16 v[208:211], a[216:219], a[112:115], v[208:211]
  ds_read_b64_tr_b16 a[208:209], v5 offset:24576
  v_mfma_f32_16x16x32_bf16 v[208:211], a[220:223], a[128:131], v[208:211]
  ds_read_b64_tr_b16 a[210:211], v5 offset:30720
  v_mfma_f32_16x16x32_bf16 v[212:215], a[220:223], a[132:135], v[212:215]
  ds_read_b64_tr_b16 a[212:213], v5 offset:36864
  v_mfma_f32_16x16x32_bf16 v[212:215], a[216:219], a[116:119], v[212:215]
  ds_read_b64_tr_b16 a[214:215], v5 offset:43008
  v_mfma_f32_16x16x32_bf16 v[216:219], a[216:219], a[120:123], v[216:219]
  buffer_load_dwordx4 v26, s[12:15], s63 offen offset:1024  lds
  v_mfma_f32_16x16x32_bf16 v[216:219], a[220:223], a[136:139], v[216:219]
  v_mfma_f32_16x16x32_bf16 v[220:223], a[220:223], a[140:143], v[220:223]
  v_mfma_f32_16x16x32_bf16 v[220:223], a[216:219], a[124:127], v[220:223]
  v_mfma_f32_16x16x32_bf16 v[236:239], a[224:227], a[124:127], v[236:239]
  ds_read_b64_tr_b16 a[216:217], v5 offset:24584
  v_mfma_f32_16x16x32_bf16 v[236:239], a[228:231], a[140:143], v[236:239]
  ds_read_b64_tr_b16 a[218:219], v5 offset:30728
  v_mfma_f32_16x16x32_bf16 v[232:235], a[228:231], a[136:139], v[232:235]
  ds_read_b64_tr_b16 a[220:221], v5 offset:36872
  v_mfma_f32_16x16x32_bf16 v[232:235], a[224:227], a[120:123], v[232:235]
  ds_read_b64_tr_b16 a[222:223], v5 offset:43016
  v_mfma_f32_16x16x32_bf16 v[228:231], a[224:227], a[116:119], v[228:231]
  v_mfma_f32_16x16x32_bf16 v[228:231], a[228:231], a[132:135], v[228:231]
  v_mfma_f32_16x16x32_bf16 v[224:227], a[228:231], a[128:131], v[224:227]
  v_mfma_f32_16x16x32_bf16 v[224:227], a[224:227], a[112:115], v[224:227]
  s_waitcnt lgkmcnt(6)
  v_bfe_u32 v40, v37, 2, 7
  v_mfma_f32_16x16x32_bf16 v[48:51], a[208:211], a[144:147], v[48:51]
  s_waitcnt lgkmcnt(4)
  ds_read_b64_tr_b16 a[224:225], v6 offset:24576
  v_add_u32 v40, 159744, v40
  v_mfma_f32_16x16x32_bf16 v[48:51], a[212:215], a[160:163], v[48:51]
  s_waitcnt vmcnt(14)
  ds_read_b32 v40, v40
  v_mfma_f32_16x16x32_bf16 v[52:55], a[212:215], a[164:167], v[52:55]
  s_waitcnt vmcnt(13)
  ds_read_b64_tr_b16 a[228:229], v6 offset:36864
  v_mfma_f32_16x16x32_bf16 v[52:55], a[208:211], a[148:151], v[52:55]
  s_min_u32 s50, s47, 1
  ds_read_b64_tr_b16 a[226:227], v6 offset:30720
  v_mfma_f32_16x16x32_bf16 v[56:59], a[208:211], a[152:155], v[56:59]
  s_lshl_b32 s51, s46, 7
  ds_read_b64_tr_b16 a[230:231], v6 offset:43008
  v_mfma_f32_16x16x32_bf16 v[56:59], a[212:215], a[168:171], v[56:59]
  s_waitcnt vmcnt(12) lgkmcnt(3)
  s_or_b32 s50, s50, s72
  v_mfma_f32_16x16x32_bf16 v[60:63], a[212:215], a[172:175], v[60:63]
  s_lshl_b32 s50, s50, 28
  v_mfma_f32_16x16x32_bf16 v[60:63], a[208:211], a[156:159], v[60:63]
  s_add_u32 s51, s51, s50
  v_xor_b32_dpp v40, v40, v40 quad_perm:[0,0,0,0] row_mask:0xf bank_mask:0xf
  v_mfma_f32_16x16x32_bf16 a[12:15], a[216:219], a[156:159], a[12:15]
  s_add_u32 s51, s51, 3178496
  ds_read_b64_tr_b16 a[208:209], v6 offset:24584
  v_cmp_ne_u32 vcc, 0, v40
  v_mfma_f32_16x16x32_bf16 a[12:15], a[220:223], a[172:175], a[12:15]
  s_cmp_lg_u64 vcc, 0
  ds_read_b64_tr_b16 a[210:211], v6 offset:30728
  v_mfma_f32_16x16x32_bf16 a[8:11], a[220:223], a[168:171], a[8:11]
  buffer_load_dwordx4 a[184:187], v46, s[4:7], s67 offen offset:0 sc1
  v_mfma_f32_16x16x32_bf16 a[8:11], a[216:219], a[152:155], a[8:11]
  s_cselect_b32 s97, 1, 0
  ds_read_b64_tr_b16 a[212:213], v6 offset:36872
  v_mfma_f32_16x16x32_bf16 a[4:7], a[216:219], a[148:151], a[4:7]
  s_mov_b64 exec, 0
  s_cmp_eq_u32 s72, 0
  s_cbranch_scc1 L_pg13
  s_cmp_eq_u32 s72, 1
  s_cbranch_scc1 L_pg14
  s_cmp_eq_u32 s72, 2
  s_cbranch_scc1 L_pg15
  s_branch L_pg16
L_hop3:
  s_mov_b64 exec, -1
  ds_read_b64_tr_b16 a[214:215], v6 offset:43016
  v_mfma_f32_16x16x32_bf16 a[4:7], a[220:223], a[164:167], a[4:7]
  buffer_load_dwordx4 a[188:191], v47, s[4:7], s67 offen offset:0 sc1
  v_mfma_f32_16x16x32_bf16 a[0:3], a[220:223], a[160:163], a[0:3]
  s_add_u32 s48, s75, 28672
  v_mfma_f32_16x16x32_bf16 a[0:3], a[216:219], a[144:147], a[0:3]
  s_waitcnt lgkmcnt(5)
  buffer_load_dwordx4 a[192:195], v42, s[4:7], s48 offen offset:0 sc1
  v_mfma_f32_16x16x32_bf16 v[64:67], a[224:227], a[144:147], v[64:67]
  s_waitcnt lgkmcnt(4)
  ds_read_b64_tr_b16 a[216:217], v5 offset:24704
  v_mfma_f32_16x16x32_bf16 v[64:67], a[228:231], a[160:163], v[64:67]
  buffer_load_dwordx4 v27, s[12:15], s63 offen offset:2048  lds
  v_mfma_f32_16x16x32_bf16 v[68:71], a[228:231], a[164:167], v[68:71]
  ds_read_b64_tr_b16 a[220:221], v5 offset:36992
  v_mfma_f32_16x16x32_bf16 v[68:71], a[224:227], a[148:151], v[68:71]
  ds_read_b64_tr_b16 a[218:219], v5 offset:30848
  v_mfma_f32_16x16x32_bf16 v[72:75], a[224:227], a[152:155], v[72:75]
  ds_read_b64_tr_b16 a[222:223], v5 offset:43136
  v_mfma_f32_16x16x32_bf16 v[72:75], a[228:231], a[168:171], v[72:75]
  v_mfma_f32_16x16x32_bf16 v[76:79], a[228:231], a[172:175], v[76:79]
  v_mfma_f32_16x16x32_bf16 v[76:79], a[224:227], a[156:159], v[76:79]
  s_waitcnt lgkmcnt(6)
  v_mfma_f32_16x16x32_bf16 a[28:31], a[208:211], a[156:159], a[28:31]
  s_waitcnt lgkmcnt(4)
  ds_read_b64_tr_b16 a[224:225], v5 offset:24712
  v_mfma_f32_16x16x32_bf16 a[28:31], a[212:215], a[172:175], a[28:31]
  ds_read_b64_tr_b16 a[226:227], v5 offset:30856
  v_mfma_f32_16x16x32_bf16 a[24:27], a[212:215], a[168:171], a[24:27]
  ds_read_b64_tr_b16 a[228:229], v5 offset:37000
  v_mfma_f32_16x16x32_bf16 a[24:27], a[208:211], a[152:155], a[24:27]
  ds_read_b64_tr_b16 a[230:231], v5 offset:43144
  v_mfma_f32_16x16x32_bf16 a[20:23], a[208:211], a[148:151], a[20:23]
  buffer_load_dwordx4 a[196:199], v43, s[4:7], s48 offen offset:0 sc1
  v_mfma_f32_16x16x32_bf16 a[20:23], a[212:215], a[164:167], a[20:23]
  v_mfma_f32_16x16x32_bf16 a[16:19], a[212:215], a[160:163], a[16:19]
  v_mov_b32 v41, s40
  v_mfma_f32_16x16x32_bf16 a[16:19], a[208:211], a[144:147], a[16:19]
  s_waitcnt lgkmcnt(5)
  v_mfma_f32_16x16x32_bf16 v[80:83], a[216:219], a[144:147], v[80:83]
  s_waitcnt lgkmcnt(4)
  ds_read_b64_tr_b16 a[208:209], v6 offset:24704
  v_mfma_f32_16x16x32_bf16 v[80:83], a[220:223], a[160:163], v[80:83]
  ds_read_b64_tr_b16 a[210:211], v6 offset:30848
  v_mfma_f32_16x16x32_bf16 v[84:87], a[220:223], a[164:167], v[84:87]
  ds_read_b64_tr_b16 a[212:213], v6 offset:36992
  v_mfma_f32_16x16x32_bf16 v[84:87], a[216:219], a[148:151], v[84:87]
  ds_read_b64_tr_b16 a[214:215], v6 offset:43136
  v_mfma_f32_16x16x32_bf16 v[88:91], a[216:219], a[152:155], v[88:91]
  buffer_load_dwordx4 a[200:203], v46, s[4:7], s48 offen offset:0 sc1
  v_mfma_f32_16x16x32_bf16 v[88:91], a[220:223], a[168:171], v[88:91]
  buffer_load_dwordx4 a[204:207], v47, s[4:7], s48 offen offset:0 sc1
  v_mfma_f32_16x16x32_bf16 v[92:95], a[220:223], a[172:175], v[92:95]
  buffer_store_dword v41, v0, s[4:7], s51 offen sc1
  v_mfma_f32_16x16x32_bf16 v[92:95], a[216:219], a[156:159], v[92:95]
  s_waitcnt lgkmcnt(6)
  v_mfma_f32_16x16x32_bf16 a[44:47], a[224:227], a[156:159], a[44:47]
  s_waitcnt lgkmcnt(4)
  ds_read_b64_tr_b16 a[216:217], v6 offset:24712
  v_mfma_f32_16x16x32_bf16 a[44:47], a[228:231], a[172:175], a[44:47]
  s_mov_b32 s49, 5505024
  ds_read_b64_tr_b16 a[218:219], v6 offset:30856
  v_mfma_f32_16x16x32_bf16 a[40:43], a[228:231], a[168:171], a[40:43]
  ds_read_b64_tr_b16 a[220:221], v6 offset:37000
  v_mfma_f32_16x16x32_bf16 a[40:43], a[224:227], a[152:155], a[40:43]
  ds_read_b64_tr_b16 a[222:223], v6 offset:43144
  v_mfma_f32_16x16x32_bf16 a[36:39], a[224:227], a[148:151], a[36:39]
  buffer_load_dword a255, v44, s[8:11], s49 offen
  v_mfma_f32_16x16x32_bf16 a[36:39], a[228:231], a[164:167], a[36:39]
  s_mov_b32 s52, 1179648
  v_mfma_f32_16x16x32_bf16 a[32:35], a[228:231], a[160:163], a[32:35]
  buffer_load_dword a255, v45, s[12:15], s52 offen
  v_mfma_f32_16x16x32_bf16 a[32:35], a[224:227], a[144:147], a[32:35]
  s_waitcnt lgkmcnt(6)
  v_mfma_f32_16x16x32_bf16 v[96:99], a[208:211], a[144:147], v[96:99]
  s_waitcnt lgkmcnt(4)
  ds_read_b64_tr_b16 a[224:225], v5 offset:24832
  v_mfma_f32_16x16x32_bf16 v[96:99], a[212:215], a[160:163], v[96:99]
  ds_read_b64_tr_b16 a[226:227], v5 offset:30976
  v_mfma_f32_16x16x32_bf16 v[100:103], a[212:215], a[164:167], v[100:103]
  s_add_u32 m0, s74, 147456
  ds_read_b64_tr_b16 a[228:229], v5 offset:37120
  v_mfma_f32_16x16x32_bf16 v[100:103], a[208:211], a[148:151], v[100:103]
  s_mov_b32 s53, 3145728
  ds_read_b64_tr_b16 a[230:231], v5 offset:43264
  v_mfma_f32_16x16x32_bf16 v[104:107], a[208:211], a[152:155], v[104:107]
  buffer_load_dwordx4 v22, s[8:11], s53 offen offset:0  lds
  v_mfma_f32_16x16x32_bf16 v[104:107], a[212:215], a[168:171], v[104:107]
  v_mfma_f32_16x16x32_bf16 v[108:111], a[212:215], a[172:175], v[108:111]
  v_mfma_f32_16x16x32_bf16 v[108:111], a[208:211], a[156:159], v[108:111]
  s_waitcnt lgkmcnt(6)
  v_mfma_f32_16x16x32_bf16 a[60:63], a[216:219], a[156:159], a[60:63]
  s_waitcnt lgkmcnt(4)
  ds_read_b64_tr_b16 a[208:209], v5 offset:24840
  v_mfma_f32_16x16x32_bf16 a[60:63], a[220:223], a[172:175], a[60:63]
  ds_read_b64_tr_b16 a[210:211], v5 offset:30984
  v_mfma_f32_16x16x32_bf16 a[56:59], a[220:223], a[168:171], a[56:59]
  ds_read_b64_tr_b16 a[212:213], v5 offset:37128
  v_mfma_f32_16x16x32_bf16 a[56:59], a[216:219], a[152:155], a[56:59]
  ds_read_b64_tr_b16 a[214:215], v5 offset:43272
  v_mfma_f32_16x16x32_bf16 a[52:55], a[216:219], a[148:151], a[52:55]
  buffer_load_dwordx4 v23, s[8:11], s53 offen offset:1024  lds
  v_mfma_f32_16x16x32_bf16 a[52:55], a[220:223], a[164:167], a[52:55]
  buffer_load_dwordx4 v24, s[8:11], s53 offen offset:2048  lds
  v_mfma_f32_16x16x32_bf16 a[48:51], a[220:223], a[160:163], a[48:51]
  v_mfma_f32_16x16x32_bf16 a[48:51], a[216:219], a[144:147], a[48:51]
  s_waitcnt lgkmcnt(6)
  v_mfma_f32_16x16x32_bf16 v[112:115], a[224:227], a[144:147], v[112:115]
  s_waitcnt lgkmcnt(4)
  ds_read_b64_tr_b16 a[216:217], v6 offset:24832
  v_mfma_f32_16x16x32_bf16 v[112:115], a[228:231], a[160:163], v[112:115]
  s_add_u32 m0, s74, 0
  ds_read_b64_tr_b16 a[218:219], v6 offset:30976
  v_mfma_f32_16x16x32_bf16 v[116:119], a[228:231], a[164:167], v[116:119]
  s_mov_b32 s54, 3538944
  ds_read_b64_tr_b16 a[220:221], v6 offset:37120
  v_mfma_f32_16x16x32_bf16 v[116:119], a[224:227], a[148:151], v[116:119]
  ds_read_b64_tr_b16 a[222:223], v6 offset:43264
  v_mfma_f32_16x16x32_bf16 v[120:123], a[224:227], a[152:155], v[120:123]
  buffer_load_dwordx4 v22, s[8:11], s54 offen offset:0  lds
  v_mfma_f32_16x16x32_bf16 v[120:123], a[228:231], a[168:171], v[120:123]
  v_mfma_f32_16x16x32_bf16 v[124:127], a[228:231], a[172:175], v[124:127]
  s_waitcnt lgkmcnt(6)
  v_mfma_f32_16x16x32_bf16 v[124:127], a[224:227], a[156:159], v[124:127]
  buffer_load_dwordx4 v23, s[8:11], s54 offen offset:1024  lds
  v_mfma_f32_16x16x32_bf16 a[76:79], a[208:211], a[156:159], a[76:79]
  s_waitcnt lgkmcnt(4)
  ds_read_b64_tr_b16 a[224:225], v6 offset:24840
  v_mfma_f32_16x16x32_bf16 a[76:79], a[212:215], a[172:175], a[76:79]
  ds_read_b64_tr_b16 a[226:227], v6 offset:30984
  v_mfma_f32_16x16x32_bf16 a[72:75], a[212:215], a[168:171], a[72:75]
  ds_read_b64_tr_b16 a[228:229], v6 offset:37128
  v_mfma_f32_16x16x32_bf16 a[72:75], a[208:211], a[152:155], a[72:75]
  ds_read_b64_tr_b16 a[230:231], v6 offset:43272
  v_mfma_f32_16x16x32_bf16 a[68:71], a[208:211], a[148:151], a[68:71]
  buffer_load_dwordx4 v24, s[8:11], s54 offen offset:2048  lds
  v_mfma_f32_16x16x32_bf16 a[68:71], a[212:215], a[164:167], a[68:71]
  v_mfma_f32_16x16x32_bf16 a[64:67], a[212:215], a[160:163], a[64:67]
  s_waitcnt lgkmcnt(4)
  v_mfma_f32_16x16x32_bf16 a[64:67], a[208:211], a[144:147], a[64:67]
  s_add_u32 m0, s74, 12288
  v_mfma_f32_16x16x32_bf16 v[128:131], a[216:219], a[144:147], v[128:131]
  s_mov_b32 s55, 786432
  ds_read_b64_tr_b16 a[208:209], v15 offset:0
  v_mfma_f32_16x16x32_bf16 v[128:131], a[220:223], a[160:163], v[128:131]
  ds_read_b64_tr_b16 a[210:211], v15 offset:1536
  v_mfma_f32_16x16x32_bf16 v[132:135], a[220:223], a[164:167], v[132:135]
  ds_read_b64_tr_b16 a[212:213], v15 offset:6144
  v_mfma_f32_16x16x32_bf16 v[132:135], a[216:219], a[148:151], v[132:135]
  ds_read_b64_tr_b16 a[214:215], v15 offset:7680
  v_mfma_f32_16x16x32_bf16 v[136:139], a[216:219], a[152:155], v[136:139]
  buffer_load_dwordx4 v25, s[12:15], s55 offen offset:0  lds
  v_mfma_f32_16x16x32_bf16 v[136:139], a[220:223], a[168:171], v[136:139]
  v_mfma_f32_16x16x32_bf16 v[140:143], a[220:223], a[172:175], v[140:143]
  v_mfma_f32_16x16x32_bf16 v[140:143], a[216:219], a[156:159], v[140:143]
  s_waitcnt lgkmcnt(6)
  v_mfma_f32_16x16x32_bf16 v[252:255], a[224:227], a[156:159], v[252:255]
  s_waitcnt lgkmcnt(4)
  ds_read_b64_tr_b16 a[216:217], v15 offset:3072
  v_mfma_f32_16x16x32_bf16 v[252:255], a[228:231], a[172:175], v[252:255]
  ds_read_b64_tr_b16 a[218:219], v15 offset:4608
  v_mfma_f32_16x16x32_bf16 v[248:251], a[228:231], a[168:171], v[248:251]
  ds_read_b64_tr_b16 a[220:221], v15 offset:9216
  v_mfma_f32_16x16x32_bf16 v[248:251], a[224:227], a[152:155], v[248:251]
  ds_read_b64_tr_b16 a[222:223], v15 offset:10752
  v_mfma_f32_16x16x32_bf16 v[244:247], a[224:227], a[148:151], v[244:247]
  s_add_u32 s56, s75, 32768
  v_mfma_f32_16x16x32_bf16 v[244:247], a[228:231], a[164:167], v[244:247]
  buffer_load_dwordx4 a[80:83], v42, s[4:7], s56 offen offset:0 sc1
  v_mfma_f32_16x16x32_bf16 v[240:243], a[228:231], a[160:163], v[240:243]
  v_mfma_f32_16x16x32_bf16 v[240:243], a[224:227], a[144:147], v[240:243]
  s_waitcnt lgkmcnt(6)
  v_mfma_f32_16x16x32_bf16 v[192:195], a[208:211], a[144:147], v[192:195]
  s_waitcnt lgkmcnt(4)
  ds_read_b64_tr_b16 a[224:225], v15 offset:32
  v_mfma_f32_16x16x32_bf16 v[192:195], a[212:215], a[160:163], v[192:195]
  ds_read_b64_tr_b16 a[226:227], v15 offset:1568
  v_mfma_f32_16x16x32_bf16 v[196:199], a[212:215], a[164:167], v[196:199]
  ds_read_b64_tr_b16 a[228:229], v15 offset:6176
  v_mfma_f32_16x16x32_bf16 v[196:199], a[208:211], a[148:151], v[196:199]
  ds_read_b64_tr_b16 a[230:231], v15 offset:7712
  v_mfma_f32_16x16x32_bf16 v[200:203], a[208:211], a[152:155], v[200:203]
  buffer_load_dwordx4 a[84:87], v43, s[4:7], s56 offen offset:0 sc1
  v_mfma_f32_16x16x32_bf16 v[200:203], a[212:215], a[168:171], v[200:203]
  v_mfma_f32_16x16x32_bf16 v[204:207], a[212:215], a[172:175], v[204:207]
  s_waitcnt lgkmcnt(6)
  v_mfma_f32_16x16x32_bf16 v[204:207], a[208:211], a[156:159], v[204:207]
  buffer_load_dwordx4 v26, s[12:15], s55 offen offset:1024  lds
  v_mfma_f32_16x16x32_bf16 v[156:159], a[216:219], a[156:159], v[156:159]
  s_waitcnt lgkmcnt(4)
  ds_read_b64_tr_b16 a[208:209], v15 offset:3104
  v_mfma_f32_16x16x32_bf16 v[156:159], a[220:223], a[172:175], v[156:159]
  ds_read_b64_tr_b16 a[210:211], v15 offset:4640
  v_mfma_f32_16x16x32_bf16 v[152:155], a[220:223], a[168:171], v[152:155]
  ds_read_b64_tr_b16 a[212:213], v15 offset:9248
  v_mfma_f32_16x16x32_bf16 v[152:155], a[216:219], a[152:155], v[152:155]
  ds_read_b64_tr_b16 a[214:215], v15 offset:10784
  v_mfma_f32_16x16x32_bf16 v[148:151], a[216:219], a[148:151], v[148:151]
  v_mfma_f32_16x16x32_bf16 v[148:151], a[220:223], a[164:167], v[148:151]
  v_mfma_f32_16x16x32_bf16 v[144:147], a[220:223], a[160:163], v[144:147]
  v_mfma_f32_16x16x32_bf16 v[144:147], a[216:219], a[144:147], v[144:147]
  s_waitcnt lgkmcnt(6)
  v_mfma_f32_16x16x32_bf16 v[160:163], a[224:227], a[144:147], v[160:163]
  s_waitcnt lgkmcnt(4)
  ds_read_b64_tr_b16 a[216:217], v15 offset:64
  v_mfma_f32_16x16x32_bf16 v[160:163], a[228:231], a[160:163], v[160:163]
  ds_read_b64_tr_b16 a[218:219], v15 offset:1600
  v_mfma_f32_16x16x32_bf16 v[164:167], a[228:231], a[164:167], v[164:167]
  ds_read_b64_tr_b16 a[220:221], v15 offset:6208
  v_mfma_f32_16x16x32_bf16 v[164:167], a[224:227], a[148:151], v[164:167]
  ds_read_b64_tr_b16 a[222:223], v15 offset:7744
  v_mfma_f32_16x16x32_bf16 v[168:171], a[224:227], a[152:155], v[168:171]
  buffer_load_dwordx4 a[88:91], v46, s[4:7], s56 offen offset:0 sc1
  v_mfma_f32_16x16x32_bf16 v[168:171], a[228:231], a[168:171], v[168:171]
  v_mfma_f32_16x16x32_bf16 v[172:175], a[228:231], a[172:175], v[172:175]
  ds_read_b64_tr_b16 a[228:229], v15 offset:9280
  v_mfma_f32_16x16x32_bf16 v[172:175], a[224:227], a[156:159], v[172:175]
  s_waitcnt lgkmcnt(7)
  ds_read_b64_tr_b16 a[230:231], v15 offset:10816
  v_mfma_f32_16x16x32_bf16 v[188:191], a[208:211], a[156:159], v[188:191]
  s_waitcnt lgkmcnt(6)
  ds_read_b64_tr_b16 a[224:225], v15 offset:3136
  v_mfma_f32_16x16x32_bf16 v[188:191], a[212:215], a[172:175], v[188:191]
  ds_read_b64_tr_b16 a[226:227], v15 offset:4672
  v_mfma_f32_16x16x32_bf16 v[184:187], a[212:215], a[168:171], v[184:187]
  buffer_load_dwordx4 a[92:95], v47, s[4:7], s56 offen offset:0 sc1
  v_mfma_f32_16x16x32_bf16 v[184:187], a[208:211], a[152:155], v[184:187]
  v_mfma_f32_16x16x32_bf16 v[180:183], a[208:211], a[148:151], v[180:183]
  s_add_u32 s57, s75, 36864
  v_mfma_f32_16x16x32_bf16 v[180:183], a[212:215], a[164:167], v[180:183]
  buffer_load_dwordx4 a[96:99], v42, s[4:7], s57 offen offset:0 sc1
  v_mfma_f32_16x16x32_bf16 v[176:179], a[212:215], a[160:163], v[176:179]
  v_mfma_f32_16x16x32_bf16 v[176:179], a[208:211], a[144:147], v[176:179]
  s_waitcnt vmcnt(19) lgkmcnt(0)
  s_barrier
  v_mfma_f32_16x16x32_bf16 v[208:211], a[216:219], a[144:147], v[208:211]
  ds_read_b64_tr_b16 a[208:209], v9 offset:12288
  v_mfma_f32_16x16x32_bf16 v[208:211], a[220:223], a[160:163], v[208:211]
  ds_read_b64_tr_b16 a[210:211], v9 offset:18432
  v_mfma_f32_16x16x32_bf16 v[212:215], a[220:223], a[164:167], v[212:215]
  ds_read_b64_tr_b16 a[212:213], v9 offset:24576
  v_mfma_f32_16x16x32_bf16 v[212:215], a[216:219], a[148:151], v[212:215]
  ds_read_b64_tr_b16 a[214:215], v9 offset:30720
  v_mfma_f32_16x16x32_bf16 v[216:219], a[216:219], a[152:155], v[216:219]
  buffer_load_dwordx4 v27, s[12:15], s55 offen offset:2048  lds
  v_mfma_f32_16x16x32_bf16 v[216:219], a[220:223], a[168:171], v[216:219]
  v_mfma_f32_16x16x32_bf16 v[220:223], a[220:223], a[172:175], v[220:223]
  v_mfma_f32_16x16x32_bf16 v[220:223], a[216:219], a[156:159], v[220:223]
  v_mfma_f32_16x16x32_bf16 v[236:239], a[224:227], a[156:159], v[236:239]
  ds_read_b64_tr_b16 a[216:217], v9 offset:12296
  v_mfma_f32_16x16x32_bf16 v[236:239], a[228:231], a[172:175], v[236:239]
  ds_read_b64_tr_b16 a[218:219], v9 offset:18440
  v_mfma_f32_16x16x32_bf16 v[232:235], a[228:231], a[168:171], v[232:235]
  ds_read_b64_tr_b16 a[220:221], v9 offset:24584
  v_mfma_f32_16x16x32_bf16 v[232:235], a[224:227], a[152:155], v[232:235]
  ds_read_b64_tr_b16 a[222:223], v9 offset:30728
  v_mfma_f32_16x16x32_bf16 v[228:231], a[224:227], a[148:151], v[228:231]
  v_mfma_f32_16x16x32_bf16 v[228:231], a[228:231], a[164:167], v[228:231]
  v_mfma_f32_16x16x32_bf16 v[224:227], a[228:231], a[160:163], v[224:227]
  s_waitcnt lgkmcnt(6)
  v_mfma_f32_16x16x32_bf16 v[224:227], a[224:227], a[144:147], v[224:227]
  buffer_load_dwordx4 a[100:103], v43, s[4:7], s57 offen offset:0 sc1
  v_mfma_f32_16x16x32_bf16 v[48:51], a[208:211], a[176:179], v[48:51]
  s_waitcnt lgkmcnt(4)
  ds_read_b64_tr_b16 a[224:225], v10 offset:12288
  v_mfma_f32_16x16x32_bf16 v[48:51], a[212:215], a[192:195], v[48:51]
  s_waitcnt vmcnt(20)
  ds_read_b64_tr_b16 a[226:227], v10 offset:18432
  v_mfma_f32_16x16x32_bf16 v[52:55], a[212:215], a[196:199], v[52:55]
  ds_read_b64_tr_b16 a[228:229], v10 offset:24576
  v_mfma_f32_16x16x32_bf16 v[52:55], a[208:211], a[180:183], v[52:55]
  ds_read_b64_tr_b16 a[230:231], v10 offset:30720
  v_mfma_f32_16x16x32_bf16 v[56:59], a[208:211], a[184:187], v[56:59]
  buffer_load_dwordx4 a[104:107], v46, s[4:7], s57 offen offset:0 sc1
  s_waitcnt vmcnt(20)
  v_mfma_f32_16x16x32_bf16 v[56:59], a[212:215], a[200:203], v[56:59]
  s_waitcnt vmcnt(19)
  v_mfma_f32_16x16x32_bf16 v[60:63], a[212:215], a[204:207], v[60:63]
  v_mfma_f32_16x16x32_bf16 v[60:63], a[208:211], a[188:191], v[60:63]
  s_waitcnt lgkmcnt(6)
  v_mfma_f32_16x16x32_bf16 a[12:15], a[216:219], a[188:191], a[12:15]
  s_waitcnt lgkmcnt(4)
  ds_read_b64_tr_b16 a[208:209], v10 offset:12296
  v_mfma_f32_16x16x32_bf16 a[12:15], a[220:223], a[204:207], a[12:15]
  ds_read_b64_tr_b16 a[210:211], v10 offset:18440
  v_mfma_f32_16x16x32_bf16 a[8:11], a[220:223], a[200:203], a[8:11]
  ds_read_b64_tr_b16 a[212:213], v10 offset:24584
  v_mfma_f32_16x16x32_bf16 a[8:11], a[216:219], a[184:187], a[8:11]
  ds_read_b64_tr_b16 a[214:215], v10 offset:30728
  v_mfma_f32_16x16x32_bf16 a[4:7], a[216:219], a[180:183], a[4:7]
  buffer_load_dwordx4 a[108:111], v47, s[4:7], s57 offen offset:0 sc1
  v_mfma_f32_16x16x32_bf16 a[4:7], a[220:223], a[196:199], a[4:7]
  s_mov_b32 s58, 7077888
  v_mfma_f32_16x16x32_bf16 a[0:3], a[220:223], a[192:195], a[0:3]
  buffer_load_dword a255, v44, s[8:11], s58 offen
  v_mfma_f32_16x16x32_bf16 a[0:3], a[216:219], a[176:179], a[0:3]
  s_waitcnt lgkmcnt(6)
  s_mov_b32 s59, 1572864
  v_mfma_f32_16x16x32_bf16 v[64:67], a[224:227], a[176:179], v[64:67]
  s_waitcnt lgkmcnt(4)
  ds_read_b64_tr_b16 a[216:217], v9 offset:12416
  v_mfma_f32_16x16x32_bf16 v[64:67], a[228:231], a[192:195], v[64:67]
  buffer_load_dword a255, v45, s[12:15], s59 offen
  v_mfma_f32_16x16x32_bf16 v[68:71], a[228:231], a[196:199], v[68:71]
  ds_read_b64_tr_b16 a[220:221], v9 offset:24704
  v_mfma_f32_16x16x32_bf16 v[68:71], a[224:227], a[180:183], v[68:71]
  ds_read_b64_tr_b16 a[222:223], v9 offset:30848
  v_mfma_f32_16x16x32_bf16 v[72:75], a[224:227], a[184:187], v[72:75]
  ds_read_b64_tr_b16 a[218:219], v9 offset:18560
  v_mfma_f32_16x16x32_bf16 v[72:75], a[228:231], a[200:203], v[72:75]
  s_waitcnt lgkmcnt(6)
  v_mfma_f32_16x16x32_bf16 v[76:79], a[228:231], a[204:207], v[76:79]
  s_add_u32 m0, s74, 24576
  v_mfma_f32_16x16x32_bf16 v[76:79], a[224:227], a[188:191], v[76:79]
  s_mov_b32 s60, 3932160
  v_mfma_f32_16x16x32_bf16 a[28:31], a[208:211], a[188:191], a[28:31]
  s_waitcnt lgkmcnt(4)
  ds_read_b64_tr_b16 a[224:225], v9 offset:12424
  v_mfma_f32_16x16x32_bf16 a[28:31], a[212:215], a[204:207], a[28:31]
  ds_read_b64_tr_b16 a[226:227], v9 offset:18568
  v_mfma_f32_16x16x32_bf16 a[24:27], a[212:215], a[200:203], a[24:27]
  ds_read_b64_tr_b16 a[228:229], v9 offset:24712
  v_mfma_f32_16x16x32_bf16 a[24:27], a[208:211], a[184:187], a[24:27]
  buffer_load_dwordx4 v22, s[8:11], s60 offen offset:0  lds
  v_mfma_f32_16x16x32_bf16 a[20:23], a[208:211], a[180:183], a[20:23]
  ds_read_b64_tr_b16 a[230:231], v9 offset:30856
  v_mfma_f32_16x16x32_bf16 a[20:23], a[212:215], a[196:199], a[20:23]
  buffer_load_dwordx4 v23, s[8:11], s60 offen offset:1024  lds
  v_mfma_f32_16x16x32_bf16 a[16:19], a[212:215], a[192:195], a[16:19]
  v_mfma_f32_16x16x32_bf16 a[16:19], a[208:211], a[176:179], a[16:19]
  s_waitcnt lgkmcnt(4)
  v_mfma_f32_16x16x32_bf16 v[80:83], a[216:219], a[176:179], v[80:83]
  ds_read_b64_tr_b16 a[208:209], v10 offset:12416
  v_mfma_f32_16x16x32_bf16 v[80:83], a[220:223], a[192:195], v[80:83]
  ds_read_b64_tr_b16 a[210:211], v10 offset:18560
  v_mfma_f32_16x16x32_bf16 v[84:87], a[220:223], a[196:199], v[84:87]
  ds_read_b64_tr_b16 a[212:213], v10 offset:24704
  v_mfma_f32_16x16x32_bf16 v[84:87], a[216:219], a[180:183], v[84:87]
  ds_read_b64_tr_b16 a[214:215], v10 offset:30848
  v_mfma_f32_16x16x32_bf16 v[88:91], a[216:219], a[184:187], v[88:91]
  buffer_load_dwordx4 v24, s[8:11], s60 offen offset:2048  lds
  v_mfma_f32_16x16x32_bf16 v[88:91], a[220:223], a[200:203], v[88:91]
  s_add_u32 m0, s74, 36864
  v_mfma_f32_16x16x32_bf16 v[92:95], a[220:223], a[204:207], v[92:95]
  s_mov_b32 s3, 4325376
  v_mfma_f32_16x16x32_bf16 v[92:95], a[216:219], a[188:191], v[92:95]
  s_waitcnt lgkmcnt(6)
  buffer_load_dwordx4 v22, s[8:11], s3 offen offset:0  lds
  v_mfma_f32_16x16x32_bf16 a[44:47], a[224:227], a[188:191], a[44:47]
  s_waitcnt lgkmcnt(4)
  ds_read_b64_tr_b16 a[216:217], v10 offset:12424
  v_mfma_f32_16x16x32_bf16 a[44:47], a[228:231], a[204:207], a[44:47]
  ds_read_b64_tr_b16 a[218:219], v10 offset:18568
  v_mfma_f32_16x16x32_bf16 a[40:43], a[228:231], a[200:203], a[40:43]
  ds_read_b64_tr_b16 a[220:221], v10 offset:24712
  v_mfma_f32_16x16x32_bf16 a[40:43], a[224:227], a[184:187], a[40:43]
  ds_read_b64_tr_b16 a[222:223], v10 offset:30856
  v_mfma_f32_16x16x32_bf16 a[36:39], a[224:227], a[180:183], a[36:39]
  buffer_load_dwordx4 v23, s[8:11], s3 offen offset:1024  lds
  v_mfma_f32_16x16x32_bf16 a[36:39], a[228:231], a[196:199], a[36:39]
  v_mfma_f32_16x16x32_bf16 a[32:35], a[228:231], a[192:195], a[32:35]
  s_waitcnt lgkmcnt(6)
  v_mfma_f32_16x16x32_bf16 a[32:35], a[224:227], a[176:179], a[32:35]
  buffer_load_dwordx4 v24, s[8:11], s3 offen offset:2048  lds
  v_mfma_f32_16x16x32_bf16 v[96:99], a[208:211], a[176:179], v[96:99]
  s_waitcnt lgkmcnt(4)
  ds_read_b64_tr_b16 a[224:225], v9 offset:12544
  v_mfma_f32_16x16x32_bf16 v[96:99], a[212:215], a[192:195], v[96:99]
  ds_read_b64_tr_b16 a[226:227], v9 offset:18688
  v_mfma_f32_16x16x32_bf16 v[100:103], a[212:215], a[196:199], v[100:103]
  ds_read_b64_tr_b16 a[228:229], v9 offset:24832
  v_mfma_f32_16x16x32_bf16 v[100:103], a[208:211], a[180:183], v[100:103]
  s_add_u32 m0, s74, 49152
  ds_read_b64_tr_b16 a[230:231], v9 offset:30976
  v_mfma_f32_16x16x32_bf16 v[104:107], a[208:211], a[184:187], v[104:107]
  s_mov_b32 s61, 983040
  v_mfma_f32_16x16x32_bf16 v[104:107], a[212:215], a[200:203], v[104:107]
  buffer_load_dwordx4 v25, s[12:15], s61 offen offset:0  lds
  v_mfma_f32_16x16x32_bf16 v[108:111], a[212:215], a[204:207], v[108:111]
  v_mfma_f32_16x16x32_bf16 v[108:111], a[208:211], a[188:191], v[108:111]
  s_waitcnt lgkmcnt(6)
  v_mfma_f32_16x16x32_bf16 a[60:63], a[216:219], a[188:191], a[60:63]
  s_waitcnt lgkmcnt(4)
  ds_read_b64_tr_b16 a[208:209], v9 offset:12552
  v_mfma_f32_16x16x32_bf16 a[60:63], a[220:223], a[204:207], a[60:63]
  ds_read_b64_tr_b16 a[210:211], v9 offset:18696
  v_mfma_f32_16x16x32_bf16 a[56:59], a[220:223], a[200:203], a[56:59]
  ds_read_b64_tr_b16 a[212:213], v9 offset:24840
  v_mfma_f32_16x16x32_bf16 a[56:59], a[216:219], a[184:187], a[56:59]
  ds_read_b64_tr_b16 a[214:215], v9 offset:30984
  v_mfma_f32_16x16x32_bf16 a[52:55], a[216:219], a[180:183], a[52:55]
  v_mfma_f32_16x16x32_bf16 a[52:55], a[220:223], a[196:199], a[52:55]
  v_mfma_f32_16x16x32_bf16 a[48:51], a[220:223], a[192:195], a[48:51]
  v_mfma_f32_16x16x32_bf16 a[48:51], a[216:219], a[176:179], a[48:51]
  s_waitcnt lgkmcnt(4)
  v_mfma_f32_16x16x32_bf16 v[112:115], a[224:227], a[176:179], v[112:115]
  s_add_u32 s64, s75, 40960
  ds_read_b64_tr_b16 a[216:217], v10 offset:12544
  v_mfma_f32_16x16x32_bf16 v[112:115], a[228:231], a[192:195], v[112:115]
  ds_read_b64_tr_b16 a[218:219], v10 offset:18688
  v_mfma_f32_16x16x32_bf16 v[116:119], a[228:231], a[196:199], v[116:119]
  ds_read_b64_tr_b16 a[220:221], v10 offset:24832
  v_mfma_f32_16x16x32_bf16 v[116:119], a[224:227], a[180:183], v[116:119]
  ds_read_b64_tr_b16 a[222:223], v10 offset:30976
  v_mfma_f32_16x16x32_bf16 v[120:123], a[224:227], a[184:187], v[120:123]
  buffer_load_dwordx4 a[112:115], v42, s[4:7], s64 offen offset:0 sc1
  v_mfma_f32_16x16x32_bf16 v[120:123], a[228:231], a[200:203], v[120:123]
  v_mfma_f32_16x16x32_bf16 v[124:127], a[228:231], a[204:207], v[124:127]
  buffer_load_dwordx4 a[116:119], v43, s[4:7], s64 offen offset:0 sc1
  v_mfma_f32_16x16x32_bf16 v[124:127], a[224:227], a[188:191], v[124:127]
  s_waitcnt lgkmcnt(6)
  v_mfma_f32_16x16x32_bf16 a[76:79], a[208:211], a[188:191], a[76:79]
  s_waitcnt lgkmcnt(4)
  ds_read_b64_tr_b16 a[224:225], v10 offset:12552
  v_mfma_f32_16x16x32_bf16 a[76:79], a[212:215], a[204:207], a[76:79]
L_pg3:
  s_cbranch_execz L_hop0
  ds_read_b64_tr_b16 a[226:227], v10 offset:18696
  v_mfma_f32_16x16x32_bf16 a[72:75], a[212:215], a[200:203], a[72:75]
  ds_read_b64_tr_b16 a[228:229], v10 offset:24840
  v_mfma_f32_16x16x32_bf16 a[72:75], a[208:211], a[184:187], a[72:75]
  ds_read_b64_tr_b16 a[230:231], v10 offset:30984
  v_mfma_f32_16x16x32_bf16 a[68:71], a[208:211], a[180:183], a[68:71]
  buffer_load_dwordx4 v26, s[12:15], s61 offen offset:1024  lds
  v_mfma_f32_16x16x32_bf16 a[68:71], a[212:215], a[196:199], a[68:71]
  v_mfma_f32_16x16x32_bf16 a[64:67], a[212:215], a[192:195], a[64:67]
  v_mfma_f32_16x16x32_bf16 a[64:67], a[208:211], a[176:179], a[64:67]
  s_waitcnt lgkmcnt(6)
  v_mfma_f32_16x16x32_bf16 v[128:131], a[216:219], a[176:179], v[128:131]
  s_waitcnt lgkmcnt(4)
  ds_read_b64_tr_b16 a[208:209], v15 offset:36864
  v_mfma_f32_16x16x32_bf16 v[128:131], a[220:223], a[192:195], v[128:131]
  ds_read_b64_tr_b16 a[210:211], v15 offset:38400
  v_mfma_f32_16x16x32_bf16 v[132:135], a[220:223], a[196:199], v[132:135]
  ds_read_b64_tr_b16 a[212:213], v15 offset:43008
  v_mfma_f32_16x16x32_bf16 v[132:135], a[216:219], a[180:183], v[132:135]
  ds_read_b64_tr_b16 a[214:215], v15 offset:44544
  v_mfma_f32_16x16x32_bf16 v[136:139], a[216:219], a[184:187], v[136:139]
  v_mfma_f32_16x16x32_bf16 v[136:139], a[220:223], a[200:203], v[136:139]
  v_mfma_f32_16x16x32_bf16 v[140:143], a[220:223], a[204:207], v[140:143]
  v_mfma_f32_16x16x32_bf16 v[140:143], a[216:219], a[188:191], v[140:143]
  s_waitcnt lgkmcnt(6)
  v_mfma_f32_16x16x32_bf16 v[252:255], a[224:227], a[188:191], v[252:255]
  s_waitcnt lgkmcnt(4)
  ds_read_b64_tr_b16 a[216:217], v15 offset:39936
  v_mfma_f32_16x16x32_bf16 v[252:255], a[228:231], a[204:207], v[252:255]
  ds_read_b64_tr_b16 a[218:219], v15 offset:41472
  v_mfma_f32_16x16x32_bf16 v[248:251], a[228:231], a[200:203], v[248:251]
  ds_read_b64_tr_b16 a[220:221], v15 offset:46080
  v_mfma_f32_16x16x32_bf16 v[248:251], a[224:227], a[184:187], v[248:251]
  ds_read_b64_tr_b16 a[222:223], v15 offset:47616
  v_mfma_f32_16x16x32_bf16 v[244:247], a[224:227], a[180:183], v[244:247]
  buffer_load_dwordx4 a[120:123], v46, s[4:7], s64 offen offset:0 sc1
  v_mfma_f32_16x16x32_bf16 v[244:247], a[228:231], a[196:199], v[244:247]
  buffer_load_dwordx4 a[124:127], v47, s[4:7], s64 offen offset:0 sc1
  v_mfma_f32_16x16x32_bf16 v[240:243], a[228:231], a[192:195], v[240:243]
  v_mfma_f32_16x16x32_bf16 v[240:243], a[224:227], a[176:179], v[240:243]
  s_waitcnt lgkmcnt(4)
  v_mfma_f32_16x16x32_bf16 v[192:195], a[208:211], a[176:179], v[192:195]
  s_add_u32 s65, s75, 45056
  ds_read_b64_tr_b16 a[224:225], v15 offset:36896
  v_mfma_f32_16x16x32_bf16 v[192:195], a[212:215], a[192:195], v[192:195]
  ds_read_b64_tr_b16 a[226:227], v15 offset:38432
  v_mfma_f32_16x16x32_bf16 v[196:199], a[212:215], a[196:199], v[196:199]
  ds_read_b64_tr_b16 a[228:229], v15 offset:43040
  v_mfma_f32_16x16x32_bf16 v[196:199], a[208:211], a[180:183], v[196:199]
  ds_read_b64_tr_b16 a[230:231], v15 offset:44576
  v_mfma_f32_16x16x32_bf16 v[200:203], a[208:211], a[184:187], v[200:203]
  buffer_load_dwordx4 a[128:131], v42, s[4:7], s65 offen offset:0 sc1
  v_mfma_f32_16x16x32_bf16 v[200:203], a[212:215], a[200:203], v[200:203]
  v_mfma_f32_16x16x32_bf16 v[204:207], a[212:215], a[204:207], v[204:207]
  buffer_load_dwordx4 v27, s[12:15], s61 offen offset:2048  lds
  v_mfma_f32_16x16x32_bf16 v[204:207], a[208:211], a[188:191], v[204:207]
  s_waitcnt lgkmcnt(6)
  v_mfma_f32_16x16x32_bf16 v[156:159], a[216:219], a[188:191], v[156:159]
  s_waitcnt lgkmcnt(4)
  ds_read_b64_tr_b16 a[208:209], v15 offset:39968
  v_mfma_f32_16x16x32_bf16 v[156:159], a[220:223], a[204:207], v[156:159]
  ds_read_b64_tr_b16 a[210:211], v15 offset:41504
  v_mfma_f32_16x16x32_bf16 v[152:155], a[220:223], a[200:203], v[152:155]
  ds_read_b64_tr_b16 a[212:213], v15 offset:46112
  v_mfma_f32_16x16x32_bf16 v[152:155], a[216:219], a[184:187], v[152:155]
  ds_read_b64_tr_b16 a[214:215], v15 offset:47648
  v_mfma_f32_16x16x32_bf16 v[148:151], a[216:219], a[180:183], v[148:151]
  v_mfma_f32_16x16x32_bf16 v[148:151], a[220:223], a[196:199], v[148:151]
  v_mfma_f32_16x16x32_bf16 v[144:147], a[220:223], a[192:195], v[144:147]
  v_mfma_f32_16x16x32_bf16 v[144:147], a[216:219], a[176:179], v[144:147]
  s_waitcnt lgkmcnt(6)
  v_mfma_f32_16x16x32_bf16 v[160:163], a[224:227], a[176:179], v[160:163]
  s_waitcnt lgkmcnt(4)
  ds_read_b64_tr_b16 a[216:217], v15 offset:36928
  v_mfma_f32_16x16x32_bf16 v[160:163], a[228:231], a[192:195], v[160:163]
  ds_read_b64_tr_b16 a[218:219], v15 offset:38464
  v_mfma_f32_16x16x32_bf16 v[164:167], a[228:231], a[196:199], v[164:167]
  ds_read_b64_tr_b16 a[220:221], v15 offset:43072
  v_mfma_f32_16x16x32_bf16 v[164:167], a[224:227], a[180:183], v[164:167]
  ds_read_b64_tr_b16 a[222:223], v15 offset:44608
  v_mfma_f32_16x16x32_bf16 v[168:171], a[224:227], a[184:187], v[168:171]
  buffer_load_dwordx4 a[132:135], v43, s[4:7], s65 offen offset:0 sc1
  v_mfma_f32_16x16x32_bf16 v[168:171], a[228:231], a[200:203], v[168:171]
  v_mfma_f32_16x16x32_bf16 v[172:175], a[228:231], a[204:207], v[172:175]
  ds_read_b64_tr_b16 a[228:229], v15 offset:46144
  v_mfma_f32_16x16x32_bf16 v[172:175], a[224:227], a[188:191], v[172:175]
  s_waitcnt lgkmcnt(7)
  ds_read_b64_tr_b16 a[230:231], v15 offset:47680
  v_mfma_f32_16x16x32_bf16 v[188:191], a[208:211], a[188:191], v[188:191]
  s_waitcnt lgkmcnt(6)
  ds_read_b64_tr_b16 a[224:225], v15 offset:40000
  v_mfma_f32_16x16x32_bf16 v[188:191], a[212:215], a[204:207], v[188:191]
  ds_read_b64_tr_b16 a[226:227], v15 offset:41536
  v_mfma_f32_16x16x32_bf16 v[184:187], a[212:215], a[200:203], v[184:187]
  buffer_load_dwordx4 a[136:139], v46, s[4:7], s65 offen offset:0 sc1
  v_mfma_f32_16x16x32_bf16 v[184:187], a[208:211], a[184:187], v[184:187]
  v_mfma_f32_16x16x32_bf16 v[180:183], a[208:211], a[180:183], v[180:183]
  v_mfma_f32_16x16x32_bf16 v[180:183], a[212:215], a[196:199], v[180:183]
  buffer_load_dwordx4 a[140:143], v47, s[4:7], s65 offen offset:0 sc1
  v_mfma_f32_16x16x32_bf16 v[176:179], a[212:215], a[192:195], v[176:179]
  v_mfma_f32_16x16x32_bf16 v[176:179], a[208:211], a[176:179], v[176:179]
  s_waitcnt vmcnt(22) lgkmcnt(0)
  s_barrier
  v_mfma_f32_16x16x32_bf16 v[208:211], a[216:219], a[176:179], v[208:211]
  s_add_u32 m0, s74, 61440
  ds_read_b64_tr_b16 a[208:209], v9 offset:49152
  v_mfma_f32_16x16x32_bf16 v[208:211], a[220:223], a[192:195], v[208:211]
  s_mov_b32 s62, 4718592
  ds_read_b64_tr_b16 a[210:211], v9 offset:55296
  v_mfma_f32_16x16x32_bf16 v[212:215], a[220:223], a[196:199], v[212:215]
  ds_read_b64_tr_b16 a[212:213], v1 offset:0
  v_mfma_f32_16x16x32_bf16 v[212:215], a[216:219], a[180:183], v[212:215]
  ds_read_b64_tr_b16 a[214:215], v1 offset:6144
  v_mfma_f32_16x16x32_bf16 v[216:219], a[216:219], a[184:187], v[216:219]
  buffer_load_dwordx4 v22, s[8:11], s62 offen offset:0  lds
  v_mfma_f32_16x16x32_bf16 v[216:219], a[220:223], a[200:203], v[216:219]
  v_mfma_f32_16x16x32_bf16 v[220:223], a[220:223], a[204:207], v[220:223]
  buffer_load_dwordx4 v23, s[8:11], s62 offen offset:1024  lds
  v_mfma_f32_16x16x32_bf16 v[220:223], a[216:219], a[188:191], v[220:223]
  v_mfma_f32_16x16x32_bf16 v[236:239], a[224:227], a[188:191], v[236:239]
  ds_read_b64_tr_b16 a[216:217], v9 offset:49160
  v_mfma_f32_16x16x32_bf16 v[236:239], a[228:231], a[204:207], v[236:239]
  ds_read_b64_tr_b16 a[218:219], v9 offset:55304
  v_mfma_f32_16x16x32_bf16 v[232:235], a[228:231], a[200:203], v[232:235]
  ds_read_b64_tr_b16 a[220:221], v1 offset:8
  v_mfma_f32_16x16x32_bf16 v[232:235], a[224:227], a[184:187], v[232:235]
  ds_read_b64_tr_b16 a[222:223], v1 offset:6152
  v_mfma_f32_16x16x32_bf16 v[228:231], a[224:227], a[180:183], v[228:231]
  buffer_load_dwordx4 v24, s[8:11], s62 offen offset:2048  lds
  v_mfma_f32_16x16x32_bf16 v[228:231], a[228:231], a[196:199], v[228:231]
  v_mfma_f32_16x16x32_bf16 v[224:227], a[228:231], a[192:195], v[224:227]
  s_waitcnt lgkmcnt(4)
  v_mfma_f32_16x16x32_bf16 v[224:227], a[224:227], a[176:179], v[224:227]
  s_add_u32 m0, s74, 73728
  v_mfma_f32_16x16x32_bf16 v[48:51], a[208:211], a[80:83], v[48:51]
  s_mov_b32 s66, 5111808
  ds_read_b64_tr_b16 a[224:225], v10 offset:49152
  v_mfma_f32_16x16x32_bf16 v[48:51], a[212:215], a[96:99], v[48:51]
  s_waitcnt vmcnt(24)
  ds_read_b64_tr_b16 a[226:227], v10 offset:55296
  v_mfma_f32_16x16x32_bf16 v[52:55], a[212:215], a[100:103], v[52:55]
  ds_read_b64_tr_b16 a[228:229], v2 offset:0
  v_mfma_f32_16x16x32_bf16 v[52:55], a[208:211], a[84:87], v[52:55]
  ds_read_b64_tr_b16 a[230:231], v2 offset:6144
  v_mfma_f32_16x16x32_bf16 v[56:59], a[208:211], a[88:91], v[56:59]
  buffer_load_dwordx4 v22, s[8:11], s66 offen offset:0  lds
  s_waitcnt vmcnt(24)
  v_mfma_f32_16x16x32_bf16 v[56:59], a[212:215], a[104:107], v[56:59]
  buffer_load_dwordx4 v23, s[8:11], s66 offen offset:1024  lds
  s_waitcnt vmcnt(24)
  v_mfma_f32_16x16x32_bf16 v[60:63], a[212:215], a[108:111], v[60:63]
  v_mfma_f32_16x16x32_bf16 v[60:63], a[208:211], a[92:95], v[60:63]
  s_waitcnt lgkmcnt(6)
  v_mfma_f32_16x16x32_bf16 a[12:15], a[216:219], a[92:95], a[12:15]
  s_waitcnt lgkmcnt(4)
  ds_read_b64_tr_b16 a[208:209], v10 offset:49160
  v_mfma_f32_16x16x32_bf16 a[12:15], a[220:223], a[108:111], a[12:15]
  ds_read_b64_tr_b16 a[210:211], v10 offset:55304
  v_mfma_f32_16x16x32_bf16 a[8:11], a[220:223], a[104:107], a[8:11]
  ds_read_b64_tr_b16 a[212:213], v2 offset:8
  v_mfma_f32_16x16x32_bf16 a[8:11], a[216:219], a[88:91], a[8:11]
  ds_read_b64_tr_b16 a[214:215], v2 offset:6152
  v_mfma_f32_16x16x32_bf16 a[4:7], a[216:219], a[84:87], a[4:7]
  buffer_load_dwordx4 v24, s[8:11], s66 offen offset:2048  lds
  v_mfma_f32_16x16x32_bf16 a[4:7], a[220:223], a[100:103], a[4:7]
  s_add_u32 m0, s74, 86016
  v_mfma_f32_16x16x32_bf16 a[0:3], a[220:223], a[96:99], a[0:3]
  s_mov_b32 s50, 1179648
  v_mfma_f32_16x16x32_bf16 a[0:3], a[216:219], a[80:83], a[0:3]
  s_waitcnt lgkmcnt(6)
  buffer_load_dwordx4 v25, s[12:15], s50 offen offset:0  lds
  v_mfma_f32_16x16x32_bf16 v[64:67], a[224:227], a[80:83], v[64:67]
  s_waitcnt lgkmcnt(4)
  ds_read_b64_tr_b16 a[216:217], v9 offset:49280
  v_mfma_f32_16x16x32_bf16 v[64:67], a[228:231], a[96:99], v[64:67]
  ds_read_b64_tr_b16 a[218:219], v9 offset:55424
  v_mfma_f32_16x16x32_bf16 v[68:71], a[228:231], a[100:103], v[68:71]
  ds_read_b64_tr_b16 a[220:221], v1 offset:128
  v_mfma_f32_16x16x32_bf16 v[68:71], a[224:227], a[84:87], v[68:71]
  ds_read_b64_tr_b16 a[222:223], v1 offset:6272
  v_mfma_f32_16x16x32_bf16 v[72:75], a[224:227], a[88:91], v[72:75]
  v_mfma_f32_16x16x32_bf16 v[72:75], a[228:231], a[104:107], v[72:75]
  v_mfma_f32_16x16x32_bf16 v[76:79], a[228:231], a[108:111], v[76:79]
  v_mfma_f32_16x16x32_bf16 v[76:79], a[224:227], a[92:95], v[76:79]
  s_waitcnt lgkmcnt(6)
  v_mfma_f32_16x16x32_bf16 a[28:31], a[208:211], a[92:95], a[28:31]
  s_waitcnt lgkmcnt(4)
  ds_read_b64_tr_b16 a[224:225], v9 offset:49288
  v_mfma_f32_16x16x32_bf16 a[28:31], a[212:215], a[108:111], a[28:31]
  ds_read_b64_tr_b16 a[226:227], v9 offset:55432
  v_mfma_f32_16x16x32_bf16 a[24:27], a[212:215], a[104:107], a[24:27]
  s_add_u32 s67, s75, 49152
  ds_read_b64_tr_b16 a[228:229], v1 offset:136
  v_mfma_f32_16x16x32_bf16 a[24:27], a[208:211], a[88:91], a[24:27]
  ds_read_b64_tr_b16 a[230:231], v1 offset:6280
  v_mfma_f32_16x16x32_bf16 a[20:23], a[208:211], a[84:87], a[20:23]
  buffer_load_dwordx4 a[144:147], v42, s[4:7], s67 offen offset:0 sc1
  v_mfma_f32_16x16x32_bf16 a[20:23], a[212:215], a[100:103], a[20:23]
  v_mfma_f32_16x16x32_bf16 a[16:19], a[212:215], a[96:99], a[16:19]
  v_mfma_f32_16x16x32_bf16 a[16:19], a[208:211], a[80:83], a[16:19]
  s_waitcnt lgkmcnt(6)
  v_mfma_f32_16x16x32_bf16 v[80:83], a[216:219], a[80:83], v[80:83]
  s_waitcnt lgkmcnt(4)
  ds_read_b64_tr_b16 a[208:209], v10 offset:49280
  v_mfma_f32_16x16x32_bf16 v[80:83], a[220:223], a[96:99], v[80:83]
  ds_read_b64_tr_b16 a[210:211], v10 offset:55424
  v_mfma_f32_16x16x32_bf16 v[84:87], a[220:223], a[100:103], v[84:87]
  ds_read_b64_tr_b16 a[212:213], v2 offset:128
  v_mfma_f32_16x16x32_bf16 v[84:87], a[216:219], a[84:87], v[84:87]
  ds_read_b64_tr_b16 a[214:215], v2 offset:6272
  v_mfma_f32_16x16x32_bf16 v[88:91], a[216:219], a[88:91], v[88:91]
  buffer_load_dwordx4 a[148:151], v43, s[4:7], s67 offen offset:0 sc1
  v_mfma_f32_16x16x32_bf16 v[88:91], a[220:223], a[104:107], v[88:91]
  buffer_load_dwordx4 v26, s[12:15], s50 offen offset:1024  lds
  v_mfma_f32_16x16x32_bf16 v[92:95], a[220:223], a[108:111], v[92:95]
  v_mfma_f32_16x16x32_bf16 v[92:95], a[216:219], a[92:95], v[92:95]
  s_waitcnt lgkmcnt(6)
  v_mfma_f32_16x16x32_bf16 a[44:47], a[224:227], a[92:95], a[44:47]
  s_waitcnt lgkmcnt(4)
  ds_read_b64_tr_b16 a[216:217], v10 offset:49288
  v_mfma_f32_16x16x32_bf16 a[44:47], a[228:231], a[108:111], a[44:47]
  ds_read_b64_tr_b16 a[218:219], v10 offset:55432
  v_mfma_f32_16x16x32_bf16 a[40:43], a[228:231], a[104:107], a[40:43]
  ds_read_b64_tr_b16 a[220:221], v2 offset:136
  v_mfma_f32_16x16x32_bf16 a[40:43], a[224:227], a[88:91], a[40:43]
  ds_read_b64_tr_b16 a[222:223], v2 offset:6280
  v_mfma_f32_16x16x32_bf16 a[36:39], a[224:227], a[84:87], a[36:39]
  v_mfma_f32_16x16x32_bf16 a[36:39], a[228:231], a[100:103], a[36:39]
  v_mfma_f32_16x16x32_bf16 a[32:35], a[228:231], a[96:99], a[32:35]
  v_mfma_f32_16x16x32_bf16 a[32:35], a[224:227], a[80:83], a[32:35]
  s_waitcnt lgkmcnt(6)
  v_mfma_f32_16x16x32_bf16 v[96:99], a[208:211], a[80:83], v[96:99]
  s_waitcnt lgkmcnt(4)
  ds_read_b64_tr_b16 a[224:225], v9 offset:49408
  v_mfma_f32_16x16x32_bf16 v[96:99], a[212:215], a[96:99], v[96:99]
  ds_read_b64_tr_b16 a[226:227], v9 offset:55552
  v_mfma_f32_16x16x32_bf16 v[100:103], a[212:215], a[100:103], v[100:103]
  ds_read_b64_tr_b16 a[228:229], v1 offset:256
  v_mfma_f32_16x16x32_bf16 v[100:103], a[208:211], a[84:87], v[100:103]
  ds_read_b64_tr_b16 a[230:231], v1 offset:6400
  v_mfma_f32_16x16x32_bf16 v[104:107], a[208:211], a[88:91], v[104:107]
  buffer_load_dwordx4 a[152:155], v46, s[4:7], s67 offen offset:0 sc1
  v_mfma_f32_16x16x32_bf16 v[104:107], a[212:215], a[104:107], v[104:107]
  v_mfma_f32_16x16x32_bf16 v[108:111], a[212:215], a[108:111], v[108:111]
  buffer_load_dwordx4 a[156:159], v47, s[4:7], s67 offen offset:0 sc1
  v_mfma_f32_16x16x32_bf16 v[108:111], a[208:211], a[92:95], v[108:111]
  s_waitcnt lgkmcnt(6)
  v_mfma_f32_16x16x32_bf16 a[60:63], a[216:219], a[92:95], a[60:63]
  s_waitcnt lgkmcnt(4)
  ds_read_b64_tr_b16 a[208:209], v9 offset:49416
  v_mfma_f32_16x16x32_bf16 a[60:63], a[220:223], a[108:111], a[60:63]
  ds_read_b64_tr_b16 a[210:211], v9 offset:55560
  v_mfma_f32_16x16x32_bf16 a[56:59], a[220:223], a[104:107], a[56:59]
  s_add_u32 s63, s75, 53248
  ds_read_b64_tr_b16 a[212:213], v1 offset:264
  v_mfma_f32_16x16x32_bf16 a[56:59], a[216:219], a[88:91], a[56:59]
  ds_read_b64_tr_b16 a[214:215], v1 offset:6408
  v_mfma_f32_16x16x32_bf16 a[52:55], a[216:219], a[84:87], a[52:55]
  buffer_load_dwordx4 a[160:163], v42, s[4:7], s63 offen offset:0 sc1
  v_mfma_f32_16x16x32_bf16 a[52:55], a[220:223], a[100:103], a[52:55]
  v_mfma_f32_16x16x32_bf16 a[48:51], a[220:223], a[96:99], a[48:51]
  v_mfma_f32_16x16x32_bf16 a[48:51], a[216:219], a[80:83], a[48:51]
  s_waitcnt lgkmcnt(6)
  v_mfma_f32_16x16x32_bf16 v[112:115], a[224:227], a[80:83], v[112:115]
  s_waitcnt lgkmcnt(4)
  ds_read_b64_tr_b16 a[216:217], v10 offset:49408
  v_mfma_f32_16x16x32_bf16 v[112:115], a[228:231], a[96:99], v[112:115]
  ds_read_b64_tr_b16 a[218:219], v10 offset:55552
  v_mfma_f32_16x16x32_bf16 v[116:119], a[228:231], a[100:103], v[116:119]
  ds_read_b64_tr_b16 a[220:221], v2 offset:256
  v_mfma_f32_16x16x32_bf16 v[116:119], a[224:227], a[84:87], v[116:119]
  ds_read_b64_tr_b16 a[222:223], v2 offset:6400
  v_mfma_f32_16x16x32_bf16 v[120:123], a[224:227], a[88:91], v[120:123]
  buffer_load_dwordx4 v27, s[12:15], s50 offen offset:2048  lds
  v_mfma_f32_16x16x32_bf16 v[120:123], a[228:231], a[104:107], v[120:123]
  v_mfma_f32_16x16x32_bf16 v[124:127], a[228:231], a[108:111], v[124:127]
  v_mfma_f32_16x16x32_bf16 v[124:127], a[224:227], a[92:95], v[124:127]
  s_waitcnt lgkmcnt(6)
  v_mfma_f32_16x16x32_bf16 a[76:79], a[208:211], a[92:95], a[76:79]
  s_waitcnt lgkmcnt(4)
  ds_read_b64_tr_b16 a[224:225], v10 offset:49416
  v_mfma_f32_16x16x32_bf16 a[76:79], a[212:215], a[108:111], a[76:79]
  ds_read_b64_tr_b16 a[226:227], v10 offset:55560
  v_mfma_f32_16x16x32_bf16 a[72:75], a[212:215], a[104:107], a[72:75]
  ds_read_b64_tr_b16 a[228:229], v2 offset:264
  v_mfma_f32_16x16x32_bf16 a[72:75], a[208:211], a[88:91], a[72:75]
  ds_read_b64_tr_b16 a[230:231], v2 offset:6408
  v_mfma_f32_16x16x32_bf16 a[68:71], a[208:211], a[84:87], a[68:71]
  v_mfma_f32_16x16x32_bf16 a[68:71], a[212:215], a[100:103], a[68:71]
  buffer_load_dwordx4 a[164:167], v43, s[4:7], s63 offen offset:0 sc1
  v_mfma_f32_16x16x32_bf16 a[64:67], a[212:215], a[96:99], a[64:67]
  v_mfma_f32_16x16x32_bf16 a[64:67], a[208:211], a[80:83], a[64:67]
  s_waitcnt lgkmcnt(6)
  v_mfma_f32_16x16x32_bf16 v[128:131], a[216:219], a[80:83], v[128:131]
  s_waitcnt lgkmcnt(4)
  ds_read_b64_tr_b16 a[208:209], v13 offset:12288
  v_mfma_f32_16x16x32_bf16 v[128:131], a[220:223], a[96:99], v[128:131]
  ds_read_b64_tr_b16 a[210:211], v13 offset:13824
  v_mfma_f32_16x16x32_bf16 v[132:135], a[220:223], a[100:103], v[132:135]
  ds_read_b64_tr_b16 a[212:213], v13 offset:18432
  v_mfma_f32_16x16x32_bf16 v[132:135], a[216:219], a[84:87], v[132:135]
  ds_read_b64_tr_b16 a[214:215], v13 offset:19968
  v_mfma_f32_16x16x32_bf16 v[136:139], a[216:219], a[88:91], v[136:139]
  buffer_load_dwordx4 a[168:171], v46, s[4:7], s63 offen offset:0 sc1
  v_mfma_f32_16x16x32_bf16 v[136:139], a[220:223], a[104:107], v[136:139]
  v_mfma_f32_16x16x32_bf16 v[140:143], a[220:223], a[108:111], v[140:143]
  s_waitcnt lgkmcnt(6)
  v_mfma_f32_16x16x32_bf16 v[140:143], a[216:219], a[92:95], v[140:143]
  buffer_load_dwordx4 a[172:175], v47, s[4:7], s63 offen offset:0 sc1
  v_mfma_f32_16x16x32_bf16 v[252:255], a[224:227], a[92:95], v[252:255]
  s_waitcnt lgkmcnt(4)
  ds_read_b64_tr_b16 a[216:217], v13 offset:15360
  v_mfma_f32_16x16x32_bf16 v[252:255], a[228:231], a[108:111], v[252:255]
  ds_read_b64_tr_b16 a[218:219], v13 offset:16896
  v_mfma_f32_16x16x32_bf16 v[248:251], a[228:231], a[104:107], v[248:251]
  s_add_u32 m0, s74, 98304
  ds_read_b64_tr_b16 a[220:221], v13 offset:21504
  v_mfma_f32_16x16x32_bf16 v[248:251], a[224:227], a[88:91], v[248:251]
  s_mov_b32 s48, 1376256
  ds_read_b64_tr_b16 a[222:223], v13 offset:23040
  v_mfma_f32_16x16x32_bf16 v[244:247], a[224:227], a[84:87], v[244:247]
  buffer_load_dwordx4 v25, s[12:15], s48 offen offset:0  lds
  v_mfma_f32_16x16x32_bf16 v[244:247], a[228:231], a[100:103], v[244:247]
  v_mfma_f32_16x16x32_bf16 v[240:243], a[228:231], a[96:99], v[240:243]
  v_mfma_f32_16x16x32_bf16 v[240:243], a[224:227], a[80:83], v[240:243]
  s_waitcnt lgkmcnt(6)
  v_mfma_f32_16x16x32_bf16 v[192:195], a[208:211], a[80:83], v[192:195]
  s_waitcnt lgkmcnt(4)
  ds_read_b64_tr_b16 a[224:225], v13 offset:12320
  v_mfma_f32_16x16x32_bf16 v[192:195], a[212:215], a[96:99], v[192:195]
  ds_read_b64_tr_b16 a[226:227], v13 offset:13856
  v_mfma_f32_16x16x32_bf16 v[196:199], a[212:215], a[100:103], v[196:199]
  ds_read_b64_tr_b16 a[228:229], v13 offset:18464
  v_mfma_f32_16x16x32_bf16 v[196:199], a[208:211], a[84:87], v[196:199]
  ds_read_b64_tr_b16 a[230:231], v13 offset:20000
  v_mfma_f32_16x16x32_bf16 v[200:203], a[208:211], a[88:91], v[200:203]
  v_mfma_f32_16x16x32_bf16 v[200:203], a[212:215], a[104:107], v[200:203]
  v_mfma_f32_16x16x32_bf16 v[204:207], a[212:215], a[108:111], v[204:207]
  s_waitcnt lgkmcnt(6)
  v_mfma_f32_16x16x32_bf16 v[204:207], a[208:211], a[92:95], v[204:207]
  s_add_u32 s51, s75, 57344
  v_mfma_f32_16x16x32_bf16 v[156:159], a[216:219], a[92:95], v[156:159]
  s_waitcnt lgkmcnt(4)
  ds_read_b64_tr_b16 a[208:209], v13 offset:15392
  v_mfma_f32_16x16x32_bf16 v[156:159], a[220:223], a[108:111], v[156:159]
  ds_read_b64_tr_b16 a[210:211], v13 offset:16928
  v_mfma_f32_16x16x32_bf16 v[152:155], a[220:223], a[104:107], v[152:155]
  ds_read_b64_tr_b16 a[212:213], v13 offset:21536
  v_mfma_f32_16x16x32_bf16 v[152:155], a[216:219], a[88:91], v[152:155]
  ds_read_b64_tr_b16 a[214:215], v13 offset:23072
  v_mfma_f32_16x16x32_bf16 v[148:151], a[216:219], a[84:87], v[148:151]
  buffer_load_dwordx4 a[176:179], v42, s[4:7], s51 offen offset:0 sc1
  v_mfma_f32_16x16x32_bf16 v[148:151], a[220:223], a[100:103], v[148:151]
  buffer_load_dwordx4 a[180:183], v43, s[4:7], s51 offen offset:0 sc1
  v_mfma_f32_16x16x32_bf16 v[144:147], a[220:223], a[96:99], v[144:147]
  v_mfma_f32_16x16x32_bf16 v[144:147], a[216:219], a[80:83], v[144:147]
  s_waitcnt lgkmcnt(6)
  v_mfma_f32_16x16x32_bf16 v[160:163], a[224:227], a[80:83], v[160:163]
  s_waitcnt lgkmcnt(4)
  ds_read_b64_tr_b16 a[216:217], v13 offset:12352
  v_mfma_f32_16x16x32_bf16 v[160:163], a[228:231], a[96:99], v[160:163]
  ds_read_b64_tr_b16 a[220:221], v13 offset:18496
  v_mfma_f32_16x16x32_bf16 v[164:167], a[228:231], a[100:103], v[164:167]
  ds_read_b64_tr_b16 a[218:219], v13 offset:13888
  v_mfma_f32_16x16x32_bf16 v[164:167], a[224:227], a[84:87], v[164:167]
  ds_read_b64_tr_b16 a[222:223], v13 offset:20032
  v_mfma_f32_16x16x32_bf16 v[168:171], a[224:227], a[88:91], v[168:171]
  buffer_load_dwordx4 v26, s[12:15], s48 offen offset:1024  lds
  v_mfma_f32_16x16x32_bf16 v[168:171], a[228:231], a[104:107], v[168:171]
  s_lshr_b32 s49, s2, 3
  v_mfma_f32_16x16x32_bf16 v[172:175], a[228:231], a[108:111], v[172:175]
  s_lshl_b32 s49, s49, 2
  ds_read_b64_tr_b16 a[228:229], v13 offset:21568
  v_mfma_f32_16x16x32_bf16 v[172:175], a[224:227], a[92:95], v[172:175]
  s_waitcnt lgkmcnt(5)
  s_add_u32 s49, s49, s72
  ds_read_b64_tr_b16 a[230:231], v13 offset:23104
  v_mfma_f32_16x16x32_bf16 v[188:191], a[208:211], a[92:95], v[188:191]
  s_lshl_b32 s49, s49, 7
  ds_read_b64_tr_b16 a[224:225], v13 offset:15424
  v_mfma_f32_16x16x32_bf16 v[188:191], a[212:215], a[108:111], v[188:191]
  s_add_u32 s49, s49, 6144
  ds_read_b64_tr_b16 a[226:227], v13 offset:16960
  v_mfma_f32_16x16x32_bf16 v[184:187], a[212:215], a[104:107], v[184:187]
  v_mov_b32 v40, s49
  v_mfma_f32_16x16x32_bf16 v[184:187], a[208:211], a[88:91], v[184:187]
  s_getpc_b64 s[82:83]
  v_mfma_f32_16x16x32_bf16 v[180:183], a[208:211], a[84:87], v[180:183]
  global_load_dword v40, v40, s[82:83]
  v_mfma_f32_16x16x32_bf16 v[180:183], a[212:215], a[100:103], v[180:183]
  v_mfma_f32_16x16x32_bf16 v[176:179], a[212:215], a[96:99], v[176:179]
  v_mfma_f32_16x16x32_bf16 v[176:179], a[208:211], a[80:83], v[176:179]
  s_waitcnt vmcnt(25) lgkmcnt(0)
  s_barrier
  v_mfma_f32_16x16x32_bf16 v[208:211], a[216:219], a[80:83], v[208:211]
  ds_read_b64_tr_b16 a[208:209], v1 offset:24576
  v_mfma_f32_16x16x32_bf16 v[208:211], a[220:223], a[96:99], v[208:211]
  ds_read_b64_tr_b16 a[210:211], v1 offset:30720
  v_mfma_f32_16x16x32_bf16 v[212:215], a[220:223], a[100:103], v[212:215]
  ds_read_b64_tr_b16 a[212:213], v1 offset:36864
  v_mfma_f32_16x16x32_bf16 v[212:215], a[216:219], a[84:87], v[212:215]
  buffer_load_dwordx4 a[184:187], v46, s[4:7], s51 offen offset:0 sc1
  v_mfma_f32_16x16x32_bf16 v[216:219], a[216:219], a[88:91], v[216:219]
  ds_read_b64_tr_b16 a[214:215], v1 offset:43008
  v_mfma_f32_16x16x32_bf16 v[216:219], a[220:223], a[104:107], v[216:219]
  buffer_load_dwordx4 a[188:191], v47, s[4:7], s51 offen offset:0 sc1
  v_mfma_f32_16x16x32_bf16 v[220:223], a[220:223], a[108:111], v[220:223]
  v_mfma_f32_16x16x32_bf16 v[220:223], a[216:219], a[92:95], v[220:223]
  v_mfma_f32_16x16x32_bf16 v[236:239], a[224:227], a[92:95], v[236:239]
  s_add_u32 s52, s75, 61440
  ds_read_b64_tr_b16 a[216:217], v1 offset:24584
  v_mfma_f32_16x16x32_bf16 v[236:239], a[228:231], a[108:111], v[236:239]
  ds_read_b64_tr_b16 a[218:219], v1 offset:30728
  v_mfma_f32_16x16x32_bf16 v[232:235], a[228:231], a[104:107], v[232:235]
  ds_read_b64_tr_b16 a[220:221], v1 offset:36872
  v_mfma_f32_16x16x32_bf16 v[232:235], a[224:227], a[88:91], v[232:235]
  ds_read_b64_tr_b16 a[222:223], v1 offset:43016
  v_mfma_f32_16x16x32_bf16 v[228:231], a[224:227], a[84:87], v[228:231]
  buffer_load_dwordx4 a[192:195], v42, s[4:7], s52 offen offset:0 sc1
  v_mfma_f32_16x16x32_bf16 v[228:231], a[228:231], a[100:103], v[228:231]
  buffer_load_dwordx4 v27, s[12:15], s48 offen offset:2048  lds
  v_mfma_f32_16x16x32_bf16 v[224:227], a[228:231], a[96:99], v[224:227]
  v_mfma_f32_16x16x32_bf16 v[224:227], a[224:227], a[80:83], v[224:227]
  s_waitcnt lgkmcnt(6)
  v_mfma_f32_16x16x32_bf16 v[48:51], a[208:211], a[112:115], v[48:51]
  s_waitcnt lgkmcnt(4)
  ds_read_b64_tr_b16 a[224:225], v2 offset:24576
  v_mfma_f32_16x16x32_bf16 v[48:51], a[212:215], a[128:131], v[48:51]
  s_waitcnt vmcnt(28)
  ds_read_b64_tr_b16 a[226:227], v2 offset:30720
  v_mfma_f32_16x16x32_bf16 v[52:55], a[212:215], a[132:135], v[52:55]
  ds_read_b64_tr_b16 a[228:229], v2 offset:36864
  v_mfma_f32_16x16x32_bf16 v[52:55], a[208:211], a[116:119], v[52:55]
  ds_read_b64_tr_b16 a[230:231], v2 offset:43008
  v_mfma_f32_16x16x32_bf16 v[56:59], a[208:211], a[120:123], v[56:59]
  s_waitcnt vmcnt(27)
  v_mfma_f32_16x16x32_bf16 v[56:59], a[212:215], a[136:139], v[56:59]
  s_waitcnt vmcnt(26)
  v_mfma_f32_16x16x32_bf16 v[60:63], a[212:215], a[140:143], v[60:63]
  v_mfma_f32_16x16x32_bf16 v[60:63], a[208:211], a[124:127], v[60:63]
  s_waitcnt lgkmcnt(6)
  v_mfma_f32_16x16x32_bf16 a[12:15], a[216:219], a[124:127], a[12:15]
  s_waitcnt lgkmcnt(4)
  ds_read_b64_tr_b16 a[208:209], v2 offset:24584
  v_mfma_f32_16x16x32_bf16 a[12:15], a[220:223], a[140:143], a[12:15]
  ds_read_b64_tr_b16 a[210:211], v2 offset:30728
  v_mfma_f32_16x16x32_bf16 a[8:11], a[220:223], a[136:139], a[8:11]
  ds_read_b64_tr_b16 a[212:213], v2 offset:36872
  v_mfma_f32_16x16x32_bf16 a[8:11], a[216:219], a[120:123], a[8:11]
  ds_read_b64_tr_b16 a[214:215], v2 offset:43016
  v_mfma_f32_16x16x32_bf16 a[4:7], a[216:219], a[116:119], a[4:7]
  buffer_load_dwordx4 a[196:199], v43, s[4:7], s52 offen offset:0 sc1
  v_mfma_f32_16x16x32_bf16 a[4:7], a[220:223], a[132:135], a[4:7]
  v_mfma_f32_16x16x32_bf16 a[0:3], a[220:223], a[128:131], a[0:3]
  s_waitcnt lgkmcnt(6)
  v_mfma_f32_16x16x32_bf16 a[0:3], a[216:219], a[112:115], a[0:3]
  buffer_load_dwordx4 a[200:203], v46, s[4:7], s52 offen offset:0 sc1
  v_mfma_f32_16x16x32_bf16 v[64:67], a[224:227], a[112:115], v[64:67]
  s_waitcnt lgkmcnt(4)
  ds_read_b64_tr_b16 a[216:217], v1 offset:24704
  v_mfma_f32_16x16x32_bf16 v[64:67], a[228:231], a[128:131], v[64:67]
  ds_read_b64_tr_b16 a[218:219], v1 offset:30848
  v_mfma_f32_16x16x32_bf16 v[68:71], a[228:231], a[132:135], v[68:71]
  ds_read_b64_tr_b16 a[220:221], v1 offset:36992
  v_mfma_f32_16x16x32_bf16 v[68:71], a[224:227], a[116:119], v[68:71]
  ds_read_b64_tr_b16 a[222:223], v1 offset:43136
  v_mfma_f32_16x16x32_bf16 v[72:75], a[224:227], a[120:123], v[72:75]
  buffer_load_dwordx4 a[204:207], v47, s[4:7], s52 offen offset:0 sc1
  v_mfma_f32_16x16x32_bf16 v[72:75], a[228:231], a[136:139], v[72:75]
  v_mfma_f32_16x16x32_bf16 v[76:79], a[228:231], a[140:143], v[76:79]
  v_mfma_f32_16x16x32_bf16 v[76:79], a[224:227], a[124:127], v[76:79]
  s_waitcnt lgkmcnt(4)
  v_mfma_f32_16x16x32_bf16 a[28:31], a[208:211], a[124:127], a[28:31]
  s_add_u32 m0, s74, 110592
  ds_read_b64_tr_b16 a[224:225], v1 offset:24712
  v_mfma_f32_16x16x32_bf16 a[28:31], a[212:215], a[140:143], a[28:31]
  s_mov_b32 s53, 1572864
  ds_read_b64_tr_b16 a[226:227], v1 offset:30856
  v_mfma_f32_16x16x32_bf16 a[24:27], a[212:215], a[136:139], a[24:27]
  ds_read_b64_tr_b16 a[228:229], v1 offset:37000
  v_mfma_f32_16x16x32_bf16 a[24:27], a[208:211], a[120:123], a[24:27]
  ds_read_b64_tr_b16 a[230:231], v1 offset:43144
  v_mfma_f32_16x16x32_bf16 a[20:23], a[208:211], a[116:119], a[20:23]
  buffer_load_dwordx4 v25, s[12:15], s53 offen offset:0  lds
  v_mfma_f32_16x16x32_bf16 a[20:23], a[212:215], a[132:135], a[20:23]
  v_mfma_f32_16x16x32_bf16 a[16:19], a[212:215], a[128:131], a[16:19]
  v_mfma_f32_16x16x32_bf16 a[16:19], a[208:211], a[112:115], a[16:19]
  s_waitcnt lgkmcnt(6)
  v_mfma_f32_16x16x32_bf16 v[80:83], a[216:219], a[112:115], v[80:83]
  s_waitcnt lgkmcnt(4)
  ds_read_b64_tr_b16 a[208:209], v2 offset:24704
  v_mfma_f32_16x16x32_bf16 v[80:83], a[220:223], a[128:131], v[80:83]
  ds_read_b64_tr_b16 a[210:211], v2 offset:30848
  v_mfma_f32_16x16x32_bf16 v[84:87], a[220:223], a[132:135], v[84:87]
  ds_read_b64_tr_b16 a[212:213], v2 offset:36992
  v_mfma_f32_16x16x32_bf16 v[84:87], a[216:219], a[116:119], v[84:87]
  ds_read_b64_tr_b16 a[214:215], v2 offset:43136
  v_mfma_f32_16x16x32_bf16 v[88:91], a[216:219], a[120:123], v[88:91]
  v_mfma_f32_16x16x32_bf16 v[88:91], a[220:223], a[136:139], v[88:91]
  s_add_u32 s54, s75, 65536
  v_mfma_f32_16x16x32_bf16 v[92:95], a[220:223], a[140:143], v[92:95]
  buffer_load_dwordx4 a[80:83], v42, s[4:7], s54 offen offset:0 sc1
  v_mfma_f32_16x16x32_bf16 v[92:95], a[216:219], a[124:127], v[92:95]
  s_waitcnt lgkmcnt(6)
  v_mfma_f32_16x16x32_bf16 a[44:47], a[224:227], a[124:127], a[44:47]
  s_waitcnt lgkmcnt(4)
  ds_read_b64_tr_b16 a[216:217], v2 offset:24712
  v_mfma_f32_16x16x32_bf16 a[44:47], a[228:231], a[140:143], a[44:47]
  ds_read_b64_tr_b16 a[218:219], v2 offset:30856
  v_mfma_f32_16x16x32_bf16 a[40:43], a[228:231], a[136:139], a[40:43]
  ds_read_b64_tr_b16 a[220:221], v2 offset:37000
  v_mfma_f32_16x16x32_bf16 a[40:43], a[224:227], a[120:123], a[40:43]
  ds_read_b64_tr_b16 a[222:223], v2 offset:43144
  v_mfma_f32_16x16x32_bf16 a[36:39], a[224:227], a[116:119], a[36:39]
  buffer_load_dwordx4 a[84:87], v43, s[4:7], s54 offen offset:0 sc1
  v_mfma_f32_16x16x32_bf16 a[36:39], a[228:231], a[132:135], a[36:39]
  v_mfma_f32_16x16x32_bf16 a[32:35], a[228:231], a[128:131], a[32:35]
  s_waitcnt lgkmcnt(6)
  v_mfma_f32_16x16x32_bf16 a[32:35], a[224:227], a[112:115], a[32:35]
  buffer_load_dwordx4 v26, s[12:15], s53 offen offset:1024  lds
  v_mfma_f32_16x16x32_bf16 v[96:99], a[208:211], a[112:115], v[96:99]
  s_waitcnt lgkmcnt(4)
  ds_read_b64_tr_b16 a[224:225], v1 offset:24832
  v_mfma_f32_16x16x32_bf16 v[96:99], a[212:215], a[128:131], v[96:99]
  ds_read_b64_tr_b16 a[226:227], v1 offset:30976
  v_mfma_f32_16x16x32_bf16 v[100:103], a[212:215], a[132:135], v[100:103]
  ds_read_b64_tr_b16 a[228:229], v1 offset:37120
  v_mfma_f32_16x16x32_bf16 v[100:103], a[208:211], a[116:119], v[100:103]
  ds_read_b64_tr_b16 a[230:231], v1 offset:43264
  v_mfma_f32_16x16x32_bf16 v[104:107], a[208:211], a[120:123], v[104:107]
  v_mfma_f32_16x16x32_bf16 v[104:107], a[212:215], a[136:139], v[104:107]
  v_mfma_f32_16x16x32_bf16 v[108:111], a[212:215], a[140:143], v[108:111]
  v_mfma_f32_16x16x32_bf16 v[108:111], a[208:211], a[124:127], v[108:111]
  s_waitcnt lgkmcnt(6)
  v_mfma_f32_16x16x32_bf16 a[60:63], a[216:219], a[124:127], a[60:63]
  s_waitcnt lgkmcnt(4)
  ds_read_b64_tr_b16 a[208:209], v1 offset:24840
  v_mfma_f32_16x16x32_bf16 a[60:63], a[220:223], a[140:143], a[60:63]
  ds_read_b64_tr_b16 a[210:211], v1 offset:30984
  v_mfma_f32_16x16x32_bf16 a[56:59], a[220:223], a[136:139], a[56:59]
  ds_read_b64_tr_b16 a[212:213], v1 offset:37128
  v_mfma_f32_16x16x32_bf16 a[56:59], a[216:219], a[120:123], a[56:59]
  ds_read_b64_tr_b16 a[214:215], v1 offset:43272
  v_mfma_f32_16x16x32_bf16 a[52:55], a[216:219], a[116:119], a[52:55]
  buffer_load_dwordx4 a[88:91], v46, s[4:7], s54 offen offset:0 sc1
  v_mfma_f32_16x16x32_bf16 a[52:55], a[220:223], a[132:135], a[52:55]
L_pg4:
  s_cbranch_execz L_hop0
  v_mfma_f32_16x16x32_bf16 a[48:51], a[220:223], a[128:131], a[48:51]
  v_mfma_f32_16x16x32_bf16 a[48:51], a[216:219], a[112:115], a[48:51]
  s_waitcnt lgkmcnt(6)
  v_mfma_f32_16x16x32_bf16 v[112:115], a[224:227], a[112:115], v[112:115]
  s_waitcnt lgkmcnt(4)
  ds_read_b64_tr_b16 a[216:217], v2 offset:24832
  v_mfma_f32_16x16x32_bf16 v[112:115], a[228:231], a[128:131], v[112:115]
  ds_read_b64_tr_b16 a[218:219], v2 offset:30976
  v_mfma_f32_16x16x32_bf16 v[116:119], a[228:231], a[132:135], v[116:119]
  ds_read_b64_tr_b16 a[220:221], v2 offset:37120
  v_mfma_f32_16x16x32_bf16 v[116:119], a[224:227], a[116:119], v[116:119]
  ds_read_b64_tr_b16 a[222:223], v2 offset:43264
  v_mfma_f32_16x16x32_bf16 v[120:123], a[224:227], a[120:123], v[120:123]
  buffer_load_dwordx4 a[92:95], v47, s[4:7], s54 offen offset:0 sc1
  v_mfma_f32_16x16x32_bf16 v[120:123], a[228:231], a[136:139], v[120:123]
  s_add_u32 s56, s75, 69632
  v_mfma_f32_16x16x32_bf16 v[124:127], a[228:231], a[140:143], v[124:127]
  buffer_load_dwordx4 a[96:99], v42, s[4:7], s56 offen offset:0 sc1
  v_mfma_f32_16x16x32_bf16 v[124:127], a[224:227], a[124:127], v[124:127]
  s_waitcnt lgkmcnt(6)
  v_mfma_f32_16x16x32_bf16 a[76:79], a[208:211], a[124:127], a[76:79]
  s_waitcnt lgkmcnt(4)
  ds_read_b64_tr_b16 a[224:225], v2 offset:24840
  v_mfma_f32_16x16x32_bf16 a[76:79], a[212:215], a[140:143], a[76:79]
  ds_read_b64_tr_b16 a[226:227], v2 offset:30984
  v_mfma_f32_16x16x32_bf16 a[72:75], a[212:215], a[136:139], a[72:75]
  ds_read_b64_tr_b16 a[228:229], v2 offset:37128
  v_mfma_f32_16x16x32_bf16 a[72:75], a[208:211], a[120:123], a[72:75]
  ds_read_b64_tr_b16 a[230:231], v2 offset:43272
  v_mfma_f32_16x16x32_bf16 a[68:71], a[208:211], a[116:119], a[68:71]
  buffer_load_dwordx4 v27, s[12:15], s53 offen offset:2048  lds
  v_mfma_f32_16x16x32_bf16 a[68:71], a[212:215], a[132:135], a[68:71]
  v_mfma_f32_16x16x32_bf16 a[64:67], a[212:215], a[128:131], a[64:67]
  v_mfma_f32_16x16x32_bf16 a[64:67], a[208:211], a[112:115], a[64:67]
  s_waitcnt lgkmcnt(6)
  v_mfma_f32_16x16x32_bf16 v[128:131], a[216:219], a[112:115], v[128:131]
  s_waitcnt lgkmcnt(4)
  ds_read_b64_tr_b16 a[208:209], v14 offset:0
  v_mfma_f32_16x16x32_bf16 v[128:131], a[220:223], a[128:131], v[128:131]
  ds_read_b64_tr_b16 a[210:211], v14 offset:1536
  v_mfma_f32_16x16x32_bf16 v[132:135], a[220:223], a[132:135], v[132:135]
  ds_read_b64_tr_b16 a[212:213], v14 offset:6144
  v_mfma_f32_16x16x32_bf16 v[132:135], a[216:219], a[116:119], v[132:135]
  ds_read_b64_tr_b16 a[214:215], v14 offset:7680
  v_mfma_f32_16x16x32_bf16 v[136:139], a[216:219], a[120:123], v[136:139]
  v_mfma_f32_16x16x32_bf16 v[136:139], a[220:223], a[136:139], v[136:139]
  v_mfma_f32_16x16x32_bf16 v[140:143], a[220:223], a[140:143], v[140:143]
  v_mfma_f32_16x16x32_bf16 v[140:143], a[216:219], a[124:127], v[140:143]
  s_waitcnt lgkmcnt(6)
  v_mfma_f32_16x16x32_bf16 v[252:255], a[224:227], a[124:127], v[252:255]
  s_waitcnt lgkmcnt(4)
  ds_read_b64_tr_b16 a[216:217], v14 offset:3072
  v_mfma_f32_16x16x32_bf16 v[252:255], a[228:231], a[140:143], v[252:255]
  ds_read_b64_tr_b16 a[218:219], v14 offset:4608
  v_mfma_f32_16x16x32_bf16 v[248:251], a[228:231], a[136:139], v[248:251]
  ds_read_b64_tr_b16 a[220:221], v14 offset:9216
  v_mfma_f32_16x16x32_bf16 v[248:251], a[224:227], a[120:123], v[248:251]
  ds_read_b64_tr_b16 a[222:223], v14 offset:10752
  v_mfma_f32_16x16x32_bf16 v[244:247], a[224:227], a[116:119], v[244:247]
  buffer_load_dwordx4 a[100:103], v43, s[4:7], s56 offen offset:0 sc1
  v_mfma_f32_16x16x32_bf16 v[244:247], a[228:231], a[132:135], v[244:247]
  buffer_load_dwordx4 a[104:107], v46, s[4:7], s56 offen offset:0 sc1
  v_mfma_f32_16x16x32_bf16 v[240:243], a[228:231], a[128:131], v[240:243]
  v_mfma_f32_16x16x32_bf16 v[240:243], a[224:227], a[112:115], v[240:243]
  s_waitcnt lgkmcnt(6)
  v_mfma_f32_16x16x32_bf16 v[192:195], a[208:211], a[112:115], v[192:195]
  s_waitcnt lgkmcnt(4)
  ds_read_b64_tr_b16 a[224:225], v14 offset:32
  v_mfma_f32_16x16x32_bf16 v[192:195], a[212:215], a[128:131], v[192:195]
  ds_read_b64_tr_b16 a[226:227], v14 offset:1568
  v_mfma_f32_16x16x32_bf16 v[196:199], a[212:215], a[132:135], v[196:199]
  ds_read_b64_tr_b16 a[228:229], v14 offset:6176
  v_mfma_f32_16x16x32_bf16 v[196:199], a[208:211], a[116:119], v[196:199]
  ds_read_b64_tr_b16 a[230:231], v14 offset:7712
  v_mfma_f32_16x16x32_bf16 v[200:203], a[208:211], a[120:123], v[200:203]
  buffer_load_dwordx4 a[108:111], v47, s[4:7], s56 offen offset:0 sc1
  v_mfma_f32_16x16x32_bf16 v[200:203], a[212:215], a[136:139], v[200:203]
  v_mfma_f32_16x16x32_bf16 v[204:207], a[212:215], a[140:143], v[204:207]
  v_mfma_f32_16x16x32_bf16 v[204:207], a[208:211], a[124:127], v[204:207]
  s_waitcnt lgkmcnt(6)
  v_mfma_f32_16x16x32_bf16 v[156:159], a[216:219], a[124:127], v[156:159]
  s_waitcnt lgkmcnt(4)
  ds_read_b64_tr_b16 a[208:209], v14 offset:3104
  v_mfma_f32_16x16x32_bf16 v[156:159], a[220:223], a[140:143], v[156:159]
  ds_read_b64_tr_b16 a[210:211], v14 offset:4640
  v_mfma_f32_16x16x32_bf16 v[152:155], a[220:223], a[136:139], v[152:155]
  ds_read_b64_tr_b16 a[212:213], v14 offset:9248
  v_mfma_f32_16x16x32_bf16 v[152:155], a[216:219], a[120:123], v[152:155]
  ds_read_b64_tr_b16 a[214:215], v14 offset:10784
  v_mfma_f32_16x16x32_bf16 v[148:151], a[216:219], a[116:119], v[148:151]
  v_mfma_f32_16x16x32_bf16 v[148:151], a[220:223], a[132:135], v[148:151]
  v_mfma_f32_16x16x32_bf16 v[144:147], a[220:223], a[128:131], v[144:147]
  v_mfma_f32_16x16x32_bf16 v[144:147], a[216:219], a[112:115], v[144:147]
  s_waitcnt lgkmcnt(6)
  v_mfma_f32_16x16x32_bf16 v[160:163], a[224:227], a[112:115], v[160:163]
  s_waitcnt lgkmcnt(4)
  ds_read_b64_tr_b16 a[216:217], v14 offset:64
  v_mfma_f32_16x16x32_bf16 v[160:163], a[228:231], a[128:131], v[160:163]
  ds_read_b64_tr_b16 a[218:219], v14 offset:1600
  v_mfma_f32_16x16x32_bf16 v[164:167], a[228:231], a[132:135], v[164:167]
  ds_read_b64_tr_b16 a[220:221], v14 offset:6208
  v_mfma_f32_16x16x32_bf16 v[164:167], a[224:227], a[116:119], v[164:167]
  ds_read_b64_tr_b16 a[222:223], v14 offset:7744
  v_mfma_f32_16x16x32_bf16 v[168:171], a[224:227], a[120:123], v[168:171]
  v_mfma_f32_16x16x32_bf16 v[168:171], a[228:231], a[136:139], v[168:171]
  v_mfma_f32_16x16x32_bf16 v[172:175], a[228:231], a[140:143], v[172:175]
  ds_read_b64_tr_b16 a[228:229], v14 offset:9280
  v_mfma_f32_16x16x32_bf16 v[172:175], a[224:227], a[124:127], v[172:175]
  s_waitcnt lgkmcnt(7)
  ds_read_b64_tr_b16 a[230:231], v14 offset:10816
  v_mfma_f32_16x16x32_bf16 v[188:191], a[208:211], a[124:127], v[188:191]
  s_waitcnt lgkmcnt(6)
  ds_read_b64_tr_b16 a[224:225], v14 offset:3136
  v_mfma_f32_16x16x32_bf16 v[188:191], a[212:215], a[140:143], v[188:191]
  ds_read_b64_tr_b16 a[226:227], v14 offset:4672
  v_mfma_f32_16x16x32_bf16 v[184:187], a[212:215], a[136:139], v[184:187]
  v_mfma_f32_16x16x32_bf16 v[184:187], a[208:211], a[120:123], v[184:187]
  v_mfma_f32_16x16x32_bf16 v[180:183], a[208:211], a[116:119], v[180:183]
  v_mfma_f32_16x16x32_bf16 v[180:183], a[212:215], a[132:135], v[180:183]
  v_mfma_f32_16x16x32_bf16 v[176:179], a[212:215], a[128:131], v[176:179]
  v_mfma_f32_16x16x32_bf16 v[176:179], a[208:211], a[112:115], v[176:179]
  s_waitcnt vmcnt(26) lgkmcnt(0)
  s_barrier
  v_mfma_f32_16x16x32_bf16 v[208:211], a[216:219], a[112:115], v[208:211]
  ds_read_b64_tr_b16 a[208:209], v5 offset:12288
  v_mfma_f32_16x16x32_bf16 v[208:211], a[220:223], a[128:131], v[208:211]
  ds_read_b64_tr_b16 a[210:211], v5 offset:18432
  v_mfma_f32_16x16x32_bf16 v[212:215], a[220:223], a[132:135], v[212:215]
  s_add_u32 m0, s74, 122880
  ds_read_b64_tr_b16 a[212:213], v5 offset:24576
  v_mfma_f32_16x16x32_bf16 v[212:215], a[216:219], a[116:119], v[212:215]
  s_mov_b32 s55, 1769472
  ds_read_b64_tr_b16 a[214:215], v5 offset:30720
  v_mfma_f32_16x16x32_bf16 v[216:219], a[216:219], a[120:123], v[216:219]
  buffer_load_dwordx4 v25, s[12:15], s55 offen offset:0  lds
  v_mfma_f32_16x16x32_bf16 v[216:219], a[220:223], a[136:139], v[216:219]
  v_mfma_f32_16x16x32_bf16 v[220:223], a[220:223], a[140:143], v[220:223]
  v_mfma_f32_16x16x32_bf16 v[220:223], a[216:219], a[124:127], v[220:223]
  v_mfma_f32_16x16x32_bf16 v[236:239], a[224:227], a[124:127], v[236:239]
  ds_read_b64_tr_b16 a[216:217], v5 offset:12296
  v_mfma_f32_16x16x32_bf16 v[236:239], a[228:231], a[140:143], v[236:239]
  ds_read_b64_tr_b16 a[218:219], v5 offset:18440
  v_mfma_f32_16x16x32_bf16 v[232:235], a[228:231], a[136:139], v[232:235]
  ds_read_b64_tr_b16 a[220:221], v5 offset:24584
  v_mfma_f32_16x16x32_bf16 v[232:235], a[224:227], a[120:123], v[232:235]
  ds_read_b64_tr_b16 a[222:223], v5 offset:30728
  v_mfma_f32_16x16x32_bf16 v[228:231], a[224:227], a[116:119], v[228:231]
  v_mfma_f32_16x16x32_bf16 v[228:231], a[228:231], a[132:135], v[228:231]
  v_mfma_f32_16x16x32_bf16 v[224:227], a[228:231], a[128:131], v[224:227]
  s_waitcnt lgkmcnt(6)
  v_mfma_f32_16x16x32_bf16 v[224:227], a[224:227], a[112:115], v[224:227]
  s_add_u32 s57, s75, 73728
  v_mfma_f32_16x16x32_bf16 v[48:51], a[208:211], a[144:147], v[48:51]
  s_waitcnt lgkmcnt(4)
  ds_read_b64_tr_b16 a[224:225], v6 offset:12288
  v_mfma_f32_16x16x32_bf16 v[48:51], a[212:215], a[160:163], v[48:51]
  s_waitcnt vmcnt(26)
  ds_read_b64_tr_b16 a[226:227], v6 offset:18432
  v_mfma_f32_16x16x32_bf16 v[52:55], a[212:215], a[164:167], v[52:55]
  ds_read_b64_tr_b16 a[228:229], v6 offset:24576
  v_mfma_f32_16x16x32_bf16 v[52:55], a[208:211], a[148:151], v[52:55]
  ds_read_b64_tr_b16 a[230:231], v6 offset:30720
  v_mfma_f32_16x16x32_bf16 v[56:59], a[208:211], a[152:155], v[56:59]
  buffer_load_dwordx4 a[112:115], v42, s[4:7], s57 offen offset:0 sc1
  s_waitcnt vmcnt(26)
  v_mfma_f32_16x16x32_bf16 v[56:59], a[212:215], a[168:171], v[56:59]
  buffer_load_dwordx4 a[116:119], v43, s[4:7], s57 offen offset:0 sc1
  s_waitcnt vmcnt(26)
  v_mfma_f32_16x16x32_bf16 v[60:63], a[212:215], a[172:175], v[60:63]
  v_mfma_f32_16x16x32_bf16 v[60:63], a[208:211], a[156:159], v[60:63]
  s_waitcnt lgkmcnt(6)
  v_mfma_f32_16x16x32_bf16 a[12:15], a[216:219], a[156:159], a[12:15]
  s_waitcnt lgkmcnt(4)
  ds_read_b64_tr_b16 a[208:209], v6 offset:12296
  v_mfma_f32_16x16x32_bf16 a[12:15], a[220:223], a[172:175], a[12:15]
  ds_read_b64_tr_b16 a[210:211], v6 offset:18440
  v_mfma_f32_16x16x32_bf16 a[8:11], a[220:223], a[168:171], a[8:11]
  ds_read_b64_tr_b16 a[212:213], v6 offset:24584
  v_mfma_f32_16x16x32_bf16 a[8:11], a[216:219], a[152:155], a[8:11]
  ds_read_b64_tr_b16 a[214:215], v6 offset:30728
  v_mfma_f32_16x16x32_bf16 a[4:7], a[216:219], a[148:151], a[4:7]
  buffer_load_dwordx4 v26, s[12:15], s55 offen offset:1024  lds
  v_mfma_f32_16x16x32_bf16 a[4:7], a[220:223], a[164:167], a[4:7]
  v_mfma_f32_16x16x32_bf16 a[0:3], a[220:223], a[160:163], a[0:3]
  v_mfma_f32_16x16x32_bf16 a[0:3], a[216:219], a[144:147], a[0:3]
  s_waitcnt lgkmcnt(6)
  v_mfma_f32_16x16x32_bf16 v[64:67], a[224:227], a[144:147], v[64:67]
  s_waitcnt lgkmcnt(4)
  ds_read_b64_tr_b16 a[216:217], v5 offset:12416
  v_mfma_f32_16x16x32_bf16 v[64:67], a[228:231], a[160:163], v[64:67]
  ds_read_b64_tr_b16 a[218:219], v5 offset:18560
  v_mfma_f32_16x16x32_bf16 v[68:71], a[228:231], a[164:167], v[68:71]
  ds_read_b64_tr_b16 a[220:221], v5 offset:24704
  v_mfma_f32_16x16x32_bf16 v[68:71], a[224:227], a[148:151], v[68:71]
  ds_read_b64_tr_b16 a[222:223], v5 offset:30848
  v_mfma_f32_16x16x32_bf16 v[72:75], a[224:227], a[152:155], v[72:75]
  v_mfma_f32_16x16x32_bf16 v[72:75], a[228:231], a[168:171], v[72:75]
  v_mfma_f32_16x16x32_bf16 v[76:79], a[228:231], a[172:175], v[76:79]
  buffer_load_dwordx4 a[120:123], v46, s[4:7], s57 offen offset:0 sc1
  v_mfma_f32_16x16x32_bf16 v[76:79], a[224:227], a[156:159], v[76:79]
  s_waitcnt lgkmcnt(6)
  v_mfma_f32_16x16x32_bf16 a[28:31], a[208:211], a[156:159], a[28:31]
  s_waitcnt lgkmcnt(4)
  ds_read_b64_tr_b16 a[224:225], v5 offset:12424
  v_mfma_f32_16x16x32_bf16 a[28:31], a[212:215], a[172:175], a[28:31]
  ds_read_b64_tr_b16 a[226:227], v5 offset:18568
  v_mfma_f32_16x16x32_bf16 a[24:27], a[212:215], a[168:171], a[24:27]
  ds_read_b64_tr_b16 a[228:229], v5 offset:24712
  v_mfma_f32_16x16x32_bf16 a[24:27], a[208:211], a[152:155], a[24:27]
  ds_read_b64_tr_b16 a[230:231], v5 offset:30856
  v_mfma_f32_16x16x32_bf16 a[20:23], a[208:211], a[148:151], a[20:23]
  buffer_load_dwordx4 a[124:127], v47, s[4:7], s57 offen offset:0 sc1
  v_mfma_f32_16x16x32_bf16 a[20:23], a[212:215], a[164:167], a[20:23]
  v_mfma_f32_16x16x32_bf16 a[16:19], a[212:215], a[160:163], a[16:19]
  s_waitcnt lgkmcnt(6)
  v_mfma_f32_16x16x32_bf16 a[16:19], a[208:211], a[144:147], a[16:19]
  s_add_u32 s58, s75, 77824
  v_mfma_f32_16x16x32_bf16 v[80:83], a[216:219], a[144:147], v[80:83]
  s_waitcnt lgkmcnt(4)
  ds_read_b64_tr_b16 a[208:209], v6 offset:12416
  v_mfma_f32_16x16x32_bf16 v[80:83], a[220:223], a[160:163], v[80:83]
  ds_read_b64_tr_b16 a[210:211], v6 offset:18560
  v_mfma_f32_16x16x32_bf16 v[84:87], a[220:223], a[164:167], v[84:87]
  ds_read_b64_tr_b16 a[212:213], v6 offset:24704
  v_mfma_f32_16x16x32_bf16 v[84:87], a[216:219], a[148:151], v[84:87]
  ds_read_b64_tr_b16 a[214:215], v6 offset:30848
  v_mfma_f32_16x16x32_bf16 v[88:91], a[216:219], a[152:155], v[88:91]
  buffer_load_dwordx4 a[128:131], v42, s[4:7], s58 offen offset:0 sc1
  v_mfma_f32_16x16x32_bf16 v[88:91], a[220:223], a[168:171], v[88:91]
  buffer_load_dwordx4 v27, s[12:15], s55 offen offset:2048  lds
  v_mfma_f32_16x16x32_bf16 v[92:95], a[220:223], a[172:175], v[92:95]
  v_mfma_f32_16x16x32_bf16 v[92:95], a[216:219], a[156:159], v[92:95]
  s_waitcnt lgkmcnt(6)
  v_mfma_f32_16x16x32_bf16 a[44:47], a[224:227], a[156:159], a[44:47]
  s_waitcnt lgkmcnt(4)
  ds_read_b64_tr_b16 a[216:217], v6 offset:12424
  v_mfma_f32_16x16x32_bf16 a[44:47], a[228:231], a[172:175], a[44:47]
  ds_read_b64_tr_b16 a[218:219], v6 offset:18568
  v_mfma_f32_16x16x32_bf16 a[40:43], a[228:231], a[168:171], a[40:43]
  ds_read_b64_tr_b16 a[220:221], v6 offset:24712
  v_mfma_f32_16x16x32_bf16 a[40:43], a[224:227], a[152:155], a[40:43]
  ds_read_b64_tr_b16 a[222:223], v6 offset:30856
  v_mfma_f32_16x16x32_bf16 a[36:39], a[224:227], a[148:151], a[36:39]
  v_mfma_f32_16x16x32_bf16 a[36:39], a[228:231], a[164:167], a[36:39]
  v_mfma_f32_16x16x32_bf16 a[32:35], a[228:231], a[160:163], a[32:35]
  v_mfma_f32_16x16x32_bf16 a[32:35], a[224:227], a[144:147], a[32:35]
  s_waitcnt lgkmcnt(6)
  v_mfma_f32_16x16x32_bf16 v[96:99], a[208:211], a[144:147], v[96:99]
  s_waitcnt lgkmcnt(4)
  ds_read_b64_tr_b16 a[224:225], v5 offset:12544
  v_mfma_f32_16x16x32_bf16 v[96:99], a[212:215], a[160:163], v[96:99]
  ds_read_b64_tr_b16 a[226:227], v5 offset:18688
  v_mfma_f32_16x16x32_bf16 v[100:103], a[212:215], a[164:167], v[100:103]
  ds_read_b64_tr_b16 a[228:229], v5 offset:24832
  v_mfma_f32_16x16x32_bf16 v[100:103], a[208:211], a[148:151], v[100:103]
  ds_read_b64_tr_b16 a[230:231], v5 offset:30976
  v_mfma_f32_16x16x32_bf16 v[104:107], a[208:211], a[152:155], v[104:107]
  buffer_load_dwordx4 a[132:135], v43, s[4:7], s58 offen offset:0 sc1
  v_mfma_f32_16x16x32_bf16 v[104:107], a[212:215], a[168:171], v[104:107]
  v_mfma_f32_16x16x32_bf16 v[108:111], a[212:215], a[172:175], v[108:111]
  buffer_load_dwordx4 a[136:139], v46, s[4:7], s58 offen offset:0 sc1
  v_mfma_f32_16x16x32_bf16 v[108:111], a[208:211], a[156:159], v[108:111]
  s_waitcnt lgkmcnt(6)
  v_mfma_f32_16x16x32_bf16 a[60:63], a[216:219], a[156:159], a[60:63]
  s_waitcnt lgkmcnt(4)
  ds_read_b64_tr_b16 a[208:209], v5 offset:12552
  v_mfma_f32_16x16x32_bf16 a[60:63], a[220:223], a[172:175], a[60:63]
  ds_read_b64_tr_b16 a[210:211], v5 offset:18696
  v_mfma_f32_16x16x32_bf16 a[56:59], a[220:223], a[168:171], a[56:59]
  ds_read_b64_tr_b16 a[212:213], v5 offset:24840
  v_mfma_f32_16x16x32_bf16 a[56:59], a[216:219], a[152:155], a[56:59]
  ds_read_b64_tr_b16 a[214:215], v5 offset:30984
  v_mfma_f32_16x16x32_bf16 a[52:55], a[216:219], a[148:151], a[52:55]
  buffer_load_dwordx4 a[140:143], v47, s[4:7], s58 offen offset:0 sc1
  v_mfma_f32_16x16x32_bf16 a[52:55], a[220:223], a[164:167], a[52:55]
  v_mfma_f32_16x16x32_bf16 a[48:51], a[220:223], a[160:163], a[48:51]
  s_waitcnt lgkmcnt(4)
  v_mfma_f32_16x16x32_bf16 a[48:51], a[216:219], a[144:147], a[48:51]
  s_add_u32 m0, s74, 135168
  v_mfma_f32_16x16x32_bf16 v[112:115], a[224:227], a[144:147], v[112:115]
  s_mov_b32 s75, 5505024
  ds_read_b64_tr_b16 a[216:217], v6 offset:12544
  v_mfma_f32_16x16x32_bf16 v[112:115], a[228:231], a[160:163], v[112:115]
  ds_read_b64_tr_b16 a[218:219], v6 offset:18688
  v_mfma_f32_16x16x32_bf16 v[116:119], a[228:231], a[164:167], v[116:119]
  ds_read_b64_tr_b16 a[220:221], v6 offset:24832
  v_mfma_f32_16x16x32_bf16 v[116:119], a[224:227], a[148:151], v[116:119]
  ds_read_b64_tr_b16 a[222:223], v6 offset:30976
  v_mfma_f32_16x16x32_bf16 v[120:123], a[224:227], a[152:155], v[120:123]
  buffer_load_dwordx4 v22, s[8:11], s75 offen offset:0  lds
  v_mfma_f32_16x16x32_bf16 v[120:123], a[228:231], a[168:171], v[120:123]
  buffer_load_dwordx4 v23, s[8:11], s75 offen offset:1024  lds
  v_mfma_f32_16x16x32_bf16 v[124:127], a[228:231], a[172:175], v[124:127]
  v_mfma_f32_16x16x32_bf16 v[124:127], a[224:227], a[156:159], v[124:127]
  s_waitcnt lgkmcnt(6)
  v_mfma_f32_16x16x32_bf16 a[76:79], a[208:211], a[156:159], a[76:79]
  s_waitcnt lgkmcnt(4)
  ds_read_b64_tr_b16 a[224:225], v6 offset:12552
  v_mfma_f32_16x16x32_bf16 a[76:79], a[212:215], a[172:175], a[76:79]
  ds_read_b64_tr_b16 a[226:227], v6 offset:18696
  v_mfma_f32_16x16x32_bf16 a[72:75], a[212:215], a[168:171], a[72:75]
  ds_read_b64_tr_b16 a[228:229], v6 offset:24840
  v_mfma_f32_16x16x32_bf16 a[72:75], a[208:211], a[152:155], a[72:75]
  ds_read_b64_tr_b16 a[230:231], v6 offset:30984
  v_mfma_f32_16x16x32_bf16 a[68:71], a[208:211], a[148:151], a[68:71]
  buffer_load_dwordx4 v24, s[8:11], s75 offen offset:2048  lds
  v_mfma_f32_16x16x32_bf16 a[68:71], a[212:215], a[164:167], a[68:71]
  s_add_u32 m0, s74, 147456
  v_mfma_f32_16x16x32_bf16 a[64:67], a[212:215], a[160:163], a[64:67]
  s_mov_b32 s59, 5898240
  v_mfma_f32_16x16x32_bf16 a[64:67], a[208:211], a[144:147], a[64:67]
  s_waitcnt lgkmcnt(6)
  buffer_load_dwordx4 v22, s[8:11], s59 offen offset:0  lds
  v_mfma_f32_16x16x32_bf16 v[128:131], a[216:219], a[144:147], v[128:131]
  s_waitcnt lgkmcnt(4)
  ds_read_b64_tr_b16 a[208:209], v14 offset:36864
  v_mfma_f32_16x16x32_bf16 v[128:131], a[220:223], a[160:163], v[128:131]
  ds_read_b64_tr_b16 a[210:211], v14 offset:38400
  v_mfma_f32_16x16x32_bf16 v[132:135], a[220:223], a[164:167], v[132:135]
  ds_read_b64_tr_b16 a[212:213], v14 offset:43008
  v_mfma_f32_16x16x32_bf16 v[132:135], a[216:219], a[148:151], v[132:135]
  ds_read_b64_tr_b16 a[214:215], v14 offset:44544
  v_mfma_f32_16x16x32_bf16 v[136:139], a[216:219], a[152:155], v[136:139]
  buffer_load_dwordx4 v23, s[8:11], s59 offen offset:1024  lds
  v_mfma_f32_16x16x32_bf16 v[136:139], a[220:223], a[168:171], v[136:139]
  buffer_load_dwordx4 v24, s[8:11], s59 offen offset:2048  lds
  v_mfma_f32_16x16x32_bf16 v[140:143], a[220:223], a[172:175], v[140:143]
  v_mfma_f32_16x16x32_bf16 v[140:143], a[216:219], a[156:159], v[140:143]
  s_waitcnt lgkmcnt(4)
  v_mfma_f32_16x16x32_bf16 v[252:255], a[224:227], a[156:159], v[252:255]
  s_add_u32 m0, s74, 0
  ds_read_b64_tr_b16 a[216:217], v14 offset:39936
  v_mfma_f32_16x16x32_bf16 v[252:255], a[228:231], a[172:175], v[252:255]
  s_mov_b32 s60, 6291456
  ds_read_b64_tr_b16 a[218:219], v14 offset:41472
  v_mfma_f32_16x16x32_bf16 v[248:251], a[228:231], a[168:171], v[248:251]
  ds_read_b64_tr_b16 a[220:221], v14 offset:46080
  v_mfma_f32_16x16x32_bf16 v[248:251], a[224:227], a[152:155], v[248:251]
  ds_read_b64_tr_b16 a[222:223], v14 offset:47616
  v_mfma_f32_16x16x32_bf16 v[244:247], a[224:227], a[148:151], v[244:247]
  buffer_load_dwordx4 v22, s[8:11], s60 offen offset:0  lds
  v_mfma_f32_16x16x32_bf16 v[244:247], a[228:231], a[164:167], v[244:247]
  buffer_load_dwordx4 v23, s[8:11], s60 offen offset:1024  lds
  v_mfma_f32_16x16x32_bf16 v[240:243], a[228:231], a[160:163], v[240:243]
  v_mfma_f32_16x16x32_bf16 v[240:243], a[224:227], a[144:147], v[240:243]
  s_waitcnt lgkmcnt(6)
  v_mfma_f32_16x16x32_bf16 v[192:195], a[208:211], a[144:147], v[192:195]
  s_waitcnt lgkmcnt(4)
  ds_read_b64_tr_b16 a[224:225], v14 offset:36896
  v_mfma_f32_16x16x32_bf16 v[192:195], a[212:215], a[160:163], v[192:195]
  ds_read_b64_tr_b16 a[226:227], v14 offset:38432
  v_mfma_f32_16x16x32_bf16 v[196:199], a[212:215], a[164:167], v[196:199]
  ds_read_b64_tr_b16 a[228:229], v14 offset:43040
  v_mfma_f32_16x16x32_bf16 v[196:199], a[208:211], a[148:151], v[196:199]
  ds_read_b64_tr_b16 a[230:231], v14 offset:44576
  v_mfma_f32_16x16x32_bf16 v[200:203], a[208:211], a[152:155], v[200:203]
  buffer_load_dwordx4 v24, s[8:11], s60 offen offset:2048  lds
  v_mfma_f32_16x16x32_bf16 v[200:203], a[212:215], a[168:171], v[200:203]
  s_add_u32 m0, s74, 12288
  v_mfma_f32_16x16x32_bf16 v[204:207], a[212:215], a[172:175], v[204:207]
  s_mov_b32 s3, 6684672
  v_mfma_f32_16x16x32_bf16 v[204:207], a[208:211], a[156:159], v[204:207]
  s_waitcnt lgkmcnt(6)
  buffer_load_dwordx4 v22, s[8:11], s3 offen offset:0  lds
  v_mfma_f32_16x16x32_bf16 v[156:159], a[216:219], a[156:159], v[156:159]
  s_waitcnt lgkmcnt(4)
  ds_read_b64_tr_b16 a[208:209], v14 offset:39968
  v_mfma_f32_16x16x32_bf16 v[156:159], a[220:223], a[172:175], v[156:159]
  ds_read_b64_tr_b16 a[210:211], v14 offset:41504
  v_mfma_f32_16x16x32_bf16 v[152:155], a[220:223], a[168:171], v[152:155]
  ds_read_b64_tr_b16 a[212:213], v14 offset:46112
  v_mfma_f32_16x16x32_bf16 v[152:155], a[216:219], a[152:155], v[152:155]
  ds_read_b64_tr_b16 a[214:215], v14 offset:47648
  v_mfma_f32_16x16x32_bf16 v[148:151], a[216:219], a[148:151], v[148:151]
  buffer_load_dwordx4 v23, s[8:11], s3 offen offset:1024  lds
  v_mfma_f32_16x16x32_bf16 v[148:151], a[220:223], a[164:167], v[148:151]
  v_mfma_f32_16x16x32_bf16 v[144:147], a[220:223], a[160:163], v[144:147]
  buffer_load_dwordx4 v24, s[8:11], s3 offen offset:2048  lds
  v_mfma_f32_16x16x32_bf16 v[144:147], a[216:219], a[144:147], v[144:147]
  s_waitcnt lgkmcnt(6)
  v_mfma_f32_16x16x32_bf16 v[160:163], a[224:227], a[144:147], v[160:163]
  s_waitcnt lgkmcnt(4)
  ds_read_b64_tr_b16 a[216:217], v14 offset:36928
  v_mfma_f32_16x16x32_bf16 v[160:163], a[228:231], a[160:163], v[160:163]
  s_add_u32 m0, s74, 24576
  ds_read_b64_tr_b16 a[220:221], v14 offset:43072
  v_mfma_f32_16x16x32_bf16 v[164:167], a[228:231], a[164:167], v[164:167]
  s_mov_b32 s64, 7077888
  ds_read_b64_tr_b16 a[222:223], v14 offset:44608
  v_mfma_f32_16x16x32_bf16 v[164:167], a[224:227], a[148:151], v[164:167]
  ds_read_b64_tr_b16 a[218:219], v14 offset:38464
  v_mfma_f32_16x16x32_bf16 v[168:171], a[224:227], a[152:155], v[168:171]
  buffer_load_dwordx4 v22, s[8:11], s64 offen offset:0  lds
  v_mfma_f32_16x16x32_bf16 v[168:171], a[228:231], a[168:171], v[168:171]
  v_mfma_f32_16x16x32_bf16 v[172:175], a[228:231], a[172:175], v[172:175]
  ds_read_b64_tr_b16 a[228:229], v14 offset:46144
  v_mfma_f32_16x16x32_bf16 v[172:175], a[224:227], a[156:159], v[172:175]
  s_waitcnt lgkmcnt(7)
  ds_read_b64_tr_b16 a[230:231], v14 offset:47680
  v_mfma_f32_16x16x32_bf16 v[188:191], a[208:211], a[156:159], v[188:191]
  s_waitcnt lgkmcnt(6)
  ds_read_b64_tr_b16 a[224:225], v14 offset:40000
  v_mfma_f32_16x16x32_bf16 v[188:191], a[212:215], a[172:175], v[188:191]
  ds_read_b64_tr_b16 a[226:227], v14 offset:41536
  v_mfma_f32_16x16x32_bf16 v[184:187], a[212:215], a[168:171], v[184:187]
  buffer_load_dwordx4 v23, s[8:11], s64 offen offset:1024  lds
  v_mfma_f32_16x16x32_bf16 v[184:187], a[208:211], a[152:155], v[184:187]
  buffer_load_dwordx4 v24, s[8:11], s64 offen offset:2048  lds
  v_mfma_f32_16x16x32_bf16 v[180:183], a[208:211], a[148:151], v[180:183]
  v_mfma_f32_16x16x32_bf16 v[180:183], a[212:215], a[164:167], v[180:183]
  v_mfma_f32_16x16x32_bf16 v[176:179], a[212:215], a[160:163], v[176:179]
  s_add_u32 m0, s74, 36864
  v_mfma_f32_16x16x32_bf16 v[176:179], a[208:211], a[144:147], v[176:179]
  s_waitcnt vmcnt(18) lgkmcnt(0)
  s_barrier
  v_mfma_f32_16x16x32_bf16 v[208:211], a[216:219], a[144:147], v[208:211]
  s_mov_b32 s61, 7471104
  ds_read_b64_tr_b16 a[232:233], v15 offset:0
  ds_read_b64_tr_b16 a[234:235], v15 offset:1536
  v_mfma_f32_16x16x32_bf16 v[208:211], a[220:223], a[160:163], v[208:211]
  ds_read_b64_tr_b16 a[236:237], v15 offset:6144
  ds_read_b64_tr_b16 a[238:239], v15 offset:7680
  v_mfma_f32_16x16x32_bf16 v[212:215], a[220:223], a[164:167], v[212:215]
  buffer_load_dwordx4 v22, s[8:11], s61 offen offset:0  lds
  v_mfma_f32_16x16x32_bf16 v[212:215], a[216:219], a[148:151], v[212:215]
  ds_read_b64_tr_b16 a[240:241], v15 offset:12288
  ds_read_b64_tr_b16 a[242:243], v15 offset:13824
  v_mfma_f32_16x16x32_bf16 v[216:219], a[216:219], a[152:155], v[216:219]
  ds_read_b64_tr_b16 a[244:245], v15 offset:18432
  ds_read_b64_tr_b16 a[246:247], v15 offset:19968
  v_mfma_f32_16x16x32_bf16 v[216:219], a[220:223], a[168:171], v[216:219]
  buffer_load_dwordx4 v23, s[8:11], s61 offen offset:1024  lds
  v_mfma_f32_16x16x32_bf16 v[220:223], a[220:223], a[172:175], v[220:223]
  ds_read_b64_tr_b16 a[248:249], v15 offset:24576
  v_mfma_f32_16x16x32_bf16 v[220:223], a[216:219], a[156:159], v[220:223]
  ds_read_b64_tr_b16 a[250:251], v15 offset:26112
  v_mfma_f32_16x16x32_bf16 v[236:239], a[224:227], a[156:159], v[236:239]
  buffer_load_dwordx4 v24, s[8:11], s61 offen offset:2048  lds
  v_mfma_f32_16x16x32_bf16 v[236:239], a[228:231], a[172:175], v[236:239]
  ds_read_b64_tr_b16 a[252:253], v15 offset:30720
  v_mfma_f32_16x16x32_bf16 v[232:235], a[228:231], a[168:171], v[232:235]
  ds_read_b64_tr_b16 a[254:255], v15 offset:32256
  v_mfma_f32_16x16x32_bf16 v[232:235], a[224:227], a[152:155], v[232:235]
  v_mfma_f32_16x16x32_bf16 v[228:231], a[224:227], a[148:151], v[228:231]
  v_mfma_f32_16x16x32_bf16 v[228:231], a[228:231], a[164:167], v[228:231]
  s_add_u32 m0, s74, 49152
  v_mfma_f32_16x16x32_bf16 v[224:227], a[228:231], a[160:163], v[224:227]
  s_mov_b32 s65, 0
  v_mfma_f32_16x16x32_bf16 v[224:227], a[224:227], a[144:147], v[224:227]
  s_waitcnt lgkmcnt(10)
  buffer_load_dwordx4 v28, s[16:19], s65 offen offset:0  lds
  v_mfma_f32_16x16x32_bf16 v[204:207], a[232:235], a[188:191], v[204:207]
  s_waitcnt lgkmcnt(8)
  v_mfma_f32_16x16x32_bf16 v[204:207], a[236:239], a[204:207], v[204:207]
  s_waitcnt lgkmcnt(6)
  v_mfma_f32_16x16x32_bf16 v[204:207], a[240:243], a[92:95], v[204:207]
  s_waitcnt lgkmcnt(4)
  ds_read_b64_tr_b16 a[208:209], v15 offset:3072
  v_mfma_f32_16x16x32_bf16 v[204:207], a[244:247], a[108:111], v[204:207]
  s_waitcnt lgkmcnt(3)
  ds_read_b64_tr_b16 a[210:211], v15 offset:4608
  v_mfma_f32_16x16x32_bf16 v[204:207], a[248:251], a[124:127], v[204:207]
  buffer_load_dwordx4 v29, s[16:19], s65 offen offset:1024  lds
  s_waitcnt vmcnt(20) lgkmcnt(2)
  v_mfma_f32_16x16x32_bf16 v[204:207], a[252:255], a[140:143], v[204:207]
  ds_read_b64_tr_b16 a[212:213], v15 offset:9216
  v_mfma_f32_16x16x32_bf16 v[200:203], a[252:255], a[136:139], v[200:203]
  ds_read_b64_tr_b16 a[214:215], v15 offset:10752
  v_mfma_f32_16x16x32_bf16 v[200:203], a[248:251], a[120:123], v[200:203]
  v_mfma_f32_16x16x32_bf16 v[200:203], a[244:247], a[104:107], v[200:203]
  ds_read_b64_tr_b16 a[216:217], v15 offset:15360
  v_mfma_f32_16x16x32_bf16 v[200:203], a[240:243], a[88:91], v[200:203]
  ds_read_b64_tr_b16 a[218:219], v15 offset:16896
  v_lshrrev_b32 v44, 4, v37
  v_mfma_f32_16x16x32_bf16 v[200:203], a[236:239], a[200:203], v[200:203]
  v_mul_u32_u24 v45, 21846, v44
  v_mfma_f32_16x16x32_bf16 v[200:203], a[232:235], a[184:187], v[200:203]
  ds_read_b64_tr_b16 a[220:221], v15 offset:21504
  v_lshrrev_b32 v45, 16, v45
  v_mfma_f32_16x16x32_bf16 v[196:199], a[232:235], a[180:183], v[196:199]
  ds_read_b64_tr_b16 a[222:223], v15 offset:23040
  v_mul_u32_u24 v45, 11904, v45
  v_mfma_f32_16x16x32_bf16 v[196:199], a[236:239], a[196:199], v[196:199]
  buffer_load_dwordx4 v30, s[16:19], s65 offen offset:2048  lds
  v_mfma_f32_16x16x32_bf16 v[196:199], a[240:243], a[84:87], v[196:199]
  ds_read_b64_tr_b16 a[224:225], v15 offset:27648
  v_mfma_f32_16x16x32_bf16 v[196:199], a[244:247], a[100:103], v[196:199]
  s_add_u32 m0, s74, 61440
  ds_read_b64_tr_b16 a[226:227], v15 offset:29184
  v_mfma_f32_16x16x32_bf16 v[196:199], a[248:251], a[116:119], v[196:199]
  s_mov_b32 s62, 12288
  v_mfma_f32_16x16x32_bf16 v[196:199], a[252:255], a[132:135], v[196:199]
  s_mul_i32 s66, s47, 786432
  ds_read_b64_tr_b16 a[228:229], v15 offset:33792
  v_mfma_f32_16x16x32_bf16 v[192:195], a[252:255], a[128:131], v[192:195]
  s_mul_i32 s67, s73, 384
  ds_read_b64_tr_b16 a[230:231], v15 offset:35328
  v_mfma_f32_16x16x32_bf16 v[192:195], a[248:251], a[112:115], v[192:195]
  s_add_u32 s66, s66, s67
  v_mfma_f32_16x16x32_bf16 v[192:195], a[244:247], a[96:99], v[192:195]
  buffer_load_dwordx4 v28, s[16:19], s62 offen offset:0  lds
  v_mfma_f32_16x16x32_bf16 v[192:195], a[240:243], a[80:83], v[192:195]
  s_add_u32 s66, s66, 589824
  v_cmp_gt_u32 vcc, 12, v44
  v_lshl_add_u32 v44, v44, 7, v45
  v_mfma_f32_16x16x32_bf16 v[192:195], a[236:239], a[192:195], v[192:195]
  v_add_u32 v44, s66, v44
  v_mov_b32 v45, 0x40000000
  v_mfma_f32_16x16x32_bf16 v[192:195], a[232:235], a[176:179], v[192:195]
  s_waitcnt lgkmcnt(10)
  v_cndmask_b32 v44, v45, v44, vcc
  v_mfma_f32_16x16x32_bf16 v[144:147], a[208:211], a[176:179], v[144:147]
  s_waitcnt lgkmcnt(8)
  ds_read_b64_tr_b16 a[252:253], v15 offset:30752
  ds_read_b64_tr_b16 a[254:255], v15 offset:32288
  v_mfma_f32_16x16x32_bf16 v[144:147], a[212:215], a[192:195], v[144:147]
  s_waitcnt lgkmcnt(6)
  ds_read_b64_tr_b16 a[248:249], v15 offset:24608
  ds_read_b64_tr_b16 a[250:251], v15 offset:26144
  v_mfma_f32_16x16x32_bf16 v[144:147], a[216:219], a[80:83], v[144:147]
  buffer_load_dwordx4 v29, s[16:19], s62 offen offset:1024  lds
  v_mfma_f32_16x16x32_bf16 v[144:147], a[220:223], a[96:99], v[144:147]
  s_waitcnt lgkmcnt(6)
  ds_read_b64_tr_b16 a[244:245], v15 offset:18464
  ds_read_b64_tr_b16 a[246:247], v15 offset:20000
  v_mfma_f32_16x16x32_bf16 v[144:147], a[224:227], a[112:115], v[144:147]
  s_waitcnt lgkmcnt(6)
  ds_read_b64_tr_b16 a[240:241], v15 offset:12320
  ds_read_b64_tr_b16 a[242:243], v15 offset:13856
  v_mfma_f32_16x16x32_bf16 v[144:147], a[228:231], a[128:131], v[144:147]
  ds_read_b64_tr_b16 a[236:237], v15 offset:6176
  ds_read_b64_tr_b16 a[238:239], v15 offset:7712
  v_mfma_f32_16x16x32_bf16 v[148:151], a[228:231], a[132:135], v[148:151]
  ds_read_b64_tr_b16 a[232:233], v15 offset:32
  ds_read_b64_tr_b16 a[234:235], v15 offset:1568
  v_mfma_f32_16x16x32_bf16 v[148:151], a[224:227], a[116:119], v[148:151]
  buffer_load_dwordx4 v30, s[16:19], s62 offen offset:2048  lds
  v_mfma_f32_16x16x32_bf16 v[148:151], a[220:223], a[100:103], v[148:151]
  v_mul_f32 v144, v192, v144
  v_mul_f32 v192, s80, v192
  v_mfma_f32_16x16x32_bf16 v[148:151], a[216:219], a[84:87], v[148:151]
  s_add_u32 m0, s74, 73728
  v_mul_f32 v145, v193, v145
  v_mul_f32 v193, s80, v193
  v_mfma_f32_16x16x32_bf16 v[148:151], a[212:215], a[196:199], v[148:151]
  s_mov_b32 s50, 0
  v_mul_f32 v146, v194, v146
  v_mul_f32 v194, s80, v194
  v_mfma_f32_16x16x32_bf16 v[148:151], a[208:211], a[180:183], v[148:151]
L_pg5:
  s_cbranch_execz L_hop1
  v_mul_f32 v147, v195, v147
  v_mul_f32 v195, s80, v195
  v_mfma_f32_16x16x32_bf16 v[152:155], a[208:211], a[184:187], v[152:155]
  v_exp_f32 v192, v192
  v_mfma_f32_16x16x32_bf16 v[152:155], a[212:215], a[200:203], v[152:155]
  v_exp_f32 v193, v193
  v_mfma_f32_16x16x32_bf16 v[152:155], a[216:219], a[88:91], v[152:155]
  buffer_load_dwordx4 v31, s[20:23], s50 offen offset:0  lds
  v_mfma_f32_16x16x32_bf16 v[152:155], a[220:223], a[104:107], v[152:155]
  v_exp_f32 v194, v194
  v_mfma_f32_16x16x32_bf16 v[152:155], a[224:227], a[120:123], v[152:155]
  v_exp_f32 v195, v195
  v_mfma_f32_16x16x32_bf16 v[152:155], a[228:231], a[136:139], v[152:155]
  v_fma_f32 v192, v192, s81, s81
  v_fma_f32 v193, v193, s81, s81
  v_mfma_f32_16x16x32_bf16 v[156:159], a[228:231], a[140:143], v[156:159]
  v_fma_f32 v194, v194, s81, s81
  v_fma_f32 v195, v195, s81, s81
  v_mfma_f32_16x16x32_bf16 v[156:159], a[224:227], a[124:127], v[156:159]
  v_rcp_f32 v192, v192
  v_mfma_f32_16x16x32_bf16 v[156:159], a[220:223], a[108:111], v[156:159]
  buffer_load_dwordx4 v32, s[20:23], s50 offen offset:1024  lds
  v_mfma_f32_16x16x32_bf16 v[156:159], a[216:219], a[92:95], v[156:159]
  v_rcp_f32 v193, v193
  v_mfma_f32_16x16x32_bf16 v[156:159], a[212:215], a[204:207], v[156:159]
  v_rcp_f32 v194, v194
  v_mfma_f32_16x16x32_bf16 v[156:159], a[208:211], a[188:191], v[156:159]
  s_waitcnt lgkmcnt(0)
  v_rcp_f32 v195, v195
  v_mfma_f32_16x16x32_bf16 v[172:175], a[232:235], a[188:191], v[172:175]
  v_mul_f32 v148, v196, v148
  v_mul_f32 v196, s80, v196
  v_mfma_f32_16x16x32_bf16 v[172:175], a[236:239], a[204:207], v[172:175]
  v_mul_f32 v149, v197, v149
  v_mul_f32 v197, s80, v197
  v_mfma_f32_16x16x32_bf16 v[172:175], a[240:243], a[92:95], v[172:175]
  buffer_load_dwordx4 v33, s[20:23], s50 offen offset:2048  lds
  v_mfma_f32_16x16x32_bf16 v[172:175], a[244:247], a[108:111], v[172:175]
  s_add_u32 m0, s74, 86016
  v_mul_f32 v150, v198, v150
  v_mul_f32 v198, s80, v198
  v_mfma_f32_16x16x32_bf16 v[172:175], a[248:251], a[124:127], v[172:175]
  s_mov_b32 s63, 24576
  v_mul_f32 v151, v199, v151
  v_mul_f32 v199, s80, v199
  v_mfma_f32_16x16x32_bf16 v[172:175], a[252:255], a[140:143], v[172:175]
  v_exp_f32 v196, v196
  v_mfma_f32_16x16x32_bf16 v[168:171], a[252:255], a[136:139], v[168:171]
  v_exp_f32 v197, v197
  v_mfma_f32_16x16x32_bf16 v[168:171], a[248:251], a[120:123], v[168:171]
  v_exp_f32 v198, v198
  v_mfma_f32_16x16x32_bf16 v[168:171], a[244:247], a[104:107], v[168:171]
  buffer_load_dwordx4 v28, s[16:19], s63 offen offset:0  lds
  v_mfma_f32_16x16x32_bf16 v[168:171], a[240:243], a[88:91], v[168:171]
  v_exp_f32 v199, v199
  v_mfma_f32_16x16x32_bf16 v[168:171], a[236:239], a[200:203], v[168:171]
  v_fma_f32 v196, v196, s81, s81
  v_fma_f32 v197, v197, s81, s81
  v_mfma_f32_16x16x32_bf16 v[168:171], a[232:235], a[184:187], v[168:171]
  v_fma_f32 v198, v198, s81, s81
  v_fma_f32 v199, v199, s81, s81
  v_mfma_f32_16x16x32_bf16 v[164:167], a[232:235], a[180:183], v[164:167]
  v_rcp_f32 v196, v196
  v_mfma_f32_16x16x32_bf16 v[164:167], a[236:239], a[196:199], v[164:167]
  ds_read_b64_tr_b16 a[208:209], v15 offset:3104
  ds_read_b64_tr_b16 a[210:211], v15 offset:4640
  v_mfma_f32_16x16x32_bf16 v[164:167], a[240:243], a[84:87], v[164:167]
  ds_read_b64_tr_b16 a[212:213], v15 offset:9248
  ds_read_b64_tr_b16 a[214:215], v15 offset:10784
  v_mfma_f32_16x16x32_bf16 v[164:167], a[244:247], a[100:103], v[164:167]
  ds_read_b64_tr_b16 a[216:217], v15 offset:15392
  ds_read_b64_tr_b16 a[218:219], v15 offset:16928
  v_mfma_f32_16x16x32_bf16 v[164:167], a[248:251], a[116:119], v[164:167]
  ds_read_b64_tr_b16 a[220:221], v15 offset:21536
  ds_read_b64_tr_b16 a[222:223], v15 offset:23072
  v_mfma_f32_16x16x32_bf16 v[164:167], a[252:255], a[132:135], v[164:167]
  ds_read_b64_tr_b16 a[224:225], v15 offset:27680
  ds_read_b64_tr_b16 a[226:227], v15 offset:29216
  v_mfma_f32_16x16x32_bf16 v[160:163], a[252:255], a[128:131], v[160:163]
  ds_read_b64_tr_b16 a[228:229], v15 offset:33824
  ds_read_b64_tr_b16 a[230:231], v15 offset:35360
  v_mfma_f32_16x16x32_bf16 v[160:163], a[248:251], a[112:115], v[160:163]
  buffer_load_dwordx4 v29, s[16:19], s63 offen offset:1024  lds
  v_mfma_f32_16x16x32_bf16 v[160:163], a[244:247], a[96:99], v[160:163]
  buffer_load_dwordx4 v30, s[16:19], s63 offen offset:2048  lds
  v_mfma_f32_16x16x32_bf16 v[160:163], a[240:243], a[80:83], v[160:163]
  v_rcp_f32 v197, v197
  v_mfma_f32_16x16x32_bf16 v[160:163], a[236:239], a[192:195], v[160:163]
  v_rcp_f32 v198, v198
  v_mfma_f32_16x16x32_bf16 v[160:163], a[232:235], a[176:179], v[160:163]
  s_waitcnt lgkmcnt(10)
  v_rcp_f32 v199, v199
  v_mfma_f32_16x16x32_bf16 v[176:179], a[208:211], a[176:179], v[176:179]
  s_waitcnt lgkmcnt(8)
  v_mul_f32 v152, v200, v152
  v_mul_f32 v200, s80, v200
  v_mfma_f32_16x16x32_bf16 v[176:179], a[212:215], a[192:195], v[176:179]
  s_waitcnt lgkmcnt(6)
  v_mul_f32 v153, v201, v153
  v_mul_f32 v201, s80, v201
  v_mfma_f32_16x16x32_bf16 v[176:179], a[216:219], a[80:83], v[176:179]
  s_waitcnt lgkmcnt(4)
  ds_read_b64_tr_b16 a[232:233], v15 offset:64
  v_mul_f32 v144, v192, v144
  v_mfma_f32_16x16x32_bf16 v[176:179], a[220:223], a[96:99], v[176:179]
  s_waitcnt lgkmcnt(3)
  v_mul_f32 v154, v202, v154
  v_mul_f32 v202, s80, v202
  v_mfma_f32_16x16x32_bf16 v[176:179], a[224:227], a[112:115], v[176:179]
  s_waitcnt lgkmcnt(1)
  v_mul_f32 v155, v203, v155
  v_mul_f32 v203, s80, v203
  v_mfma_f32_16x16x32_bf16 v[176:179], a[228:231], a[128:131], v[176:179]
  v_exp_f32 v200, v200
  v_mfma_f32_16x16x32_bf16 v[180:183], a[228:231], a[132:135], v[180:183]
  v_exp_f32 v201, v201
  v_mfma_f32_16x16x32_bf16 v[180:183], a[224:227], a[116:119], v[180:183]
  v_exp_f32 v202, v202
  v_mfma_f32_16x16x32_bf16 v[180:183], a[220:223], a[100:103], v[180:183]
  v_exp_f32 v203, v203
  v_mfma_f32_16x16x32_bf16 v[180:183], a[216:219], a[84:87], v[180:183]
  v_fma_f32 v200, v200, s81, s81
  v_fma_f32 v201, v201, s81, s81
  v_mfma_f32_16x16x32_bf16 v[180:183], a[212:215], a[196:199], v[180:183]
  v_fma_f32 v202, v202, s81, s81
  v_fma_f32 v203, v203, s81, s81
  v_mfma_f32_16x16x32_bf16 v[180:183], a[208:211], a[180:183], v[180:183]
  v_rcp_f32 v200, v200
  v_mfma_f32_16x16x32_bf16 v[184:187], a[208:211], a[184:187], v[184:187]
  v_rcp_f32 v201, v201
  v_mfma_f32_16x16x32_bf16 v[184:187], a[212:215], a[200:203], v[184:187]
  v_rcp_f32 v202, v202
  v_mfma_f32_16x16x32_bf16 v[184:187], a[216:219], a[88:91], v[184:187]
  ds_read_b64_tr_b16 a[234:235], v15 offset:1600
  ds_read_b64_tr_b16 a[236:237], v15 offset:6208
  v_mfma_f32_16x16x32_bf16 v[184:187], a[220:223], a[104:107], v[184:187]
  ds_read_b64_tr_b16 a[238:239], v15 offset:7744
  ds_read_b64_tr_b16 a[240:241], v15 offset:12352
  v_mfma_f32_16x16x32_bf16 v[184:187], a[224:227], a[120:123], v[184:187]
  ds_read_b64_tr_b16 a[242:243], v15 offset:13888
  ds_read_b64_tr_b16 a[244:245], v15 offset:18496
  v_mfma_f32_16x16x32_bf16 v[184:187], a[228:231], a[136:139], v[184:187]
  ds_read_b64_tr_b16 a[246:247], v15 offset:20032
  ds_read_b64_tr_b16 a[248:249], v15 offset:24640
  v_mfma_f32_16x16x32_bf16 v[188:191], a[228:231], a[140:143], v[188:191]
  ds_read_b64_tr_b16 a[250:251], v15 offset:26176
  ds_read_b64_tr_b16 a[252:253], v15 offset:30784
  v_mfma_f32_16x16x32_bf16 v[188:191], a[224:227], a[124:127], v[188:191]
  s_mov_b32 s49, 24576
  ds_read_b64_tr_b16 a[254:255], v15 offset:32320
  v_mul_f32 v145, v193, v145
  v_mfma_f32_16x16x32_bf16 v[188:191], a[220:223], a[108:111], v[188:191]
  v_rcp_f32 v203, v203
  v_mfma_f32_16x16x32_bf16 v[188:191], a[216:219], a[92:95], v[188:191]
  v_mul_f32 v156, v204, v156
  v_mul_f32 v204, s80, v204
  v_mfma_f32_16x16x32_bf16 v[188:191], a[212:215], a[204:207], v[188:191]
  v_mul_f32 v157, v205, v157
  v_mul_f32 v205, s80, v205
  v_mfma_f32_16x16x32_bf16 v[188:191], a[208:211], a[188:191], v[188:191]
  s_waitcnt lgkmcnt(10)
  v_mul_f32 v158, v206, v158
  v_mul_f32 v206, s80, v206
  v_mfma_f32_16x16x32_bf16 v[220:223], a[232:235], a[188:191], v[220:223]
  s_waitcnt lgkmcnt(8)
  v_mul_f32 v159, v207, v159
  v_mul_f32 v207, s80, v207
  v_mfma_f32_16x16x32_bf16 v[220:223], a[236:239], a[204:207], v[220:223]
  s_waitcnt lgkmcnt(6)
  v_exp_f32 v204, v204
  v_mfma_f32_16x16x32_bf16 v[220:223], a[240:243], a[92:95], v[220:223]
  s_waitcnt lgkmcnt(4)
  v_exp_f32 v205, v205
  v_mfma_f32_16x16x32_bf16 v[220:223], a[244:247], a[108:111], v[220:223]
  s_waitcnt lgkmcnt(2)
  v_exp_f32 v206, v206
  v_mfma_f32_16x16x32_bf16 v[220:223], a[248:251], a[124:127], v[220:223]
  s_waitcnt lgkmcnt(0)
  v_exp_f32 v207, v207
  v_mfma_f32_16x16x32_bf16 v[220:223], a[252:255], a[140:143], v[220:223]
  v_fma_f32 v204, v204, s81, s81
  v_fma_f32 v205, v205, s81, s81
  v_mfma_f32_16x16x32_bf16 v[216:219], a[252:255], a[136:139], v[216:219]
  buffer_load_dword v22, v44, s[20:23], s49 offen
  v_mfma_f32_16x16x32_bf16 v[216:219], a[248:251], a[120:123], v[216:219]
  v_fma_f32 v206, v206, s81, s81
  v_fma_f32 v207, v207, s81, s81
  v_mfma_f32_16x16x32_bf16 v[216:219], a[244:247], a[104:107], v[216:219]
  v_rcp_f32 v204, v204
  v_mfma_f32_16x16x32_bf16 v[216:219], a[240:243], a[88:91], v[216:219]
  v_rcp_f32 v205, v205
  v_mfma_f32_16x16x32_bf16 v[216:219], a[236:239], a[200:203], v[216:219]
  v_rcp_f32 v206, v206
  v_mfma_f32_16x16x32_bf16 v[216:219], a[232:235], a[184:187], v[216:219]
  v_rcp_f32 v207, v207
  v_mfma_f32_16x16x32_bf16 v[212:215], a[232:235], a[180:183], v[212:215]
  v_mul_f32 v176, v160, v176
  v_mul_f32 v160, s80, v160
  v_mfma_f32_16x16x32_bf16 v[212:215], a[236:239], a[196:199], v[212:215]
  v_mul_f32 v177, v161, v177
  v_mul_f32 v161, s80, v161
  v_mfma_f32_16x16x32_bf16 v[212:215], a[240:243], a[84:87], v[212:215]
  ds_read_b64_tr_b16 a[208:209], v15 offset:3136
  ds_read_b64_tr_b16 a[210:211], v15 offset:4672
  v_mfma_f32_16x16x32_bf16 v[212:215], a[244:247], a[100:103], v[212:215]
  ds_read_b64_tr_b16 a[212:213], v15 offset:9280
  ds_read_b64_tr_b16 a[214:215], v15 offset:10816
  v_mfma_f32_16x16x32_bf16 v[212:215], a[248:251], a[116:119], v[212:215]
  ds_read_b64_tr_b16 a[216:217], v15 offset:15424
  ds_read_b64_tr_b16 a[218:219], v15 offset:16960
  v_mfma_f32_16x16x32_bf16 v[212:215], a[252:255], a[132:135], v[212:215]
  ds_read_b64_tr_b16 a[220:221], v15 offset:21568
  ds_read_b64_tr_b16 a[222:223], v15 offset:23104
  v_mfma_f32_16x16x32_bf16 v[208:211], a[252:255], a[128:131], v[208:211]
  ds_read_b64_tr_b16 a[224:225], v15 offset:27712
  ds_read_b64_tr_b16 a[226:227], v15 offset:29248
  v_mfma_f32_16x16x32_bf16 v[208:211], a[248:251], a[112:115], v[208:211]
  ds_read_b64_tr_b16 a[228:229], v15 offset:33856
  ds_read_b64_tr_b16 a[230:231], v15 offset:35392
  v_mfma_f32_16x16x32_bf16 v[208:211], a[244:247], a[96:99], v[208:211]
  v_mul_f32 v178, v162, v178
  v_mul_f32 v162, s80, v162
  v_mfma_f32_16x16x32_bf16 v[208:211], a[240:243], a[80:83], v[208:211]
  v_mul_f32 v179, v163, v179
  v_mul_f32 v163, s80, v163
  v_mfma_f32_16x16x32_bf16 v[208:211], a[236:239], a[192:195], v[208:211]
  v_exp_f32 v160, v160
  v_mfma_f32_16x16x32_bf16 v[208:211], a[232:235], a[176:179], v[208:211]
  s_waitcnt lgkmcnt(10)
  v_exp_f32 v161, v161
  v_mfma_f32_16x16x32_bf16 v[224:227], a[208:211], a[176:179], v[224:227]
  s_waitcnt lgkmcnt(8)
  v_exp_f32 v162, v162
  v_mfma_f32_16x16x32_bf16 v[224:227], a[212:215], a[192:195], v[224:227]
  s_waitcnt vmcnt(13) lgkmcnt(0)
  s_barrier
  v_exp_f32 v163, v163
  v_mfma_f32_16x16x32_bf16 v[224:227], a[216:219], a[80:83], v[224:227]
  v_fma_f32 v160, v160, s81, s81
  v_fma_f32 v161, v161, s81, s81
  v_mfma_f32_16x16x32_bf16 v[224:227], a[220:223], a[96:99], v[224:227]
  v_fma_f32 v162, v162, s81, s81
  v_fma_f32 v163, v163, s81, s81
  v_mfma_f32_16x16x32_bf16 v[224:227], a[224:227], a[112:115], v[224:227]
  v_rcp_f32 v160, v160
  v_mfma_f32_16x16x32_bf16 v[224:227], a[228:231], a[128:131], v[224:227]
  v_rcp_f32 v161, v161
  v_mfma_f32_16x16x32_bf16 v[228:231], a[228:231], a[132:135], v[228:231]
  v_rcp_f32 v162, v162
  v_mfma_f32_16x16x32_bf16 v[228:231], a[224:227], a[116:119], v[228:231]
  v_rcp_f32 v163, v163
  v_mfma_f32_16x16x32_bf16 v[228:231], a[220:223], a[100:103], v[228:231]
  ds_read_b64_tr_b16 a[232:233], v9 offset:36864
  v_mul_f32 v146, v194, v146
  v_mfma_f32_16x16x32_bf16 v[228:231], a[216:219], a[84:87], v[228:231]
  ds_read_b64_tr_b16 a[234:235], v9 offset:43008
  v_mul_f32 v147, v195, v147
  v_mfma_f32_16x16x32_bf16 v[228:231], a[212:215], a[196:199], v[228:231]
  ds_read_b64_tr_b16 a[236:237], v9 offset:49152
  v_cvt_pk_bf16_f32 v192, v144, v145
  v_mfma_f32_16x16x32_bf16 v[228:231], a[208:211], a[180:183], v[228:231]
  s_add_u32 m0, s74, 98304
  ds_read_b64_tr_b16 a[238:239], v9 offset:55296
  v_cvt_pk_bf16_f32 v193, v146, v147
  v_mfma_f32_16x16x32_bf16 v[232:235], a[208:211], a[184:187], v[232:235]
  s_mov_b32 s51, 12288
  ds_read_b64_tr_b16 a[240:241], v1 offset:0
  v_mul_f32 v148, v196, v148
  v_mfma_f32_16x16x32_bf16 v[232:235], a[212:215], a[200:203], v[232:235]
  s_lshr_b32 s48, s2, 3
  ds_read_b64_tr_b16 a[242:243], v1 offset:6144
  v_mul_f32 v149, v197, v149
  v_mfma_f32_16x16x32_bf16 v[232:235], a[216:219], a[88:91], v[232:235]
  s_lshl_b32 s48, s48, 2
  ds_read_b64_tr_b16 a[244:245], v1 offset:12288
  v_mul_f32 v150, v198, v150
  v_mfma_f32_16x16x32_bf16 v[232:235], a[220:223], a[104:107], v[232:235]
  s_add_u32 s48, s48, s72
  ds_read_b64_tr_b16 a[246:247], v1 offset:18432
  v_mul_f32 v151, v199, v151
  v_mfma_f32_16x16x32_bf16 v[232:235], a[224:227], a[120:123], v[232:235]
  s_lshl_b32 s48, s48, 7
  ds_read_b64_tr_b16 a[248:249], v1 offset:24576
  v_mov_b32 v41, s40
  v_mfma_f32_16x16x32_bf16 v[232:235], a[228:231], a[136:139], v[232:235]
  s_add_u32 s48, s48, 6144
  ds_read_b64_tr_b16 a[250:251], v1 offset:30720
  v_add_u32 v41, 1, v41
  v_mfma_f32_16x16x32_bf16 v[236:239], a[228:231], a[140:143], v[236:239]
  s_mov_b32 s52, 49152
  ds_read_b64_tr_b16 a[252:253], v1 offset:36864
  v_mov_b32 v25, s48
  v_mfma_f32_16x16x32_bf16 v[236:239], a[224:227], a[124:127], v[236:239]
  ds_read_b64_tr_b16 a[254:255], v1 offset:43008
  v_xor_b32 v5, 64, v7
  v_mfma_f32_16x16x32_bf16 v[236:239], a[220:223], a[108:111], v[236:239]
  v_mul_f32 v180, v164, v180
  v_mul_f32 v164, s80, v164
  v_mfma_f32_16x16x32_bf16 v[236:239], a[216:219], a[92:95], v[236:239]
  v_mul_f32 v181, v165, v181
  v_mul_f32 v165, s80, v165
  v_mfma_f32_16x16x32_bf16 v[236:239], a[212:215], a[204:207], v[236:239]
  buffer_load_dwordx4 v31, s[20:23], s51 offen offset:0  lds
  v_mfma_f32_16x16x32_bf16 v[236:239], a[208:211], a[188:191], v[236:239]
  s_waitcnt lgkmcnt(10)
  v_mul_f32 v182, v166, v182
  v_mul_f32 v166, s80, v166
  v_mfma_f32_16x16x32_bf16 v[60:63], a[232:235], a[188:191], v[60:63]
  s_waitcnt lgkmcnt(8)
  v_mul_f32 v183, v167, v183
  v_mul_f32 v167, s80, v167
  v_mfma_f32_16x16x32_bf16 v[60:63], a[236:239], a[204:207], v[60:63]
  s_waitcnt lgkmcnt(6)
  v_exp_f32 v164, v164
  v_mfma_f32_16x16x32_bf16 v[60:63], a[240:243], a[92:95], v[60:63]
  s_waitcnt lgkmcnt(2)
  v_exp_f32 v165, v165
  v_mfma_f32_16x16x32_bf16 v[60:63], a[244:247], a[108:111], v[60:63]
  buffer_load_dword v22, v44, s[16:19], s52 offen
  v_mfma_f32_16x16x32_bf16 v[60:63], a[248:251], a[124:127], v[60:63]
  s_waitcnt lgkmcnt(0)
  v_exp_f32 v166, v166
  v_mfma_f32_16x16x32_bf16 v[60:63], a[252:255], a[140:143], v[60:63]
  v_exp_f32 v167, v167
  v_mfma_f32_16x16x32_bf16 v[56:59], a[252:255], a[136:139], v[56:59]
  buffer_load_dwordx4 v32, s[20:23], s51 offen offset:1024  lds
  v_mfma_f32_16x16x32_bf16 v[56:59], a[248:251], a[120:123], v[56:59]
  ds_read_b64_tr_b16 a[228:229], v1 offset:36872
  v_xor_b32 v6, 64, v8
  v_mfma_f32_16x16x32_bf16 v[56:59], a[244:247], a[104:107], v[56:59]
  ds_read_b64_tr_b16 a[224:225], v1 offset:24584
  v_and_b32 v14, 0x180, v38
  v_mfma_f32_16x16x32_bf16 v[56:59], a[240:243], a[88:91], v[56:59]
  ds_read_b64_tr_b16 a[220:221], v1 offset:12296
  v_lshlrev_b32 v24, 3, v37
  v_mfma_f32_16x16x32_bf16 v[56:59], a[236:239], a[200:203], v[56:59]
  ds_read_b64_tr_b16 a[216:217], v1 offset:8
  v_min_u32 v24, 1792, v24
  v_mfma_f32_16x16x32_bf16 v[56:59], a[232:235], a[184:187], v[56:59]
  ds_read_b64_tr_b16 a[212:213], v9 offset:49160
  v_cvt_pk_bf16_f32 v196, v148, v149
  v_mfma_f32_16x16x32_bf16 v[52:55], a[232:235], a[180:183], v[52:55]
  ds_read_b64_tr_b16 a[208:209], v9 offset:36872
  v_cvt_pk_bf16_f32 v197, v150, v151
  v_mfma_f32_16x16x32_bf16 v[52:55], a[236:239], a[196:199], v[52:55]
  ds_read_b64_tr_b16 a[210:211], v9 offset:43016
  v_mul_f32 v152, v200, v152
  v_mfma_f32_16x16x32_bf16 v[52:55], a[240:243], a[84:87], v[52:55]
  buffer_load_dwordx4 v33, s[20:23], s51 offen offset:2048  lds
  v_mfma_f32_16x16x32_bf16 v[52:55], a[244:247], a[100:103], v[52:55]
  s_add_u32 m0, s74, 110592
  ds_read_b64_tr_b16 a[214:215], v9 offset:55304
  v_mul_f32 v153, v201, v153
  v_mfma_f32_16x16x32_bf16 v[52:55], a[248:251], a[116:119], v[52:55]
  s_mov_b32 s54, 36864
  ds_read_b64_tr_b16 a[218:219], v1 offset:6152
  v_mul_f32 v154, v202, v154
  v_mfma_f32_16x16x32_bf16 v[52:55], a[252:255], a[132:135], v[52:55]
  ds_read_b64_tr_b16 a[222:223], v1 offset:18440
  v_mul_f32 v155, v203, v155
  v_mfma_f32_16x16x32_bf16 v[48:51], a[252:255], a[128:131], v[48:51]
  ds_read_b64_tr_b16 a[226:227], v1 offset:30728
  v_fma_f32 v164, v164, s81, s81
  v_mfma_f32_16x16x32_bf16 v[48:51], a[248:251], a[112:115], v[48:51]
  ds_read_b64_tr_b16 a[230:231], v1 offset:43016
  v_fma_f32 v165, v165, s81, s81
  v_mfma_f32_16x16x32_bf16 v[48:51], a[244:247], a[96:99], v[48:51]
  v_fma_f32 v166, v166, s81, s81
  v_fma_f32 v167, v167, s81, s81
  v_mfma_f32_16x16x32_bf16 v[48:51], a[240:243], a[80:83], v[48:51]
  v_rcp_f32 v164, v164
  v_mfma_f32_16x16x32_bf16 v[48:51], a[236:239], a[192:195], v[48:51]
  buffer_load_dwordx4 v28, s[16:19], s54 offen offset:0  lds
  v_mfma_f32_16x16x32_bf16 v[48:51], a[232:235], a[176:179], v[48:51]
  s_waitcnt lgkmcnt(5)
  v_rcp_f32 v165, v165
  v_mfma_f32_16x16x32_bf16 a[0:3], a[208:211], a[176:179], a[0:3]
  s_waitcnt lgkmcnt(4)
  v_rcp_f32 v166, v166
  v_mfma_f32_16x16x32_bf16 a[0:3], a[212:215], a[192:195], a[0:3]
  s_waitcnt lgkmcnt(3)
  v_rcp_f32 v167, v167
  v_mfma_f32_16x16x32_bf16 a[0:3], a[216:219], a[80:83], a[0:3]
  s_waitcnt lgkmcnt(2)
  v_mul_f32 v184, v168, v184
  v_mul_f32 v168, s80, v168
  v_mfma_f32_16x16x32_bf16 a[0:3], a[220:223], a[96:99], a[0:3]
  s_waitcnt lgkmcnt(1)
  v_mul_f32 v185, v169, v185
  v_mul_f32 v169, s80, v169
  v_mfma_f32_16x16x32_bf16 a[0:3], a[224:227], a[112:115], a[0:3]
  s_waitcnt lgkmcnt(0)
  v_exp_f32 v168, v168
  v_mfma_f32_16x16x32_bf16 a[0:3], a[228:231], a[128:131], a[0:3]
  v_exp_f32 v169, v169
  v_mfma_f32_16x16x32_bf16 a[4:7], a[228:231], a[132:135], a[4:7]
  buffer_load_dwordx4 v29, s[16:19], s54 offen offset:1024  lds
  v_mfma_f32_16x16x32_bf16 a[4:7], a[224:227], a[116:119], a[4:7]
  ds_read_b64_tr_b16 a[252:253], v2 offset:36864
  v_cvt_pk_bf16_f32 v200, v152, v153
  v_mfma_f32_16x16x32_bf16 a[4:7], a[220:223], a[100:103], a[4:7]
  ds_read_b64_tr_b16 a[248:249], v2 offset:24576
  v_cvt_pk_bf16_f32 v201, v154, v155
  v_mfma_f32_16x16x32_bf16 a[4:7], a[216:219], a[84:87], a[4:7]
  ds_read_b64_tr_b16 a[244:245], v2 offset:12288
  v_mul_f32 v156, v204, v156
  v_mfma_f32_16x16x32_bf16 a[4:7], a[212:215], a[196:199], a[4:7]
  ds_read_b64_tr_b16 a[240:241], v2 offset:0
  v_mul_f32 v157, v205, v157
  v_mfma_f32_16x16x32_bf16 a[4:7], a[208:211], a[180:183], a[4:7]
  ds_read_b64_tr_b16 a[236:237], v10 offset:49152
  v_mul_f32 v158, v206, v158
  v_mfma_f32_16x16x32_bf16 a[8:11], a[208:211], a[184:187], a[8:11]
  ds_read_b64_tr_b16 a[232:233], v10 offset:36864
  v_mul_f32 v159, v207, v159
  v_mfma_f32_16x16x32_bf16 a[8:11], a[212:215], a[200:203], a[8:11]
  s_mov_b32 s53, 73728
  ds_read_b64_tr_b16 a[234:235], v10 offset:43008
  v_cvt_pk_bf16_f32 v204, v156, v157
  v_mfma_f32_16x16x32_bf16 a[8:11], a[216:219], a[88:91], a[8:11]
  buffer_load_dwordx4 v30, s[16:19], s54 offen offset:2048  lds
  v_mfma_f32_16x16x32_bf16 a[8:11], a[220:223], a[104:107], a[8:11]
  s_add_u32 m0, s74, 122880
  ds_read_b64_tr_b16 a[238:239], v10 offset:55296
  v_cvt_pk_bf16_f32 v205, v158, v159
  v_mfma_f32_16x16x32_bf16 a[8:11], a[224:227], a[120:123], a[8:11]
  s_mov_b32 s56, 24576
  ds_read_b64_tr_b16 a[242:243], v2 offset:6144
  v_mul_f32 v186, v170, v186
  v_mfma_f32_16x16x32_bf16 a[8:11], a[228:231], a[136:139], a[8:11]
  ds_read_b64_tr_b16 a[246:247], v2 offset:18432
  v_mul_f32 v170, s80, v170
  v_mfma_f32_16x16x32_bf16 a[12:15], a[228:231], a[140:143], a[12:15]
  ds_read_b64_tr_b16 a[250:251], v2 offset:30720
  v_mul_f32 v187, v171, v187
  v_mfma_f32_16x16x32_bf16 a[12:15], a[224:227], a[124:127], a[12:15]
  ds_read_b64_tr_b16 a[254:255], v2 offset:43008
  v_mul_f32 v171, s80, v171
  v_mfma_f32_16x16x32_bf16 a[12:15], a[220:223], a[108:111], a[12:15]
  v_exp_f32 v170, v170
  v_mfma_f32_16x16x32_bf16 a[12:15], a[216:219], a[92:95], a[12:15]
  v_exp_f32 v171, v171
  v_mfma_f32_16x16x32_bf16 a[12:15], a[212:215], a[204:207], a[12:15]
  buffer_load_dwordx4 v31, s[20:23], s56 offen offset:0  lds
  v_mfma_f32_16x16x32_bf16 a[12:15], a[208:211], a[188:191], a[12:15]
  s_waitcnt lgkmcnt(4)
  v_fma_f32 v168, v168, s81, s81
  v_fma_f32 v169, v169, s81, s81
  v_mfma_f32_16x16x32_bf16 v[76:79], a[232:235], a[188:191], v[76:79]
  buffer_load_dword v22, v44, s[20:23], s53 offen
  v_mfma_f32_16x16x32_bf16 v[76:79], a[236:239], a[204:207], v[76:79]
  s_waitcnt lgkmcnt(3)
  v_fma_f32 v170, v170, s81, s81
  v_fma_f32 v171, v171, s81, s81
  v_mfma_f32_16x16x32_bf16 v[76:79], a[240:243], a[92:95], v[76:79]
  s_waitcnt lgkmcnt(2)
  v_rcp_f32 v168, v168
  v_mfma_f32_16x16x32_bf16 v[76:79], a[244:247], a[108:111], v[76:79]
  s_waitcnt lgkmcnt(1)
  v_rcp_f32 v169, v169
  v_mfma_f32_16x16x32_bf16 v[76:79], a[248:251], a[124:127], v[76:79]
  s_waitcnt lgkmcnt(0)
  v_rcp_f32 v170, v170
  v_mfma_f32_16x16x32_bf16 v[76:79], a[252:255], a[140:143], v[76:79]
  v_rcp_f32 v171, v171
  v_mfma_f32_16x16x32_bf16 v[72:75], a[252:255], a[136:139], v[72:75]
  buffer_load_dwordx4 v32, s[20:23], s56 offen offset:1024  lds
  v_mfma_f32_16x16x32_bf16 v[72:75], a[248:251], a[120:123], v[72:75]
  ds_read_b64_tr_b16 a[228:229], v2 offset:36872
  v_cvt_pk_bf16_f32 v48, v48, v49
  v_mfma_f32_16x16x32_bf16 v[72:75], a[244:247], a[104:107], v[72:75]
  ds_read_b64_tr_b16 a[224:225], v2 offset:24584
  v_cvt_pk_bf16_f32 v49, v50, v51
  v_mfma_f32_16x16x32_bf16 v[72:75], a[240:243], a[88:91], v[72:75]
  ds_read_b64_tr_b16 a[220:221], v2 offset:12296
  v_cvt_pk_bf16_f32 v52, v52, v53
  v_mfma_f32_16x16x32_bf16 v[72:75], a[236:239], a[200:203], v[72:75]
  ds_read_b64_tr_b16 a[216:217], v2 offset:8
  v_cvt_pk_bf16_f32 v53, v54, v55
  v_mfma_f32_16x16x32_bf16 v[72:75], a[232:235], a[184:187], v[72:75]
  ds_read_b64_tr_b16 a[212:213], v10 offset:49160
  v_cvt_pk_bf16_f32 v56, v56, v57
  v_mfma_f32_16x16x32_bf16 v[68:71], a[232:235], a[180:183], v[68:71]
  ds_read_b64_tr_b16 a[208:209], v10 offset:36872
  v_cvt_pk_bf16_f32 v57, v58, v59
  v_mfma_f32_16x16x32_bf16 v[68:71], a[236:239], a[196:199], v[68:71]
  ds_read_b64_tr_b16 a[210:211], v10 offset:43016
  v_mul_f32 v188, v172, v188
  v_mfma_f32_16x16x32_bf16 v[68:71], a[240:243], a[84:87], v[68:71]
  buffer_load_dwordx4 v33, s[20:23], s56 offen offset:2048  lds
  v_mfma_f32_16x16x32_bf16 v[68:71], a[244:247], a[100:103], v[68:71]
  ds_read_b64_tr_b16 a[214:215], v10 offset:55304
  v_mul_f32 v172, s80, v172
  v_mfma_f32_16x16x32_bf16 v[68:71], a[248:251], a[116:119], v[68:71]
  ds_read_b64_tr_b16 a[218:219], v2 offset:6152
  v_mul_f32 v189, v173, v189
  v_mfma_f32_16x16x32_bf16 v[68:71], a[252:255], a[132:135], v[68:71]
  ds_read_b64_tr_b16 a[222:223], v2 offset:18440
  v_mul_f32 v173, s80, v173
  v_mfma_f32_16x16x32_bf16 v[64:67], a[252:255], a[128:131], v[64:67]
  ds_read_b64_tr_b16 a[226:227], v2 offset:30728
  v_mul_f32 v190, v174, v190
  v_mfma_f32_16x16x32_bf16 v[64:67], a[248:251], a[112:115], v[64:67]
  ds_read_b64_tr_b16 a[230:231], v2 offset:43016
  v_mul_f32 v174, s80, v174
  v_mfma_f32_16x16x32_bf16 v[64:67], a[244:247], a[96:99], v[64:67]
  s_lshr_b32 s57, s2, 3
  v_mul_f32 v191, v175, v191
  v_mul_f32 v175, s80, v175
  v_mfma_f32_16x16x32_bf16 v[64:67], a[240:243], a[80:83], v[64:67]
  s_lshl_b32 s57, s57, 2
  v_exp_f32 v172, v172
  v_mfma_f32_16x16x32_bf16 v[64:67], a[236:239], a[192:195], v[64:67]
  v_exp_f32 v173, v173
  v_mfma_f32_16x16x32_bf16 v[64:67], a[232:235], a[176:179], v[64:67]
  s_waitcnt lgkmcnt(5)
  v_exp_f32 v174, v174
  v_mfma_f32_16x16x32_bf16 a[16:19], a[208:211], a[176:179], a[16:19]
  s_waitcnt lgkmcnt(4)
  v_exp_f32 v175, v175
  v_mfma_f32_16x16x32_bf16 a[16:19], a[212:215], a[192:195], a[16:19]
  s_waitcnt lgkmcnt(3)
  v_fma_f32 v172, v172, s81, s81
  v_fma_f32 v173, v173, s81, s81
  v_mfma_f32_16x16x32_bf16 a[16:19], a[216:219], a[80:83], a[16:19]
  s_waitcnt lgkmcnt(2)
  v_fma_f32 v174, v174, s81, s81
  v_fma_f32 v175, v175, s81, s81
  v_mfma_f32_16x16x32_bf16 a[16:19], a[220:223], a[96:99], a[16:19]
  s_waitcnt lgkmcnt(1)
  v_rcp_f32 v172, v172
  v_mfma_f32_16x16x32_bf16 a[16:19], a[224:227], a[112:115], a[16:19]
  s_waitcnt lgkmcnt(0)
  v_rcp_f32 v173, v173
  v_mfma_f32_16x16x32_bf16 a[16:19], a[228:231], a[128:131], a[16:19]
  v_rcp_f32 v174, v174
  v_mfma_f32_16x16x32_bf16 a[20:23], a[228:231], a[132:135], a[20:23]
  v_rcp_f32 v175, v175
  v_mfma_f32_16x16x32_bf16 a[20:23], a[224:227], a[116:119], a[20:23]
  ds_read_b64_tr_b16 a[252:253], v1 offset:36992
  v_cvt_pk_bf16_f32 v60, v60, v61
  v_mfma_f32_16x16x32_bf16 a[20:23], a[220:223], a[100:103], a[20:23]
  ds_read_b64_tr_b16 a[248:249], v1 offset:24704
  v_cvt_pk_bf16_f32 v61, v62, v63
  v_mfma_f32_16x16x32_bf16 a[20:23], a[216:219], a[84:87], a[20:23]
  ds_read_b64_tr_b16 a[250:251], v1 offset:30848
  v_mul_f32 v176, v160, v176
  v_mfma_f32_16x16x32_bf16 a[20:23], a[212:215], a[196:199], a[20:23]
  s_mov_b32 s55, 98304
  ds_read_b64_tr_b16 a[244:245], v1 offset:12416
  v_mul_f32 v177, v161, v177
  v_mfma_f32_16x16x32_bf16 a[20:23], a[208:211], a[180:183], a[20:23]
  ds_read_b64_tr_b16 a[240:241], v1 offset:128
  v_accvgpr_read_b32 v50, a0
  v_mfma_f32_16x16x32_bf16 a[24:27], a[208:211], a[184:187], a[24:27]
  ds_read_b64_tr_b16 a[236:237], v9 offset:49280
  v_accvgpr_read_b32 v51, a1
  v_mfma_f32_16x16x32_bf16 a[24:27], a[212:215], a[200:203], a[24:27]
  ds_read_b64_tr_b16 a[232:233], v9 offset:36992
  v_mul_f32 v224, v208, v224
  v_mfma_f32_16x16x32_bf16 a[24:27], a[216:219], a[88:91], a[24:27]
  s_add_u32 s57, s57, s72
  ds_read_b64_tr_b16 a[234:235], v9 offset:43136
  v_mul_f32 v208, s80, v208
  v_mfma_f32_16x16x32_bf16 a[24:27], a[220:223], a[104:107], a[24:27]
  s_lshl_b32 s58, s44, 7
  ds_read_b64_tr_b16 a[238:239], v9 offset:55424
  v_mul_f32 v225, v209, v225
  v_mfma_f32_16x16x32_bf16 a[24:27], a[224:227], a[120:123], a[24:27]
  s_add_u32 s57, s57, s58
  ds_read_b64_tr_b16 a[242:243], v1 offset:6272
  v_mul_f32 v209, s80, v209
  v_mfma_f32_16x16x32_bf16 a[24:27], a[228:231], a[136:139], a[24:27]
  s_mul_i32 s57, s57, 1920
  ds_read_b64_tr_b16 a[246:247], v1 offset:18560
  v_mul_f32 v226, v210, v226
  v_mfma_f32_16x16x32_bf16 a[28:31], a[228:231], a[140:143], a[28:31]
  buffer_load_dword v23, v24, s[28:31], s57 offen
  v_mfma_f32_16x16x32_bf16 a[28:31], a[224:227], a[124:127], a[28:31]
  ds_read_b64_tr_b16 a[254:255], v1 offset:43136
  v_mul_f32 v210, s80, v210
  v_mfma_f32_16x16x32_bf16 a[28:31], a[220:223], a[108:111], a[28:31]
  v_mul_f32 v227, v211, v227
  v_mul_f32 v211, s80, v211
  v_mfma_f32_16x16x32_bf16 a[28:31], a[216:219], a[92:95], a[28:31]
  buffer_load_dword v22, v44, s[16:19], s55 offen
  v_mfma_f32_16x16x32_bf16 a[28:31], a[212:215], a[204:207], a[28:31]
  v_exp_f32 v208, v208
  v_mfma_f32_16x16x32_bf16 a[28:31], a[208:211], a[188:191], a[28:31]
  s_waitcnt lgkmcnt(4)
  v_exp_f32 v209, v209
  v_mfma_f32_16x16x32_bf16 v[92:95], a[232:235], a[188:191], v[92:95]
  s_waitcnt lgkmcnt(3)
  v_exp_f32 v210, v210
  v_mfma_f32_16x16x32_bf16 v[92:95], a[236:239], a[204:207], v[92:95]
  s_waitcnt lgkmcnt(2)
  v_exp_f32 v211, v211
  v_mfma_f32_16x16x32_bf16 v[92:95], a[240:243], a[92:95], v[92:95]
  s_waitcnt lgkmcnt(1)
  v_fma_f32 v208, v208, s81, s81
  v_fma_f32 v209, v209, s81, s81
  v_mfma_f32_16x16x32_bf16 v[92:95], a[244:247], a[108:111], v[92:95]
  v_fma_f32 v210, v210, s81, s81
  v_fma_f32 v211, v211, s81, s81
  v_mfma_f32_16x16x32_bf16 v[92:95], a[248:251], a[124:127], v[92:95]
  s_waitcnt lgkmcnt(0)
  v_rcp_f32 v208, v208
  v_mfma_f32_16x16x32_bf16 v[92:95], a[252:255], a[140:143], v[92:95]
  v_rcp_f32 v209, v209
  v_mfma_f32_16x16x32_bf16 v[88:91], a[252:255], a[136:139], v[88:91]
  v_rcp_f32 v210, v210
  v_mfma_f32_16x16x32_bf16 v[88:91], a[248:251], a[120:123], v[88:91]
  v_rcp_f32 v211, v211
  v_mfma_f32_16x16x32_bf16 v[88:91], a[244:247], a[104:107], v[88:91]
  ds_read_b64_tr_b16 a[228:229], v1 offset:37000
  v_mul_f32 v178, v162, v178
  v_mfma_f32_16x16x32_bf16 v[88:91], a[240:243], a[88:91], v[88:91]
  ds_read_b64_tr_b16 a[224:225], v1 offset:24712
  v_mul_f32 v179, v163, v179
  v_mfma_f32_16x16x32_bf16 v[88:91], a[236:239], a[200:203], v[88:91]
L_pg6:
  s_cbranch_execz L_hop1
  ds_read_b64_tr_b16 a[220:221], v1 offset:12424
  v_cvt_pk_bf16_f32 v194, v176, v177
  v_mfma_f32_16x16x32_bf16 v[88:91], a[232:235], a[184:187], v[88:91]
  ds_read_b64_tr_b16 a[216:217], v1 offset:136
  v_cvt_pk_bf16_f32 v195, v178, v179
  v_mfma_f32_16x16x32_bf16 v[84:87], a[232:235], a[180:183], v[84:87]
  ds_read_b64_tr_b16 a[212:213], v9 offset:49288
  v_mul_f32 v180, v164, v180
  v_mfma_f32_16x16x32_bf16 v[84:87], a[236:239], a[196:199], v[84:87]
  ds_read_b64_tr_b16 a[208:209], v9 offset:37000
  v_mul_f32 v181, v165, v181
  v_mfma_f32_16x16x32_bf16 v[84:87], a[240:243], a[84:87], v[84:87]
  ds_read_b64_tr_b16 a[210:211], v9 offset:43144
  v_mul_f32 v228, v212, v228
  v_mfma_f32_16x16x32_bf16 v[84:87], a[244:247], a[100:103], v[84:87]
  ds_read_b64_tr_b16 a[214:215], v9 offset:55432
  v_mul_f32 v212, s80, v212
  v_mfma_f32_16x16x32_bf16 v[84:87], a[248:251], a[116:119], v[84:87]
  ds_read_b64_tr_b16 a[218:219], v1 offset:6280
  v_mul_f32 v229, v213, v229
  v_mfma_f32_16x16x32_bf16 v[84:87], a[252:255], a[132:135], v[84:87]
  ds_read_b64_tr_b16 a[222:223], v1 offset:18568
  v_mul_f32 v213, s80, v213
  v_mfma_f32_16x16x32_bf16 v[80:83], a[252:255], a[128:131], v[80:83]
  ds_read_b64_tr_b16 a[226:227], v1 offset:30856
  v_mul_f32 v230, v214, v230
  v_mfma_f32_16x16x32_bf16 v[80:83], a[248:251], a[112:115], v[80:83]
  ds_read_b64_tr_b16 a[230:231], v1 offset:43144
  v_mul_f32 v214, s80, v214
  v_mfma_f32_16x16x32_bf16 v[80:83], a[244:247], a[96:99], v[80:83]
  v_mul_f32 v231, v215, v231
  v_mul_f32 v215, s80, v215
  v_mfma_f32_16x16x32_bf16 v[80:83], a[240:243], a[80:83], v[80:83]
  v_exp_f32 v212, v212
  v_mfma_f32_16x16x32_bf16 v[80:83], a[236:239], a[192:195], v[80:83]
  v_exp_f32 v213, v213
  v_mfma_f32_16x16x32_bf16 v[80:83], a[232:235], a[176:179], v[80:83]
  s_waitcnt lgkmcnt(5)
  v_exp_f32 v214, v214
  v_mfma_f32_16x16x32_bf16 a[32:35], a[208:211], a[176:179], a[32:35]
  s_waitcnt lgkmcnt(4)
  v_exp_f32 v215, v215
  v_mfma_f32_16x16x32_bf16 a[32:35], a[212:215], a[192:195], a[32:35]
  s_waitcnt lgkmcnt(3)
  v_fma_f32 v212, v212, s81, s81
  v_fma_f32 v213, v213, s81, s81
  v_mfma_f32_16x16x32_bf16 a[32:35], a[216:219], a[80:83], a[32:35]
  s_waitcnt lgkmcnt(2)
  v_fma_f32 v214, v214, s81, s81
  v_fma_f32 v215, v215, s81, s81
  v_mfma_f32_16x16x32_bf16 a[32:35], a[220:223], a[96:99], a[32:35]
  s_waitcnt lgkmcnt(1)
  v_rcp_f32 v212, v212
  v_mfma_f32_16x16x32_bf16 a[32:35], a[224:227], a[112:115], a[32:35]
  s_waitcnt lgkmcnt(0)
  v_rcp_f32 v213, v213
  v_mfma_f32_16x16x32_bf16 a[32:35], a[228:231], a[128:131], a[32:35]
  v_rcp_f32 v214, v214
  v_mfma_f32_16x16x32_bf16 a[36:39], a[228:231], a[132:135], a[36:39]
  v_rcp_f32 v215, v215
  v_mfma_f32_16x16x32_bf16 a[36:39], a[224:227], a[116:119], a[36:39]
  s_mov_b32 s75, 122880
  ds_read_b64_tr_b16 a[252:253], v2 offset:36992
  v_mul_f32 v182, v166, v182
  v_mfma_f32_16x16x32_bf16 a[36:39], a[220:223], a[100:103], a[36:39]
  ds_read_b64_tr_b16 a[248:249], v2 offset:24704
  v_mul_f32 v183, v167, v183
  v_mfma_f32_16x16x32_bf16 a[36:39], a[216:219], a[84:87], a[36:39]
  ds_read_b64_tr_b16 a[250:251], v2 offset:30848
  v_cvt_pk_bf16_f32 v198, v180, v181
  v_mfma_f32_16x16x32_bf16 a[36:39], a[212:215], a[196:199], a[36:39]
  ds_read_b64_tr_b16 a[244:245], v2 offset:12416
  v_cvt_pk_bf16_f32 v199, v182, v183
  v_mfma_f32_16x16x32_bf16 a[36:39], a[208:211], a[180:183], a[36:39]
  ds_read_b64_tr_b16 a[240:241], v2 offset:128
  v_mul_f32 v184, v168, v184
  v_mfma_f32_16x16x32_bf16 a[40:43], a[208:211], a[184:187], a[40:43]
  ds_read_b64_tr_b16 a[236:237], v10 offset:49280
  v_mul_f32 v185, v169, v185
  v_mfma_f32_16x16x32_bf16 a[40:43], a[212:215], a[200:203], a[40:43]
  ds_read_b64_tr_b16 a[232:233], v10 offset:36992
  v_mul_f32 v186, v170, v186
  v_mfma_f32_16x16x32_bf16 a[40:43], a[216:219], a[88:91], a[40:43]
  ds_read_b64_tr_b16 a[234:235], v10 offset:43136
  v_mul_f32 v187, v171, v187
  v_mfma_f32_16x16x32_bf16 a[40:43], a[220:223], a[104:107], a[40:43]
  ds_read_b64_tr_b16 a[238:239], v10 offset:55424
  v_mul_f32 v232, v216, v232
  v_mfma_f32_16x16x32_bf16 a[40:43], a[224:227], a[120:123], a[40:43]
  ds_read_b64_tr_b16 a[242:243], v2 offset:6272
  v_mul_f32 v216, s80, v216
  v_mfma_f32_16x16x32_bf16 a[40:43], a[228:231], a[136:139], a[40:43]
  s_getpc_b64 s[82:83]
  ds_read_b64_tr_b16 a[246:247], v2 offset:18560
  v_mul_f32 v233, v217, v233
  v_mfma_f32_16x16x32_bf16 a[44:47], a[228:231], a[140:143], a[44:47]
  buffer_load_dword v22, v44, s[20:23], s75 offen
  v_mfma_f32_16x16x32_bf16 a[44:47], a[224:227], a[124:127], a[44:47]
  ds_read_b64_tr_b16 a[254:255], v2 offset:43136
  v_mul_f32 v217, s80, v217
  v_mfma_f32_16x16x32_bf16 a[44:47], a[220:223], a[108:111], a[44:47]
  v_mul_f32 v234, v218, v234
  v_mul_f32 v218, s80, v218
  v_mfma_f32_16x16x32_bf16 a[44:47], a[216:219], a[92:95], a[44:47]
  v_mul_f32 v235, v219, v235
  v_mul_f32 v219, s80, v219
  v_mfma_f32_16x16x32_bf16 a[44:47], a[212:215], a[204:207], a[44:47]
  v_exp_f32 v216, v216
  v_mfma_f32_16x16x32_bf16 a[44:47], a[208:211], a[188:191], a[44:47]
  s_waitcnt lgkmcnt(4)
  v_exp_f32 v217, v217
  v_mfma_f32_16x16x32_bf16 v[108:111], a[232:235], a[188:191], v[108:111]
  s_waitcnt lgkmcnt(3)
  v_exp_f32 v218, v218
  v_mfma_f32_16x16x32_bf16 v[108:111], a[236:239], a[204:207], v[108:111]
  s_waitcnt lgkmcnt(2)
  v_exp_f32 v219, v219
  v_mfma_f32_16x16x32_bf16 v[108:111], a[240:243], a[92:95], v[108:111]
  s_waitcnt lgkmcnt(1)
  v_cvt_pk_bf16_f32 v202, v184, v185
  v_fma_f32 v216, v216, s81, s81
  v_mfma_f32_16x16x32_bf16 v[108:111], a[244:247], a[108:111], v[108:111]
  s_waitcnt lgkmcnt(0)
  v_fma_f32 v217, v217, s81, s81
  v_fma_f32 v218, v218, s81, s81
  v_mfma_f32_16x16x32_bf16 v[108:111], a[248:251], a[124:127], v[108:111]
  global_load_dword v25, v25, s[82:83]
  v_mfma_f32_16x16x32_bf16 v[108:111], a[252:255], a[140:143], v[108:111]
  v_rcp_f32 v216, v216
  v_mfma_f32_16x16x32_bf16 v[104:107], a[252:255], a[136:139], v[104:107]
  v_rcp_f32 v217, v217
  v_mfma_f32_16x16x32_bf16 v[104:107], a[248:251], a[120:123], v[104:107]
  v_rcp_f32 v218, v218
  v_mfma_f32_16x16x32_bf16 v[104:107], a[244:247], a[104:107], v[104:107]
  ds_read_b64_tr_b16 a[228:229], v2 offset:37000
  v_cvt_pk_bf16_f32 v203, v186, v187
  v_mfma_f32_16x16x32_bf16 v[104:107], a[240:243], a[88:91], v[104:107]
  ds_read_b64_tr_b16 a[224:225], v2 offset:24712
  v_mul_f32 v188, v172, v188
  v_mfma_f32_16x16x32_bf16 v[104:107], a[236:239], a[200:203], v[104:107]
  ds_read_b64_tr_b16 a[220:221], v2 offset:12424
  v_mul_f32 v189, v173, v189
  v_mfma_f32_16x16x32_bf16 v[104:107], a[232:235], a[184:187], v[104:107]
  ds_read_b64_tr_b16 a[216:217], v2 offset:136
  v_mul_f32 v190, v174, v190
  v_mfma_f32_16x16x32_bf16 v[100:103], a[232:235], a[180:183], v[100:103]
  ds_read_b64_tr_b16 a[212:213], v10 offset:49288
  v_mul_f32 v191, v175, v191
  v_mfma_f32_16x16x32_bf16 v[100:103], a[236:239], a[196:199], v[100:103]
  ds_read_b64_tr_b16 a[208:209], v10 offset:37000
  v_cvt_pk_bf16_f32 v206, v188, v189
  v_mfma_f32_16x16x32_bf16 v[100:103], a[240:243], a[84:87], v[100:103]
  ds_read_b64_tr_b16 a[210:211], v10 offset:43144
  v_cvt_pk_bf16_f32 v207, v190, v191
  v_mfma_f32_16x16x32_bf16 v[100:103], a[244:247], a[100:103], v[100:103]
  ds_read_b64_tr_b16 a[214:215], v10 offset:55432
  v_mul_f32 v224, v208, v224
  v_mfma_f32_16x16x32_bf16 v[100:103], a[248:251], a[116:119], v[100:103]
  ds_read_b64_tr_b16 a[218:219], v2 offset:6280
  v_mul_f32 v225, v209, v225
  v_mfma_f32_16x16x32_bf16 v[100:103], a[252:255], a[132:135], v[100:103]
  ds_read_b64_tr_b16 a[222:223], v2 offset:18568
  v_mul_f32 v226, v210, v226
  v_mfma_f32_16x16x32_bf16 v[96:99], a[252:255], a[128:131], v[96:99]
  ds_read_b64_tr_b16 a[226:227], v2 offset:30856
  v_mul_f32 v227, v211, v227
  v_mfma_f32_16x16x32_bf16 v[96:99], a[248:251], a[112:115], v[96:99]
  ds_read_b64_tr_b16 a[230:231], v2 offset:43144
  v_fma_f32 v219, v219, s81, s81
  v_mfma_f32_16x16x32_bf16 v[96:99], a[244:247], a[96:99], v[96:99]
  v_rcp_f32 v219, v219
  v_mfma_f32_16x16x32_bf16 v[96:99], a[240:243], a[80:83], v[96:99]
  v_mul_f32 v236, v220, v236
  v_mul_f32 v220, s80, v220
  v_mfma_f32_16x16x32_bf16 v[96:99], a[236:239], a[192:195], v[96:99]
  v_mul_f32 v237, v221, v237
  v_mul_f32 v221, s80, v221
  v_mfma_f32_16x16x32_bf16 v[96:99], a[232:235], a[176:179], v[96:99]
  s_waitcnt lgkmcnt(5)
  v_mul_f32 v238, v222, v238
  v_mul_f32 v222, s80, v222
  v_mfma_f32_16x16x32_bf16 a[48:51], a[208:211], a[176:179], a[48:51]
  s_waitcnt lgkmcnt(4)
  v_mul_f32 v239, v223, v239
  v_mul_f32 v223, s80, v223
  v_mfma_f32_16x16x32_bf16 a[48:51], a[212:215], a[192:195], a[48:51]
  s_waitcnt lgkmcnt(3)
  v_exp_f32 v220, v220
  v_mfma_f32_16x16x32_bf16 a[48:51], a[216:219], a[80:83], a[48:51]
  s_waitcnt lgkmcnt(2)
  v_exp_f32 v221, v221
  v_mfma_f32_16x16x32_bf16 a[48:51], a[220:223], a[96:99], a[48:51]
  s_waitcnt lgkmcnt(0)
  v_exp_f32 v222, v222
  v_mfma_f32_16x16x32_bf16 a[48:51], a[224:227], a[112:115], a[48:51]
  s_mov_b32 s59, 147456
  v_exp_f32 v223, v223
  v_mfma_f32_16x16x32_bf16 a[48:51], a[228:231], a[128:131], a[48:51]
  v_cvt_pk_bf16_f32 v208, v224, v225
  v_fma_f32 v220, v220, s81, s81
  v_mfma_f32_16x16x32_bf16 a[52:55], a[228:231], a[132:135], a[52:55]
  v_rcp_f32 v220, v220
  v_mfma_f32_16x16x32_bf16 a[52:55], a[224:227], a[116:119], a[52:55]
  ds_read_b64_tr_b16 a[252:253], v1 offset:37120
  v_cvt_pk_bf16_f32 v209, v226, v227
  v_mfma_f32_16x16x32_bf16 a[52:55], a[220:223], a[100:103], a[52:55]
  ds_read_b64_tr_b16 a[248:249], v1 offset:24832
  v_mul_f32 v228, v212, v228
  v_mfma_f32_16x16x32_bf16 a[52:55], a[216:219], a[84:87], a[52:55]
  ds_read_b64_tr_b16 a[244:245], v1 offset:12544
  v_mul_f32 v229, v213, v229
  v_mfma_f32_16x16x32_bf16 a[52:55], a[212:215], a[196:199], a[52:55]
  ds_read_b64_tr_b16 a[240:241], v1 offset:256
  v_mul_f32 v230, v214, v230
  v_mfma_f32_16x16x32_bf16 a[52:55], a[208:211], a[180:183], a[52:55]
  ds_read_b64_tr_b16 a[236:237], v9 offset:49408
  v_mul_f32 v231, v215, v231
  v_mfma_f32_16x16x32_bf16 a[56:59], a[208:211], a[184:187], a[56:59]
  ds_read_b64_tr_b16 a[238:239], v9 offset:55552
  v_cvt_pk_bf16_f32 v212, v228, v229
  v_mfma_f32_16x16x32_bf16 a[56:59], a[212:215], a[200:203], a[56:59]
  ds_read_b64_tr_b16 a[232:233], v9 offset:37120
  v_cvt_pk_bf16_f32 v213, v230, v231
  v_mfma_f32_16x16x32_bf16 a[56:59], a[216:219], a[88:91], a[56:59]
  ds_read_b64_tr_b16 a[234:235], v9 offset:43264
  v_mul_f32 v232, v216, v232
  v_mfma_f32_16x16x32_bf16 a[56:59], a[220:223], a[104:107], a[56:59]
  buffer_load_dword v22, v44, s[16:19], s59 offen
  v_mfma_f32_16x16x32_bf16 a[56:59], a[224:227], a[120:123], a[56:59]
  ds_read_b64_tr_b16 a[242:243], v1 offset:6400
  v_mul_f32 v233, v217, v233
  v_mfma_f32_16x16x32_bf16 a[56:59], a[228:231], a[136:139], a[56:59]
  ds_read_b64_tr_b16 a[246:247], v1 offset:18688
  v_mul_f32 v234, v218, v234
  v_mfma_f32_16x16x32_bf16 a[60:63], a[228:231], a[140:143], a[60:63]
  ds_read_b64_tr_b16 a[250:251], v1 offset:30976
  v_mul_f32 v235, v219, v235
  v_mfma_f32_16x16x32_bf16 a[60:63], a[224:227], a[124:127], a[60:63]
  ds_read_b64_tr_b16 a[254:255], v1 offset:43264
  v_fma_f32 v221, v221, s81, s81
  v_mfma_f32_16x16x32_bf16 a[60:63], a[220:223], a[108:111], a[60:63]
  v_rcp_f32 v221, v221
  v_mfma_f32_16x16x32_bf16 a[60:63], a[216:219], a[92:95], a[60:63]
  v_cvt_pk_bf16_f32 v50, v50, v51
  v_accvgpr_read_b32 v42, a3
  v_mfma_f32_16x16x32_bf16 a[60:63], a[212:215], a[204:207], a[60:63]
  v_accvgpr_read_b32 v51, a2
  v_accvgpr_read_b32 v54, a4
  v_mfma_f32_16x16x32_bf16 a[60:63], a[208:211], a[188:191], a[60:63]
  s_waitcnt lgkmcnt(4)
  v_cvt_pk_bf16_f32 v51, v51, v42
  v_accvgpr_read_b32 v55, a5
  v_mfma_f32_16x16x32_bf16 v[124:127], a[232:235], a[188:191], v[124:127]
  v_cvt_pk_bf16_f32 v54, v54, v55
  v_accvgpr_read_b32 v43, a7
  v_mfma_f32_16x16x32_bf16 v[124:127], a[236:239], a[204:207], v[124:127]
  s_waitcnt lgkmcnt(3)
  v_accvgpr_read_b32 v55, a6
  v_accvgpr_read_b32 v58, a8
  v_mfma_f32_16x16x32_bf16 v[124:127], a[240:243], a[92:95], v[124:127]
  s_waitcnt lgkmcnt(2)
  v_cvt_pk_bf16_f32 v55, v55, v43
  v_accvgpr_read_b32 v59, a9
  v_mfma_f32_16x16x32_bf16 v[124:127], a[244:247], a[108:111], v[124:127]
  s_waitcnt lgkmcnt(1)
  v_cvt_pk_bf16_f32 v58, v58, v59
  v_accvgpr_read_b32 v42, a11
  v_mfma_f32_16x16x32_bf16 v[124:127], a[248:251], a[124:127], v[124:127]
  s_waitcnt lgkmcnt(0)
  v_accvgpr_read_b32 v59, a10
  v_accvgpr_read_b32 v62, a12
  v_mfma_f32_16x16x32_bf16 v[124:127], a[252:255], a[140:143], v[124:127]
  buffer_store_dwordx4 v[192:195], v37, s[4:7], s76 offen offset:0 sc1
  v_mfma_f32_16x16x32_bf16 v[120:123], a[252:255], a[136:139], v[120:123]
  v_cvt_pk_bf16_f32 v59, v59, v42
  v_accvgpr_read_b32 v63, a13
  v_mfma_f32_16x16x32_bf16 v[120:123], a[248:251], a[120:123], v[120:123]
  v_cvt_pk_bf16_f32 v64, v64, v65
  v_cvt_pk_bf16_f32 v65, v66, v67
  v_mfma_f32_16x16x32_bf16 v[120:123], a[244:247], a[104:107], v[120:123]
  ds_read_b64_tr_b16 a[228:229], v1 offset:37128
  v_cvt_pk_bf16_f32 v62, v62, v63
  v_mfma_f32_16x16x32_bf16 v[120:123], a[240:243], a[88:91], v[120:123]
  ds_read_b64_tr_b16 a[224:225], v1 offset:24840
  v_accvgpr_read_b32 v43, a15
  v_mfma_f32_16x16x32_bf16 v[120:123], a[236:239], a[200:203], v[120:123]
  ds_read_b64_tr_b16 a[220:221], v1 offset:12552
  v_accvgpr_read_b32 v63, a14
  v_mfma_f32_16x16x32_bf16 v[120:123], a[232:235], a[184:187], v[120:123]
  ds_read_b64_tr_b16 a[216:217], v1 offset:264
  v_cvt_pk_bf16_f32 v63, v63, v43
  v_mfma_f32_16x16x32_bf16 v[116:119], a[232:235], a[180:183], v[116:119]
  ds_read_b64_tr_b16 a[212:213], v9 offset:49416
  v_cvt_pk_bf16_f32 v68, v68, v69
  v_mfma_f32_16x16x32_bf16 v[116:119], a[236:239], a[196:199], v[116:119]
  ds_read_b64_tr_b16 a[208:209], v9 offset:37128
  v_cvt_pk_bf16_f32 v69, v70, v71
  v_mfma_f32_16x16x32_bf16 v[116:119], a[240:243], a[84:87], v[116:119]
  ds_read_b64_tr_b16 a[210:211], v9 offset:43272
  v_cvt_pk_bf16_f32 v72, v72, v73
  v_mfma_f32_16x16x32_bf16 v[116:119], a[244:247], a[100:103], v[116:119]
  ds_read_b64_tr_b16 a[214:215], v9 offset:55560
  v_cvt_pk_bf16_f32 v73, v74, v75
  v_mfma_f32_16x16x32_bf16 v[116:119], a[248:251], a[116:119], v[116:119]
  ds_read_b64_tr_b16 a[218:219], v1 offset:6408
  v_cvt_pk_bf16_f32 v76, v76, v77
  v_mfma_f32_16x16x32_bf16 v[116:119], a[252:255], a[132:135], v[116:119]
  ds_read_b64_tr_b16 a[222:223], v1 offset:18696
  v_cvt_pk_bf16_f32 v77, v78, v79
  v_mfma_f32_16x16x32_bf16 v[112:115], a[252:255], a[128:131], v[112:115]
  ds_read_b64_tr_b16 a[226:227], v1 offset:30984
  v_accvgpr_read_b32 v66, a16
  v_mfma_f32_16x16x32_bf16 v[112:115], a[248:251], a[112:115], v[112:115]
  ds_read_b64_tr_b16 a[230:231], v1 offset:43272
  v_accvgpr_read_b32 v67, a17
  v_mfma_f32_16x16x32_bf16 v[112:115], a[244:247], a[96:99], v[112:115]
  v_cvt_pk_bf16_f32 v66, v66, v67
  v_accvgpr_read_b32 v42, a19
  v_mfma_f32_16x16x32_bf16 v[112:115], a[240:243], a[80:83], v[112:115]
  v_accvgpr_read_b32 v67, a18
  v_accvgpr_read_b32 v70, a20
  v_mfma_f32_16x16x32_bf16 v[112:115], a[236:239], a[192:195], v[112:115]
  v_cvt_pk_bf16_f32 v67, v67, v42
  v_accvgpr_read_b32 v71, a21
  v_mfma_f32_16x16x32_bf16 v[112:115], a[232:235], a[176:179], v[112:115]
  s_waitcnt lgkmcnt(5)
  v_cvt_pk_bf16_f32 v70, v70, v71
  v_accvgpr_read_b32 v43, a23
  v_mfma_f32_16x16x32_bf16 a[64:67], a[208:211], a[176:179], a[64:67]
  s_waitcnt lgkmcnt(3)
  v_accvgpr_read_b32 v71, a22
  v_accvgpr_read_b32 v74, a24
  v_mfma_f32_16x16x32_bf16 a[64:67], a[212:215], a[192:195], a[64:67]
  s_mov_b32 s60, 147456
  v_cvt_pk_bf16_f32 v71, v71, v43
  v_accvgpr_read_b32 v75, a25
  v_mfma_f32_16x16x32_bf16 a[64:67], a[216:219], a[80:83], a[64:67]
  s_waitcnt lgkmcnt(2)
  v_cvt_pk_bf16_f32 v74, v74, v75
  v_accvgpr_read_b32 v42, a27
  v_mfma_f32_16x16x32_bf16 a[64:67], a[220:223], a[96:99], a[64:67]
  s_waitcnt lgkmcnt(1)
  v_accvgpr_read_b32 v75, a26
  v_accvgpr_read_b32 v78, a28
  v_mfma_f32_16x16x32_bf16 a[64:67], a[224:227], a[112:115], a[64:67]
  s_waitcnt lgkmcnt(0)
  v_cvt_pk_bf16_f32 v75, v75, v42
  v_accvgpr_read_b32 v79, a29
  v_mfma_f32_16x16x32_bf16 a[64:67], a[228:231], a[128:131], a[64:67]
  v_cvt_pk_bf16_f32 v80, v80, v81
  v_cvt_pk_bf16_f32 v81, v82, v83
  v_mfma_f32_16x16x32_bf16 a[68:71], a[228:231], a[132:135], a[68:71]
  ds_read_b64_tr_b16 a[252:253], v2 offset:37120
  v_cvt_pk_bf16_f32 v78, v78, v79
  v_mfma_f32_16x16x32_bf16 a[68:71], a[224:227], a[116:119], a[68:71]
  ds_read_b64_tr_b16 a[248:249], v2 offset:24832
  v_accvgpr_read_b32 v43, a31
  v_mfma_f32_16x16x32_bf16 a[68:71], a[220:223], a[100:103], a[68:71]
  ds_read_b64_tr_b16 a[244:245], v2 offset:12544
  v_accvgpr_read_b32 v79, a30
  v_mfma_f32_16x16x32_bf16 a[68:71], a[216:219], a[84:87], a[68:71]
  ds_read_b64_tr_b16 a[240:241], v2 offset:256
  v_cvt_pk_bf16_f32 v79, v79, v43
  v_mfma_f32_16x16x32_bf16 a[68:71], a[212:215], a[196:199], a[68:71]
  ds_read_b64_tr_b16 a[236:237], v10 offset:49408
  v_cvt_pk_bf16_f32 v84, v84, v85
  v_mfma_f32_16x16x32_bf16 a[68:71], a[208:211], a[180:183], a[68:71]
  ds_read_b64_tr_b16 a[232:233], v10 offset:37120
  v_cvt_pk_bf16_f32 v85, v86, v87
  v_mfma_f32_16x16x32_bf16 a[72:75], a[208:211], a[184:187], a[72:75]
  buffer_load_dword v22, v44, s[20:23], s60 offen
  v_mfma_f32_16x16x32_bf16 a[72:75], a[212:215], a[200:203], a[72:75]
  ds_read_b64_tr_b16 a[234:235], v10 offset:43264
  v_cvt_pk_bf16_f32 v88, v88, v89
  v_mfma_f32_16x16x32_bf16 a[72:75], a[216:219], a[88:91], a[72:75]
  buffer_store_dwordx4 v[196:199], v37, s[4:7], s76 offen offset:1024 sc1
  v_mfma_f32_16x16x32_bf16 a[72:75], a[220:223], a[104:107], a[72:75]
  ds_read_b64_tr_b16 a[238:239], v10 offset:55552
  v_cvt_pk_bf16_f32 v89, v90, v91
  v_mfma_f32_16x16x32_bf16 a[72:75], a[224:227], a[120:123], a[72:75]
  ds_read_b64_tr_b16 a[242:243], v2 offset:6400
  v_cvt_pk_bf16_f32 v92, v92, v93
  v_mfma_f32_16x16x32_bf16 a[72:75], a[228:231], a[136:139], a[72:75]
  ds_read_b64_tr_b16 a[246:247], v2 offset:18688
  v_cvt_pk_bf16_f32 v93, v94, v95
  v_mfma_f32_16x16x32_bf16 a[76:79], a[228:231], a[140:143], a[76:79]
  ds_read_b64_tr_b16 a[250:251], v2 offset:30976
  v_accvgpr_read_b32 v82, a32
  v_mfma_f32_16x16x32_bf16 a[76:79], a[224:227], a[124:127], a[76:79]
  ds_read_b64_tr_b16 a[254:255], v2 offset:43264
  v_accvgpr_read_b32 v83, a33
  v_mfma_f32_16x16x32_bf16 a[76:79], a[220:223], a[108:111], a[76:79]
  v_cvt_pk_bf16_f32 v82, v82, v83
  v_accvgpr_read_b32 v42, a35
  v_mfma_f32_16x16x32_bf16 a[76:79], a[216:219], a[92:95], a[76:79]
  v_accvgpr_read_b32 v83, a34
  v_accvgpr_read_b32 v86, a36
  v_mfma_f32_16x16x32_bf16 a[76:79], a[212:215], a[204:207], a[76:79]
  v_cvt_pk_bf16_f32 v83, v83, v42
  v_accvgpr_read_b32 v87, a37
  v_mfma_f32_16x16x32_bf16 a[76:79], a[208:211], a[188:191], a[76:79]
  s_waitcnt lgkmcnt(5)
  v_cvt_pk_bf16_f32 v86, v86, v87
  v_accvgpr_read_b32 v43, a39
  v_mfma_f32_16x16x32_bf16 v[140:143], a[232:235], a[188:191], v[140:143]
  s_waitcnt lgkmcnt(4)
  v_accvgpr_read_b32 v87, a38
  v_accvgpr_read_b32 v90, a40
  v_mfma_f32_16x16x32_bf16 v[140:143], a[236:239], a[204:207], v[140:143]
  s_waitcnt lgkmcnt(3)
  v_cvt_pk_bf16_f32 v87, v87, v43
  v_accvgpr_read_b32 v91, a41
  v_mfma_f32_16x16x32_bf16 v[140:143], a[240:243], a[92:95], v[140:143]
  s_waitcnt lgkmcnt(2)
  v_cvt_pk_bf16_f32 v90, v90, v91
  v_accvgpr_read_b32 v42, a43
  v_mfma_f32_16x16x32_bf16 v[140:143], a[244:247], a[108:111], v[140:143]
  s_waitcnt lgkmcnt(1)
  v_accvgpr_read_b32 v91, a42
  v_accvgpr_read_b32 v94, a44
  v_mfma_f32_16x16x32_bf16 v[140:143], a[248:251], a[124:127], v[140:143]
  s_waitcnt vmcnt(29)
  s_barrier
  v_cvt_pk_bf16_f32 v91, v91, v42
  v_accvgpr_read_b32 v95, a45
  s_waitcnt lgkmcnt(0)
  v_mfma_f32_16x16x32_bf16 v[140:143], a[252:255], a[140:143], v[140:143]
  v_cvt_pk_bf16_f32 v96, v96, v97
  v_cvt_pk_bf16_f32 v97, v98, v99
  v_mfma_f32_16x16x32_bf16 v[136:139], a[252:255], a[136:139], v[136:139]
  v_cvt_pk_bf16_f32 v94, v94, v95
  v_accvgpr_read_b32 v43, a47
  v_mfma_f32_16x16x32_bf16 v[136:139], a[248:251], a[120:123], v[136:139]
  v_accvgpr_read_b32 v95, a46
  v_cvt_pk_bf16_f32 v100, v100, v101
  v_mfma_f32_16x16x32_bf16 v[136:139], a[244:247], a[104:107], v[136:139]
  ds_read_b64_tr_b16 a[228:229], v2 offset:37128
  v_cvt_pk_bf16_f32 v95, v95, v43
  v_mfma_f32_16x16x32_bf16 v[136:139], a[240:243], a[88:91], v[136:139]
  ds_read_b64_tr_b16 a[224:225], v2 offset:24840
  v_cvt_pk_bf16_f32 v101, v102, v103
  v_mfma_f32_16x16x32_bf16 v[136:139], a[236:239], a[200:203], v[136:139]
  ds_read_b64_tr_b16 a[220:221], v2 offset:12552
  v_cvt_pk_bf16_f32 v104, v104, v105
  v_mfma_f32_16x16x32_bf16 v[136:139], a[232:235], a[184:187], v[136:139]
  ds_read_b64_tr_b16 a[216:217], v2 offset:264
  v_cvt_pk_bf16_f32 v105, v106, v107
  v_mfma_f32_16x16x32_bf16 v[132:135], a[232:235], a[180:183], v[132:135]
  ds_read_b64_tr_b16 a[212:213], v10 offset:49416
  v_cvt_pk_bf16_f32 v108, v108, v109
  v_mfma_f32_16x16x32_bf16 v[132:135], a[236:239], a[196:199], v[132:135]
  ds_read_b64_tr_b16 a[208:209], v10 offset:37128
  v_cvt_pk_bf16_f32 v109, v110, v111
  v_mfma_f32_16x16x32_bf16 v[132:135], a[240:243], a[84:87], v[132:135]
  ds_read_b64_tr_b16 a[210:211], v10 offset:43272
  v_accvgpr_read_b32 v98, a48
  v_mfma_f32_16x16x32_bf16 v[132:135], a[244:247], a[100:103], v[132:135]
  ds_read_b64_tr_b16 a[214:215], v10 offset:55560
  v_accvgpr_read_b32 v99, a49
  v_mfma_f32_16x16x32_bf16 v[132:135], a[248:251], a[116:119], v[132:135]
  ds_read_b64_tr_b16 a[218:219], v2 offset:6408
  v_cvt_pk_bf16_f32 v98, v98, v99
  v_mfma_f32_16x16x32_bf16 v[132:135], a[252:255], a[132:135], v[132:135]
  ds_read_b64_tr_b16 a[222:223], v2 offset:18696
  v_accvgpr_read_b32 v42, a51
  v_mfma_f32_16x16x32_bf16 v[128:131], a[252:255], a[128:131], v[128:131]
  ds_read_b64_tr_b16 a[226:227], v2 offset:30984
  v_accvgpr_read_b32 v99, a50
  v_mfma_f32_16x16x32_bf16 v[128:131], a[248:251], a[112:115], v[128:131]
  ds_read_b64_tr_b16 a[230:231], v2 offset:43272
  v_cvt_pk_bf16_f32 v99, v99, v42
  v_mfma_f32_16x16x32_bf16 v[128:131], a[244:247], a[96:99], v[128:131]
  v_accvgpr_read_b32 v102, a52
  v_accvgpr_read_b32 v103, a53
  v_mfma_f32_16x16x32_bf16 v[128:131], a[240:243], a[80:83], v[128:131]
  buffer_store_dwordx4 v[200:203], v37, s[4:7], s76 offen offset:2048 sc1
  v_mfma_f32_16x16x32_bf16 v[128:131], a[236:239], a[192:195], v[128:131]
  v_cvt_pk_bf16_f32 v102, v102, v103
  v_accvgpr_read_b32 v43, a55
  v_mfma_f32_16x16x32_bf16 v[128:131], a[232:235], a[176:179], v[128:131]
  s_waitcnt lgkmcnt(5)
  v_accvgpr_read_b32 v103, a54
  v_accvgpr_read_b32 v106, a56
  v_mfma_f32_16x16x32_bf16 v[240:243], a[208:211], a[176:179], v[240:243]
  s_waitcnt lgkmcnt(4)
  v_cvt_pk_bf16_f32 v103, v103, v43
  v_accvgpr_read_b32 v107, a57
  v_mfma_f32_16x16x32_bf16 v[240:243], a[212:215], a[192:195], v[240:243]
  s_waitcnt lgkmcnt(3)
  v_cvt_pk_bf16_f32 v106, v106, v107
  v_accvgpr_read_b32 v42, a59
  v_mfma_f32_16x16x32_bf16 v[240:243], a[216:219], a[80:83], v[240:243]
  s_waitcnt lgkmcnt(2)
  v_accvgpr_read_b32 v107, a58
  v_accvgpr_read_b32 v110, a60
  v_mfma_f32_16x16x32_bf16 v[240:243], a[220:223], a[96:99], v[240:243]
  s_waitcnt lgkmcnt(1)
  v_cvt_pk_bf16_f32 v107, v107, v42
  v_accvgpr_read_b32 v111, a61
  v_mfma_f32_16x16x32_bf16 v[240:243], a[224:227], a[112:115], v[240:243]
  s_waitcnt lgkmcnt(0)
  v_cvt_pk_bf16_f32 v112, v112, v113
  v_cvt_pk_bf16_f32 v113, v114, v115
  v_mfma_f32_16x16x32_bf16 v[240:243], a[228:231], a[128:131], v[240:243]
  v_cvt_pk_bf16_f32 v110, v110, v111
  v_accvgpr_read_b32 v43, a63
  v_mfma_f32_16x16x32_bf16 v[244:247], a[228:231], a[132:135], v[244:247]
  v_accvgpr_read_b32 v111, a62
  v_cvt_pk_bf16_f32 v116, v116, v117
  v_mfma_f32_16x16x32_bf16 v[244:247], a[224:227], a[116:119], v[244:247]
  v_cvt_pk_bf16_f32 v111, v111, v43
  v_cvt_pk_bf16_f32 v117, v118, v119
  v_mfma_f32_16x16x32_bf16 v[244:247], a[220:223], a[100:103], v[244:247]
  v_cvt_pk_bf16_f32 v120, v120, v121
  v_cvt_pk_bf16_f32 v121, v122, v123
  v_mfma_f32_16x16x32_bf16 v[244:247], a[216:219], a[84:87], v[244:247]
  v_cvt_pk_bf16_f32 v124, v124, v125
  v_cvt_pk_bf16_f32 v125, v126, v127
  v_mfma_f32_16x16x32_bf16 v[244:247], a[212:215], a[196:199], v[244:247]
  v_accvgpr_read_b32 v114, a64
  v_accvgpr_read_b32 v115, a65
  v_mfma_f32_16x16x32_bf16 v[244:247], a[208:211], a[180:183], v[244:247]
  v_cvt_pk_bf16_f32 v114, v114, v115
  v_accvgpr_read_b32 v42, a67
  v_mfma_f32_16x16x32_bf16 v[248:251], a[208:211], a[184:187], v[248:251]
  v_cvt_pk_bf16_f32 v216, v232, v233
  v_accvgpr_read_b32 v115, a66
  v_mfma_f32_16x16x32_bf16 v[248:251], a[212:215], a[200:203], v[248:251]
  ds_read_b128 a[144:147], v18 offset:0
  v_cvt_pk_bf16_f32 v217, v234, v235
  v_mfma_f32_16x16x32_bf16 v[248:251], a[216:219], a[88:91], v[248:251]
  ds_read_b128 a[148:151], v19 offset:0
  v_cvt_pk_bf16_f32 v115, v115, v42
  v_mfma_f32_16x16x32_bf16 v[248:251], a[220:223], a[104:107], v[248:251]
  ds_read_b128 a[152:155], v18 offset:128
  v_mul_f32 v236, v220, v236
  v_mfma_f32_16x16x32_bf16 v[248:251], a[224:227], a[120:123], v[248:251]
  ds_read_b128 a[156:159], v19 offset:128
  v_accvgpr_read_b32 v118, a68
  v_mfma_f32_16x16x32_bf16 v[248:251], a[228:231], a[136:139], v[248:251]
  ds_read_b128 a[160:163], v18 offset:256
  v_accvgpr_read_b32 v119, a69
  v_mfma_f32_16x16x32_bf16 v[252:255], a[228:231], a[140:143], v[252:255]
  ds_read_b128 a[164:167], v19 offset:256
  v_cvt_pk_bf16_f32 v118, v118, v119
  v_mfma_f32_16x16x32_bf16 v[252:255], a[224:227], a[124:127], v[252:255]
  v_accvgpr_read_b32 v43, a71
  v_accvgpr_read_b32 v119, a70
  v_mfma_f32_16x16x32_bf16 v[252:255], a[220:223], a[108:111], v[252:255]
  v_mul_f32 v237, v221, v237
  v_cvt_pk_bf16_f32 v119, v119, v43
  v_mfma_f32_16x16x32_bf16 v[252:255], a[216:219], a[92:95], v[252:255]
  v_accvgpr_read_b32 v122, a72
  v_accvgpr_read_b32 v123, a73
  v_mfma_f32_16x16x32_bf16 v[252:255], a[212:215], a[204:207], v[252:255]
  v_cvt_pk_bf16_f32 v122, v122, v123
  v_accvgpr_read_b32 v42, a75
  v_mfma_f32_16x16x32_bf16 v[252:255], a[208:211], a[188:191], v[252:255]
  s_waitcnt lgkmcnt(5)
  v_fma_f32 v222, v222, s81, s81
  v_accvgpr_read_b32 v123, a74
  v_mfma_f32_16x16x32_bf16 v[144:147], a[144:147], v[48:51], 0
  s_waitcnt lgkmcnt(4)
  v_cvt_pk_bf16_f32 v123, v123, v42
  v_cvt_pk_bf16_f32 v128, v128, v129
  v_mfma_f32_16x16x32_bf16 v[144:147], a[148:151], v[64:67], v[144:147]
  s_waitcnt lgkmcnt(3)
  v_cvt_pk_bf16_f32 v129, v130, v131
  v_cvt_pk_bf16_f32 v130, v240, v241
  v_mfma_f32_16x16x32_bf16 v[144:147], a[152:155], v[80:83], v[144:147]
L_pg7:
  s_cbranch_execz L_hop1
  s_waitcnt lgkmcnt(2)
  v_accvgpr_read_b32 v126, a76
  v_cvt_pk_bf16_f32 v131, v242, v243
  v_mfma_f32_16x16x32_bf16 v[144:147], a[156:159], v[96:99], v[144:147]
  s_waitcnt lgkmcnt(1)
  ds_read_b128 a[252:255], v19 offset:6400
  v_accvgpr_read_b32 v127, a77
  v_mfma_f32_16x16x32_bf16 v[144:147], a[160:163], v[112:115], v[144:147]
  s_waitcnt lgkmcnt(1)
  ds_read_b128 a[248:251], v18 offset:6400
  v_fma_f32 v223, v223, s81, s81
  v_mfma_f32_16x16x32_bf16 v[144:147], a[164:167], v[128:131], v[144:147]
  ds_read_b128 a[240:243], v18 offset:6272
  ds_read_b128 a[244:247], v19 offset:6272
  v_mfma_f32_16x16x32_bf16 v[148:151], a[144:147], v[52:55], 0
  buffer_store_dwordx4 v[204:207], v37, s[4:7], s76 offen offset:3072 sc1
  v_mfma_f32_16x16x32_bf16 v[148:151], a[148:151], v[68:71], v[148:151]
  ds_read_b128 a[236:239], v19 offset:6144
  v_cvt_pk_bf16_f32 v132, v132, v133
  v_mfma_f32_16x16x32_bf16 v[148:151], a[152:155], v[84:87], v[148:151]
  ds_read_b128 a[232:235], v18 offset:6144
  v_cvt_pk_bf16_f32 v133, v134, v135
  v_mfma_f32_16x16x32_bf16 v[148:151], a[156:159], v[100:103], v[148:151]
  v_cvt_pk_bf16_f32 v134, v244, v245
  v_cvt_pk_bf16_f32 v135, v246, v247
  v_mfma_f32_16x16x32_bf16 v[148:151], a[160:163], v[116:119], v[148:151]
  v_cvt_pk_bf16_f32 v126, v126, v127
  v_accvgpr_read_b32 v43, a79
  v_mfma_f32_16x16x32_bf16 v[148:151], a[164:167], v[132:135], v[148:151]
  v_accvgpr_read_b32 v127, a78
  v_cvt_pk_bf16_f32 v136, v136, v137
  v_mfma_f32_16x16x32_bf16 v[152:155], a[144:147], v[56:59], 0
  v_cvt_pk_bf16_f32 v127, v127, v43
  v_cvt_pk_bf16_f32 v137, v138, v139
  v_mfma_f32_16x16x32_bf16 v[152:155], a[148:151], v[72:75], v[152:155]
  v_rcp_f32 v222, v222
  v_mfma_f32_16x16x32_bf16 v[152:155], a[152:155], v[88:91], v[152:155]
  s_waitcnt vmcnt(28) lgkmcnt(0)
  s_barrier
  v_cvt_pk_bf16_f32 v138, v248, v249
  v_cvt_pk_bf16_f32 v139, v250, v251
  v_mfma_f32_16x16x32_bf16 v[152:155], a[156:159], v[104:107], v[152:155]
  v_cvt_pk_bf16_f32 v140, v140, v141
  v_cvt_pk_bf16_f32 v141, v142, v143
  v_mfma_f32_16x16x32_bf16 v[152:155], a[160:163], v[120:123], v[152:155]
  v_cvt_pk_bf16_f32 v142, v252, v253
  v_cvt_pk_bf16_f32 v143, v254, v255
  v_mfma_f32_16x16x32_bf16 v[152:155], a[164:167], v[136:139], v[152:155]
  s_add_u32 m0, s74, 49152
  v_exp_f32 v144, v144
  v_mfma_f32_16x16x32_bf16 v[156:159], a[144:147], v[60:63], 0
  s_mov_b32 s81, 49152
  v_exp_f32 v145, v145
  v_mfma_f32_16x16x32_bf16 v[156:159], a[148:151], v[76:79], v[156:159]
  v_exp_f32 v146, v146
  v_mfma_f32_16x16x32_bf16 v[156:159], a[152:155], v[92:95], v[156:159]
  v_exp_f32 v147, v147
  v_mfma_f32_16x16x32_bf16 v[156:159], a[156:159], v[108:111], v[156:159]
  v_mul_f32 v238, v222, v238
  v_add_f32 v44, v144, v145
  v_mfma_f32_16x16x32_bf16 v[156:159], a[160:163], v[124:127], v[156:159]
  v_cvt_pk_bf16_f32 v144, v144, v145
  v_add_f32 v44, v44, v146
  v_mfma_f32_16x16x32_bf16 v[156:159], a[164:167], v[140:143], v[156:159]
  v_add_f32 v44, v44, v147
  v_cvt_pk_bf16_f32 v145, v146, v147
  v_mfma_f32_16x16x32_bf16 v[176:179], a[232:235], v[48:51], 0
  v_exp_f32 v148, v148
  v_mfma_f32_16x16x32_bf16 v[176:179], a[236:239], v[64:67], v[176:179]
  v_exp_f32 v149, v149
  v_mfma_f32_16x16x32_bf16 v[176:179], a[240:243], v[80:83], v[176:179]
  v_exp_f32 v150, v150
  v_mfma_f32_16x16x32_bf16 v[176:179], a[244:247], v[96:99], v[176:179]
  buffer_load_dwordx4 v28, s[16:19], s81 offen offset:0  lds
  v_mfma_f32_16x16x32_bf16 v[176:179], a[248:251], v[112:115], v[176:179]
  v_exp_f32 v151, v151
  v_mfma_f32_16x16x32_bf16 v[176:179], a[252:255], v[128:131], v[176:179]
  v_add_f32 v45, v148, v149
  v_cvt_pk_bf16_f32 v148, v148, v149
  v_mfma_f32_16x16x32_bf16 v[180:183], a[232:235], v[52:55], 0
  v_exp_f32 v152, v152
  v_mfma_f32_16x16x32_bf16 v[180:183], a[236:239], v[68:71], v[180:183]
  v_exp_f32 v153, v153
  v_mfma_f32_16x16x32_bf16 v[180:183], a[240:243], v[84:87], v[180:183]
  v_exp_f32 v154, v154
  v_mfma_f32_16x16x32_bf16 v[180:183], a[244:247], v[100:103], v[180:183]
  v_exp_f32 v155, v155
  v_mfma_f32_16x16x32_bf16 v[180:183], a[248:251], v[116:119], v[180:183]
  v_exp_f32 v156, v156
  v_mfma_f32_16x16x32_bf16 v[180:183], a[252:255], v[132:135], v[180:183]
  buffer_load_dwordx4 v29, s[16:19], s81 offen offset:1024  lds
  v_mfma_f32_16x16x32_bf16 v[184:187], a[232:235], v[56:59], 0
  v_exp_f32 v157, v157
  v_mfma_f32_16x16x32_bf16 v[184:187], a[236:239], v[72:75], v[184:187]
  ds_read_b128 a[200:203], v18 offset:12288
  v_cvt_pk_bf16_f32 v149, v150, v151
  v_mfma_f32_16x16x32_bf16 v[184:187], a[240:243], v[88:91], v[184:187]
  ds_read_b128 a[204:207], v19 offset:12288
  v_add_f32 v45, v45, v150
  v_mfma_f32_16x16x32_bf16 v[184:187], a[244:247], v[104:107], v[184:187]
  ds_read_b128 a[208:211], v18 offset:12416
  v_add_f32 v45, v45, v151
  v_mfma_f32_16x16x32_bf16 v[184:187], a[248:251], v[120:123], v[184:187]
  ds_read_b128 a[212:215], v19 offset:12416
  v_add_f32 v46, v152, v153
  v_mfma_f32_16x16x32_bf16 v[184:187], a[252:255], v[136:139], v[184:187]
  ds_read_b128 a[216:219], v18 offset:12544
  v_cvt_pk_bf16_f32 v152, v152, v153
  v_mfma_f32_16x16x32_bf16 v[188:191], a[232:235], v[60:63], 0
  ds_read_b128 a[220:223], v19 offset:12544
  v_cvt_pk_bf16_f32 v153, v154, v155
  v_mfma_f32_16x16x32_bf16 v[188:191], a[236:239], v[76:79], v[188:191]
  buffer_load_dwordx4 v30, s[16:19], s81 offen offset:2048  lds
  v_mfma_f32_16x16x32_bf16 v[188:191], a[240:243], v[92:95], v[188:191]
  s_add_u32 m0, s74, 135168
  v_exp_f32 v158, v158
  v_mfma_f32_16x16x32_bf16 v[188:191], a[244:247], v[108:111], v[188:191]
  s_add_u32 s3, s87, 40960
  v_exp_f32 v159, v159
  v_mfma_f32_16x16x32_bf16 v[188:191], a[248:251], v[124:127], v[188:191]
  v_add_f32 v46, v46, v154
  v_add_f32 v47, v156, v157
  v_mfma_f32_16x16x32_bf16 v[188:191], a[252:255], v[140:143], v[188:191]
  s_waitcnt lgkmcnt(5)
  v_add_f32 v46, v46, v155
  v_add_f32 v47, v47, v158
  v_mfma_f32_16x16x32_bf16 v[160:163], a[200:203], v[48:51], 0
  s_waitcnt lgkmcnt(3)
  v_cvt_pk_bf16_f32 v156, v156, v157
  v_add_f32 v47, v47, v159
  v_mfma_f32_16x16x32_bf16 v[160:163], a[204:207], v[64:67], v[160:163]
  buffer_store_dwordx2 v[208:209], v38, s[4:7], s77 offen offset:0 sc1
  v_mfma_f32_16x16x32_bf16 v[160:163], a[208:211], v[80:83], v[160:163]
  s_waitcnt lgkmcnt(1)
  v_exp_f32 v176, v176
  v_mfma_f32_16x16x32_bf16 v[160:163], a[212:215], v[96:99], v[160:163]
  buffer_load_dwordx4 v34, s[28:31], s3 offen offset:0  lds
  v_mfma_f32_16x16x32_bf16 v[160:163], a[216:219], v[112:115], v[160:163]
  s_waitcnt lgkmcnt(0)
  v_exp_f32 v177, v177
  v_mfma_f32_16x16x32_bf16 v[160:163], a[220:223], v[128:131], v[160:163]
  v_exp_f32 v178, v178
  v_mfma_f32_16x16x32_bf16 v[164:167], a[220:223], v[132:135], 0
  v_exp_f32 v179, v179
  v_mfma_f32_16x16x32_bf16 v[164:167], a[216:219], v[116:119], v[164:167]
  ds_read_b128 a[224:227], v18 offset:18432
  v_add_f32 v44, v44, v176
  v_mfma_f32_16x16x32_bf16 v[164:167], a[212:215], v[100:103], v[164:167]
  ds_read_b128 a[228:231], v19 offset:18432
  v_cvt_pk_bf16_f32 v146, v176, v177
  v_mfma_f32_16x16x32_bf16 v[164:167], a[208:211], v[84:87], v[164:167]
  ds_read_b128 a[144:147], v18 offset:18560
  v_add_f32 v44, v44, v177
  v_mfma_f32_16x16x32_bf16 v[164:167], a[204:207], v[68:71], v[164:167]
  ds_read_b128 a[148:151], v19 offset:18560
  v_cvt_pk_bf16_f32 v220, v236, v237
  v_mfma_f32_16x16x32_bf16 v[164:167], a[200:203], v[52:55], v[164:167]
  ds_read_b128 a[152:155], v18 offset:18688
  v_xor_b32 v1, 64, v3
  v_mfma_f32_16x16x32_bf16 v[168:171], a[200:203], v[56:59], 0
  buffer_load_dwordx4 v35, s[28:31], s3 offen offset:1024  lds
  v_mfma_f32_16x16x32_bf16 v[168:171], a[204:207], v[72:75], v[168:171]
  ds_read_b128 a[156:159], v19 offset:18688
  v_add_f32 v44, v44, v178
  v_mfma_f32_16x16x32_bf16 v[168:171], a[208:211], v[88:91], v[168:171]
  v_add_f32 v44, v44, v179
  v_cvt_pk_bf16_f32 v147, v178, v179
  v_mfma_f32_16x16x32_bf16 v[168:171], a[212:215], v[104:107], v[168:171]
  v_exp_f32 v180, v180
  v_mfma_f32_16x16x32_bf16 v[168:171], a[216:219], v[120:123], v[168:171]
  v_exp_f32 v181, v181
  v_mfma_f32_16x16x32_bf16 v[168:171], a[220:223], v[136:139], v[168:171]
  v_exp_f32 v182, v182
  v_mfma_f32_16x16x32_bf16 v[172:175], a[220:223], v[140:143], 0
  v_exp_f32 v183, v183
  v_mfma_f32_16x16x32_bf16 v[172:175], a[216:219], v[124:127], v[172:175]
  s_waitcnt vmcnt(28) lgkmcnt(0)
  s_barrier
  v_add_f32 v45, v45, v180
  v_cvt_pk_bf16_f32 v150, v180, v181
  v_mfma_f32_16x16x32_bf16 v[172:175], a[212:215], v[108:111], v[172:175]
  buffer_load_dwordx4 v36, s[28:31], s3 offen offset:2048  lds
  v_mfma_f32_16x16x32_bf16 v[172:175], a[208:211], v[92:95], v[172:175]
  v_add_f32 v45, v45, v181
  v_cvt_pk_bf16_f32 v151, v182, v183
  v_mfma_f32_16x16x32_bf16 v[172:175], a[204:207], v[76:79], v[172:175]
  s_add_u32 m0, s74, 147456
  v_exp_f32 v184, v184
  v_mfma_f32_16x16x32_bf16 v[172:175], a[200:203], v[60:63], v[172:175]
  s_add_u32 s64, s87, 163840
  v_exp_f32 v185, v185
  v_mfma_f32_16x16x32_bf16 v[176:179], a[224:227], v[48:51], 0
  v_exp_f32 v186, v186
  v_mfma_f32_16x16x32_bf16 v[176:179], a[228:231], v[64:67], v[176:179]
  v_exp_f32 v187, v187
  v_mfma_f32_16x16x32_bf16 v[176:179], a[144:147], v[80:83], v[176:179]
  buffer_store_dwordx2 v[212:213], v38, s[4:7], s77 offen offset:512 sc1
  v_mfma_f32_16x16x32_bf16 v[176:179], a[148:151], v[96:99], v[176:179]
  v_add_f32 v45, v45, v182
  v_add_f32 v46, v46, v184
  v_mfma_f32_16x16x32_bf16 v[176:179], a[152:155], v[112:115], v[176:179]
  v_add_f32 v45, v45, v183
  v_add_f32 v46, v46, v185
  v_mfma_f32_16x16x32_bf16 v[176:179], a[156:159], v[128:131], v[176:179]
  v_cvt_pk_bf16_f32 v154, v184, v185
  v_add_f32 v46, v46, v186
  v_mfma_f32_16x16x32_bf16 v[180:183], a[156:159], v[132:135], 0
  v_add_f32 v46, v46, v187
  v_cvt_pk_bf16_f32 v155, v186, v187
  v_mfma_f32_16x16x32_bf16 v[180:183], a[152:155], v[116:119], v[180:183]
  v_exp_f32 v188, v188
  v_mfma_f32_16x16x32_bf16 v[180:183], a[148:151], v[100:103], v[180:183]
  v_exp_f32 v189, v189
  v_mfma_f32_16x16x32_bf16 v[180:183], a[144:147], v[84:87], v[180:183]
  buffer_load_dwordx4 v34, s[28:31], s64 offen offset:0  lds
  v_mfma_f32_16x16x32_bf16 v[180:183], a[228:231], v[68:71], v[180:183]
  v_exp_f32 v190, v190
  v_mfma_f32_16x16x32_bf16 v[180:183], a[224:227], v[52:55], v[180:183]
  v_exp_f32 v191, v191
  v_mfma_f32_16x16x32_bf16 v[184:187], a[224:227], v[56:59], 0
  v_cvt_pk_bf16_f32 v157, v158, v159
  v_add_f32 v47, v47, v188
  v_mfma_f32_16x16x32_bf16 v[184:187], a[228:231], v[72:75], v[184:187]
  ds_read_b64_tr_b16 a[160:161], v5 offset:24704
  v_cvt_pk_bf16_f32 v158, v188, v189
  v_mfma_f32_16x16x32_bf16 v[184:187], a[144:147], v[88:91], v[184:187]
  ds_read_b64_tr_b16 a[162:163], v5 offset:30848
  v_add_f32 v47, v47, v189
  v_mfma_f32_16x16x32_bf16 v[184:187], a[148:151], v[104:107], v[184:187]
  v_add_f32 v47, v47, v190
  v_cvt_pk_bf16_f32 v159, v190, v191
  v_mfma_f32_16x16x32_bf16 v[184:187], a[152:155], v[120:123], v[184:187]
  ds_read_b64_tr_b16 a[164:165], v6 offset:24704
  v_add_f32 v47, v47, v191
  v_mfma_f32_16x16x32_bf16 v[184:187], a[156:159], v[136:139], v[184:187]
  buffer_load_dwordx4 v35, s[28:31], s64 offen offset:1024  lds
  v_mfma_f32_16x16x32_bf16 v[188:191], a[156:159], v[140:143], 0
  ds_read_b64_tr_b16 a[166:167], v6 offset:30848
  v_xor_b32 v2, 64, v4
  v_mfma_f32_16x16x32_bf16 v[188:191], a[152:155], v[124:127], v[188:191]
  v_rcp_f32 v223, v223
  v_mfma_f32_16x16x32_bf16 v[188:191], a[148:151], v[108:111], v[188:191]
  ds_read_b64_tr_b16 a[248:249], v7 offset:24704
  v_mul_f32 v239, v223, v239
  v_mfma_f32_16x16x32_bf16 v[188:191], a[144:147], v[92:95], v[188:191]
  ds_read_b64_tr_b16 a[250:251], v7 offset:30848
  v_cvt_pk_bf16_f32 v221, v238, v239
  v_mfma_f32_16x16x32_bf16 v[188:191], a[228:231], v[76:79], v[188:191]
  v_xor_b32 v9, 64, v11
  v_xor_b32 v10, 64, v12
  v_mfma_f32_16x16x32_bf16 v[188:191], a[224:227], v[60:63], v[188:191]
  s_waitcnt lgkmcnt(4)
  ds_read_b64_tr_b16 a[252:253], v8 offset:24704
  ds_read_b64_tr_b16 a[254:255], v8 offset:30848
  v_mfma_f32_16x16x32_bf16 a[0:3], a[160:163], v[144:147], 0
  buffer_load_dwordx4 v36, s[28:31], s64 offen offset:2048  lds
  v_mfma_f32_16x16x32_bf16 a[4:7], a[160:163], v[148:151], 0
  buffer_store_dwordx2 v[216:217], v38, s[4:7], s77 offen offset:1024 sc1
  v_mfma_f32_16x16x32_bf16 a[8:11], a[160:163], v[152:155], 0
  s_add_u32 m0, s74, 0
  v_exp_f32 v160, v160
  v_mfma_f32_16x16x32_bf16 a[12:15], a[160:163], v[156:159], 0
  s_waitcnt lgkmcnt(4)
  s_mov_b32 s87, 36864
  v_exp_f32 v161, v161
  v_mfma_f32_16x16x32_bf16 a[28:31], a[164:167], v[156:159], 0
  ds_read_b64_tr_b16 a[200:201], v5 offset:24832
  ds_read_b64_tr_b16 a[202:203], v5 offset:30976
  v_mfma_f32_16x16x32_bf16 a[24:27], a[164:167], v[152:155], 0
  v_add_f32 v44, v44, v160
  v_cvt_pk_bf16_f32 v160, v160, v161
  v_mfma_f32_16x16x32_bf16 a[20:23], a[164:167], v[148:151], 0
  buffer_load_dwordx4 v31, s[20:23], s87 offen offset:0  lds
  v_mfma_f32_16x16x32_bf16 a[16:19], a[164:167], v[144:147], 0
  s_waitcnt lgkmcnt(4)
  v_exp_f32 v162, v162
  v_mfma_f32_16x16x32_bf16 a[32:35], a[248:251], v[144:147], 0
  ds_read_b64_tr_b16 a[204:205], v6 offset:24832
  v_add_f32 v44, v44, v161
  v_mfma_f32_16x16x32_bf16 a[36:39], a[248:251], v[148:151], 0
  ds_read_b64_tr_b16 a[206:207], v6 offset:30976
  v_add_f32 v44, v44, v162
  v_mfma_f32_16x16x32_bf16 a[40:43], a[248:251], v[152:155], 0
  v_exp_f32 v163, v163
  v_mfma_f32_16x16x32_bf16 a[44:47], a[248:251], v[156:159], 0
  s_waitcnt lgkmcnt(4)
  v_add_f32 v44, v44, v163
  v_cvt_pk_bf16_f32 v161, v162, v163
  v_mfma_f32_16x16x32_bf16 a[60:63], a[252:255], v[156:159], 0
  v_exp_f32 v164, v164
  v_mfma_f32_16x16x32_bf16 a[56:59], a[252:255], v[152:155], 0
  ds_read_b64_tr_b16 a[208:209], v7 offset:24832
  ds_read_b64_tr_b16 a[210:211], v7 offset:30976
  v_mfma_f32_16x16x32_bf16 a[52:55], a[252:255], v[148:151], 0
  s_waitcnt lgkmcnt(4)
  v_exp_f32 v165, v165
  v_mfma_f32_16x16x32_bf16 a[48:51], a[252:255], v[144:147], 0
  buffer_load_dwordx4 v32, s[20:23], s87 offen offset:1024  lds
  v_mfma_f32_16x16x32_bf16 a[64:67], a[200:203], v[144:147], 0
  ds_read_b64_tr_b16 a[212:213], v8 offset:24832
  v_add_f32 v45, v45, v164
  v_mfma_f32_16x16x32_bf16 a[68:71], a[200:203], v[148:151], 0
  ds_read_b64_tr_b16 a[214:215], v8 offset:30976
  v_add_f32 v45, v45, v165
  v_mfma_f32_16x16x32_bf16 a[72:75], a[200:203], v[152:155], 0
  v_exp_f32 v166, v166
  v_mfma_f32_16x16x32_bf16 a[76:79], a[200:203], v[156:159], 0
  s_waitcnt lgkmcnt(4)
  v_cvt_pk_bf16_f32 v164, v164, v165
  v_add_f32 v45, v45, v166
  v_mfma_f32_16x16x32_bf16 a[92:95], a[204:207], v[156:159], 0
  v_exp_f32 v167, v167
  v_mfma_f32_16x16x32_bf16 a[88:91], a[204:207], v[152:155], 0
  ds_read_b64_tr_b16 a[216:217], v8 offset:24576
  ds_read_b64_tr_b16 a[218:219], v8 offset:30720
  v_mfma_f32_16x16x32_bf16 a[84:87], a[204:207], v[148:151], 0
  v_exp_f32 v168, v168
  v_mfma_f32_16x16x32_bf16 a[80:83], a[204:207], v[144:147], 0
  s_waitcnt lgkmcnt(4)
  ds_read_b64_tr_b16 a[220:221], v7 offset:24576
  ds_read_b64_tr_b16 a[222:223], v7 offset:30720
  v_mfma_f32_16x16x32_bf16 a[96:99], a[208:211], v[144:147], 0
  buffer_load_dwordx4 v33, s[20:23], s87 offen offset:2048  lds
  v_mfma_f32_16x16x32_bf16 a[100:103], a[208:211], v[148:151], 0
  buffer_store_dwordx2 v[220:221], v38, s[4:7], s77 offen offset:1536 sc1
  v_mfma_f32_16x16x32_bf16 a[104:107], a[208:211], v[152:155], 0
  s_add_u32 m0, s74, 12288
  v_add_f32 v45, v45, v167
  v_cvt_pk_bf16_f32 v165, v166, v167
  v_mfma_f32_16x16x32_bf16 a[108:111], a[208:211], v[156:159], 0
  s_waitcnt lgkmcnt(4)
  s_add_u32 s61, s99, 0
  v_exp_f32 v169, v169
  v_mfma_f32_16x16x32_bf16 a[124:127], a[212:215], v[156:159], 0
  v_add_f32 v46, v46, v168
  v_cvt_pk_bf16_f32 v168, v168, v169
  v_mfma_f32_16x16x32_bf16 a[120:123], a[212:215], v[152:155], 0
  ds_read_b64_tr_b16 a[224:225], v6 offset:24576
  ds_read_b64_tr_b16 a[226:227], v6 offset:30720
  v_mfma_f32_16x16x32_bf16 a[116:119], a[212:215], v[148:151], 0
  ds_read_b64_tr_b16 a[228:229], v5 offset:24576
  v_add_f32 v46, v46, v169
  v_mfma_f32_16x16x32_bf16 a[112:115], a[212:215], v[144:147], 0
  s_waitcnt lgkmcnt(5)
  v_exp_f32 v170, v170
  v_mfma_f32_16x16x32_bf16 a[232:235], a[216:219], v[144:147], 0
  buffer_load_dwordx4 v34, s[28:31], s61 offen offset:0  lds
  v_mfma_f32_16x16x32_bf16 a[236:239], a[216:219], v[148:151], 0
  ds_read_b64_tr_b16 a[230:231], v5 offset:30720
  v_add_f32 v46, v46, v170
  v_mfma_f32_16x16x32_bf16 a[240:243], a[216:219], v[152:155], 0
  v_exp_f32 v171, v171
  v_mfma_f32_16x16x32_bf16 a[244:247], a[216:219], v[156:159], 0
  s_waitcnt lgkmcnt(4)
  v_exp_f32 v172, v172
  v_mfma_f32_16x16x32_bf16 v[252:255], a[220:223], v[156:159], 0
  v_add_f32 v46, v46, v171
  v_cvt_pk_bf16_f32 v169, v170, v171
  v_mfma_f32_16x16x32_bf16 v[248:251], a[220:223], v[152:155], 0
  ds_read_b128 a[144:147], v18 offset:36864
  v_add_f32 v47, v47, v172
  v_mfma_f32_16x16x32_bf16 v[244:247], a[220:223], v[148:151], 0
  ds_read_b128 a[148:151], v19 offset:36864
  ds_read_b128 a[152:155], v18 offset:36992
  v_mfma_f32_16x16x32_bf16 v[240:243], a[220:223], v[144:147], 0
  s_waitcnt lgkmcnt(5)
  ds_read_b128 a[156:159], v19 offset:36992
  ds_read_b128 a[160:163], v18 offset:37120
  v_mfma_f32_16x16x32_bf16 v[224:227], a[224:227], v[144:147], 0
  buffer_load_dwordx4 v35, s[28:31], s61 offen offset:1024  lds
  v_mfma_f32_16x16x32_bf16 v[228:231], a[224:227], v[148:151], 0
  v_exp_f32 v173, v173
  v_mfma_f32_16x16x32_bf16 v[232:235], a[224:227], v[152:155], 0
  ds_read_b128 a[164:167], v19 offset:37120
  v_add_f32 v47, v47, v173
  v_mfma_f32_16x16x32_bf16 v[236:239], a[224:227], v[156:159], 0
  s_waitcnt lgkmcnt(6)
  v_exp_f32 v174, v174
  v_mfma_f32_16x16x32_bf16 v[220:223], a[228:231], v[156:159], 0
  v_cvt_pk_bf16_f32 v172, v172, v173
  v_add_f32 v47, v47, v174
  v_mfma_f32_16x16x32_bf16 v[216:219], a[228:231], v[152:155], 0
  v_exp_f32 v175, v175
  v_mfma_f32_16x16x32_bf16 v[212:215], a[228:231], v[148:151], 0
  v_add_f32 v47, v47, v175
  v_cvt_pk_bf16_f32 v173, v174, v175
  v_mfma_f32_16x16x32_bf16 v[208:211], a[228:231], v[144:147], 0
  s_waitcnt lgkmcnt(4)
  v_exp_f32 v176, v176
  v_mfma_f32_16x16x32_bf16 v[144:147], a[144:147], v[48:51], 0
  buffer_load_dwordx4 v36, s[28:31], s61 offen offset:2048  lds
  v_mfma_f32_16x16x32_bf16 v[144:147], a[148:151], v[64:67], v[144:147]
  s_waitcnt lgkmcnt(3)
  v_exp_f32 v177, v177
  v_mfma_f32_16x16x32_bf16 v[144:147], a[152:155], v[80:83], v[144:147]
  s_waitcnt lgkmcnt(2)
  v_add_f32 v44, v44, v176
  v_cvt_pk_bf16_f32 v162, v176, v177
  v_mfma_f32_16x16x32_bf16 v[144:147], a[156:159], v[96:99], v[144:147]
  s_waitcnt lgkmcnt(1)
  v_exp_f32 v178, v178
  v_mfma_f32_16x16x32_bf16 v[144:147], a[160:163], v[112:115], v[144:147]
  s_waitcnt lgkmcnt(0)
  ds_read_b128 a[248:251], v18 offset:43008
  v_add_f32 v44, v44, v177
  v_mfma_f32_16x16x32_bf16 v[144:147], a[164:167], v[128:131], v[144:147]
  ds_read_b128 a[252:255], v19 offset:43008
  v_add_f32 v44, v44, v178
  v_mfma_f32_16x16x32_bf16 v[148:151], a[164:167], v[132:135], 0
  v_exp_f32 v179, v179
  v_mfma_f32_16x16x32_bf16 v[148:151], a[160:163], v[116:119], v[148:151]
  v_exp_f32 v180, v180
  v_mfma_f32_16x16x32_bf16 v[148:151], a[156:159], v[100:103], v[148:151]
  v_add_f32 v44, v44, v179
  v_cvt_pk_bf16_f32 v163, v178, v179
  v_mfma_f32_16x16x32_bf16 v[148:151], a[152:155], v[84:87], v[148:151]
  v_exp_f32 v181, v181
  v_mfma_f32_16x16x32_bf16 v[148:151], a[148:151], v[68:71], v[148:151]
  ds_read_b128 a[200:203], v18 offset:43136
  v_add_f32 v45, v45, v180
  v_mfma_f32_16x16x32_bf16 v[148:151], a[144:147], v[52:55], v[148:151]
  ds_read_b128 a[204:207], v19 offset:43136
  ds_read_b128 a[208:211], v18 offset:43264
  v_mfma_f32_16x16x32_bf16 v[152:155], a[144:147], v[56:59], 0
  ds_read_b128 a[212:215], v19 offset:43264
  v_add_f32 v45, v45, v181
  v_mfma_f32_16x16x32_bf16 v[152:155], a[148:151], v[72:75], v[152:155]
  v_exp_f32 v182, v182
  v_mfma_f32_16x16x32_bf16 v[152:155], a[152:155], v[88:91], v[152:155]
  v_cvt_pk_bf16_f32 v166, v180, v181
  v_add_f32 v45, v45, v182
  v_mfma_f32_16x16x32_bf16 v[152:155], a[156:159], v[104:107], v[152:155]
  v_exp_f32 v183, v183
  v_mfma_f32_16x16x32_bf16 v[152:155], a[160:163], v[120:123], v[152:155]
  v_exp_f32 v184, v184
  v_mfma_f32_16x16x32_bf16 v[152:155], a[164:167], v[136:139], v[152:155]
  v_add_f32 v45, v45, v183
  v_cvt_pk_bf16_f32 v167, v182, v183
  v_mfma_f32_16x16x32_bf16 v[156:159], a[164:167], v[140:143], 0
  v_add_f32 v46, v46, v184
  v_mfma_f32_16x16x32_bf16 v[156:159], a[160:163], v[124:127], v[156:159]
  s_waitcnt vmcnt(33) lgkmcnt(0)
  s_barrier
  v_exp_f32 v185, v185
  v_mfma_f32_16x16x32_bf16 v[156:159], a[156:159], v[108:111], v[156:159]
  v_exp_f32 v186, v186
  v_mfma_f32_16x16x32_bf16 v[156:159], a[152:155], v[92:95], v[156:159]
  v_add_f32 v46, v46, v185
  v_cvt_pk_bf16_f32 v170, v184, v185
  v_mfma_f32_16x16x32_bf16 v[156:159], a[148:151], v[76:79], v[156:159]
  s_add_u32 m0, s74, 24576
  v_exp_f32 v187, v187
  v_mfma_f32_16x16x32_bf16 v[156:159], a[144:147], v[60:63], v[156:159]
  s_mov_b32 s65, 61440
  v_add_f32 v46, v46, v186
  v_cvt_pk_bf16_f32 v171, v186, v187
  v_mfma_f32_16x16x32_bf16 v[176:179], a[248:251], v[48:51], 0
  ds_read_b64_tr_b16 a[216:217], v9 offset:0
  v_add_f32 v46, v46, v187
  v_mfma_f32_16x16x32_bf16 v[176:179], a[252:255], v[64:67], v[176:179]
  v_exp_f32 v188, v188
  v_mfma_f32_16x16x32_bf16 v[176:179], a[200:203], v[80:83], v[176:179]
  v_exp_f32 v189, v189
  v_mfma_f32_16x16x32_bf16 v[176:179], a[204:207], v[96:99], v[176:179]
  v_add_f32 v47, v47, v188
  v_cvt_pk_bf16_f32 v174, v188, v189
  v_mfma_f32_16x16x32_bf16 v[176:179], a[208:211], v[112:115], v[176:179]
  v_exp_f32 v190, v190
  v_mfma_f32_16x16x32_bf16 v[176:179], a[212:215], v[128:131], v[176:179]
  ds_read_b64_tr_b16 a[218:219], v9 offset:6144
  v_add_f32 v47, v47, v189
  v_mfma_f32_16x16x32_bf16 v[180:183], a[212:215], v[132:135], 0
  v_exp_f32 v191, v191
  v_mfma_f32_16x16x32_bf16 v[180:183], a[208:211], v[116:119], v[180:183]
  v_add_f32 v47, v47, v190
  v_cvt_pk_bf16_f32 v175, v190, v191
  v_mfma_f32_16x16x32_bf16 v[180:183], a[204:207], v[100:103], v[180:183]
  buffer_load_dwordx4 v28, s[16:19], s65 offen offset:0  lds
  v_mfma_f32_16x16x32_bf16 v[180:183], a[200:203], v[84:87], v[180:183]
  ds_read_b64_tr_b16 a[220:221], v10 offset:0
  v_add_f32 v47, v47, v191
  v_mfma_f32_16x16x32_bf16 v[180:183], a[252:255], v[68:71], v[180:183]
  v_exp_f32 v144, v144
  v_mfma_f32_16x16x32_bf16 v[180:183], a[248:251], v[52:55], v[180:183]
  v_exp_f32 v145, v145
  v_mfma_f32_16x16x32_bf16 v[184:187], a[248:251], v[56:59], 0
  v_add_f32 v44, v44, v144
  v_cvt_pk_bf16_f32 v144, v144, v145
  v_mfma_f32_16x16x32_bf16 v[184:187], a[252:255], v[72:75], v[184:187]
  ds_read_b64_tr_b16 a[222:223], v10 offset:6144
  v_add_f32 v44, v44, v145
  v_mfma_f32_16x16x32_bf16 v[184:187], a[200:203], v[88:91], v[184:187]
  buffer_load_dwordx4 v29, s[16:19], s65 offen offset:1024  lds
  v_mfma_f32_16x16x32_bf16 v[184:187], a[204:207], v[104:107], v[184:187]
  v_exp_f32 v146, v146
  v_mfma_f32_16x16x32_bf16 v[184:187], a[208:211], v[120:123], v[184:187]
  ds_read_b64_tr_b16 a[224:225], v11 offset:0
  v_add_f32 v44, v44, v146
  v_mfma_f32_16x16x32_bf16 v[184:187], a[212:215], v[136:139], v[184:187]
  v_exp_f32 v147, v147
  v_mfma_f32_16x16x32_bf16 v[188:191], a[212:215], v[140:143], 0
  v_add_f32 v44, v44, v147
  v_cvt_pk_bf16_f32 v145, v146, v147
  v_mfma_f32_16x16x32_bf16 v[188:191], a[208:211], v[124:127], v[188:191]
  v_exp_f32 v148, v148
  v_mfma_f32_16x16x32_bf16 v[188:191], a[204:207], v[108:111], v[188:191]
  buffer_load_dwordx4 v30, s[16:19], s65 offen offset:2048  lds
  v_mfma_f32_16x16x32_bf16 v[188:191], a[200:203], v[92:95], v[188:191]
  s_add_u32 m0, s74, 36864
  ds_read_b64_tr_b16 a[226:227], v11 offset:6144
  v_add_f32 v45, v45, v148
  v_mfma_f32_16x16x32_bf16 v[188:191], a[252:255], v[76:79], v[188:191]
  s_add_u32 s67, s99, 61440
  v_exp_f32 v149, v149
  v_mfma_f32_16x16x32_bf16 v[188:191], a[248:251], v[60:63], v[188:191]
  s_waitcnt lgkmcnt(4)
  v_add_f32 v45, v45, v149
  v_cvt_pk_bf16_f32 v148, v148, v149
  v_mfma_f32_16x16x32_bf16 v[208:211], a[216:219], v[160:163], v[208:211]
  v_exp_f32 v150, v150
  v_mfma_f32_16x16x32_bf16 v[212:215], a[216:219], v[164:167], v[212:215]
  ds_read_b64_tr_b16 a[228:229], v12 offset:0
  ds_read_b64_tr_b16 a[230:231], v12 offset:6144
  v_mfma_f32_16x16x32_bf16 v[216:219], a[216:219], v[168:171], v[216:219]
  buffer_load_dwordx4 v34, s[28:31], s67 offen offset:0  lds
  v_mfma_f32_16x16x32_bf16 v[220:223], a[216:219], v[172:175], v[220:223]
  s_waitcnt lgkmcnt(4)
  ds_read_b64_tr_b16 a[144:145], v9 offset:128
  v_add_f32 v45, v45, v150
  v_mfma_f32_16x16x32_bf16 v[236:239], a[220:223], v[172:175], v[236:239]
  v_exp_f32 v151, v151
  v_mfma_f32_16x16x32_bf16 v[232:235], a[220:223], v[168:171], v[232:235]
  ds_read_b64_tr_b16 a[146:147], v9 offset:6272
  v_add_f32 v45, v45, v151
  v_mfma_f32_16x16x32_bf16 v[228:231], a[220:223], v[164:167], v[228:231]
  s_waitcnt vmcnt(7)
  buffer_store_dword v41, v0, s[4:7], s41 offen sc1
  v_mfma_f32_16x16x32_bf16 v[224:227], a[220:223], v[160:163], v[224:227]
  s_waitcnt lgkmcnt(4)
  v_exp_f32 v152, v152
  v_mfma_f32_16x16x32_bf16 v[240:243], a[224:227], v[160:163], v[240:243]
  buffer_load_dwordx4 v35, s[28:31], s67 offen offset:1024  lds
  v_mfma_f32_16x16x32_bf16 v[244:247], a[224:227], v[164:167], v[244:247]
  s_mul_i32 s96, s98, -3407360
  ds_read_b64_tr_b16 a[148:149], v10 offset:128
  ds_read_b64_tr_b16 a[150:151], v10 offset:6272
  v_mfma_f32_16x16x32_bf16 v[248:251], a[224:227], v[168:171], v[248:251]
  s_lshr_b32 s86, s44, 1
  v_cvt_pk_bf16_f32 v149, v150, v151
  v_add_f32 v46, v46, v152
  v_mfma_f32_16x16x32_bf16 v[252:255], a[224:227], v[172:175], v[252:255]
  s_waitcnt lgkmcnt(4)
  s_lshl_b32 s86, s86, 10
  v_exp_f32 v153, v153
  v_mfma_f32_16x16x32_bf16 a[244:247], a[228:231], v[172:175], a[244:247]
  s_add_u32 s86, s86, 16384
  v_add_f32 v46, v46, v153
  v_cvt_pk_bf16_f32 v152, v152, v153
  v_mfma_f32_16x16x32_bf16 a[240:243], a[228:231], v[168:171], a[240:243]
  s_add_u32 s86, s86, s96
  ds_read_b64_tr_b16 a[152:153], v11 offset:128
  ds_read_b64_tr_b16 a[154:155], v11 offset:6272
  v_mfma_f32_16x16x32_bf16 a[236:239], a[228:231], v[164:167], a[236:239]
  buffer_load_dwordx4 v36, s[28:31], s67 offen offset:2048  lds
  v_mfma_f32_16x16x32_bf16 a[232:235], a[228:231], v[160:163], a[232:235]
  s_waitcnt lgkmcnt(4)
  s_add_u32 m0, s74, 61440
  v_exp_f32 v154, v154
  v_mfma_f32_16x16x32_bf16 a[0:3], a[144:147], v[160:163], a[0:3]
  s_mov_b32 s66, 49152
  ds_read_b64_tr_b16 a[156:157], v12 offset:128
  v_add_f32 v46, v46, v154
  v_mfma_f32_16x16x32_bf16 a[4:7], a[144:147], v[164:167], a[4:7]
  s_add_u32 s15, s88, 0
  ds_read_b64_tr_b16 a[158:159], v12 offset:6272
  ds_read_b64_tr_b16 a[160:161], v9 offset:256
  v_mfma_f32_16x16x32_bf16 a[8:11], a[144:147], v[168:171], a[8:11]
  v_exp_f32 v155, v155
  v_mfma_f32_16x16x32_bf16 a[12:15], a[144:147], v[172:175], a[12:15]
  s_waitcnt lgkmcnt(5)
  v_add_f32 v46, v46, v155
  v_cvt_pk_bf16_f32 v153, v154, v155
  v_mfma_f32_16x16x32_bf16 a[28:31], a[148:151], v[172:175], a[28:31]
  buffer_load_dwordx4 v31, s[20:23], s66 offen offset:0  lds
  v_mfma_f32_16x16x32_bf16 a[24:27], a[148:151], v[168:171], a[24:27]
  ds_read_b64_tr_b16 a[162:163], v9 offset:6400
  ds_read_b64_tr_b16 a[164:165], v10 offset:256
  v_mfma_f32_16x16x32_bf16 a[20:23], a[148:151], v[164:167], a[20:23]
  v_exp_f32 v156, v156
  v_mfma_f32_16x16x32_bf16 a[16:19], a[148:151], v[160:163], a[16:19]
  s_waitcnt lgkmcnt(5)
  ds_read_b64_tr_b16 a[166:167], v10 offset:6400
  v_add_f32 v47, v47, v156
  v_mfma_f32_16x16x32_bf16 a[32:35], a[152:155], v[160:163], a[32:35]
  v_exp_f32 v157, v157
  v_mfma_f32_16x16x32_bf16 a[36:39], a[152:155], v[164:167], a[36:39]
  s_waitcnt lgkmcnt(4)
  v_add_f32 v47, v47, v157
  v_cvt_pk_bf16_f32 v156, v156, v157
  v_mfma_f32_16x16x32_bf16 a[40:43], a[152:155], v[168:171], a[40:43]
  buffer_load_dwordx4 v32, s[20:23], s66 offen offset:1024  lds
  v_mfma_f32_16x16x32_bf16 a[44:47], a[152:155], v[172:175], a[44:47]
  s_xor_b32 s8, s44, 1
  v_exp_f32 v158, v158
  v_mfma_f32_16x16x32_bf16 a[60:63], a[156:159], v[172:175], a[60:63]
  s_sub_u32 s8, s8, s44
  ds_read_b64_tr_b16 a[248:249], v11 offset:256
  v_add_f32 v47, v47, v158
  v_mfma_f32_16x16x32_bf16 a[56:59], a[156:159], v[168:171], a[56:59]
  s_mul_i32 s8, s8, 3407872
  ds_read_b64_tr_b16 a[250:251], v11 offset:6400
  v_lshrrev_b32 v13, 9, v37
  v_mfma_f32_16x16x32_bf16 a[52:55], a[156:159], v[164:167], a[52:55]
  s_add_u32 s8, s8, s15
  v_exp_f32 v159, v159
  v_mfma_f32_16x16x32_bf16 a[48:51], a[156:159], v[160:163], a[48:51]
  s_waitcnt lgkmcnt(4)
  v_mul_u32_u24 v13, 3407360, v13
  v_add_f32 v47, v47, v159
  v_mfma_f32_16x16x32_bf16 a[64:67], a[160:163], v[160:163], a[64:67]
L_pg8:
  s_cbranch_execz L_hop1
  buffer_load_dwordx4 v33, s[20:23], s66 offen offset:2048  lds
  v_mfma_f32_16x16x32_bf16 a[68:71], a[160:163], v[164:167], a[68:71]
  s_add_u32 m0, s74, 86016
  ds_read_b64_tr_b16 a[252:253], v12 offset:256
  ds_read_b64_tr_b16 a[254:255], v12 offset:6400
  v_mfma_f32_16x16x32_bf16 a[72:75], a[160:163], v[168:171], a[72:75]
  s_add_u32 s62, s99, 122880
  v_exp_f32 v176, v176
  v_mfma_f32_16x16x32_bf16 a[76:79], a[160:163], v[172:175], a[76:79]
  s_waitcnt lgkmcnt(4)
  s_xor_b32 s9, s44, 2
  v_exp_f32 v177, v177
  v_mfma_f32_16x16x32_bf16 a[92:95], a[164:167], v[172:175], a[92:95]
  s_sub_u32 s9, s9, s44
  v_exp_f32 v178, v178
  v_mfma_f32_16x16x32_bf16 a[88:91], a[164:167], v[168:171], a[88:91]
  s_mul_i32 s9, s9, 3407872
  ds_read_b128 a[200:203], v20 offset:12288
  ds_read_b128 a[204:207], v21 offset:12288
  v_mfma_f32_16x16x32_bf16 a[84:87], a[164:167], v[164:167], a[84:87]
  buffer_load_dwordx4 v34, s[28:31], s62 offen offset:0  lds
  v_mfma_f32_16x16x32_bf16 a[80:83], a[164:167], v[160:163], a[80:83]
  s_waitcnt lgkmcnt(4)
  s_add_u32 s9, s9, s15
  ds_read_b128 a[208:211], v20 offset:12416
  v_add_u32 v13, v13, v37
  v_mfma_f32_16x16x32_bf16 a[96:99], a[248:251], v[160:163], a[96:99]
  ds_read_b128 a[212:215], v21 offset:12416
  v_cvt_pk_bf16_f32 v157, v158, v159
  v_mfma_f32_16x16x32_bf16 a[100:103], a[248:251], v[164:167], a[100:103]
  s_waitcnt lgkmcnt(4)
  ds_read_b128 a[216:219], v20 offset:12544
  v_add_f32 v44, v44, v176
  v_mfma_f32_16x16x32_bf16 a[104:107], a[248:251], v[168:171], a[104:107]
  s_xor_b32 s10, s44, 3
  ds_read_b128 a[220:223], v21 offset:12544
  v_add_f32 v44, v44, v177
  v_mfma_f32_16x16x32_bf16 a[108:111], a[248:251], v[172:175], a[108:111]
  s_sub_u32 s10, s10, s44
  v_exp_f32 v179, v179
  v_mfma_f32_16x16x32_bf16 a[124:127], a[252:255], v[172:175], a[124:127]
  buffer_load_dwordx4 v35, s[28:31], s62 offen offset:1024  lds
  v_mfma_f32_16x16x32_bf16 a[120:123], a[252:255], v[168:171], a[120:123]
  s_mul_i32 s10, s10, 3407872
  v_cvt_pk_bf16_f32 v146, v176, v177
  v_add_f32 v44, v44, v178
  v_mfma_f32_16x16x32_bf16 a[116:119], a[252:255], v[164:167], a[116:119]
  s_add_u32 s10, s10, s15
  v_add_f32 v44, v44, v179
  v_cvt_pk_bf16_f32 v147, v178, v179
  v_mfma_f32_16x16x32_bf16 a[112:115], a[252:255], v[160:163], a[112:115]
  s_waitcnt lgkmcnt(5)
  v_exp_f32 v180, v180
  v_mfma_f32_16x16x32_bf16 v[160:163], a[200:203], v[48:51], 0
  s_waitcnt lgkmcnt(4)
  ds_read_b128 a[224:227], v20 offset:18432
  v_add_f32 v45, v45, v180
  v_mfma_f32_16x16x32_bf16 v[160:163], a[204:207], v[64:67], v[160:163]
  s_waitcnt lgkmcnt(2)
  v_exp_f32 v181, v181
  v_mfma_f32_16x16x32_bf16 v[160:163], a[208:211], v[80:83], v[160:163]
  buffer_load_dwordx4 v36, s[28:31], s62 offen offset:2048  lds
  v_mfma_f32_16x16x32_bf16 v[160:163], a[212:215], v[96:99], v[160:163]
  s_xor_b32 s11, s44, 4
  v_add_f32 v45, v45, v181
  v_cvt_pk_bf16_f32 v150, v180, v181
  v_mfma_f32_16x16x32_bf16 v[160:163], a[216:219], v[112:115], v[160:163]
  s_waitcnt lgkmcnt(1)
  s_sub_u32 s11, s11, s44
  v_exp_f32 v182, v182
  v_mfma_f32_16x16x32_bf16 v[160:163], a[220:223], v[128:131], v[160:163]
  s_mul_i32 s11, s11, 3407872
  v_exp_f32 v183, v183
  v_mfma_f32_16x16x32_bf16 v[164:167], a[220:223], v[132:135], 0
  s_add_u32 s11, s11, s15
  v_add_f32 v45, v45, v182
  v_cvt_pk_bf16_f32 v151, v182, v183
  v_mfma_f32_16x16x32_bf16 v[164:167], a[216:219], v[116:119], v[164:167]
  v_exp_f32 v184, v184
  v_mfma_f32_16x16x32_bf16 v[164:167], a[212:215], v[100:103], v[164:167]
  v_add_f32 v45, v45, v183
  v_add_f32 v46, v46, v184
  v_mfma_f32_16x16x32_bf16 v[164:167], a[208:211], v[84:87], v[164:167]
  ds_read_b128 a[228:231], v21 offset:18432
  v_mfma_f32_16x16x32_bf16 v[164:167], a[204:207], v[68:71], v[164:167]
  s_xor_b32 s12, s44, 5
  ds_read_b128 a[144:147], v20 offset:18560
  v_mfma_f32_16x16x32_bf16 v[164:167], a[200:203], v[52:55], v[164:167]
  s_sub_u32 s12, s12, s44
  ds_read_b128 a[148:151], v21 offset:18560
  ds_read_b128 a[152:155], v20 offset:18688
  v_mfma_f32_16x16x32_bf16 v[168:171], a[200:203], v[56:59], 0
  s_mul_i32 s12, s12, 3407872
  ds_read_b128 a[156:159], v21 offset:18688
  v_mfma_f32_16x16x32_bf16 v[168:171], a[204:207], v[72:75], v[168:171]
  s_add_u32 s12, s12, s15
  v_exp_f32 v185, v185
  v_mfma_f32_16x16x32_bf16 v[168:171], a[208:211], v[88:91], v[168:171]
  v_exp_f32 v186, v186
  v_mfma_f32_16x16x32_bf16 v[168:171], a[212:215], v[104:107], v[168:171]
  v_exp_f32 v187, v187
  v_mfma_f32_16x16x32_bf16 v[168:171], a[216:219], v[120:123], v[168:171]
  v_add_f32 v46, v46, v185
  v_cvt_pk_bf16_f32 v154, v184, v185
  v_mfma_f32_16x16x32_bf16 v[168:171], a[220:223], v[136:139], v[168:171]
  v_add_f32 v46, v46, v186
  v_cvt_pk_bf16_f32 v155, v186, v187
  v_mfma_f32_16x16x32_bf16 v[172:175], a[220:223], v[140:143], 0
  s_xor_b32 s13, s44, 6
  v_exp_f32 v188, v188
  v_mfma_f32_16x16x32_bf16 v[172:175], a[216:219], v[124:127], v[172:175]
  s_waitcnt lgkmcnt(0)
  s_barrier
  v_add_f32 v46, v46, v187
  v_add_f32 v47, v47, v188
  v_mfma_f32_16x16x32_bf16 v[172:175], a[212:215], v[108:111], v[172:175]
  buffer_load_dword v40, v14, s[4:7], s78 offen offset:0 sc1
  v_mfma_f32_16x16x32_bf16 v[172:175], a[208:211], v[92:95], v[172:175]
  s_sub_u32 s13, s13, s44
  v_exp_f32 v189, v189
  v_mfma_f32_16x16x32_bf16 v[172:175], a[204:207], v[76:79], v[172:175]
  s_add_u32 m0, s74, 73728
  v_exp_f32 v190, v190
  v_mfma_f32_16x16x32_bf16 v[172:175], a[200:203], v[60:63], v[172:175]
  s_mov_b32 s50, 73728
  v_exp_f32 v191, v191
  v_mfma_f32_16x16x32_bf16 v[176:179], a[224:227], v[48:51], 0
  s_mul_i32 s13, s13, 3407872
  v_add_f32 v47, v47, v189
  v_cvt_pk_bf16_f32 v158, v188, v189
  v_mfma_f32_16x16x32_bf16 v[176:179], a[228:231], v[64:67], v[176:179]
  s_add_u32 s13, s13, s15
  v_add_f32 v47, v47, v190
  v_cvt_pk_bf16_f32 v159, v190, v191
  v_mfma_f32_16x16x32_bf16 v[176:179], a[144:147], v[80:83], v[176:179]
  s_xor_b32 s14, s44, 7
  v_add_f32 v47, v47, v191
  v_mfma_f32_16x16x32_bf16 v[176:179], a[148:151], v[96:99], v[176:179]
  s_sub_u32 s14, s14, s44
  v_exp_f32 v160, v160
  v_mfma_f32_16x16x32_bf16 v[176:179], a[152:155], v[112:115], v[176:179]
  s_mul_i32 s14, s14, 3407872
  v_exp_f32 v161, v161
  v_mfma_f32_16x16x32_bf16 v[176:179], a[156:159], v[128:131], v[176:179]
  s_add_u32 s14, s14, s15
  v_exp_f32 v162, v162
  v_mfma_f32_16x16x32_bf16 v[180:183], a[156:159], v[132:135], 0
  v_exp_f32 v163, v163
  v_mfma_f32_16x16x32_bf16 v[180:183], a[152:155], v[116:119], v[180:183]
  v_add_f32 v44, v44, v160
  v_cvt_pk_bf16_f32 v160, v160, v161
  v_mfma_f32_16x16x32_bf16 v[180:183], a[148:151], v[100:103], v[180:183]
  buffer_load_dwordx4 v28, s[16:19], s50 offen offset:0  lds
  v_mfma_f32_16x16x32_bf16 v[180:183], a[144:147], v[84:87], v[180:183]
  v_exp_f32 v164, v164
  v_mfma_f32_16x16x32_bf16 v[180:183], a[228:231], v[68:71], v[180:183]
  v_exp_f32 v165, v165
  v_mfma_f32_16x16x32_bf16 v[180:183], a[224:227], v[52:55], v[180:183]
  v_exp_f32 v166, v166
  v_mfma_f32_16x16x32_bf16 v[184:187], a[224:227], v[56:59], 0
  ds_read_b64_tr_b16 a[160:161], v11 offset:24704
  v_add_f32 v44, v44, v161
  v_mfma_f32_16x16x32_bf16 v[184:187], a[228:231], v[72:75], v[184:187]
  ds_read_b64_tr_b16 a[162:163], v11 offset:30848
  v_cvt_pk_bf16_f32 v161, v162, v163
  v_mfma_f32_16x16x32_bf16 v[184:187], a[144:147], v[88:91], v[184:187]
  v_exp_f32 v167, v167
  v_mfma_f32_16x16x32_bf16 v[184:187], a[148:151], v[104:107], v[184:187]
  ds_read_b64_tr_b16 a[164:165], v12 offset:24704
  v_add_f32 v44, v44, v162
  v_mfma_f32_16x16x32_bf16 v[184:187], a[152:155], v[120:123], v[184:187]
  buffer_load_dwordx4 v29, s[16:19], s50 offen offset:1024  lds
  v_mfma_f32_16x16x32_bf16 v[184:187], a[156:159], v[136:139], v[184:187]
  ds_read_b64_tr_b16 a[166:167], v12 offset:30848
  v_add_f32 v44, v44, v163
  v_mfma_f32_16x16x32_bf16 v[188:191], a[156:159], v[140:143], 0
  v_add_f32 v45, v45, v164
  v_cvt_pk_bf16_f32 v164, v164, v165
  v_mfma_f32_16x16x32_bf16 v[188:191], a[152:155], v[124:127], v[188:191]
  v_add_f32 v45, v45, v165
  v_cvt_pk_bf16_f32 v165, v166, v167
  v_mfma_f32_16x16x32_bf16 v[188:191], a[148:151], v[108:111], v[188:191]
  ds_read_b64_tr_b16 a[248:249], v9 offset:24832
  v_add_f32 v45, v45, v166
  v_mfma_f32_16x16x32_bf16 v[188:191], a[144:147], v[92:95], v[188:191]
  ds_read_b64_tr_b16 a[250:251], v9 offset:30976
  v_add_f32 v45, v45, v167
  v_mfma_f32_16x16x32_bf16 v[188:191], a[228:231], v[76:79], v[188:191]
  v_exp_f32 v168, v168
  v_mfma_f32_16x16x32_bf16 v[188:191], a[224:227], v[60:63], v[188:191]
  s_waitcnt lgkmcnt(4)
  v_exp_f32 v169, v169
  v_mfma_f32_16x16x32_bf16 a[32:35], a[160:163], v[144:147], a[32:35]
  buffer_load_dwordx4 v30, s[16:19], s50 offen offset:2048  lds
  v_mfma_f32_16x16x32_bf16 a[36:39], a[160:163], v[148:151], a[36:39]
  s_add_u32 m0, s74, 110592
  ds_read_b64_tr_b16 a[252:253], v10 offset:24832
  ds_read_b64_tr_b16 a[254:255], v10 offset:30976
  v_mfma_f32_16x16x32_bf16 a[40:43], a[160:163], v[152:155], a[40:43]
  s_add_u32 s63, s99, 184320
  v_exp_f32 v170, v170
  v_mfma_f32_16x16x32_bf16 a[44:47], a[160:163], v[156:159], a[44:47]
  s_waitcnt lgkmcnt(4)
  v_exp_f32 v171, v171
  v_mfma_f32_16x16x32_bf16 a[60:63], a[164:167], v[156:159], a[60:63]
  v_add_f32 v46, v46, v168
  v_cvt_pk_bf16_f32 v168, v168, v169
  v_mfma_f32_16x16x32_bf16 a[56:59], a[164:167], v[152:155], a[56:59]
  ds_read_b64_tr_b16 a[200:201], v11 offset:24832
  ds_read_b64_tr_b16 a[202:203], v11 offset:30976
  v_mfma_f32_16x16x32_bf16 a[52:55], a[164:167], v[148:151], a[52:55]
  v_add_f32 v46, v46, v169
  v_cvt_pk_bf16_f32 v169, v170, v171
  v_mfma_f32_16x16x32_bf16 a[48:51], a[164:167], v[144:147], a[48:51]
  s_waitcnt lgkmcnt(4)
  v_exp_f32 v172, v172
  v_mfma_f32_16x16x32_bf16 a[64:67], a[248:251], v[144:147], a[64:67]
  buffer_load_dwordx4 v34, s[28:31], s63 offen offset:0  lds
  v_mfma_f32_16x16x32_bf16 a[68:71], a[248:251], v[148:151], a[68:71]
  ds_read_b64_tr_b16 a[204:205], v12 offset:24832
  ds_read_b64_tr_b16 a[206:207], v12 offset:30976
  v_mfma_f32_16x16x32_bf16 a[72:75], a[248:251], v[152:155], a[72:75]
  v_exp_f32 v173, v173
  v_mfma_f32_16x16x32_bf16 a[76:79], a[248:251], v[156:159], a[76:79]
  s_waitcnt lgkmcnt(4)
  v_exp_f32 v174, v174
  v_mfma_f32_16x16x32_bf16 a[92:95], a[252:255], v[156:159], a[92:95]
  v_exp_f32 v175, v175
  v_mfma_f32_16x16x32_bf16 a[88:91], a[252:255], v[152:155], a[88:91]
  ds_read_b128 a[208:211], v18 offset:0
  v_add_f32 v46, v46, v170
  v_mfma_f32_16x16x32_bf16 a[84:87], a[252:255], v[148:151], a[84:87]
  ds_read_b128 a[212:215], v19 offset:0
  v_add_f32 v46, v46, v171
  v_mfma_f32_16x16x32_bf16 a[80:83], a[252:255], v[144:147], a[80:83]
  s_waitcnt lgkmcnt(4)
  ds_read_b128 a[216:219], v18 offset:128
  ds_read_b128 a[220:223], v19 offset:128
  v_mfma_f32_16x16x32_bf16 a[96:99], a[200:203], v[144:147], a[96:99]
  buffer_load_dwordx4 v35, s[28:31], s63 offen offset:1024  lds
  v_mfma_f32_16x16x32_bf16 a[100:103], a[200:203], v[148:151], a[100:103]
  ds_read_b128 a[224:227], v18 offset:256
  v_add_f32 v47, v47, v172
  v_mfma_f32_16x16x32_bf16 a[104:107], a[200:203], v[152:155], a[104:107]
  ds_read_b128 a[228:231], v19 offset:256
  v_add_f32 v47, v47, v173
  v_mfma_f32_16x16x32_bf16 a[108:111], a[200:203], v[156:159], a[108:111]
  s_waitcnt lgkmcnt(6)
  v_cvt_pk_bf16_f32 v172, v172, v173
  v_add_f32 v47, v47, v174
  v_mfma_f32_16x16x32_bf16 a[124:127], a[204:207], v[156:159], a[124:127]
  v_add_f32 v47, v47, v175
  v_cvt_pk_bf16_f32 v173, v174, v175
  v_mfma_f32_16x16x32_bf16 a[120:123], a[204:207], v[152:155], a[120:123]
  v_exp_f32 v176, v176
  v_mfma_f32_16x16x32_bf16 a[116:119], a[204:207], v[148:151], a[116:119]
  v_exp_f32 v177, v177
  v_mfma_f32_16x16x32_bf16 a[112:115], a[204:207], v[144:147], a[112:115]
  s_waitcnt lgkmcnt(3)
  v_exp_f32 v178, v178
  v_mfma_f32_16x16x32_bf16 v[192:195], a[208:211], v[48:51], 0
  buffer_load_dwordx4 v36, s[28:31], s63 offen offset:2048  lds
  v_mfma_f32_16x16x32_bf16 v[192:195], a[212:215], v[64:67], v[192:195]
  s_add_u32 m0, s74, 98304
  v_exp_f32 v179, v179
  v_mfma_f32_16x16x32_bf16 v[192:195], a[216:219], v[80:83], v[192:195]
  s_waitcnt lgkmcnt(2)
  s_mov_b32 s99, 61440
  v_add_f32 v44, v44, v176
  v_cvt_pk_bf16_f32 v162, v176, v177
  v_mfma_f32_16x16x32_bf16 v[192:195], a[220:223], v[96:99], v[192:195]
  s_waitcnt lgkmcnt(1)
  v_exp_f32 v180, v180
  v_mfma_f32_16x16x32_bf16 v[192:195], a[224:227], v[112:115], v[192:195]
  s_waitcnt lgkmcnt(0)
  v_exp_f32 v181, v181
  v_mfma_f32_16x16x32_bf16 v[192:195], a[228:231], v[128:131], v[192:195]
  v_exp_f32 v182, v182
  v_mfma_f32_16x16x32_bf16 v[196:199], a[228:231], v[132:135], 0
  v_exp_f32 v183, v183
  v_mfma_f32_16x16x32_bf16 v[196:199], a[224:227], v[116:119], v[196:199]
  ds_read_b128 a[156:159], v19 offset:6272
  v_cvt_pk_bf16_f32 v163, v178, v179
  v_mfma_f32_16x16x32_bf16 v[196:199], a[220:223], v[100:103], v[196:199]
  buffer_load_dwordx4 v31, s[20:23], s99 offen offset:0  lds
  v_mfma_f32_16x16x32_bf16 v[196:199], a[216:219], v[84:87], v[196:199]
  ds_read_b128 a[152:155], v18 offset:6272
  v_add_f32 v44, v44, v177
  v_mfma_f32_16x16x32_bf16 v[196:199], a[212:215], v[68:71], v[196:199]
  ds_read_b128 a[144:147], v18 offset:6144
  v_add_f32 v44, v44, v178
  v_mfma_f32_16x16x32_bf16 v[196:199], a[208:211], v[52:55], v[196:199]
  ds_read_b128 a[148:151], v19 offset:6144
  ds_read_b128 a[160:163], v18 offset:6400
  v_mfma_f32_16x16x32_bf16 v[200:203], a[208:211], v[56:59], 0
  ds_read_b128 a[164:167], v19 offset:6400
  v_add_f32 v44, v44, v179
  v_mfma_f32_16x16x32_bf16 v[200:203], a[212:215], v[72:75], v[200:203]
  v_add_f32 v45, v45, v180
  v_cvt_pk_bf16_f32 v166, v180, v181
  v_mfma_f32_16x16x32_bf16 v[200:203], a[216:219], v[88:91], v[200:203]
  s_add_u32 s43, s40, 1
  v_add_f32 v45, v45, v181
  v_cvt_pk_bf16_f32 v167, v182, v183
  v_mfma_f32_16x16x32_bf16 v[200:203], a[220:223], v[104:107], v[200:203]
  v_exp_f32 v184, v184
  v_mfma_f32_16x16x32_bf16 v[200:203], a[224:227], v[120:123], v[200:203]
  buffer_load_dwordx4 v32, s[20:23], s99 offen offset:1024  lds
  v_mfma_f32_16x16x32_bf16 v[200:203], a[228:231], v[136:139], v[200:203]
  v_exp_f32 v185, v185
  v_mfma_f32_16x16x32_bf16 v[204:207], a[228:231], v[140:143], 0
  v_exp_f32 v186, v186
  v_mfma_f32_16x16x32_bf16 v[204:207], a[224:227], v[124:127], v[204:207]
  s_waitcnt vmcnt(19) lgkmcnt(0)
  s_barrier
  v_exp_f32 v187, v187
  v_mfma_f32_16x16x32_bf16 v[204:207], a[220:223], v[108:111], v[204:207]
  v_add_f32 v45, v45, v182
  v_add_f32 v46, v46, v184
  v_mfma_f32_16x16x32_bf16 v[204:207], a[216:219], v[92:95], v[204:207]
  v_add_f32 v45, v45, v183
  v_add_f32 v46, v46, v185
  v_mfma_f32_16x16x32_bf16 v[204:207], a[212:215], v[76:79], v[204:207]
  v_cvt_pk_bf16_f32 v170, v184, v185
  v_add_f32 v46, v46, v186
  v_mfma_f32_16x16x32_bf16 v[204:207], a[208:211], v[60:63], v[204:207]
  v_add_f32 v46, v46, v187
  v_cvt_pk_bf16_f32 v171, v186, v187
  v_mfma_f32_16x16x32_bf16 v[176:179], a[144:147], v[48:51], 0
  buffer_load_dwordx4 v33, s[20:23], s99 offen offset:2048  lds
  v_mfma_f32_16x16x32_bf16 v[176:179], a[148:151], v[64:67], v[176:179]
  s_add_u32 m0, s74, 49152
  v_exp_f32 v188, v188
  v_mfma_f32_16x16x32_bf16 v[176:179], a[152:155], v[80:83], v[176:179]
  s_mov_b32 s49, 86016
  v_exp_f32 v189, v189
  v_mfma_f32_16x16x32_bf16 v[176:179], a[156:159], v[96:99], v[176:179]
  v_exp_f32 v190, v190
  v_mfma_f32_16x16x32_bf16 v[176:179], a[160:163], v[112:115], v[176:179]
  v_exp_f32 v191, v191
  v_mfma_f32_16x16x32_bf16 v[176:179], a[164:167], v[128:131], v[176:179]
  s_waitcnt vmcnt(9)
  v_add_f32 v47, v47, v188
  v_subrev_u32 v40, s43, v40
  v_mfma_f32_16x16x32_bf16 v[180:183], a[164:167], v[132:135], 0
  s_add_u32 s48, s85, 24576
  v_cvt_pk_bf16_f32 v174, v188, v189
  v_cmp_lt_u32 vcc, 7, v40
  v_mfma_f32_16x16x32_bf16 v[180:183], a[160:163], v[116:119], v[180:183]
  s_cbranch_vccnz L_spin1
L_ret1:
  v_exp_f32 v192, v192
  v_mfma_f32_16x16x32_bf16 v[180:183], a[156:159], v[100:103], v[180:183]
  buffer_load_dwordx4 v28, s[16:19], s49 offen offset:0  lds
  v_mfma_f32_16x16x32_bf16 v[180:183], a[152:155], v[84:87], v[180:183]
  buffer_load_dwordx2 a[128:129], v38, s[4:7], s48 offen offset:0 sc1
  v_mfma_f32_16x16x32_bf16 v[180:183], a[148:151], v[68:71], v[180:183]
  v_exp_f32 v193, v193
  v_mfma_f32_16x16x32_bf16 v[180:183], a[144:147], v[52:55], v[180:183]
  ds_read_b64_tr_b16 a[248:249], v9 offset:24576
  v_cvt_pk_bf16_f32 v175, v190, v191
  v_mfma_f32_16x16x32_bf16 v[184:187], a[144:147], v[56:59], 0
  ds_read_b64_tr_b16 a[250:251], v9 offset:30720
  v_add_f32 v47, v47, v189
  v_mfma_f32_16x16x32_bf16 v[184:187], a[148:151], v[72:75], v[184:187]
  s_add_u32 s52, s85, 51200
  ds_read_b64_tr_b16 a[252:253], v1 offset:0
  v_add_f32 v47, v47, v190
  v_mfma_f32_16x16x32_bf16 v[184:187], a[152:155], v[88:91], v[184:187]
  ds_read_b64_tr_b16 a[254:255], v1 offset:6144
  v_add_f32 v47, v47, v191
  v_mfma_f32_16x16x32_bf16 v[184:187], a[156:159], v[104:107], v[184:187]
  v_exp_f32 v194, v194
  v_mfma_f32_16x16x32_bf16 v[184:187], a[160:163], v[120:123], v[184:187]
  buffer_load_dwordx2 a[132:133], v38, s[4:7], s48 offen offset:512 sc1
  v_mfma_f32_16x16x32_bf16 v[184:187], a[164:167], v[136:139], v[184:187]
  v_exp_f32 v195, v195
  v_mfma_f32_16x16x32_bf16 v[188:191], a[164:167], v[140:143], 0
  v_exp_f32 v196, v196
  v_mfma_f32_16x16x32_bf16 v[188:191], a[160:163], v[124:127], v[188:191]
  ds_read_b64_tr_b16 a[200:201], v10 offset:24576
  v_add_f32 v44, v44, v192
  v_mfma_f32_16x16x32_bf16 v[188:191], a[156:159], v[108:111], v[188:191]
  ds_read_b64_tr_b16 a[202:203], v10 offset:30720
  v_cvt_pk_bf16_f32 v192, v192, v193
  v_mfma_f32_16x16x32_bf16 v[188:191], a[152:155], v[92:95], v[188:191]
  buffer_load_dwordx4 v29, s[16:19], s49 offen offset:1024  lds
  v_mfma_f32_16x16x32_bf16 v[188:191], a[148:151], v[76:79], v[188:191]
  ds_read_b64_tr_b16 a[204:205], v2 offset:0
  v_add_f32 v44, v44, v193
  v_mfma_f32_16x16x32_bf16 v[188:191], a[144:147], v[60:63], v[188:191]
  s_waitcnt lgkmcnt(3)
  ds_read_b64_tr_b16 a[206:207], v2 offset:6144
  v_add_f32 v44, v44, v194
  v_mfma_f32_16x16x32_bf16 v[220:223], a[248:251], v[156:159], v[220:223]
  buffer_load_dwordx2 a[130:131], v38, s[4:7], s52 offen offset:0 sc1
  v_mfma_f32_16x16x32_bf16 v[220:223], a[252:255], v[172:175], v[220:223]
  v_exp_f32 v197, v197
  v_mfma_f32_16x16x32_bf16 v[216:219], a[252:255], v[168:171], v[216:219]
  v_exp_f32 v198, v198
  v_mfma_f32_16x16x32_bf16 v[216:219], a[248:251], v[152:155], v[216:219]
  s_add_u32 s51, s85, 77824
  v_exp_f32 v199, v199
  v_mfma_f32_16x16x32_bf16 v[212:215], a[248:251], v[148:151], v[212:215]
  ds_read_b64_tr_b16 a[212:213], v3 offset:0
  v_add_f32 v44, v44, v195
  v_mfma_f32_16x16x32_bf16 v[212:215], a[252:255], v[164:167], v[212:215]
  ds_read_b64_tr_b16 a[208:209], v11 offset:24576
  ds_read_b64_tr_b16 a[214:215], v3 offset:6144
  v_mfma_f32_16x16x32_bf16 v[208:211], a[252:255], v[160:163], v[208:211]
  s_waitcnt lgkmcnt(5)
  ds_read_b64_tr_b16 a[210:211], v11 offset:30720
  v_cvt_pk_bf16_f32 v193, v194, v195
  v_mfma_f32_16x16x32_bf16 v[208:211], a[248:251], v[144:147], v[208:211]
  buffer_load_dwordx2 a[134:135], v38, s[4:7], s52 offen offset:512 sc1
  v_mfma_f32_16x16x32_bf16 v[224:227], a[200:203], v[144:147], v[224:227]
  s_waitcnt lgkmcnt(4)
  v_add_f32 v45, v45, v196
  v_cvt_pk_bf16_f32 v196, v196, v197
  v_mfma_f32_16x16x32_bf16 v[224:227], a[204:207], v[160:163], v[224:227]
  v_add_f32 v45, v45, v197
  v_cvt_pk_bf16_f32 v197, v198, v199
  v_mfma_f32_16x16x32_bf16 v[228:231], a[204:207], v[164:167], v[228:231]
  ds_read_b64_tr_b16 a[216:217], v12 offset:24576
  v_add_f32 v45, v45, v198
  v_mfma_f32_16x16x32_bf16 v[228:231], a[200:203], v[148:151], v[228:231]
  buffer_load_dwordx4 v30, s[16:19], s49 offen offset:2048  lds
  v_mfma_f32_16x16x32_bf16 v[232:235], a[200:203], v[152:155], v[232:235]
  ds_read_b64_tr_b16 a[218:219], v12 offset:30720
  v_add_f32 v45, v45, v199
  v_mfma_f32_16x16x32_bf16 v[232:235], a[204:207], v[168:171], v[232:235]
  buffer_load_dwordx2 a[136:137], v38, s[4:7], s51 offen offset:0 sc1
  v_mfma_f32_16x16x32_bf16 v[236:239], a[204:207], v[172:175], v[236:239]
  ds_read_b64_tr_b16 a[220:221], v4 offset:0
  v_mfma_f32_16x16x32_bf16 v[236:239], a[200:203], v[156:159], v[236:239]
  s_waitcnt lgkmcnt(3)
  ds_read_b64_tr_b16 a[222:223], v4 offset:6144
  ds_read_b128 a[152:155], v16 offset:24576
  v_mfma_f32_16x16x32_bf16 v[252:255], a[208:211], v[156:159], v[252:255]
  v_exp_f32 v200, v200
  v_mfma_f32_16x16x32_bf16 v[252:255], a[212:215], v[172:175], v[252:255]
  s_add_u32 s54, s85, 104448
  v_exp_f32 v201, v201
  v_mfma_f32_16x16x32_bf16 v[248:251], a[212:215], v[168:171], v[248:251]
  v_exp_f32 v202, v202
  v_mfma_f32_16x16x32_bf16 v[248:251], a[208:211], v[152:155], v[248:251]
  v_exp_f32 v203, v203
  v_mfma_f32_16x16x32_bf16 v[244:247], a[208:211], v[148:151], v[244:247]
  ds_read_b64_tr_b16 a[224:225], v9 offset:24704
  v_add_f32 v46, v46, v200
  v_mfma_f32_16x16x32_bf16 v[244:247], a[212:215], v[164:167], v[244:247]
  buffer_load_dwordx2 a[140:141], v38, s[4:7], s51 offen offset:512 sc1
  v_mfma_f32_16x16x32_bf16 v[240:243], a[212:215], v[160:163], v[240:243]
  ds_read_b64_tr_b16 a[226:227], v9 offset:30848
  v_cvt_pk_bf16_f32 v200, v200, v201
  v_mfma_f32_16x16x32_bf16 v[240:243], a[208:211], v[144:147], v[240:243]
  s_waitcnt lgkmcnt(5)
  ds_read_b64_tr_b16 a[228:229], v1 offset:128
  ds_read_b64_tr_b16 a[230:231], v1 offset:6272
  v_mfma_f32_16x16x32_bf16 a[232:235], a[216:219], v[144:147], a[232:235]
  s_waitcnt lgkmcnt(5)
  v_add_f32 v46, v46, v201
  v_cvt_pk_bf16_f32 v201, v202, v203
  v_mfma_f32_16x16x32_bf16 a[232:235], a[220:223], v[160:163], a[232:235]
  v_exp_f32 v204, v204
  v_mfma_f32_16x16x32_bf16 a[236:239], a[220:223], v[164:167], a[236:239]
  v_exp_f32 v205, v205
  v_mfma_f32_16x16x32_bf16 a[236:239], a[216:219], v[148:151], a[236:239]
  v_exp_f32 v206, v206
  v_mfma_f32_16x16x32_bf16 a[240:243], a[216:219], v[152:155], a[240:243]
  buffer_load_dwordx2 a[138:139], v38, s[4:7], s54 offen offset:0 sc1
  v_mfma_f32_16x16x32_bf16 a[240:243], a[220:223], v[168:171], a[240:243]
  ds_read_b64_tr_b16 a[144:145], v10 offset:24704
  v_add_f32 v46, v46, v202
  v_mfma_f32_16x16x32_bf16 a[244:247], a[220:223], v[172:175], a[244:247]
  s_waitcnt lgkmcnt(3)
  ds_read_b64_tr_b16 a[146:147], v10 offset:30848
  v_add_f32 v46, v46, v203
  v_mfma_f32_16x16x32_bf16 a[244:247], a[216:219], v[156:159], a[244:247]
  s_add_u32 s53, s85, 20480
  ds_read_b64_tr_b16 a[148:149], v2 offset:128
  ds_read_b64_tr_b16 a[150:151], v2 offset:6272
  v_mfma_f32_16x16x32_bf16 a[12:15], a[224:227], v[156:159], a[12:15]
  s_waitcnt lgkmcnt(4)
  v_exp_f32 v207, v207
  v_mfma_f32_16x16x32_bf16 a[12:15], a[228:231], v[172:175], a[12:15]
  v_exp_f32 v176, v176
  v_mfma_f32_16x16x32_bf16 a[8:11], a[228:231], v[168:171], a[8:11]
  v_exp_f32 v177, v177
  v_mfma_f32_16x16x32_bf16 a[8:11], a[224:227], v[152:155], a[8:11]
  buffer_load_dwordx2 a[142:143], v38, s[4:7], s54 offen offset:512 sc1
  v_mfma_f32_16x16x32_bf16 a[4:7], a[224:227], v[148:151], a[4:7]
  v_exp_f32 v178, v178
  v_mfma_f32_16x16x32_bf16 a[4:7], a[228:231], v[164:167], a[4:7]
  v_exp_f32 v179, v179
  v_mfma_f32_16x16x32_bf16 a[0:3], a[228:231], v[160:163], a[0:3]
  v_add_f32 v47, v47, v204
  v_cvt_pk_bf16_f32 v204, v204, v205
  v_mfma_f32_16x16x32_bf16 a[0:3], a[224:227], v[144:147], a[0:3]
  s_waitcnt lgkmcnt(2)
  ds_read_b128 a[156:159], v17 offset:24576
  v_add_f32 v47, v47, v205
  v_mfma_f32_16x16x32_bf16 a[16:19], a[144:147], v[144:147], a[16:19]
  s_waitcnt lgkmcnt(1)
  ds_read_b128 a[160:163], v16 offset:24704
  v_add_f32 v47, v47, v206
  v_mfma_f32_16x16x32_bf16 a[16:19], a[148:151], v[160:163], a[16:19]
  ds_read_b128 a[164:167], v17 offset:24704
  ds_read_b128 a[248:251], v16 offset:24832
  v_mfma_f32_16x16x32_bf16 a[20:23], a[148:151], v[164:167], a[20:23]
  buffer_load_dwordx4 a[168:171], v37, s[4:7], s53 offen offset:0 sc1
  v_mfma_f32_16x16x32_bf16 a[20:23], a[144:147], v[148:151], a[20:23]
  ds_read_b128 a[252:255], v17 offset:24832
  v_cvt_pk_bf16_f32 v205, v206, v207
  v_mfma_f32_16x16x32_bf16 a[24:27], a[144:147], v[152:155], a[24:27]
  v_add_f32 v47, v47, v207
  v_add_f32 v44, v44, v176
  v_mfma_f32_16x16x32_bf16 a[24:27], a[148:151], v[168:171], a[24:27]
  s_add_u32 s56, s85, 47104
  v_add_f32 v44, v44, v177
  v_cvt_pk_bf16_f32 v194, v176, v177
  v_mfma_f32_16x16x32_bf16 a[28:31], a[148:151], v[172:175], a[28:31]
  v_add_f32 v44, v44, v178
  v_cvt_pk_bf16_f32 v195, v178, v179
  v_mfma_f32_16x16x32_bf16 a[28:31], a[144:147], v[156:159], a[28:31]
  ds_read_b128 a[204:207], v17 offset:30720
  v_add_f32 v44, v44, v179
  v_mfma_f32_16x16x32_bf16 v[144:147], a[152:155], v[48:51], 0
  s_waitcnt lgkmcnt(4)
  v_exp_f32 v180, v180
  v_mfma_f32_16x16x32_bf16 v[144:147], a[156:159], v[64:67], v[144:147]
  buffer_load_dwordx4 a[172:175], v37, s[4:7], s53 offen offset:1024 sc1
  v_mfma_f32_16x16x32_bf16 v[144:147], a[160:163], v[80:83], v[144:147]
  s_waitcnt lgkmcnt(3)
  v_exp_f32 v181, v181
  v_mfma_f32_16x16x32_bf16 v[144:147], a[164:167], v[96:99], v[144:147]
  s_waitcnt lgkmcnt(1)
  v_exp_f32 v182, v182
  v_mfma_f32_16x16x32_bf16 v[144:147], a[248:251], v[112:115], v[144:147]
  s_lshr_b32 s58, s2, 3
  v_exp_f32 v183, v183
  v_mfma_f32_16x16x32_bf16 v[144:147], a[252:255], v[128:131], v[144:147]
  s_lshl_b32 s58, s58, 2
  v_add_f32 v45, v45, v180
  v_cvt_pk_bf16_f32 v198, v180, v181
  v_mfma_f32_16x16x32_bf16 v[148:151], a[252:255], v[132:135], 0
  s_add_u32 s58, s58, s72
  v_exp_f32 v184, v184
  v_mfma_f32_16x16x32_bf16 v[148:151], a[248:251], v[116:119], v[148:151]
  s_lshl_b32 s58, s58, 7
  v_exp_f32 v185, v185
  v_mfma_f32_16x16x32_bf16 v[148:151], a[164:167], v[100:103], v[148:151]
  buffer_load_dwordx4 a[176:179], v37, s[4:7], s56 offen offset:0 sc1
  v_mfma_f32_16x16x32_bf16 v[148:151], a[160:163], v[84:87], v[148:151]
  s_add_u32 s58, s58, 6144
  v_add_f32 v45, v45, v181
  v_cvt_pk_bf16_f32 v199, v182, v183
  v_mfma_f32_16x16x32_bf16 v[148:151], a[156:159], v[68:71], v[148:151]
  ds_read_b128 a[200:203], v16 offset:30720
  v_add_f32 v45, v45, v182
  v_mfma_f32_16x16x32_bf16 v[148:151], a[152:155], v[52:55], v[148:151]
  s_add_u32 s57, s85, 73728
  ds_read_b128 a[208:211], v16 offset:30848
  ds_read_b128 a[212:215], v17 offset:30848
  v_mfma_f32_16x16x32_bf16 v[152:155], a[152:155], v[56:59], 0
  s_getpc_b64 s[82:83]
  ds_read_b128 a[220:223], v17 offset:30976
  v_add_f32 v45, v45, v183
  v_mfma_f32_16x16x32_bf16 v[152:155], a[156:159], v[72:75], v[152:155]
  ds_read_b128 a[216:219], v16 offset:30976
  v_add_f32 v46, v46, v184
  v_mfma_f32_16x16x32_bf16 v[152:155], a[160:163], v[88:91], v[152:155]
  v_exp_f32 v186, v186
  v_mfma_f32_16x16x32_bf16 v[152:155], a[164:167], v[104:107], v[152:155]
  buffer_load_dwordx4 a[180:183], v37, s[4:7], s56 offen offset:1024 sc1
  v_mfma_f32_16x16x32_bf16 v[152:155], a[248:251], v[120:123], v[152:155]
  v_exp_f32 v187, v187
  v_mfma_f32_16x16x32_bf16 v[152:155], a[252:255], v[136:139], v[152:155]
  v_add_f32 v46, v46, v185
  v_cvt_pk_bf16_f32 v202, v184, v185
  v_mfma_f32_16x16x32_bf16 v[156:159], a[252:255], v[140:143], 0
  v_add_f32 v46, v46, v186
  v_cvt_pk_bf16_f32 v203, v186, v187
  v_mfma_f32_16x16x32_bf16 v[156:159], a[248:251], v[124:127], v[156:159]
  s_waitcnt vmcnt(18) lgkmcnt(0)
  s_barrier
  v_exp_f32 v188, v188
  v_mfma_f32_16x16x32_bf16 v[156:159], a[164:167], v[108:111], v[156:159]
  v_add_f32 v46, v46, v187
  v_mov_b32 v25, s58
  v_mfma_f32_16x16x32_bf16 v[156:159], a[160:163], v[92:95], v[156:159]
  buffer_load_dwordx4 a[184:187], v37, s[4:7], s57 offen offset:0 sc1
  v_mfma_f32_16x16x32_bf16 v[156:159], a[156:159], v[76:79], v[156:159]
  global_load_dword v25, v25, s[82:83]
  v_mfma_f32_16x16x32_bf16 v[156:159], a[152:155], v[60:63], v[156:159]
  s_add_u32 m0, s74, 24576
  v_exp_f32 v189, v189
  v_mfma_f32_16x16x32_bf16 v[176:179], a[200:203], v[48:51], 0
  s_mov_b32 s55, 73728
  v_exp_f32 v190, v190
  v_mfma_f32_16x16x32_bf16 v[176:179], a[204:207], v[64:67], v[176:179]
  s_add_u32 s75, s85, 100352
  v_exp_f32 v191, v191
  v_mfma_f32_16x16x32_bf16 v[176:179], a[208:211], v[80:83], v[176:179]
  v_add_f32 v47, v47, v188
  v_cvt_pk_bf16_f32 v206, v188, v189
  v_mfma_f32_16x16x32_bf16 v[176:179], a[212:215], v[96:99], v[176:179]
  v_add_f32 v47, v47, v189
  v_cvt_pk_bf16_f32 v207, v190, v191
  v_mfma_f32_16x16x32_bf16 v[176:179], a[216:219], v[112:115], v[176:179]
  v_add_f32 v47, v47, v190
  v_mfma_f32_16x16x32_bf16 v[176:179], a[220:223], v[128:131], v[176:179]
  buffer_load_dwordx4 a[188:191], v37, s[4:7], s57 offen offset:1024 sc1
  v_mfma_f32_16x16x32_bf16 v[180:183], a[220:223], v[132:135], 0
  v_exp_f32 v144, v144
  v_mfma_f32_16x16x32_bf16 v[180:183], a[216:219], v[116:119], v[180:183]
  v_exp_f32 v145, v145
  v_mfma_f32_16x16x32_bf16 v[180:183], a[212:215], v[100:103], v[180:183]
  v_exp_f32 v146, v146
  v_mfma_f32_16x16x32_bf16 v[180:183], a[208:211], v[84:87], v[180:183]
  buffer_load_dwordx4 v31, s[20:23], s55 offen offset:0  lds
  v_mfma_f32_16x16x32_bf16 v[180:183], a[204:207], v[68:71], v[180:183]
  v_exp_f32 v147, v147
  v_mfma_f32_16x16x32_bf16 v[180:183], a[200:203], v[52:55], v[180:183]
L_pg9:
  s_cbranch_execz L_hop2
  ds_read_b64_tr_b16 a[224:225], v3 offset:128
  ds_read_b64_tr_b16 a[226:227], v3 offset:6272
  v_mfma_f32_16x16x32_bf16 v[184:187], a[200:203], v[56:59], 0
  buffer_load_dwordx4 a[192:195], v37, s[4:7], s75 offen offset:0 sc1
  v_mfma_f32_16x16x32_bf16 v[184:187], a[204:207], v[72:75], v[184:187]
  ds_read_b64_tr_b16 a[228:229], v7 offset:12416
  v_add_f32 v47, v47, v191
  v_mfma_f32_16x16x32_bf16 v[184:187], a[208:211], v[88:91], v[184:187]
  ds_read_b64_tr_b16 a[230:231], v7 offset:18560
  v_add_f32 v44, v44, v144
  v_mfma_f32_16x16x32_bf16 v[184:187], a[212:215], v[104:107], v[184:187]
  buffer_load_dwordx4 v32, s[20:23], s55 offen offset:1024  lds
  v_mfma_f32_16x16x32_bf16 v[184:187], a[216:219], v[120:123], v[184:187]
  v_add_f32 v44, v44, v145
  v_cvt_pk_bf16_f32 v144, v144, v145
  v_mfma_f32_16x16x32_bf16 v[184:187], a[220:223], v[136:139], v[184:187]
  v_exp_f32 v148, v148
  v_mfma_f32_16x16x32_bf16 v[188:191], a[220:223], v[140:143], 0
  v_exp_f32 v149, v149
  v_mfma_f32_16x16x32_bf16 v[188:191], a[216:219], v[124:127], v[188:191]
  buffer_load_dwordx4 a[196:199], v37, s[4:7], s75 offen offset:1024 sc1
  v_mfma_f32_16x16x32_bf16 v[188:191], a[212:215], v[108:111], v[188:191]
  ds_read_b64_tr_b16 a[144:145], v4 offset:128
  v_cvt_pk_bf16_f32 v145, v146, v147
  v_mfma_f32_16x16x32_bf16 v[188:191], a[208:211], v[92:95], v[188:191]
  buffer_load_dwordx4 v33, s[20:23], s55 offen offset:2048  lds
  v_mfma_f32_16x16x32_bf16 v[188:191], a[204:207], v[76:79], v[188:191]
  s_add_u32 m0, s74, 122880
  ds_read_b64_tr_b16 a[146:147], v4 offset:6272
  v_add_f32 v44, v44, v146
  v_mfma_f32_16x16x32_bf16 v[188:191], a[200:203], v[60:63], v[188:191]
  s_waitcnt lgkmcnt(4)
  s_mov_b32 s59, 98304
  ds_read_b64_tr_b16 a[148:149], v8 offset:12416
  ds_read_b64_tr_b16 a[150:151], v8 offset:18560
  v_mfma_f32_16x16x32_bf16 a[44:47], a[224:227], v[172:175], a[44:47]
  s_waitcnt lgkmcnt(4)
  v_exp_f32 v150, v150
  v_mfma_f32_16x16x32_bf16 a[44:47], a[228:231], v[204:207], a[44:47]
  v_exp_f32 v151, v151
  v_mfma_f32_16x16x32_bf16 a[40:43], a[228:231], v[200:203], a[40:43]
  v_add_f32 v44, v44, v147
  v_add_f32 v45, v45, v148
  v_mfma_f32_16x16x32_bf16 a[40:43], a[224:227], v[168:171], a[40:43]
  buffer_load_dwordx4 v28, s[16:19], s59 offen offset:0  lds
  v_mfma_f32_16x16x32_bf16 a[36:39], a[224:227], v[164:167], a[36:39]
  v_exp_f32 v152, v152
  v_mfma_f32_16x16x32_bf16 a[36:39], a[228:231], v[196:199], a[36:39]
  ds_read_b64_tr_b16 a[152:153], v1 offset:256
  v_cvt_pk_bf16_f32 v148, v148, v149
  v_mfma_f32_16x16x32_bf16 a[32:35], a[228:231], v[192:195], a[32:35]
  ds_read_b64_tr_b16 a[154:155], v1 offset:6400
  v_add_f32 v45, v45, v149
  v_mfma_f32_16x16x32_bf16 a[32:35], a[224:227], v[160:163], a[32:35]
  s_waitcnt lgkmcnt(4)
  ds_read_b64_tr_b16 a[156:157], v5 offset:12544
  ds_read_b64_tr_b16 a[158:159], v5 offset:18688
  v_mfma_f32_16x16x32_bf16 a[48:51], a[144:147], v[160:163], a[48:51]
  s_waitcnt lgkmcnt(4)
  v_exp_f32 v153, v153
  v_mfma_f32_16x16x32_bf16 a[48:51], a[148:151], v[192:195], a[48:51]
  buffer_load_dwordx4 v29, s[16:19], s59 offen offset:1024  lds
  v_mfma_f32_16x16x32_bf16 a[52:55], a[148:151], v[196:199], a[52:55]
  v_exp_f32 v154, v154
  v_mfma_f32_16x16x32_bf16 a[52:55], a[144:147], v[164:167], a[52:55]
  v_exp_f32 v155, v155
  v_mfma_f32_16x16x32_bf16 a[56:59], a[144:147], v[168:171], a[56:59]
  ds_read_b64_tr_b16 a[164:165], v6 offset:12544
  v_cvt_pk_bf16_f32 v149, v150, v151
  v_mfma_f32_16x16x32_bf16 a[56:59], a[148:151], v[200:203], a[56:59]
  ds_read_b64_tr_b16 a[160:161], v2 offset:256
  ds_read_b64_tr_b16 a[166:167], v6 offset:18688
  v_mfma_f32_16x16x32_bf16 a[60:63], a[148:151], v[204:207], a[60:63]
  s_waitcnt lgkmcnt(5)
  ds_read_b64_tr_b16 a[162:163], v2 offset:6400
  v_add_f32 v45, v45, v150
  v_mfma_f32_16x16x32_bf16 a[60:63], a[144:147], v[172:175], a[60:63]
  buffer_load_dwordx4 v30, s[16:19], s59 offen offset:2048  lds
  v_mfma_f32_16x16x32_bf16 a[76:79], a[152:155], v[172:175], a[76:79]
  s_waitcnt lgkmcnt(4)
  v_add_f32 v45, v45, v151
  v_add_f32 v46, v46, v152
  v_mfma_f32_16x16x32_bf16 a[76:79], a[156:159], v[204:207], a[76:79]
  v_add_f32 v46, v46, v153
  v_cvt_pk_bf16_f32 v152, v152, v153
  v_mfma_f32_16x16x32_bf16 a[72:75], a[156:159], v[200:203], a[72:75]
  v_exp_f32 v156, v156
  v_mfma_f32_16x16x32_bf16 a[72:75], a[152:155], v[168:171], a[72:75]
  v_exp_f32 v157, v157
  v_mfma_f32_16x16x32_bf16 a[68:71], a[152:155], v[164:167], a[68:71]
  v_exp_f32 v158, v158
  v_mfma_f32_16x16x32_bf16 a[68:71], a[156:159], v[196:199], a[68:71]
  ds_read_b64_tr_b16 a[248:249], v3 offset:256
  v_cvt_pk_bf16_f32 v153, v154, v155
  v_mfma_f32_16x16x32_bf16 a[64:67], a[156:159], v[192:195], a[64:67]
  ds_read_b64_tr_b16 a[250:251], v3 offset:6400
  v_add_f32 v46, v46, v154
  v_mfma_f32_16x16x32_bf16 a[64:67], a[152:155], v[160:163], a[64:67]
  s_waitcnt lgkmcnt(2)
  ds_read_b64_tr_b16 a[252:253], v7 offset:12544
  ds_read_b64_tr_b16 a[254:255], v7 offset:18688
  v_mfma_f32_16x16x32_bf16 a[80:83], a[160:163], v[160:163], a[80:83]
  v_exp_f32 v159, v159
  v_mfma_f32_16x16x32_bf16 a[80:83], a[164:167], v[192:195], a[80:83]
  v_add_f32 v46, v46, v155
  v_add_f32 v47, v47, v156
  v_mfma_f32_16x16x32_bf16 a[84:87], a[164:167], v[196:199], a[84:87]
  v_add_f32 v47, v47, v157
  v_cvt_pk_bf16_f32 v156, v156, v157
  v_mfma_f32_16x16x32_bf16 a[84:87], a[160:163], v[164:167], a[84:87]
  v_exp_f32 v176, v176
  v_mfma_f32_16x16x32_bf16 a[88:91], a[160:163], v[168:171], a[88:91]
  v_exp_f32 v177, v177
  v_mfma_f32_16x16x32_bf16 a[88:91], a[164:167], v[200:203], a[88:91]
  ds_read_b64_tr_b16 a[200:201], v4 offset:256
  v_cvt_pk_bf16_f32 v157, v158, v159
  v_mfma_f32_16x16x32_bf16 a[92:95], a[164:167], v[204:207], a[92:95]
  ds_read_b64_tr_b16 a[202:203], v4 offset:6400
  v_add_f32 v47, v47, v158
  v_mfma_f32_16x16x32_bf16 a[92:95], a[160:163], v[172:175], a[92:95]
  s_waitcnt lgkmcnt(4)
  ds_read_b64_tr_b16 a[204:205], v8 offset:12544
  ds_read_b64_tr_b16 a[206:207], v8 offset:18688
  v_mfma_f32_16x16x32_bf16 a[108:111], a[248:251], v[172:175], a[108:111]
  s_waitcnt lgkmcnt(4)
  v_exp_f32 v178, v178
  v_mfma_f32_16x16x32_bf16 a[108:111], a[252:255], v[204:207], a[108:111]
  v_exp_f32 v179, v179
  v_mfma_f32_16x16x32_bf16 a[104:107], a[252:255], v[200:203], a[104:107]
  v_exp_f32 v180, v180
  v_mfma_f32_16x16x32_bf16 a[104:107], a[248:251], v[168:171], a[104:107]
  v_exp_f32 v181, v181
  v_mfma_f32_16x16x32_bf16 a[100:103], a[248:251], v[164:167], a[100:103]
  v_exp_f32 v182, v182
  v_mfma_f32_16x16x32_bf16 a[100:103], a[252:255], v[196:199], a[100:103]
  ds_read_b64_tr_b16 a[208:209], v9 offset:36864
  v_add_f32 v47, v47, v159
  v_mfma_f32_16x16x32_bf16 a[96:99], a[252:255], v[192:195], a[96:99]
  ds_read_b64_tr_b16 a[210:211], v9 offset:43008
  v_add_f32 v44, v44, v176
  v_mfma_f32_16x16x32_bf16 a[96:99], a[248:251], v[160:163], a[96:99]
  s_waitcnt lgkmcnt(4)
  ds_read_b64_tr_b16 a[212:213], v9 offset:49152
  ds_read_b64_tr_b16 a[214:215], v9 offset:55296
  v_mfma_f32_16x16x32_bf16 a[112:115], a[200:203], v[160:163], a[112:115]
  s_waitcnt lgkmcnt(4)
  v_exp_f32 v183, v183
  v_mfma_f32_16x16x32_bf16 a[112:115], a[204:207], v[192:195], a[112:115]
  ds_read_b64_tr_b16 a[216:217], v1 offset:12288
  v_cvt_pk_bf16_f32 v146, v176, v177
  v_mfma_f32_16x16x32_bf16 a[116:119], a[204:207], v[196:199], a[116:119]
  ds_read_b64_tr_b16 a[218:219], v1 offset:18432
  v_cvt_pk_bf16_f32 v147, v178, v179
  v_mfma_f32_16x16x32_bf16 a[116:119], a[200:203], v[164:167], a[116:119]
  ds_read_b64_tr_b16 a[220:221], v1 offset:36864
  ds_read_b64_tr_b16 a[222:223], v1 offset:43008
  v_mfma_f32_16x16x32_bf16 a[120:123], a[200:203], v[168:171], a[120:123]
  v_exp_f32 v184, v184
  v_mfma_f32_16x16x32_bf16 a[120:123], a[204:207], v[200:203], a[120:123]
  ds_read_b64_tr_b16 a[224:225], v5 offset:36864
  v_add_f32 v44, v44, v177
  v_mfma_f32_16x16x32_bf16 a[124:127], a[204:207], v[204:207], a[124:127]
  ds_read_b64_tr_b16 a[226:227], v5 offset:43008
  v_add_f32 v44, v44, v178
  v_mfma_f32_16x16x32_bf16 a[124:127], a[200:203], v[172:175], a[124:127]
  s_waitcnt vmcnt(21) lgkmcnt(8)
  ds_read_b64_tr_b16 a[228:229], v9 offset:12288
  ds_read_b64_tr_b16 a[230:231], v9 offset:18432
  v_mfma_f32_16x16x32_bf16 v[160:163], a[208:211], a[128:131], 0
  s_waitcnt vmcnt(16) lgkmcnt(8)
  v_exp_f32 v185, v185
  v_mfma_f32_16x16x32_bf16 v[160:163], a[212:215], a[136:139], v[160:163]
  s_waitcnt vmcnt(15)
  ds_read_b64_tr_b16 a[144:145], v10 offset:36864
  ds_read_b64_tr_b16 a[148:149], v10 offset:49152
  v_mfma_f32_16x16x32_bf16 v[168:171], a[212:215], a[140:143], 0
  ds_read_b64_tr_b16 a[146:147], v10 offset:43008
  v_add_f32 v44, v44, v179
  v_mfma_f32_16x16x32_bf16 v[168:171], a[208:211], a[132:135], v[168:171]
  s_waitcnt vmcnt(13) lgkmcnt(9)
  ds_read_b64_tr_b16 a[150:151], v10 offset:55296
  v_add_f32 v45, v45, v180
  v_mfma_f32_16x16x32_bf16 v[168:171], a[216:219], a[172:175], v[168:171]
  s_waitcnt vmcnt(11) lgkmcnt(8)
  v_exp_f32 v186, v186
  v_mfma_f32_16x16x32_bf16 v[168:171], a[220:223], a[180:183], v[168:171]
  ds_read_b64_tr_b16 a[152:153], v2 offset:12288
  ds_read_b64_tr_b16 a[156:157], v2 offset:36864
  v_mfma_f32_16x16x32_bf16 v[160:163], a[220:223], a[176:179], v[160:163]
  ds_read_b64_tr_b16 a[154:155], v2 offset:18432
  v_cvt_pk_bf16_f32 v150, v180, v181
  v_mfma_f32_16x16x32_bf16 v[160:163], a[216:219], a[168:171], v[160:163]
  s_waitcnt vmcnt(10) lgkmcnt(9)
  ds_read_b64_tr_b16 a[158:159], v2 offset:43008
  v_cvt_pk_bf16_f32 v151, v182, v183
  v_mfma_f32_16x16x32_bf16 v[160:163], a[224:227], a[184:187], v[160:163]
  s_waitcnt vmcnt(6) lgkmcnt(8)
  v_exp_f32 v187, v187
  v_mfma_f32_16x16x32_bf16 v[160:163], a[228:231], a[192:195], v[160:163]
  s_waitcnt vmcnt(4)
  ds_read_b64_tr_b16 a[160:161], v6 offset:36864
  v_add_f32 v45, v45, v181
  v_mfma_f32_16x16x32_bf16 v[168:171], a[228:231], a[196:199], v[168:171]
  ds_read_b64_tr_b16 a[162:163], v6 offset:43008
  v_add_f32 v45, v45, v182
  v_mfma_f32_16x16x32_bf16 v[168:171], a[224:227], a[188:191], v[168:171]
  s_waitcnt lgkmcnt(7)
  ds_read_b64_tr_b16 a[164:165], v10 offset:12288
  ds_read_b64_tr_b16 a[166:167], v10 offset:18432
  v_mfma_f32_16x16x32_bf16 v[164:167], a[144:147], a[128:131], 0
  s_waitcnt lgkmcnt(8)
  v_exp_f32 v188, v188
  v_mfma_f32_16x16x32_bf16 v[164:167], a[148:151], a[136:139], v[164:167]
  ds_read_b64_tr_b16 a[248:249], v10 offset:36992
  ds_read_b64_tr_b16 a[252:253], v10 offset:49280
  v_mfma_f32_16x16x32_bf16 v[172:175], a[148:151], a[140:143], 0
  ds_read_b64_tr_b16 a[250:251], v10 offset:43136
  v_add_f32 v46, v46, v184
  v_mfma_f32_16x16x32_bf16 v[172:175], a[144:147], a[132:135], v[172:175]
  s_waitcnt lgkmcnt(8)
  ds_read_b64_tr_b16 a[254:255], v10 offset:55424
  v_cvt_pk_bf16_f32 v154, v184, v185
  v_mfma_f32_16x16x32_bf16 v[172:175], a[152:155], a[172:175], v[172:175]
  s_waitcnt lgkmcnt(8)
  v_exp_f32 v189, v189
  v_mfma_f32_16x16x32_bf16 v[172:175], a[156:159], a[180:183], v[172:175]
  ds_read_b64_tr_b16 a[200:201], v2 offset:12416
  ds_read_b64_tr_b16 a[204:205], v2 offset:36992
  v_mfma_f32_16x16x32_bf16 v[164:167], a[156:159], a[176:179], v[164:167]
  ds_read_b64_tr_b16 a[202:203], v2 offset:18560
  v_cvt_pk_bf16_f32 v155, v186, v187
  v_mfma_f32_16x16x32_bf16 v[164:167], a[152:155], a[168:171], v[164:167]
  s_waitcnt lgkmcnt(9)
  ds_read_b64_tr_b16 a[206:207], v2 offset:43136
  v_add_f32 v46, v46, v185
  v_mfma_f32_16x16x32_bf16 v[164:167], a[160:163], a[184:187], v[164:167]
  s_waitcnt lgkmcnt(8)
  v_exp_f32 v190, v190
  v_mfma_f32_16x16x32_bf16 v[164:167], a[164:167], a[192:195], v[164:167]
  ds_read_b64_tr_b16 a[208:209], v6 offset:36992
  v_add_f32 v46, v46, v186
  v_mfma_f32_16x16x32_bf16 v[172:175], a[164:167], a[196:199], v[172:175]
  ds_read_b64_tr_b16 a[210:211], v6 offset:43136
  v_add_f32 v46, v46, v187
  v_mfma_f32_16x16x32_bf16 v[172:175], a[160:163], a[188:191], v[172:175]
  s_waitcnt lgkmcnt(7)
  ds_read_b64_tr_b16 a[212:213], v10 offset:12416
  ds_read_b64_tr_b16 a[214:215], v10 offset:18560
  v_mfma_f32_16x16x32_bf16 v[176:179], a[248:251], a[128:131], 0
  s_waitcnt lgkmcnt(8)
  v_exp_f32 v191, v191
  v_mfma_f32_16x16x32_bf16 v[176:179], a[252:255], a[136:139], v[176:179]
  ds_read_b64_tr_b16 a[216:217], v9 offset:36992
  ds_read_b64_tr_b16 a[220:221], v9 offset:49280
  v_mfma_f32_16x16x32_bf16 v[184:187], a[252:255], a[140:143], 0
  ds_read_b64_tr_b16 a[218:219], v9 offset:43136
  v_add_f32 v45, v45, v183
  v_mfma_f32_16x16x32_bf16 v[184:187], a[248:251], a[132:135], v[184:187]
  s_waitcnt lgkmcnt(8)
  ds_read_b64_tr_b16 a[222:223], v9 offset:55424
  v_add_f32 v47, v47, v188
  v_mfma_f32_16x16x32_bf16 v[184:187], a[200:203], a[172:175], v[184:187]
  s_waitcnt lgkmcnt(8)
  v_cvt_pk_bf16_f32 v158, v188, v189
  v_cvt_pk_bf16_f32 v159, v190, v191
  v_mfma_f32_16x16x32_bf16 v[184:187], a[204:207], a[180:183], v[184:187]
  ds_read_b64_tr_b16 a[224:225], v1 offset:12416
  ds_read_b64_tr_b16 a[228:229], v1 offset:36992
  v_mfma_f32_16x16x32_bf16 v[176:179], a[204:207], a[176:179], v[176:179]
  ds_read_b64_tr_b16 a[226:227], v1 offset:18560
  v_add_f32 v47, v47, v189
  v_mfma_f32_16x16x32_bf16 v[176:179], a[200:203], a[168:171], v[176:179]
  s_waitcnt lgkmcnt(9)
  ds_read_b64_tr_b16 a[230:231], v1 offset:43136
  v_add_f32 v47, v47, v190
  v_mfma_f32_16x16x32_bf16 v[176:179], a[208:211], a[184:187], v[176:179]
  s_waitcnt lgkmcnt(8)
  v_add_f32 v47, v47, v191
  v_cvt_pk_bf16_f32 v160, v160, v161
  v_mfma_f32_16x16x32_bf16 v[176:179], a[212:215], a[192:195], v[176:179]
  ds_read_b64_tr_b16 a[144:145], v5 offset:36992
  v_cvt_pk_bf16_f32 v161, v162, v163
  v_mfma_f32_16x16x32_bf16 v[184:187], a[212:215], a[196:199], v[184:187]
  ds_read_b64_tr_b16 a[146:147], v5 offset:43136
  v_and_b32 v160, -2, v160
  v_mfma_f32_16x16x32_bf16 v[184:187], a[208:211], a[188:191], v[184:187]
  s_waitcnt lgkmcnt(7)
  ds_read_b64_tr_b16 a[148:149], v9 offset:12416
  ds_read_b64_tr_b16 a[150:151], v9 offset:18560
  v_mfma_f32_16x16x32_bf16 v[180:183], a[216:219], a[128:131], 0
  s_waitcnt lgkmcnt(8)
  ds_read_b64_tr_b16 a[156:157], v11 offset:49152
  v_cvt_pk_bf16_f32 v162, v164, v165
  v_mfma_f32_16x16x32_bf16 v[180:183], a[220:223], a[136:139], v[180:183]
  s_waitcnt lgkmcnt(6)
  ds_read_b64_tr_b16 a[152:153], v11 offset:36864
  ds_read_b64_tr_b16 a[158:159], v11 offset:55296
  v_mfma_f32_16x16x32_bf16 v[188:191], a[220:223], a[140:143], 0
  s_add_u32 s60, s15, 0
  ds_read_b64_tr_b16 a[154:155], v11 offset:43008
  v_cvt_pk_bf16_f32 v163, v166, v167
  v_mfma_f32_16x16x32_bf16 v[188:191], a[216:219], a[132:135], v[188:191]
  buffer_store_dwordx4 v[160:163], v37, s[4:7], s60 offen sc1
  v_mfma_f32_16x16x32_bf16 v[188:191], a[224:227], a[172:175], v[188:191]
  s_waitcnt lgkmcnt(8)
  ds_read_b64_tr_b16 a[160:161], v3 offset:12288
  v_cvt_pk_bf16_f32 v168, v168, v169
  v_mfma_f32_16x16x32_bf16 v[188:191], a[228:231], a[180:183], v[188:191]
  ds_read_b64_tr_b16 a[162:163], v3 offset:18432
  ds_read_b64_tr_b16 a[164:165], v3 offset:36864
  v_mfma_f32_16x16x32_bf16 v[180:183], a[228:231], a[176:179], v[180:183]
  v_cvt_pk_bf16_f32 v169, v170, v171
  v_and_b32 v168, -2, v168
  v_mfma_f32_16x16x32_bf16 v[180:183], a[224:227], a[168:171], v[180:183]
  s_waitcnt lgkmcnt(7)
  ds_read_b64_tr_b16 a[166:167], v3 offset:43008
  v_cvt_pk_bf16_f32 v170, v172, v173
  v_mfma_f32_16x16x32_bf16 v[180:183], a[144:147], a[184:187], v[180:183]
  s_add_u32 s81, s9, 2048
  ds_read_b64_tr_b16 a[248:249], v7 offset:36864
  v_cvt_pk_bf16_f32 v171, v174, v175
  v_mfma_f32_16x16x32_bf16 v[180:183], a[148:151], a[192:195], v[180:183]
  ds_read_b64_tr_b16 a[250:251], v7 offset:43008
  ds_read_b64_tr_b16 a[252:253], v11 offset:12288
  v_mfma_f32_16x16x32_bf16 v[188:191], a[148:151], a[196:199], v[188:191]
  buffer_store_dwordx4 v[168:171], v37, s[4:7], s81 offen sc1
  v_mfma_f32_16x16x32_bf16 v[188:191], a[144:147], a[188:191], v[188:191]
  s_waitcnt lgkmcnt(7)
  ds_read_b64_tr_b16 a[254:255], v11 offset:18432
  ds_read_b64_tr_b16 a[204:205], v12 offset:49152
  v_mfma_f32_16x16x32_bf16 v[160:163], a[152:155], a[128:131], 0
  ds_read_b64_tr_b16 a[200:201], v12 offset:36864
  v_cvt_pk_bf16_f32 v176, v176, v177
  v_mfma_f32_16x16x32_bf16 v[160:163], a[156:159], a[136:139], v[160:163]
  ds_read_b64_tr_b16 a[202:203], v12 offset:43008
  v_cvt_pk_bf16_f32 v177, v178, v179
  v_mfma_f32_16x16x32_bf16 v[168:171], a[156:159], a[140:143], 0
  v_cvt_pk_bf16_f32 v184, v184, v185
  v_cvt_pk_bf16_f32 v185, v186, v187
  v_mfma_f32_16x16x32_bf16 v[168:171], a[152:155], a[132:135], v[168:171]
  s_waitcnt lgkmcnt(9)
  ds_read_b64_tr_b16 a[206:207], v12 offset:55296
  v_and_b32 v176, -2, v176
  v_mfma_f32_16x16x32_bf16 v[168:171], a[160:163], a[172:175], v[168:171]
  s_waitcnt lgkmcnt(8)
  ds_read_b64_tr_b16 a[208:209], v4 offset:12288
  v_cvt_pk_bf16_f32 v178, v180, v181
  v_mfma_f32_16x16x32_bf16 v[168:171], a[164:167], a[180:183], v[168:171]
  ds_read_b64_tr_b16 a[210:211], v4 offset:18432
  ds_read_b64_tr_b16 a[212:213], v4 offset:36864
  v_mfma_f32_16x16x32_bf16 v[160:163], a[164:167], a[176:179], v[160:163]
  s_add_u32 s3, s8, 1024
  ds_read_b128 a[228:231], v19 offset:24576
  v_cvt_pk_bf16_f32 v179, v182, v183
  v_mfma_f32_16x16x32_bf16 v[160:163], a[160:163], a[168:171], v[160:163]
  s_waitcnt lgkmcnt(10)
  ds_read_b64_tr_b16 a[214:215], v4 offset:43008
  v_cvt_pk_bf16_f32 v186, v188, v189
  v_mfma_f32_16x16x32_bf16 v[160:163], a[248:251], a[184:187], v[160:163]
  s_waitcnt lgkmcnt(9)
  ds_read_b64_tr_b16 a[216:217], v8 offset:36864
  v_cvt_pk_bf16_f32 v187, v190, v191
  v_mfma_f32_16x16x32_bf16 v[160:163], a[252:255], a[192:195], v[160:163]
  ds_read_b64_tr_b16 a[218:219], v8 offset:43008
  ds_read_b128 a[224:227], v18 offset:24576
  v_mfma_f32_16x16x32_bf16 v[168:171], a[252:255], a[196:199], v[168:171]
  ds_read_b64_tr_b16 a[220:221], v12 offset:12288
  v_mfma_f32_16x16x32_bf16 v[168:171], a[248:251], a[188:191], v[168:171]
  s_waitcnt lgkmcnt(9)
  ds_read_b64_tr_b16 a[222:223], v12 offset:18432
  ds_read_b128 a[144:147], v18 offset:24704
  v_mfma_f32_16x16x32_bf16 v[164:167], a[200:203], a[128:131], 0
  buffer_store_dwordx4 v[176:179], v37, s[4:7], s3 offen sc1
  v_mfma_f32_16x16x32_bf16 v[164:167], a[204:207], a[136:139], v[164:167]
  ds_read_b128 a[148:151], v19 offset:24704
  ds_read_b128 a[152:155], v18 offset:24832
  v_mfma_f32_16x16x32_bf16 v[172:175], a[204:207], a[140:143], 0
  s_waitcnt lgkmcnt(11)
  ds_read_b128 a[156:159], v19 offset:24832
  v_cvt_pk_bf16_f32 v160, v160, v161
  v_mfma_f32_16x16x32_bf16 v[172:175], a[200:203], a[132:135], v[172:175]
  s_add_u32 s64, s10, 3072
  v_and_b32 v184, -2, v184
  v_cvt_pk_bf16_f32 v161, v162, v163
  v_mfma_f32_16x16x32_bf16 v[172:175], a[208:211], a[172:175], v[172:175]
  s_waitcnt lgkmcnt(9)
  ds_read_b128 a[160:163], v18 offset:30720
  v_cvt_pk_bf16_f32 v168, v168, v169
  v_mfma_f32_16x16x32_bf16 v[172:175], a[212:215], a[180:183], v[172:175]
  buffer_store_dwordx4 v[184:187], v37, s[4:7], s64 offen sc1
  v_mfma_f32_16x16x32_bf16 v[164:167], a[212:215], a[176:179], v[164:167]
  v_cvt_pk_bf16_f32 v169, v170, v171
  v_mfma_f32_16x16x32_bf16 v[164:167], a[208:211], a[168:171], v[164:167]
  s_waitcnt lgkmcnt(8)
  ds_read_b128 a[164:167], v19 offset:30720
  v_mfma_f32_16x16x32_bf16 v[164:167], a[216:219], a[184:187], v[164:167]
  s_waitcnt lgkmcnt(6)
  v_mfma_f32_16x16x32_bf16 v[164:167], a[220:223], a[192:195], v[164:167]
  v_mfma_f32_16x16x32_bf16 v[172:175], a[220:223], a[196:199], v[172:175]
  ds_read_b128 a[248:251], v18 offset:30848
  v_mfma_f32_16x16x32_bf16 v[172:175], a[216:219], a[188:191], v[172:175]
  v_mfma_f32_16x16x32_bf16 v[176:179], a[224:227], v[48:51], 0
  v_cvt_pk_bf16_f32 v162, v164, v165
  v_cvt_pk_bf16_f32 v163, v166, v167
  v_mfma_f32_16x16x32_bf16 v[176:179], a[228:231], v[64:67], v[176:179]
  s_waitcnt lgkmcnt(6)
  ds_read_b128 a[252:255], v19 offset:30848
  v_mfma_f32_16x16x32_bf16 v[176:179], a[144:147], v[80:83], v[176:179]
  s_waitcnt lgkmcnt(5)
  v_cvt_pk_bf16_f32 v170, v172, v173
  v_cvt_pk_bf16_f32 v171, v174, v175
  v_mfma_f32_16x16x32_bf16 v[176:179], a[148:151], v[96:99], v[176:179]
  s_add_u32 s87, s15, 8192
  v_and_b32 v160, -2, v160
  v_mfma_f32_16x16x32_bf16 v[176:179], a[152:155], v[112:115], v[176:179]
  s_waitcnt lgkmcnt(4)
  ds_read_b128 a[200:203], v18 offset:30976
  v_mfma_f32_16x16x32_bf16 v[176:179], a[156:159], v[128:131], v[176:179]
  buffer_store_dwordx4 v[160:163], v37, s[4:7], s87 offen sc1
  v_mfma_f32_16x16x32_bf16 v[180:183], a[156:159], v[132:135], 0
  v_mfma_f32_16x16x32_bf16 v[180:183], a[152:155], v[116:119], v[180:183]
  ds_read_b128 a[204:207], v19 offset:30976
  v_mfma_f32_16x16x32_bf16 v[180:183], a[148:151], v[100:103], v[180:183]
  v_mfma_f32_16x16x32_bf16 v[180:183], a[144:147], v[84:87], v[180:183]
  v_exp_f32 v176, v176
  v_mfma_f32_16x16x32_bf16 v[180:183], a[228:231], v[68:71], v[180:183]
  v_add_f32 v44, v44, v176
  v_mfma_f32_16x16x32_bf16 v[180:183], a[224:227], v[52:55], v[180:183]
  v_mfma_f32_16x16x32_bf16 v[184:187], a[224:227], v[56:59], 0
  v_exp_f32 v177, v177
  v_mfma_f32_16x16x32_bf16 v[184:187], a[228:231], v[72:75], v[184:187]
  v_add_f32 v44, v44, v177
  v_mfma_f32_16x16x32_bf16 v[184:187], a[144:147], v[88:91], v[184:187]
  v_cvt_pk_bf16_f32 v176, v176, v177
  v_mfma_f32_16x16x32_bf16 v[184:187], a[148:151], v[104:107], v[184:187]
  s_add_u32 s61, s9, 10240
  v_and_b32 v168, -2, v168
  v_mfma_f32_16x16x32_bf16 v[184:187], a[152:155], v[120:123], v[184:187]
  v_exp_f32 v178, v178
  v_mfma_f32_16x16x32_bf16 v[184:187], a[156:159], v[136:139], v[184:187]
  buffer_store_dwordx4 v[168:171], v37, s[4:7], s61 offen sc1
  v_mfma_f32_16x16x32_bf16 v[188:191], a[156:159], v[140:143], 0
  v_exp_f32 v179, v179
  v_mfma_f32_16x16x32_bf16 v[188:191], a[152:155], v[124:127], v[188:191]
  s_waitcnt lgkmcnt(0)
  s_barrier
  v_add_f32 v44, v44, v178
  v_mfma_f32_16x16x32_bf16 v[188:191], a[148:151], v[108:111], v[188:191]
  v_add_f32 v44, v44, v179
  v_cvt_pk_bf16_f32 v177, v178, v179
  v_mfma_f32_16x16x32_bf16 v[188:191], a[144:147], v[92:95], v[188:191]
  v_exp_f32 v180, v180
  v_mfma_f32_16x16x32_bf16 v[188:191], a[228:231], v[76:79], v[188:191]
  s_add_u32 m0, s74, 73728
  v_add_f32 v45, v45, v180
  v_mfma_f32_16x16x32_bf16 v[188:191], a[224:227], v[60:63], v[188:191]
  s_mov_b32 s65, 86016
  v_mfma_f32_16x16x32_bf16 v[160:163], a[160:163], v[48:51], 0
  buffer_load_dwordx4 v31, s[20:23], s65 offen offset:0  lds
  v_mfma_f32_16x16x32_bf16 v[160:163], a[164:167], v[64:67], v[160:163]
  v_exp_f32 v181, v181
  v_mfma_f32_16x16x32_bf16 v[160:163], a[248:251], v[80:83], v[160:163]
  v_add_f32 v45, v45, v181
  v_cvt_pk_bf16_f32 v180, v180, v181
  v_mfma_f32_16x16x32_bf16 v[160:163], a[252:255], v[96:99], v[160:163]
  v_exp_f32 v182, v182
  v_mfma_f32_16x16x32_bf16 v[160:163], a[200:203], v[112:115], v[160:163]
  v_add_f32 v45, v45, v182
  v_mfma_f32_16x16x32_bf16 v[160:163], a[204:207], v[128:131], v[160:163]
  buffer_load_dwordx4 v32, s[20:23], s65 offen offset:1024  lds
  v_mfma_f32_16x16x32_bf16 v[164:167], a[204:207], v[132:135], 0
  v_exp_f32 v183, v183
  v_mfma_f32_16x16x32_bf16 v[164:167], a[200:203], v[116:119], v[164:167]
  v_add_f32 v45, v45, v183
  v_mfma_f32_16x16x32_bf16 v[164:167], a[252:255], v[100:103], v[164:167]
  ds_read_b64_tr_b16 a[208:209], v5 offset:12288
  v_cvt_pk_bf16_f32 v181, v182, v183
  v_mfma_f32_16x16x32_bf16 v[164:167], a[248:251], v[84:87], v[164:167]
  ds_read_b64_tr_b16 a[210:211], v5 offset:18432
  v_mfma_f32_16x16x32_bf16 v[164:167], a[164:167], v[68:71], v[164:167]
  ds_read_b64_tr_b16 a[212:213], v9 offset:0
  v_mfma_f32_16x16x32_bf16 v[164:167], a[160:163], v[52:55], v[164:167]
  ds_read_b64_tr_b16 a[214:215], v9 offset:6144
  v_mfma_f32_16x16x32_bf16 v[168:171], a[160:163], v[56:59], 0
  buffer_load_dwordx4 v33, s[20:23], s65 offen offset:2048  lds
  v_mfma_f32_16x16x32_bf16 v[168:171], a[164:167], v[72:75], v[168:171]
  v_exp_f32 v184, v184
  v_mfma_f32_16x16x32_bf16 v[168:171], a[248:251], v[88:91], v[168:171]
  v_exp_f32 v185, v185
  v_mfma_f32_16x16x32_bf16 v[168:171], a[252:255], v[104:107], v[168:171]
  v_exp_f32 v186, v186
  v_mfma_f32_16x16x32_bf16 v[168:171], a[200:203], v[120:123], v[168:171]
  s_add_u32 m0, s74, 0
  ds_read_b64_tr_b16 a[216:217], v6 offset:12288
  v_add_f32 v46, v46, v184
  v_mfma_f32_16x16x32_bf16 v[168:171], a[204:207], v[136:139], v[168:171]
  s_mov_b32 s67, 110592
  ds_read_b64_tr_b16 a[218:219], v6 offset:18432
  v_add_f32 v46, v46, v185
  v_mfma_f32_16x16x32_bf16 v[172:175], a[204:207], v[140:143], 0
  ds_read_b64_tr_b16 a[220:221], v10 offset:0
  v_cvt_pk_bf16_f32 v184, v184, v185
  v_mfma_f32_16x16x32_bf16 v[172:175], a[200:203], v[124:127], v[172:175]
  ds_read_b64_tr_b16 a[222:223], v10 offset:6144
  v_add_f32 v46, v46, v186
  v_mfma_f32_16x16x32_bf16 v[172:175], a[252:255], v[108:111], v[172:175]
  buffer_load_dwordx4 v28, s[16:19], s67 offen offset:0  lds
  v_mfma_f32_16x16x32_bf16 v[172:175], a[248:251], v[92:95], v[172:175]
  v_exp_f32 v187, v187
  v_mfma_f32_16x16x32_bf16 v[172:175], a[164:167], v[76:79], v[172:175]
  s_waitcnt lgkmcnt(6)
  v_exp_f32 v188, v188
  v_mfma_f32_16x16x32_bf16 v[172:175], a[160:163], v[60:63], v[172:175]
  buffer_load_dwordx4 v29, s[16:19], s67 offen offset:1024  lds
  v_mfma_f32_16x16x32_bf16 v[220:223], a[208:211], v[204:207], v[220:223]
  s_waitcnt lgkmcnt(4)
  ds_read_b64_tr_b16 a[224:225], v7 offset:12288
  v_add_f32 v46, v46, v187
  v_mfma_f32_16x16x32_bf16 v[220:223], a[212:215], v[156:159], v[220:223]
  ds_read_b64_tr_b16 a[226:227], v7 offset:18432
  v_cvt_pk_bf16_f32 v185, v186, v187
  v_mfma_f32_16x16x32_bf16 v[216:219], a[212:215], v[152:155], v[216:219]
  ds_read_b64_tr_b16 a[228:229], v11 offset:0
  v_add_f32 v47, v47, v188
  v_mfma_f32_16x16x32_bf16 v[216:219], a[208:211], v[200:203], v[216:219]
  ds_read_b64_tr_b16 a[230:231], v11 offset:6144
  v_mfma_f32_16x16x32_bf16 v[212:215], a[208:211], v[196:199], v[212:215]
  v_exp_f32 v189, v189
  v_mfma_f32_16x16x32_bf16 v[212:215], a[212:215], v[148:151], v[212:215]
  buffer_load_dwordx4 v30, s[16:19], s67 offen offset:2048  lds
  v_mfma_f32_16x16x32_bf16 v[208:211], a[212:215], v[144:147], v[208:211]
  v_exp_f32 v190, v190
  v_mfma_f32_16x16x32_bf16 v[208:211], a[208:211], v[192:195], v[208:211]
  s_waitcnt lgkmcnt(6)
  v_exp_f32 v191, v191
  v_mfma_f32_16x16x32_bf16 v[224:227], a[216:219], v[192:195], v[224:227]
  s_waitcnt lgkmcnt(4)
  ds_read_b64_tr_b16 a[144:145], v8 offset:12288
  v_add_f32 v47, v47, v189
  v_mfma_f32_16x16x32_bf16 v[224:227], a[220:223], v[144:147], v[224:227]
  ds_read_b64_tr_b16 a[146:147], v8 offset:18432
  v_cvt_pk_bf16_f32 v188, v188, v189
  v_mfma_f32_16x16x32_bf16 v[228:231], a[220:223], v[148:151], v[228:231]
  ds_read_b64_tr_b16 a[148:149], v12 offset:0
  v_add_f32 v47, v47, v190
  v_mfma_f32_16x16x32_bf16 v[228:231], a[216:219], v[196:199], v[228:231]
  ds_read_b64_tr_b16 a[150:151], v12 offset:6144
  v_add_f32 v47, v47, v191
  v_mfma_f32_16x16x32_bf16 v[232:235], a[216:219], v[200:203], v[232:235]
  v_exp_f32 v160, v160
  v_mfma_f32_16x16x32_bf16 v[232:235], a[220:223], v[152:155], v[232:235]
  v_exp_f32 v161, v161
  v_mfma_f32_16x16x32_bf16 v[236:239], a[220:223], v[156:159], v[236:239]
  v_cvt_pk_bf16_f32 v189, v190, v191
  v_add_f32 v44, v44, v160
  v_mfma_f32_16x16x32_bf16 v[236:239], a[216:219], v[204:207], v[236:239]
  s_waitcnt lgkmcnt(6)
  v_exp_f32 v162, v162
  v_mfma_f32_16x16x32_bf16 v[252:255], a[224:227], v[204:207], v[252:255]
  s_waitcnt lgkmcnt(4)
  ds_read_b64_tr_b16 a[152:153], v5 offset:12416
  v_add_f32 v44, v44, v161
  v_mfma_f32_16x16x32_bf16 v[252:255], a[228:231], v[156:159], v[252:255]
  ds_read_b64_tr_b16 a[154:155], v5 offset:18560
  v_cvt_pk_bf16_f32 v178, v160, v161
  v_mfma_f32_16x16x32_bf16 v[248:251], a[228:231], v[152:155], v[248:251]
  ds_read_b64_tr_b16 a[156:157], v9 offset:128
  v_add_f32 v44, v44, v162
  v_mfma_f32_16x16x32_bf16 v[248:251], a[224:227], v[200:203], v[248:251]
  ds_read_b64_tr_b16 a[158:159], v9 offset:6272
  v_mfma_f32_16x16x32_bf16 v[244:247], a[224:227], v[196:199], v[244:247]
  v_exp_f32 v163, v163
  v_mfma_f32_16x16x32_bf16 v[244:247], a[228:231], v[148:151], v[244:247]
  v_exp_f32 v164, v164
  v_mfma_f32_16x16x32_bf16 v[240:243], a[228:231], v[144:147], v[240:243]
  v_add_f32 v44, v44, v163
  v_cvt_pk_bf16_f32 v179, v162, v163
  v_mfma_f32_16x16x32_bf16 v[240:243], a[224:227], v[192:195], v[240:243]
  s_waitcnt lgkmcnt(6)
  v_add_f32 v45, v45, v164
  v_mfma_f32_16x16x32_bf16 a[232:235], a[144:147], v[192:195], a[232:235]
  s_waitcnt lgkmcnt(4)
  ds_read_b64_tr_b16 a[160:161], v6 offset:12416
  v_mfma_f32_16x16x32_bf16 a[232:235], a[148:151], v[144:147], a[232:235]
  ds_read_b64_tr_b16 a[162:163], v6 offset:18560
  v_mfma_f32_16x16x32_bf16 a[236:239], a[148:151], v[148:151], a[236:239]
  ds_read_b64_tr_b16 a[164:165], v10 offset:128
  v_mfma_f32_16x16x32_bf16 a[236:239], a[144:147], v[196:199], a[236:239]
  ds_read_b64_tr_b16 a[166:167], v10 offset:6272
  v_mfma_f32_16x16x32_bf16 a[240:243], a[144:147], v[200:203], a[240:243]
  v_exp_f32 v165, v165
  v_mfma_f32_16x16x32_bf16 a[240:243], a[148:151], v[152:155], a[240:243]
  v_exp_f32 v166, v166
  v_mfma_f32_16x16x32_bf16 a[244:247], a[148:151], v[156:159], a[244:247]
  v_exp_f32 v167, v167
  v_mfma_f32_16x16x32_bf16 a[244:247], a[144:147], v[204:207], a[244:247]
  s_waitcnt lgkmcnt(6)
  v_add_f32 v45, v45, v165
  v_cvt_pk_bf16_f32 v182, v164, v165
  v_mfma_f32_16x16x32_bf16 a[12:15], a[152:155], v[204:207], a[12:15]
  s_waitcnt lgkmcnt(4)
  v_add_f32 v45, v45, v166
  v_cvt_pk_bf16_f32 v183, v166, v167
  v_mfma_f32_16x16x32_bf16 a[12:15], a[156:159], v[156:159], a[12:15]
L_pg10:
  s_cbranch_execz L_hop2
  v_exp_f32 v168, v168
  v_mfma_f32_16x16x32_bf16 a[8:11], a[156:159], v[152:155], a[8:11]
  v_add_f32 v45, v45, v167
  v_add_f32 v46, v46, v168
  v_mfma_f32_16x16x32_bf16 a[8:11], a[152:155], v[200:203], a[8:11]
  v_mfma_f32_16x16x32_bf16 a[4:7], a[152:155], v[196:199], a[4:7]
  ds_read_b64_tr_b16 a[248:249], v12 offset:36992
  v_mfma_f32_16x16x32_bf16 a[4:7], a[156:159], v[148:151], a[4:7]
  ds_read_b64_tr_b16 a[250:251], v12 offset:43136
  v_mfma_f32_16x16x32_bf16 a[0:3], a[156:159], v[144:147], a[0:3]
  ds_read_b64_tr_b16 a[252:253], v12 offset:49280
  v_mfma_f32_16x16x32_bf16 a[0:3], a[152:155], v[192:195], a[0:3]
  s_waitcnt lgkmcnt(5)
  ds_read_b64_tr_b16 a[254:255], v12 offset:55424
  v_mfma_f32_16x16x32_bf16 a[16:19], a[160:163], v[192:195], a[16:19]
  s_waitcnt lgkmcnt(4)
  ds_read_b64_tr_b16 a[200:201], v4 offset:12416
  v_mfma_f32_16x16x32_bf16 a[16:19], a[164:167], v[144:147], a[16:19]
  ds_read_b64_tr_b16 a[202:203], v4 offset:18560
  v_mfma_f32_16x16x32_bf16 a[20:23], a[164:167], v[148:151], a[20:23]
  ds_read_b64_tr_b16 a[204:205], v4 offset:36992
  v_mfma_f32_16x16x32_bf16 a[20:23], a[160:163], v[196:199], a[20:23]
  ds_read_b64_tr_b16 a[206:207], v4 offset:43136
  v_mfma_f32_16x16x32_bf16 a[24:27], a[160:163], v[200:203], a[24:27]
  ds_read_b64_tr_b16 a[208:209], v8 offset:36992
  v_mfma_f32_16x16x32_bf16 a[24:27], a[164:167], v[152:155], a[24:27]
  ds_read_b64_tr_b16 a[210:211], v8 offset:43136
  v_mfma_f32_16x16x32_bf16 a[28:31], a[164:167], v[156:159], a[28:31]
  ds_read_b64_tr_b16 a[212:213], v12 offset:12416
  v_mfma_f32_16x16x32_bf16 a[28:31], a[160:163], v[204:207], a[28:31]
  s_waitcnt lgkmcnt(9)
  ds_read_b64_tr_b16 a[214:215], v12 offset:18560
  v_mfma_f32_16x16x32_bf16 v[192:195], a[248:251], a[128:131], 0
  s_waitcnt lgkmcnt(8)
  v_exp_f32 v169, v169
  v_mfma_f32_16x16x32_bf16 v[192:195], a[252:255], a[136:139], v[192:195]
  ds_read_b64_tr_b16 a[216:217], v11 offset:36992
  ds_read_b64_tr_b16 a[220:221], v11 offset:49280
  v_mfma_f32_16x16x32_bf16 v[200:203], a[252:255], a[140:143], 0
  ds_read_b64_tr_b16 a[218:219], v11 offset:43136
  v_add_f32 v46, v46, v169
  v_mfma_f32_16x16x32_bf16 v[200:203], a[248:251], a[132:135], v[200:203]
  s_waitcnt lgkmcnt(9)
  ds_read_b64_tr_b16 a[222:223], v11 offset:55424
  v_cvt_pk_bf16_f32 v186, v168, v169
  v_mfma_f32_16x16x32_bf16 v[200:203], a[200:203], a[172:175], v[200:203]
  s_waitcnt lgkmcnt(8)
  v_exp_f32 v170, v170
  v_mfma_f32_16x16x32_bf16 v[200:203], a[204:207], a[180:183], v[200:203]
  ds_read_b64_tr_b16 a[224:225], v3 offset:12416
  ds_read_b64_tr_b16 a[228:229], v3 offset:36992
  v_mfma_f32_16x16x32_bf16 v[192:195], a[204:207], a[176:179], v[192:195]
  ds_read_b64_tr_b16 a[226:227], v3 offset:18560
  v_add_f32 v46, v46, v170
  v_mfma_f32_16x16x32_bf16 v[192:195], a[200:203], a[168:171], v[192:195]
  s_waitcnt lgkmcnt(9)
  ds_read_b64_tr_b16 a[230:231], v3 offset:43136
  v_mfma_f32_16x16x32_bf16 v[192:195], a[208:211], a[184:187], v[192:195]
  s_waitcnt lgkmcnt(8)
  v_exp_f32 v171, v171
  v_mfma_f32_16x16x32_bf16 v[192:195], a[212:215], a[192:195], v[192:195]
  ds_read_b64_tr_b16 a[144:145], v7 offset:36992
  ds_read_b64_tr_b16 a[146:147], v7 offset:43136
  v_mfma_f32_16x16x32_bf16 v[200:203], a[212:215], a[196:199], v[200:203]
  ds_read_b64_tr_b16 a[148:149], v11 offset:12416
  v_cvt_pk_bf16_f32 v187, v170, v171
  v_mfma_f32_16x16x32_bf16 v[200:203], a[208:211], a[188:191], v[200:203]
  s_waitcnt lgkmcnt(8)
  ds_read_b64_tr_b16 a[150:151], v11 offset:18560
  v_add_f32 v46, v46, v171
  v_mfma_f32_16x16x32_bf16 v[196:199], a[216:219], a[128:131], 0
  s_waitcnt lgkmcnt(8)
  v_exp_f32 v172, v172
  v_mfma_f32_16x16x32_bf16 v[196:199], a[220:223], a[136:139], v[196:199]
  ds_read_b64_tr_b16 a[152:153], v9 offset:37120
  ds_read_b64_tr_b16 a[156:157], v9 offset:49408
  v_mfma_f32_16x16x32_bf16 v[204:207], a[220:223], a[140:143], 0
  ds_read_b64_tr_b16 a[154:155], v9 offset:43264
  v_add_f32 v47, v47, v172
  v_mfma_f32_16x16x32_bf16 v[204:207], a[216:219], a[132:135], v[204:207]
  s_waitcnt lgkmcnt(8)
  ds_read_b64_tr_b16 a[158:159], v9 offset:55552
  v_cvt_pk_bf16_f32 v192, v192, v193
  v_mfma_f32_16x16x32_bf16 v[204:207], a[224:227], a[172:175], v[204:207]
  s_waitcnt lgkmcnt(8)
  v_exp_f32 v173, v173
  v_mfma_f32_16x16x32_bf16 v[204:207], a[228:231], a[180:183], v[204:207]
  ds_read_b64_tr_b16 a[160:161], v1 offset:12544
  ds_read_b64_tr_b16 a[164:165], v1 offset:37120
  v_mfma_f32_16x16x32_bf16 v[196:199], a[228:231], a[176:179], v[196:199]
  ds_read_b64_tr_b16 a[162:163], v1 offset:18688
  v_add_f32 v47, v47, v173
  v_mfma_f32_16x16x32_bf16 v[196:199], a[224:227], a[168:171], v[196:199]
  s_waitcnt lgkmcnt(9)
  ds_read_b64_tr_b16 a[166:167], v1 offset:43264
  v_cvt_pk_bf16_f32 v190, v172, v173
  v_mfma_f32_16x16x32_bf16 v[196:199], a[144:147], a[184:187], v[196:199]
  s_waitcnt lgkmcnt(8)
  v_exp_f32 v174, v174
  v_mfma_f32_16x16x32_bf16 v[196:199], a[148:151], a[192:195], v[196:199]
  ds_read_b64_tr_b16 a[248:249], v5 offset:37120
  ds_read_b64_tr_b16 a[250:251], v5 offset:43264
  v_mfma_f32_16x16x32_bf16 v[204:207], a[148:151], a[196:199], v[204:207]
  ds_read_b64_tr_b16 a[252:253], v9 offset:12544
  v_add_f32 v47, v47, v174
  v_mfma_f32_16x16x32_bf16 v[204:207], a[144:147], a[188:191], v[204:207]
  s_waitcnt lgkmcnt(8)
  ds_read_b64_tr_b16 a[254:255], v9 offset:18688
  v_cvt_pk_bf16_f32 v193, v194, v195
  v_mfma_f32_16x16x32_bf16 v[160:163], a[152:155], a[128:131], 0
  s_waitcnt lgkmcnt(8)
  v_exp_f32 v175, v175
  v_mfma_f32_16x16x32_bf16 v[160:163], a[156:159], a[136:139], v[160:163]
  ds_read_b64_tr_b16 a[200:201], v10 offset:37120
  ds_read_b64_tr_b16 a[204:205], v10 offset:49408
  v_mfma_f32_16x16x32_bf16 v[168:171], a[156:159], a[140:143], 0
  ds_read_b64_tr_b16 a[202:203], v10 offset:43264
  v_add_f32 v47, v47, v175
  v_mfma_f32_16x16x32_bf16 v[168:171], a[152:155], a[132:135], v[168:171]
  s_waitcnt lgkmcnt(8)
  ds_read_b64_tr_b16 a[206:207], v10 offset:55552
  v_cvt_pk_bf16_f32 v191, v174, v175
  v_mfma_f32_16x16x32_bf16 v[168:171], a[160:163], a[172:175], v[168:171]
  s_waitcnt lgkmcnt(8)
  ds_read_b64_tr_b16 a[208:209], v2 offset:12544
  v_cvt_pk_bf16_f32 v200, v200, v201
  v_mfma_f32_16x16x32_bf16 v[168:171], a[164:167], a[180:183], v[168:171]
  ds_read_b64_tr_b16 a[210:211], v2 offset:18688
  ds_read_b64_tr_b16 a[212:213], v2 offset:37120
  v_mfma_f32_16x16x32_bf16 v[160:163], a[164:167], a[176:179], v[160:163]
  v_cvt_pk_bf16_f32 v201, v202, v203
  v_and_b32 v192, -2, v192
  v_mfma_f32_16x16x32_bf16 v[160:163], a[160:163], a[168:171], v[160:163]
  s_waitcnt lgkmcnt(7)
  ds_read_b64_tr_b16 a[214:215], v2 offset:43264
  v_cvt_pk_bf16_f32 v194, v196, v197
  v_mfma_f32_16x16x32_bf16 v[160:163], a[248:251], a[184:187], v[160:163]
  s_add_u32 s66, s8, 9216
  ds_read_b64_tr_b16 a[216:217], v6 offset:37120
  v_cvt_pk_bf16_f32 v195, v198, v199
  v_mfma_f32_16x16x32_bf16 v[160:163], a[252:255], a[192:195], v[160:163]
  ds_read_b64_tr_b16 a[218:219], v6 offset:43264
  ds_read_b128 a[228:231], v19 offset:0
  v_mfma_f32_16x16x32_bf16 v[168:171], a[252:255], a[196:199], v[168:171]
  ds_read_b64_tr_b16 a[220:221], v10 offset:12544
  v_cvt_pk_bf16_f32 v202, v204, v205
  v_mfma_f32_16x16x32_bf16 v[168:171], a[248:251], a[188:191], v[168:171]
  s_waitcnt lgkmcnt(8)
  ds_read_b64_tr_b16 a[222:223], v10 offset:18688
  ds_read_b128 a[224:227], v18 offset:0
  v_mfma_f32_16x16x32_bf16 v[164:167], a[200:203], a[128:131], 0
  buffer_store_dwordx4 v[192:195], v37, s[4:7], s66 offen sc1
  v_mfma_f32_16x16x32_bf16 v[164:167], a[204:207], a[136:139], v[164:167]
  ds_read_b128 a[144:147], v18 offset:128
  ds_read_b128 a[148:151], v19 offset:128
  v_mfma_f32_16x16x32_bf16 v[172:175], a[204:207], a[140:143], 0
  s_waitcnt lgkmcnt(10)
  ds_read_b128 a[152:155], v18 offset:256
  v_cvt_pk_bf16_f32 v203, v206, v207
  v_mfma_f32_16x16x32_bf16 v[172:175], a[200:203], a[132:135], v[172:175]
  s_add_u32 s62, s10, 11264
  ds_read_b128 a[156:159], v19 offset:256
  v_and_b32 v200, -2, v200
  v_mfma_f32_16x16x32_bf16 v[172:175], a[208:211], a[172:175], v[172:175]
  s_waitcnt lgkmcnt(10)
  v_cvt_pk_bf16_f32 v160, v160, v161
  v_cvt_pk_bf16_f32 v161, v162, v163
  v_mfma_f32_16x16x32_bf16 v[172:175], a[212:215], a[180:183], v[172:175]
  buffer_store_dwordx4 v[200:203], v37, s[4:7], s62 offen sc1
  v_mfma_f32_16x16x32_bf16 v[164:167], a[212:215], a[176:179], v[164:167]
  s_add_u32 s50, s85, 24576
  ds_read_b128 a[160:163], v18 offset:6144
  v_cvt_pk_bf16_f32 v168, v168, v169
  v_mfma_f32_16x16x32_bf16 v[164:167], a[208:211], a[168:171], v[164:167]
  s_waitcnt lgkmcnt(9)
  buffer_load_dwordx2 a[128:129], v38, s[4:7], s50 offen offset:1024 sc1
  v_mfma_f32_16x16x32_bf16 v[164:167], a[216:219], a[184:187], v[164:167]
  s_waitcnt lgkmcnt(6)
  ds_read_b128 a[164:167], v19 offset:6144
  v_cvt_pk_bf16_f32 v169, v170, v171
  v_mfma_f32_16x16x32_bf16 v[164:167], a[220:223], a[192:195], v[164:167]
  v_mfma_f32_16x16x32_bf16 v[172:175], a[220:223], a[196:199], v[172:175]
  ds_read_b128 a[248:251], v18 offset:6272
  v_mfma_f32_16x16x32_bf16 v[172:175], a[216:219], a[188:191], v[172:175]
  s_waitcnt lgkmcnt(7)
  v_mfma_f32_16x16x32_bf16 v[192:195], a[224:227], v[48:51], 0
  v_cvt_pk_bf16_f32 v162, v164, v165
  v_cvt_pk_bf16_f32 v163, v166, v167
  v_mfma_f32_16x16x32_bf16 v[192:195], a[228:231], v[64:67], v[192:195]
  s_waitcnt lgkmcnt(5)
  ds_read_b128 a[252:255], v19 offset:6272
  v_mfma_f32_16x16x32_bf16 v[192:195], a[144:147], v[80:83], v[192:195]
  buffer_load_dwordx2 a[132:133], v38, s[4:7], s50 offen offset:1536 sc1
  v_mfma_f32_16x16x32_bf16 v[192:195], a[148:151], v[96:99], v[192:195]
  s_waitcnt lgkmcnt(4)
  v_permlane32_swap_b32 v160, v162
  v_permlane32_swap_b32 v161, v163
  v_mfma_f32_16x16x32_bf16 v[192:195], a[152:155], v[112:115], v[192:195]
  s_add_u32 s63, s15, s86
  ds_read_b128 a[200:203], v18 offset:6400
  v_and_b32 v160, -2, v160
  v_mfma_f32_16x16x32_bf16 v[192:195], a[156:159], v[128:131], v[192:195]
  buffer_store_dwordx4 v[160:163], v13, s[4:7], s63 offen sc1
  v_mfma_f32_16x16x32_bf16 v[196:199], a[156:159], v[132:135], 0
  v_cvt_pk_bf16_f32 v170, v172, v173
  v_cvt_pk_bf16_f32 v171, v174, v175
  v_mfma_f32_16x16x32_bf16 v[196:199], a[152:155], v[116:119], v[196:199]
  ds_read_b128 a[204:207], v19 offset:6400
  v_mfma_f32_16x16x32_bf16 v[196:199], a[148:151], v[100:103], v[196:199]
  v_mfma_f32_16x16x32_bf16 v[196:199], a[144:147], v[84:87], v[196:199]
  s_add_u32 s99, s85, 51200
  v_exp_f32 v192, v192
  v_mfma_f32_16x16x32_bf16 v[196:199], a[228:231], v[68:71], v[196:199]
  buffer_load_dwordx2 a[130:131], v38, s[4:7], s99 offen offset:1024 sc1
  v_mfma_f32_16x16x32_bf16 v[196:199], a[224:227], v[52:55], v[196:199]
  v_add_f32 v44, v44, v192
  v_mfma_f32_16x16x32_bf16 v[200:203], a[224:227], v[56:59], 0
  v_exp_f32 v193, v193
  v_mfma_f32_16x16x32_bf16 v[200:203], a[228:231], v[72:75], v[200:203]
  v_add_f32 v44, v44, v193
  v_mfma_f32_16x16x32_bf16 v[200:203], a[144:147], v[88:91], v[200:203]
  v_permlane32_swap_b32 v168, v170
  v_permlane32_swap_b32 v169, v171
  v_mfma_f32_16x16x32_bf16 v[200:203], a[148:151], v[104:107], v[200:203]
  s_add_u32 s48, s9, s86
  v_and_b32 v168, -2, v168
  v_cvt_pk_bf16_f32 v192, v192, v193
  v_mfma_f32_16x16x32_bf16 v[200:203], a[152:155], v[120:123], v[200:203]
  v_exp_f32 v194, v194
  v_mfma_f32_16x16x32_bf16 v[200:203], a[156:159], v[136:139], v[200:203]
  buffer_store_dwordx4 v[168:171], v13, s[4:7], s48 offen sc1
  v_mfma_f32_16x16x32_bf16 v[204:207], a[156:159], v[140:143], 0
  buffer_load_dwordx2 a[134:135], v38, s[4:7], s99 offen offset:1536 sc1
  v_mfma_f32_16x16x32_bf16 v[204:207], a[152:155], v[124:127], v[204:207]
  s_waitcnt vmcnt(20) lgkmcnt(0)
  s_barrier
  v_add_f32 v44, v44, v194
  v_mfma_f32_16x16x32_bf16 v[204:207], a[148:151], v[108:111], v[204:207]
  v_exp_f32 v195, v195
  v_mfma_f32_16x16x32_bf16 v[204:207], a[144:147], v[92:95], v[204:207]
  v_add_f32 v44, v44, v195
  v_cvt_pk_bf16_f32 v193, v194, v195
  v_mfma_f32_16x16x32_bf16 v[204:207], a[228:231], v[76:79], v[204:207]
  s_add_u32 m0, s74, 49152
  v_exp_f32 v196, v196
  v_mfma_f32_16x16x32_bf16 v[204:207], a[224:227], v[60:63], v[204:207]
  s_mov_b32 s52, 98304
  v_add_f32 v45, v45, v196
  v_mfma_f32_16x16x32_bf16 v[160:163], a[160:163], v[48:51], 0
  buffer_load_dwordx4 v31, s[20:23], s52 offen offset:0  lds
  v_mfma_f32_16x16x32_bf16 v[160:163], a[164:167], v[64:67], v[160:163]
  s_add_u32 s49, s85, 77824
  v_exp_f32 v197, v197
  v_mfma_f32_16x16x32_bf16 v[160:163], a[248:251], v[80:83], v[160:163]
  buffer_load_dwordx2 a[136:137], v38, s[4:7], s49 offen offset:1024 sc1
  v_mfma_f32_16x16x32_bf16 v[160:163], a[252:255], v[96:99], v[160:163]
  v_add_f32 v45, v45, v197
  v_cvt_pk_bf16_f32 v196, v196, v197
  v_mfma_f32_16x16x32_bf16 v[160:163], a[200:203], v[112:115], v[160:163]
  v_exp_f32 v198, v198
  v_mfma_f32_16x16x32_bf16 v[160:163], a[204:207], v[128:131], v[160:163]
  buffer_load_dwordx4 v32, s[20:23], s52 offen offset:1024  lds
  v_mfma_f32_16x16x32_bf16 v[164:167], a[204:207], v[132:135], 0
  v_add_f32 v45, v45, v198
  v_mfma_f32_16x16x32_bf16 v[164:167], a[200:203], v[116:119], v[164:167]
  v_exp_f32 v199, v199
  v_mfma_f32_16x16x32_bf16 v[164:167], a[252:255], v[100:103], v[164:167]
  ds_read_b64_tr_b16 a[208:209], v11 offset:128
  v_add_f32 v45, v45, v199
  v_mfma_f32_16x16x32_bf16 v[164:167], a[248:251], v[84:87], v[164:167]
  ds_read_b64_tr_b16 a[210:211], v11 offset:6272
  v_cvt_pk_bf16_f32 v197, v198, v199
  v_mfma_f32_16x16x32_bf16 v[164:167], a[164:167], v[68:71], v[164:167]
  ds_read_b64_tr_b16 a[212:213], v3 offset:24704
  v_mfma_f32_16x16x32_bf16 v[164:167], a[160:163], v[52:55], v[164:167]
  ds_read_b64_tr_b16 a[214:215], v3 offset:30848
  v_mfma_f32_16x16x32_bf16 v[168:171], a[160:163], v[56:59], 0
  buffer_load_dwordx2 a[140:141], v38, s[4:7], s49 offen offset:1536 sc1
  v_mfma_f32_16x16x32_bf16 v[168:171], a[164:167], v[72:75], v[168:171]
  buffer_load_dwordx4 v33, s[20:23], s52 offen offset:2048  lds
  v_mfma_f32_16x16x32_bf16 v[168:171], a[248:251], v[88:91], v[168:171]
  v_exp_f32 v200, v200
  v_mfma_f32_16x16x32_bf16 v[168:171], a[252:255], v[104:107], v[168:171]
  v_add_f32 v46, v46, v200
  v_mfma_f32_16x16x32_bf16 v[168:171], a[200:203], v[120:123], v[168:171]
  s_add_u32 m0, s74, 61440
  ds_read_b64_tr_b16 a[216:217], v12 offset:128
  v_mfma_f32_16x16x32_bf16 v[168:171], a[204:207], v[136:139], v[168:171]
  s_mov_b32 s51, 122880
  ds_read_b64_tr_b16 a[218:219], v12 offset:6272
  v_mfma_f32_16x16x32_bf16 v[172:175], a[204:207], v[140:143], 0
  s_add_u32 s54, s85, 104448
  ds_read_b64_tr_b16 a[220:221], v4 offset:24704
  v_mfma_f32_16x16x32_bf16 v[172:175], a[200:203], v[124:127], v[172:175]
  ds_read_b64_tr_b16 a[222:223], v4 offset:30848
  v_mfma_f32_16x16x32_bf16 v[172:175], a[252:255], v[108:111], v[172:175]
  buffer_load_dwordx4 v28, s[16:19], s51 offen offset:0  lds
  v_mfma_f32_16x16x32_bf16 v[172:175], a[248:251], v[92:95], v[172:175]
  buffer_load_dwordx2 a[138:139], v38, s[4:7], s54 offen offset:1024 sc1
  v_mfma_f32_16x16x32_bf16 v[172:175], a[164:167], v[76:79], v[172:175]
  s_waitcnt lgkmcnt(6)
  v_exp_f32 v201, v201
  v_mfma_f32_16x16x32_bf16 v[172:175], a[160:163], v[60:63], v[172:175]
  buffer_load_dwordx4 v29, s[16:19], s51 offen offset:1024  lds
  v_mfma_f32_16x16x32_bf16 a[44:47], a[208:211], v[156:159], a[44:47]
  s_waitcnt lgkmcnt(4)
  ds_read_b64_tr_b16 a[224:225], v9 offset:256
  v_add_f32 v46, v46, v201
  v_mfma_f32_16x16x32_bf16 a[44:47], a[212:215], v[188:191], a[44:47]
  ds_read_b64_tr_b16 a[226:227], v9 offset:6400
  v_cvt_pk_bf16_f32 v200, v200, v201
  v_mfma_f32_16x16x32_bf16 a[40:43], a[212:215], v[184:187], a[40:43]
  ds_read_b64_tr_b16 a[228:229], v1 offset:24832
  v_mfma_f32_16x16x32_bf16 a[40:43], a[208:211], v[152:155], a[40:43]
  ds_read_b64_tr_b16 a[230:231], v1 offset:30976
  v_mfma_f32_16x16x32_bf16 a[36:39], a[208:211], v[148:151], a[36:39]
  buffer_load_dwordx2 a[142:143], v38, s[4:7], s54 offen offset:1536 sc1
  v_mfma_f32_16x16x32_bf16 a[36:39], a[212:215], v[180:183], a[36:39]
  v_exp_f32 v202, v202
  v_mfma_f32_16x16x32_bf16 a[32:35], a[212:215], v[176:179], a[32:35]
  buffer_load_dwordx4 v30, s[16:19], s51 offen offset:2048  lds
  v_mfma_f32_16x16x32_bf16 a[32:35], a[208:211], v[144:147], a[32:35]
  s_waitcnt lgkmcnt(6)
  v_add_f32 v46, v46, v202
  v_mfma_f32_16x16x32_bf16 a[48:51], a[216:219], v[144:147], a[48:51]
  s_waitcnt lgkmcnt(4)
  ds_read_b64_tr_b16 a[144:145], v10 offset:256
  v_mfma_f32_16x16x32_bf16 a[48:51], a[220:223], v[176:179], a[48:51]
  s_add_u32 s53, s85, 20480
  ds_read_b64_tr_b16 a[146:147], v10 offset:6400
  v_mfma_f32_16x16x32_bf16 a[52:55], a[220:223], v[180:183], a[52:55]
  ds_read_b64_tr_b16 a[148:149], v2 offset:24832
  v_mfma_f32_16x16x32_bf16 a[52:55], a[216:219], v[148:151], a[52:55]
  ds_read_b64_tr_b16 a[150:151], v2 offset:30976
  v_mfma_f32_16x16x32_bf16 a[56:59], a[216:219], v[152:155], a[56:59]
  v_exp_f32 v203, v203
  v_mfma_f32_16x16x32_bf16 a[56:59], a[220:223], v[184:187], a[56:59]
  buffer_load_dwordx4 a[168:171], v37, s[4:7], s53 offen offset:2048 sc1
  v_mfma_f32_16x16x32_bf16 a[60:63], a[220:223], v[188:191], a[60:63]
  v_add_f32 v46, v46, v203
  v_cvt_pk_bf16_f32 v201, v202, v203
  v_mfma_f32_16x16x32_bf16 a[60:63], a[216:219], v[156:159], a[60:63]
  s_waitcnt lgkmcnt(6)
  v_exp_f32 v204, v204
  v_mfma_f32_16x16x32_bf16 a[76:79], a[224:227], v[156:159], a[76:79]
  s_waitcnt lgkmcnt(4)
  ds_read_b64_tr_b16 a[152:153], v11 offset:256
  v_add_f32 v47, v47, v204
  v_mfma_f32_16x16x32_bf16 a[76:79], a[228:231], v[188:191], a[76:79]
  v_exp_f32 v205, v205
  v_mfma_f32_16x16x32_bf16 a[72:75], a[228:231], v[184:187], a[72:75]
  ds_read_b64_tr_b16 a[154:155], v11 offset:6400
  v_add_f32 v47, v47, v205
  v_mfma_f32_16x16x32_bf16 a[72:75], a[224:227], v[152:155], a[72:75]
  ds_read_b64_tr_b16 a[156:157], v3 offset:24832
  ds_read_b64_tr_b16 a[158:159], v3 offset:30976
  v_mfma_f32_16x16x32_bf16 a[68:71], a[224:227], v[148:151], a[68:71]
  v_exp_f32 v206, v206
  v_mfma_f32_16x16x32_bf16 a[68:71], a[228:231], v[180:183], a[68:71]
  v_cvt_pk_bf16_f32 v204, v204, v205
  v_add_f32 v47, v47, v206
  v_mfma_f32_16x16x32_bf16 a[64:67], a[228:231], v[176:179], a[64:67]
  buffer_load_dwordx4 a[172:175], v37, s[4:7], s53 offen offset:3072 sc1
  v_mfma_f32_16x16x32_bf16 a[64:67], a[224:227], v[144:147], a[64:67]
  s_waitcnt lgkmcnt(6)
  v_exp_f32 v207, v207
  v_mfma_f32_16x16x32_bf16 a[80:83], a[144:147], v[144:147], a[80:83]
  s_waitcnt lgkmcnt(4)
  ds_read_b64_tr_b16 a[160:161], v12 offset:256
  v_add_f32 v47, v47, v207
  v_mfma_f32_16x16x32_bf16 a[80:83], a[148:151], v[176:179], a[80:83]
  s_add_u32 s56, s85, 47104
  ds_read_b64_tr_b16 a[162:163], v12 offset:6400
  v_cvt_pk_bf16_f32 v205, v206, v207
  v_mfma_f32_16x16x32_bf16 a[84:87], a[148:151], v[180:183], a[84:87]
  v_exp_f32 v160, v160
  v_mfma_f32_16x16x32_bf16 a[84:87], a[144:147], v[148:151], a[84:87]
  ds_read_b64_tr_b16 a[164:165], v4 offset:24832
  ds_read_b64_tr_b16 a[166:167], v4 offset:30976
  v_mfma_f32_16x16x32_bf16 a[88:91], a[144:147], v[152:155], a[88:91]
  ds_read_b128 a[248:251], v20 offset:24576
  v_add_f32 v44, v44, v160
  v_mfma_f32_16x16x32_bf16 a[88:91], a[148:151], v[184:187], a[88:91]
  v_exp_f32 v161, v161
  v_mfma_f32_16x16x32_bf16 a[92:95], a[148:151], v[188:191], a[92:95]
  buffer_load_dwordx4 a[176:179], v37, s[4:7], s56 offen offset:2048 sc1
  v_mfma_f32_16x16x32_bf16 a[92:95], a[144:147], v[156:159], a[92:95]
  s_waitcnt lgkmcnt(7)
  v_add_f32 v44, v44, v161
  v_cvt_pk_bf16_f32 v194, v160, v161
  v_mfma_f32_16x16x32_bf16 a[108:111], a[152:155], v[156:159], a[108:111]
  s_waitcnt lgkmcnt(5)
  v_exp_f32 v162, v162
  v_mfma_f32_16x16x32_bf16 a[108:111], a[156:159], v[188:191], a[108:111]
  ds_read_b128 a[252:255], v21 offset:24576
  v_add_f32 v44, v44, v162
  v_mfma_f32_16x16x32_bf16 a[104:107], a[156:159], v[184:187], a[104:107]
  v_exp_f32 v163, v163
  v_mfma_f32_16x16x32_bf16 a[104:107], a[152:155], v[152:155], a[104:107]
  ds_read_b128 a[200:203], v20 offset:24704
  ds_read_b128 a[204:207], v21 offset:24704
  v_mfma_f32_16x16x32_bf16 a[100:103], a[152:155], v[148:151], a[100:103]
  buffer_load_dwordx4 a[180:183], v37, s[4:7], s56 offen offset:3072 sc1
  v_mfma_f32_16x16x32_bf16 a[100:103], a[156:159], v[180:183], a[100:103]
  ds_read_b128 a[208:211], v20 offset:24832
  v_add_f32 v44, v44, v163
  v_mfma_f32_16x16x32_bf16 a[96:99], a[156:159], v[176:179], a[96:99]
  v_exp_f32 v164, v164
  v_mfma_f32_16x16x32_bf16 a[96:99], a[152:155], v[144:147], a[96:99]
  s_waitcnt lgkmcnt(7)
  ds_read_b128 a[212:215], v21 offset:24832
  v_cvt_pk_bf16_f32 v195, v162, v163
  v_mfma_f32_16x16x32_bf16 a[112:115], a[160:163], v[144:147], a[112:115]
  s_waitcnt lgkmcnt(6)
  v_add_f32 v45, v45, v164
  v_mfma_f32_16x16x32_bf16 a[112:115], a[164:167], v[176:179], a[112:115]
  s_add_u32 s58, s85, 73728
  v_exp_f32 v165, v165
  v_mfma_f32_16x16x32_bf16 a[116:119], a[164:167], v[180:183], a[116:119]
  v_add_f32 v45, v45, v165
  v_cvt_pk_bf16_f32 v198, v164, v165
  v_mfma_f32_16x16x32_bf16 a[116:119], a[160:163], v[148:151], a[116:119]
  v_exp_f32 v166, v166
  v_mfma_f32_16x16x32_bf16 a[120:123], a[160:163], v[152:155], a[120:123]
  buffer_load_dwordx4 a[184:187], v37, s[4:7], s58 offen offset:2048 sc1
  v_mfma_f32_16x16x32_bf16 a[120:123], a[164:167], v[184:187], a[120:123]
  ds_read_b128 a[216:219], v20 offset:30720
  v_add_f32 v45, v45, v166
  v_mfma_f32_16x16x32_bf16 a[124:127], a[164:167], v[188:191], a[124:127]
  v_exp_f32 v167, v167
  v_mfma_f32_16x16x32_bf16 a[124:127], a[160:163], v[156:159], a[124:127]
  s_waitcnt lgkmcnt(6)
  v_add_f32 v45, v45, v167
  v_cvt_pk_bf16_f32 v199, v166, v167
  v_mfma_f32_16x16x32_bf16 v[144:147], a[248:251], v[48:51], 0
  s_waitcnt lgkmcnt(5)
  v_exp_f32 v168, v168
  v_mfma_f32_16x16x32_bf16 v[144:147], a[252:255], v[64:67], v[144:147]
  s_waitcnt lgkmcnt(4)
  ds_read_b128 a[220:223], v21 offset:30720
  v_add_f32 v46, v46, v168
  v_mfma_f32_16x16x32_bf16 v[144:147], a[200:203], v[80:83], v[144:147]
  s_waitcnt lgkmcnt(3)
  v_exp_f32 v169, v169
  v_mfma_f32_16x16x32_bf16 v[144:147], a[204:207], v[96:99], v[144:147]
  buffer_load_dwordx4 a[188:191], v37, s[4:7], s58 offen offset:3072 sc1
  v_mfma_f32_16x16x32_bf16 v[144:147], a[208:211], v[112:115], v[144:147]
  s_waitcnt lgkmcnt(2)
  ds_read_b128 a[224:227], v20 offset:30848
  v_add_f32 v46, v46, v169
  v_mfma_f32_16x16x32_bf16 v[144:147], a[212:215], v[128:131], v[144:147]
  ds_read_b128 a[228:231], v21 offset:30848
  v_cvt_pk_bf16_f32 v202, v168, v169
  v_mfma_f32_16x16x32_bf16 v[148:151], a[212:215], v[132:135], 0
  v_exp_f32 v170, v170
  v_mfma_f32_16x16x32_bf16 v[148:151], a[208:211], v[116:119], v[148:151]
  v_add_f32 v46, v46, v170
  v_mfma_f32_16x16x32_bf16 v[148:151], a[204:207], v[100:103], v[148:151]
  ds_read_b128 a[144:147], v20 offset:30976
  v_mfma_f32_16x16x32_bf16 v[148:151], a[200:203], v[84:87], v[148:151]
  s_add_u32 s57, s85, 100352
  v_exp_f32 v171, v171
  v_mfma_f32_16x16x32_bf16 v[148:151], a[252:255], v[68:71], v[148:151]
  buffer_load_dwordx4 a[192:195], v37, s[4:7], s57 offen offset:2048 sc1
  v_mfma_f32_16x16x32_bf16 v[148:151], a[248:251], v[52:55], v[148:151]
  ds_read_b128 a[148:151], v21 offset:30976
  v_add_f32 v46, v46, v171
  v_mfma_f32_16x16x32_bf16 v[152:155], a[248:251], v[56:59], 0
  v_exp_f32 v172, v172
  v_mfma_f32_16x16x32_bf16 v[152:155], a[252:255], v[72:75], v[152:155]
  v_cvt_pk_bf16_f32 v203, v170, v171
  v_add_f32 v47, v47, v172
  v_mfma_f32_16x16x32_bf16 v[152:155], a[200:203], v[88:91], v[152:155]
  v_exp_f32 v173, v173
  v_mfma_f32_16x16x32_bf16 v[152:155], a[204:207], v[104:107], v[152:155]
  v_exp_f32 v174, v174
  v_mfma_f32_16x16x32_bf16 v[152:155], a[208:211], v[120:123], v[152:155]
  v_add_f32 v47, v47, v173
  v_cvt_pk_bf16_f32 v206, v172, v173
  v_mfma_f32_16x16x32_bf16 v[152:155], a[212:215], v[136:139], v[152:155]
  v_exp_f32 v175, v175
  v_mfma_f32_16x16x32_bf16 v[156:159], a[212:215], v[140:143], 0
  buffer_load_dwordx4 a[196:199], v37, s[4:7], s57 offen offset:3072 sc1
  v_mfma_f32_16x16x32_bf16 v[156:159], a[208:211], v[124:127], v[156:159]
  s_waitcnt vmcnt(26) lgkmcnt(0)
  s_barrier
  v_add_f32 v47, v47, v174
  v_cvt_pk_bf16_f32 v207, v174, v175
  v_mfma_f32_16x16x32_bf16 v[156:159], a[204:207], v[108:111], v[156:159]
  v_exp_f32 v144, v144
  v_mfma_f32_16x16x32_bf16 v[156:159], a[200:203], v[92:95], v[156:159]
  v_exp_f32 v145, v145
  v_mfma_f32_16x16x32_bf16 v[156:159], a[252:255], v[76:79], v[156:159]
  s_add_u32 m0, s74, 122880
  v_exp_f32 v146, v146
  v_mfma_f32_16x16x32_bf16 v[156:159], a[248:251], v[60:63], v[156:159]
  s_mov_b32 s75, 110592
  v_add_f32 v47, v47, v175
  v_add_f32 v44, v44, v144
  v_mfma_f32_16x16x32_bf16 v[160:163], a[216:219], v[48:51], 0
  buffer_load_dwordx4 v31, s[20:23], s75 offen offset:0  lds
  v_mfma_f32_16x16x32_bf16 v[160:163], a[220:223], v[64:67], v[160:163]
  v_exp_f32 v147, v147
  v_mfma_f32_16x16x32_bf16 v[160:163], a[224:227], v[80:83], v[160:163]
  v_add_f32 v44, v44, v145
  v_cvt_pk_bf16_f32 v144, v144, v145
  v_mfma_f32_16x16x32_bf16 v[160:163], a[228:231], v[96:99], v[160:163]
  v_add_f32 v44, v44, v146
  v_cvt_pk_bf16_f32 v145, v146, v147
  v_mfma_f32_16x16x32_bf16 v[160:163], a[144:147], v[112:115], v[160:163]
  v_exp_f32 v148, v148
  v_mfma_f32_16x16x32_bf16 v[160:163], a[148:151], v[128:131], v[160:163]
  buffer_load_dwordx4 v32, s[20:23], s75 offen offset:1024  lds
  v_mfma_f32_16x16x32_bf16 v[164:167], a[148:151], v[132:135], 0
  v_exp_f32 v149, v149
  v_mfma_f32_16x16x32_bf16 v[164:167], a[144:147], v[116:119], v[164:167]
  v_add_f32 v44, v44, v147
  v_add_f32 v45, v45, v148
  v_mfma_f32_16x16x32_bf16 v[164:167], a[228:231], v[100:103], v[164:167]
  ds_read_b64_tr_b16 a[152:153], v1 offset:24576
  v_add_f32 v45, v45, v149
  v_mfma_f32_16x16x32_bf16 v[164:167], a[224:227], v[84:87], v[164:167]
  ds_read_b64_tr_b16 a[154:155], v1 offset:30720
  v_cvt_pk_bf16_f32 v148, v148, v149
  v_mfma_f32_16x16x32_bf16 v[164:167], a[220:223], v[68:71], v[164:167]
  ds_read_b64_tr_b16 a[156:157], v5 offset:24576
  v_mfma_f32_16x16x32_bf16 v[164:167], a[216:219], v[52:55], v[164:167]
  ds_read_b64_tr_b16 a[158:159], v5 offset:30720
  v_mfma_f32_16x16x32_bf16 v[168:171], a[216:219], v[56:59], 0
  buffer_load_dwordx4 v33, s[20:23], s75 offen offset:2048  lds
  v_mfma_f32_16x16x32_bf16 v[168:171], a[220:223], v[72:75], v[168:171]
  v_exp_f32 v150, v150
  v_mfma_f32_16x16x32_bf16 v[168:171], a[224:227], v[88:91], v[168:171]
  v_exp_f32 v151, v151
  v_mfma_f32_16x16x32_bf16 v[168:171], a[228:231], v[104:107], v[168:171]
  v_exp_f32 v152, v152
  v_mfma_f32_16x16x32_bf16 v[168:171], a[144:147], v[120:123], v[168:171]
  s_add_u32 m0, s74, 98304
  ds_read_b64_tr_b16 a[160:161], v2 offset:24576
  v_add_f32 v45, v45, v150
  v_mfma_f32_16x16x32_bf16 v[168:171], a[148:151], v[136:139], v[168:171]
  s_mov_b32 s55, 135168
  ds_read_b64_tr_b16 a[162:163], v2 offset:30720
  v_add_f32 v45, v45, v151
  v_mfma_f32_16x16x32_bf16 v[172:175], a[148:151], v[140:143], 0
  ds_read_b64_tr_b16 a[164:165], v6 offset:24576
  v_cvt_pk_bf16_f32 v149, v150, v151
  v_mfma_f32_16x16x32_bf16 v[172:175], a[144:147], v[124:127], v[172:175]
  ds_read_b64_tr_b16 a[166:167], v6 offset:30720
  v_add_f32 v46, v46, v152
  v_mfma_f32_16x16x32_bf16 v[172:175], a[228:231], v[108:111], v[172:175]
  buffer_load_dwordx4 v28, s[16:19], s55 offen offset:0  lds
  v_mfma_f32_16x16x32_bf16 v[172:175], a[224:227], v[92:95], v[172:175]
  v_exp_f32 v153, v153
  v_mfma_f32_16x16x32_bf16 v[172:175], a[220:223], v[76:79], v[172:175]
  s_waitcnt lgkmcnt(6)
  v_exp_f32 v154, v154
  v_mfma_f32_16x16x32_bf16 v[172:175], a[216:219], v[60:63], v[172:175]
  buffer_load_dwordx4 v29, s[16:19], s55 offen offset:1024  lds
  v_mfma_f32_16x16x32_bf16 v[220:223], a[152:155], v[188:191], v[220:223]
  s_waitcnt lgkmcnt(4)
  ds_read_b64_tr_b16 a[248:249], v3 offset:24576
  v_add_f32 v46, v46, v153
  v_mfma_f32_16x16x32_bf16 v[220:223], a[156:159], v[204:207], v[220:223]
  ds_read_b64_tr_b16 a[250:251], v3 offset:30720
  v_cvt_pk_bf16_f32 v152, v152, v153
  v_mfma_f32_16x16x32_bf16 v[216:219], a[156:159], v[200:203], v[216:219]
  ds_read_b64_tr_b16 a[252:253], v7 offset:24576
  v_add_f32 v46, v46, v154
  v_mfma_f32_16x16x32_bf16 v[216:219], a[152:155], v[184:187], v[216:219]
  ds_read_b64_tr_b16 a[254:255], v7 offset:30720
  v_mfma_f32_16x16x32_bf16 v[212:215], a[152:155], v[180:183], v[212:215]
  v_exp_f32 v155, v155
  v_mfma_f32_16x16x32_bf16 v[212:215], a[156:159], v[196:199], v[212:215]
  buffer_load_dwordx4 v30, s[16:19], s55 offen offset:2048  lds
  v_mfma_f32_16x16x32_bf16 v[208:211], a[156:159], v[192:195], v[208:211]
  v_exp_f32 v156, v156
  v_mfma_f32_16x16x32_bf16 v[208:211], a[152:155], v[176:179], v[208:211]
  s_waitcnt lgkmcnt(6)
  v_exp_f32 v157, v157
  v_mfma_f32_16x16x32_bf16 v[224:227], a[160:163], v[176:179], v[224:227]
  s_waitcnt lgkmcnt(4)
  ds_read_b64_tr_b16 a[200:201], v4 offset:24576
  v_add_f32 v46, v46, v155
  v_mfma_f32_16x16x32_bf16 v[224:227], a[164:167], v[192:195], v[224:227]
  ds_read_b64_tr_b16 a[202:203], v4 offset:30720
  v_cvt_pk_bf16_f32 v153, v154, v155
  v_mfma_f32_16x16x32_bf16 v[228:231], a[164:167], v[196:199], v[228:231]
  ds_read_b64_tr_b16 a[204:205], v8 offset:24576
  v_add_f32 v47, v47, v156
  v_mfma_f32_16x16x32_bf16 v[228:231], a[160:163], v[180:183], v[228:231]
  ds_read_b64_tr_b16 a[206:207], v8 offset:30720
  v_add_f32 v47, v47, v157
  v_mfma_f32_16x16x32_bf16 v[232:235], a[160:163], v[184:187], v[232:235]
L_pg11:
  s_cbranch_execz L_hop2
  v_exp_f32 v158, v158
  v_mfma_f32_16x16x32_bf16 v[232:235], a[164:167], v[200:203], v[232:235]
  v_exp_f32 v159, v159
  v_mfma_f32_16x16x32_bf16 v[236:239], a[164:167], v[204:207], v[236:239]
  v_exp_f32 v160, v160
  v_mfma_f32_16x16x32_bf16 v[236:239], a[160:163], v[188:191], v[236:239]
  s_waitcnt lgkmcnt(6)
  v_cvt_pk_bf16_f32 v156, v156, v157
  v_add_f32 v47, v47, v158
  v_mfma_f32_16x16x32_bf16 v[252:255], a[248:251], v[188:191], v[252:255]
  s_waitcnt lgkmcnt(4)
  ds_read_b64_tr_b16 a[208:209], v1 offset:24704
  v_cvt_pk_bf16_f32 v157, v158, v159
  v_mfma_f32_16x16x32_bf16 v[252:255], a[252:255], v[204:207], v[252:255]
  ds_read_b64_tr_b16 a[210:211], v1 offset:30848
  v_add_f32 v47, v47, v159
  v_mfma_f32_16x16x32_bf16 v[248:251], a[252:255], v[200:203], v[248:251]
  ds_read_b64_tr_b16 a[212:213], v5 offset:24704
  v_add_f32 v44, v44, v160
  v_mfma_f32_16x16x32_bf16 v[248:251], a[248:251], v[184:187], v[248:251]
  ds_read_b64_tr_b16 a[214:215], v5 offset:30848
  v_mfma_f32_16x16x32_bf16 v[244:247], a[248:251], v[180:183], v[244:247]
  v_exp_f32 v161, v161
  v_mfma_f32_16x16x32_bf16 v[244:247], a[252:255], v[196:199], v[244:247]
  v_exp_f32 v162, v162
  v_mfma_f32_16x16x32_bf16 v[240:243], a[252:255], v[192:195], v[240:243]
  v_exp_f32 v163, v163
  v_mfma_f32_16x16x32_bf16 v[240:243], a[248:251], v[176:179], v[240:243]
  s_waitcnt lgkmcnt(6)
  v_exp_f32 v164, v164
  v_mfma_f32_16x16x32_bf16 a[232:235], a[200:203], v[176:179], a[232:235]
  s_waitcnt lgkmcnt(4)
  ds_read_b64_tr_b16 a[216:217], v2 offset:24704
  v_add_f32 v44, v44, v161
  v_mfma_f32_16x16x32_bf16 a[232:235], a[204:207], v[192:195], a[232:235]
  ds_read_b64_tr_b16 a[218:219], v2 offset:30848
  v_cvt_pk_bf16_f32 v146, v160, v161
  v_mfma_f32_16x16x32_bf16 a[236:239], a[204:207], v[196:199], a[236:239]
  ds_read_b64_tr_b16 a[220:221], v6 offset:24704
  v_add_f32 v44, v44, v162
  v_mfma_f32_16x16x32_bf16 a[236:239], a[200:203], v[180:183], a[236:239]
  ds_read_b64_tr_b16 a[222:223], v6 offset:30848
  v_cvt_pk_bf16_f32 v147, v162, v163
  v_mfma_f32_16x16x32_bf16 a[240:243], a[200:203], v[184:187], a[240:243]
  v_exp_f32 v165, v165
  v_mfma_f32_16x16x32_bf16 a[240:243], a[204:207], v[200:203], a[240:243]
  v_exp_f32 v166, v166
  v_mfma_f32_16x16x32_bf16 a[244:247], a[204:207], v[204:207], a[244:247]
  v_exp_f32 v167, v167
  v_mfma_f32_16x16x32_bf16 a[244:247], a[200:203], v[188:191], a[244:247]
  s_waitcnt lgkmcnt(6)
  v_add_f32 v44, v44, v163
  v_add_f32 v45, v45, v164
  v_mfma_f32_16x16x32_bf16 a[12:15], a[208:211], v[188:191], a[12:15]
  s_waitcnt lgkmcnt(4)
  v_add_f32 v45, v45, v165
  v_cvt_pk_bf16_f32 v150, v164, v165
  v_mfma_f32_16x16x32_bf16 a[12:15], a[212:215], v[204:207], a[12:15]
  v_exp_f32 v168, v168
  v_mfma_f32_16x16x32_bf16 a[8:11], a[212:215], v[200:203], a[8:11]
  v_add_f32 v45, v45, v166
  v_cvt_pk_bf16_f32 v151, v166, v167
  v_mfma_f32_16x16x32_bf16 a[8:11], a[208:211], v[184:187], a[8:11]
  v_add_f32 v45, v45, v167
  v_add_f32 v46, v46, v168
  v_mfma_f32_16x16x32_bf16 a[4:7], a[208:211], v[180:183], a[4:7]
  ds_read_b64_tr_b16 a[224:225], v9 offset:36864
  v_mfma_f32_16x16x32_bf16 a[4:7], a[212:215], v[196:199], a[4:7]
  ds_read_b64_tr_b16 a[226:227], v9 offset:43008
  v_mfma_f32_16x16x32_bf16 a[0:3], a[212:215], v[192:195], a[0:3]
  ds_read_b64_tr_b16 a[228:229], v9 offset:49152
  v_mfma_f32_16x16x32_bf16 a[0:3], a[208:211], v[176:179], a[0:3]
  s_waitcnt lgkmcnt(5)
  ds_read_b64_tr_b16 a[230:231], v9 offset:55296
  v_mfma_f32_16x16x32_bf16 a[16:19], a[216:219], v[176:179], a[16:19]
  s_waitcnt lgkmcnt(4)
  ds_read_b64_tr_b16 a[144:145], v1 offset:12288
  v_mfma_f32_16x16x32_bf16 a[16:19], a[220:223], v[192:195], a[16:19]
  ds_read_b64_tr_b16 a[146:147], v1 offset:18432
  v_mfma_f32_16x16x32_bf16 a[20:23], a[220:223], v[196:199], a[20:23]
  ds_read_b64_tr_b16 a[148:149], v1 offset:36864
  v_mfma_f32_16x16x32_bf16 a[20:23], a[216:219], v[180:183], a[20:23]
  ds_read_b64_tr_b16 a[150:151], v1 offset:43008
  v_mfma_f32_16x16x32_bf16 a[24:27], a[216:219], v[184:187], a[24:27]
  ds_read_b64_tr_b16 a[152:153], v5 offset:36864
  v_mfma_f32_16x16x32_bf16 a[24:27], a[220:223], v[200:203], a[24:27]
  ds_read_b64_tr_b16 a[154:155], v5 offset:43008
  v_mfma_f32_16x16x32_bf16 a[28:31], a[220:223], v[204:207], a[28:31]
  ds_read_b64_tr_b16 a[156:157], v9 offset:12288
  v_mfma_f32_16x16x32_bf16 a[28:31], a[216:219], v[188:191], a[28:31]
  s_waitcnt vmcnt(26) lgkmcnt(9)
  ds_read_b64_tr_b16 a[158:159], v9 offset:18432
  v_mfma_f32_16x16x32_bf16 v[176:179], a[224:227], a[128:131], 0
  s_waitcnt vmcnt(17) lgkmcnt(8)
  v_exp_f32 v169, v169
  v_mfma_f32_16x16x32_bf16 v[176:179], a[228:231], a[136:139], v[176:179]
  s_waitcnt vmcnt(15)
  ds_read_b64_tr_b16 a[160:161], v10 offset:36864
  ds_read_b64_tr_b16 a[164:165], v10 offset:49152
  v_mfma_f32_16x16x32_bf16 v[184:187], a[228:231], a[140:143], 0
  ds_read_b64_tr_b16 a[162:163], v10 offset:43008
  v_add_f32 v46, v46, v169
  v_mfma_f32_16x16x32_bf16 v[184:187], a[224:227], a[132:135], v[184:187]
  s_waitcnt vmcnt(12) lgkmcnt(9)
  ds_read_b64_tr_b16 a[166:167], v10 offset:55296
  v_cvt_pk_bf16_f32 v154, v168, v169
  v_mfma_f32_16x16x32_bf16 v[184:187], a[144:147], a[172:175], v[184:187]
  s_waitcnt vmcnt(10) lgkmcnt(8)
  v_exp_f32 v170, v170
  v_mfma_f32_16x16x32_bf16 v[184:187], a[148:151], a[180:183], v[184:187]
  ds_read_b64_tr_b16 a[248:249], v2 offset:12288
  ds_read_b64_tr_b16 a[252:253], v2 offset:36864
  v_mfma_f32_16x16x32_bf16 v[176:179], a[148:151], a[176:179], v[176:179]
  ds_read_b64_tr_b16 a[250:251], v2 offset:18432
  v_add_f32 v46, v46, v170
  v_mfma_f32_16x16x32_bf16 v[176:179], a[144:147], a[168:171], v[176:179]
  s_waitcnt vmcnt(9) lgkmcnt(9)
  ds_read_b64_tr_b16 a[254:255], v2 offset:43008
  v_mfma_f32_16x16x32_bf16 v[176:179], a[152:155], a[184:187], v[176:179]
  s_waitcnt vmcnt(7) lgkmcnt(8)
  v_exp_f32 v171, v171
  v_mfma_f32_16x16x32_bf16 v[176:179], a[156:159], a[192:195], v[176:179]
  s_waitcnt vmcnt(6)
  ds_read_b64_tr_b16 a[200:201], v6 offset:36864
  ds_read_b64_tr_b16 a[202:203], v6 offset:43008
  v_mfma_f32_16x16x32_bf16 v[184:187], a[156:159], a[196:199], v[184:187]
  ds_read_b64_tr_b16 a[204:205], v10 offset:12288
  v_cvt_pk_bf16_f32 v155, v170, v171
  v_mfma_f32_16x16x32_bf16 v[184:187], a[152:155], a[188:191], v[184:187]
  s_waitcnt lgkmcnt(8)
  ds_read_b64_tr_b16 a[206:207], v10 offset:18432
  v_add_f32 v46, v46, v171
  v_mfma_f32_16x16x32_bf16 v[180:183], a[160:163], a[128:131], 0
  s_waitcnt lgkmcnt(8)
  v_exp_f32 v172, v172
  v_mfma_f32_16x16x32_bf16 v[180:183], a[164:167], a[136:139], v[180:183]
  ds_read_b64_tr_b16 a[208:209], v10 offset:36992
  ds_read_b64_tr_b16 a[212:213], v10 offset:49280
  v_mfma_f32_16x16x32_bf16 v[188:191], a[164:167], a[140:143], 0
  ds_read_b64_tr_b16 a[210:211], v10 offset:43136
  v_add_f32 v47, v47, v172
  v_mfma_f32_16x16x32_bf16 v[188:191], a[160:163], a[132:135], v[188:191]
  s_waitcnt lgkmcnt(8)
  ds_read_b64_tr_b16 a[214:215], v10 offset:55424
  v_cvt_pk_bf16_f32 v176, v176, v177
  v_mfma_f32_16x16x32_bf16 v[188:191], a[248:251], a[172:175], v[188:191]
  s_waitcnt lgkmcnt(8)
  v_exp_f32 v173, v173
  v_mfma_f32_16x16x32_bf16 v[188:191], a[252:255], a[180:183], v[188:191]
  ds_read_b64_tr_b16 a[216:217], v2 offset:12416
  ds_read_b64_tr_b16 a[220:221], v2 offset:36992
  v_mfma_f32_16x16x32_bf16 v[180:183], a[252:255], a[176:179], v[180:183]
  ds_read_b64_tr_b16 a[218:219], v2 offset:18560
  v_add_f32 v47, v47, v173
  v_mfma_f32_16x16x32_bf16 v[180:183], a[248:251], a[168:171], v[180:183]
  s_waitcnt lgkmcnt(9)
  ds_read_b64_tr_b16 a[222:223], v2 offset:43136
  v_cvt_pk_bf16_f32 v158, v172, v173
  v_mfma_f32_16x16x32_bf16 v[180:183], a[200:203], a[184:187], v[180:183]
  s_waitcnt lgkmcnt(8)
  v_exp_f32 v174, v174
  v_mfma_f32_16x16x32_bf16 v[180:183], a[204:207], a[192:195], v[180:183]
  ds_read_b64_tr_b16 a[224:225], v6 offset:36992
  ds_read_b64_tr_b16 a[226:227], v6 offset:43136
  v_mfma_f32_16x16x32_bf16 v[188:191], a[204:207], a[196:199], v[188:191]
  ds_read_b64_tr_b16 a[228:229], v10 offset:12416
  v_add_f32 v47, v47, v174
  v_mfma_f32_16x16x32_bf16 v[188:191], a[200:203], a[188:191], v[188:191]
  s_waitcnt lgkmcnt(8)
  ds_read_b64_tr_b16 a[230:231], v10 offset:18560
  v_cvt_pk_bf16_f32 v177, v178, v179
  v_mfma_f32_16x16x32_bf16 v[160:163], a[208:211], a[128:131], 0
  s_waitcnt lgkmcnt(8)
  v_exp_f32 v175, v175
  v_mfma_f32_16x16x32_bf16 v[160:163], a[212:215], a[136:139], v[160:163]
  ds_read_b64_tr_b16 a[144:145], v9 offset:36992
  ds_read_b64_tr_b16 a[148:149], v9 offset:49280
  v_mfma_f32_16x16x32_bf16 v[168:171], a[212:215], a[140:143], 0
  ds_read_b64_tr_b16 a[146:147], v9 offset:43136
  v_cvt_pk_bf16_f32 v159, v174, v175
  v_mfma_f32_16x16x32_bf16 v[168:171], a[208:211], a[132:135], v[168:171]
  s_waitcnt lgkmcnt(8)
  ds_read_b64_tr_b16 a[150:151], v9 offset:55424
  v_add_f32 v47, v47, v175
  v_mfma_f32_16x16x32_bf16 v[168:171], a[216:219], a[172:175], v[168:171]
  s_waitcnt lgkmcnt(8)
  ds_read_b64_tr_b16 a[152:153], v1 offset:12416
  v_and_b32 v176, -2, v176
  v_mfma_f32_16x16x32_bf16 v[168:171], a[220:223], a[180:183], v[168:171]
  ds_read_b64_tr_b16 a[154:155], v1 offset:18560
  ds_read_b64_tr_b16 a[156:157], v1 offset:36992
  v_mfma_f32_16x16x32_bf16 v[160:163], a[220:223], a[176:179], v[160:163]
  v_cvt_pk_bf16_f32 v184, v184, v185
  v_cvt_pk_bf16_f32 v185, v186, v187
  v_mfma_f32_16x16x32_bf16 v[160:163], a[216:219], a[168:171], v[160:163]
  s_waitcnt lgkmcnt(7)
  ds_read_b64_tr_b16 a[158:159], v1 offset:43136
  v_cvt_pk_bf16_f32 v178, v180, v181
  v_mfma_f32_16x16x32_bf16 v[160:163], a[224:227], a[184:187], v[160:163]
  s_add_u32 s59, s11, 4096
  ds_read_b64_tr_b16 a[160:161], v5 offset:36992
  v_cvt_pk_bf16_f32 v179, v182, v183
  v_mfma_f32_16x16x32_bf16 v[160:163], a[228:231], a[192:195], v[160:163]
  ds_read_b64_tr_b16 a[162:163], v5 offset:43136
  v_cvt_pk_bf16_f32 v186, v188, v189
  v_mfma_f32_16x16x32_bf16 v[168:171], a[228:231], a[196:199], v[168:171]
  ds_read_b64_tr_b16 a[164:165], v9 offset:12416
  v_cvt_pk_bf16_f32 v187, v190, v191
  v_mfma_f32_16x16x32_bf16 v[168:171], a[224:227], a[188:191], v[168:171]
  s_waitcnt lgkmcnt(8)
  ds_read_b64_tr_b16 a[166:167], v9 offset:18560
  v_mfma_f32_16x16x32_bf16 v[164:167], a[144:147], a[128:131], 0
  s_waitcnt lgkmcnt(8)
  ds_read_b64_tr_b16 a[252:253], v11 offset:49152
  v_cvt_pk_bf16_f32 v160, v160, v161
  v_mfma_f32_16x16x32_bf16 v[164:167], a[148:151], a[136:139], v[164:167]
  ds_read_b64_tr_b16 a[248:249], v11 offset:36864
  ds_read_b64_tr_b16 a[254:255], v11 offset:55296
  v_mfma_f32_16x16x32_bf16 v[172:175], a[148:151], a[140:143], 0
  s_waitcnt lgkmcnt(7)
  ds_read_b64_tr_b16 a[250:251], v11 offset:43008
  v_cvt_pk_bf16_f32 v161, v162, v163
  v_mfma_f32_16x16x32_bf16 v[172:175], a[144:147], a[132:135], v[172:175]
  buffer_store_dwordx4 v[176:179], v37, s[4:7], s59 offen sc1
  v_mfma_f32_16x16x32_bf16 v[172:175], a[152:155], a[172:175], v[172:175]
  s_add_u32 s60, s13, 6144
  ds_read_b64_tr_b16 a[200:201], v3 offset:12288
  v_and_b32 v184, -2, v184
  v_mfma_f32_16x16x32_bf16 v[172:175], a[156:159], a[180:183], v[172:175]
  ds_read_b64_tr_b16 a[202:203], v3 offset:18432
  ds_read_b64_tr_b16 a[204:205], v3 offset:36864
  v_mfma_f32_16x16x32_bf16 v[164:167], a[156:159], a[176:179], v[164:167]
  buffer_store_dwordx4 v[184:187], v37, s[4:7], s60 offen sc1
  v_mfma_f32_16x16x32_bf16 v[164:167], a[152:155], a[168:171], v[164:167]
  s_waitcnt lgkmcnt(9)
  ds_read_b64_tr_b16 a[206:207], v3 offset:43008
  v_cvt_pk_bf16_f32 v168, v168, v169
  v_mfma_f32_16x16x32_bf16 v[164:167], a[160:163], a[184:187], v[164:167]
  s_waitcnt lgkmcnt(8)
  ds_read_b64_tr_b16 a[208:209], v7 offset:36864
  v_cvt_pk_bf16_f32 v169, v170, v171
  v_mfma_f32_16x16x32_bf16 v[164:167], a[164:167], a[192:195], v[164:167]
  ds_read_b64_tr_b16 a[210:211], v7 offset:43008
  ds_read_b64_tr_b16 a[212:213], v11 offset:12288
  v_mfma_f32_16x16x32_bf16 v[172:175], a[164:167], a[196:199], v[172:175]
  v_mfma_f32_16x16x32_bf16 v[172:175], a[160:163], a[188:191], v[172:175]
  s_waitcnt lgkmcnt(7)
  ds_read_b64_tr_b16 a[214:215], v11 offset:18432
  ds_read_b64_tr_b16 a[220:221], v12 offset:49152
  v_mfma_f32_16x16x32_bf16 v[176:179], a[248:251], a[128:131], 0
  ds_read_b64_tr_b16 a[216:217], v12 offset:36864
  v_cvt_pk_bf16_f32 v162, v164, v165
  v_mfma_f32_16x16x32_bf16 v[176:179], a[252:255], a[136:139], v[176:179]
  ds_read_b64_tr_b16 a[218:219], v12 offset:43008
  v_cvt_pk_bf16_f32 v163, v166, v167
  v_mfma_f32_16x16x32_bf16 v[184:187], a[252:255], a[140:143], 0
  s_waitcnt lgkmcnt(9)
  ds_read_b128 a[152:155], v16 offset:0
  v_cvt_pk_bf16_f32 v170, v172, v173
  v_mfma_f32_16x16x32_bf16 v[184:187], a[248:251], a[132:135], v[184:187]
  s_add_u32 s81, s12, 5120
  ds_read_b64_tr_b16 a[222:223], v12 offset:55296
  v_and_b32 v160, -2, v160
  v_mfma_f32_16x16x32_bf16 v[184:187], a[200:203], a[172:175], v[184:187]
  s_waitcnt lgkmcnt(9)
  ds_read_b64_tr_b16 a[224:225], v4 offset:12288
  v_cvt_pk_bf16_f32 v171, v174, v175
  v_mfma_f32_16x16x32_bf16 v[184:187], a[204:207], a[180:183], v[184:187]
  ds_read_b64_tr_b16 a[226:227], v4 offset:18432
  ds_read_b64_tr_b16 a[228:229], v4 offset:36864
  v_mfma_f32_16x16x32_bf16 v[176:179], a[204:207], a[176:179], v[176:179]
  ds_read_b128 a[156:159], v17 offset:0
  v_mfma_f32_16x16x32_bf16 v[176:179], a[200:203], a[168:171], v[176:179]
  s_waitcnt lgkmcnt(11)
  ds_read_b64_tr_b16 a[230:231], v4 offset:43008
  v_mfma_f32_16x16x32_bf16 v[176:179], a[208:211], a[184:187], v[176:179]
  s_waitcnt lgkmcnt(10)
  ds_read_b64_tr_b16 a[144:145], v8 offset:36864
  v_mfma_f32_16x16x32_bf16 v[176:179], a[212:215], a[192:195], v[176:179]
  ds_read_b64_tr_b16 a[146:147], v8 offset:43008
  ds_read_b128 a[160:163], v16 offset:128
  v_mfma_f32_16x16x32_bf16 v[184:187], a[212:215], a[196:199], v[184:187]
  ds_read_b64_tr_b16 a[148:149], v12 offset:12288
  v_mfma_f32_16x16x32_bf16 v[184:187], a[208:211], a[188:191], v[184:187]
  s_waitcnt lgkmcnt(9)
  ds_read_b64_tr_b16 a[150:151], v12 offset:18432
  ds_read_b128 a[164:167], v17 offset:128
  v_mfma_f32_16x16x32_bf16 v[180:183], a[216:219], a[128:131], 0
  buffer_store_dwordx4 v[160:163], v37, s[4:7], s81 offen sc1
  v_mfma_f32_16x16x32_bf16 v[180:183], a[220:223], a[136:139], v[180:183]
  ds_read_b128 a[248:251], v16 offset:256
  ds_read_b128 a[252:255], v17 offset:256
  v_mfma_f32_16x16x32_bf16 v[188:191], a[220:223], a[140:143], 0
  s_waitcnt lgkmcnt(11)
  v_cvt_pk_bf16_f32 v176, v176, v177
  v_cvt_pk_bf16_f32 v177, v178, v179
  v_mfma_f32_16x16x32_bf16 v[188:191], a[216:219], a[132:135], v[188:191]
  s_add_u32 s3, s14, 7168
  v_and_b32 v168, -2, v168
  v_cvt_pk_bf16_f32 v184, v184, v185
  v_mfma_f32_16x16x32_bf16 v[188:191], a[224:227], a[172:175], v[188:191]
  s_waitcnt lgkmcnt(8)
  ds_read_b128 a[200:203], v16 offset:6144
  v_cvt_pk_bf16_f32 v185, v186, v187
  v_mfma_f32_16x16x32_bf16 v[188:191], a[228:231], a[180:183], v[188:191]
  buffer_store_dwordx4 v[168:171], v37, s[4:7], s3 offen sc1
  v_mfma_f32_16x16x32_bf16 v[180:183], a[228:231], a[176:179], v[180:183]
  v_mfma_f32_16x16x32_bf16 v[180:183], a[224:227], a[168:171], v[180:183]
  s_waitcnt lgkmcnt(7)
  ds_read_b128 a[204:207], v17 offset:6144
  v_mfma_f32_16x16x32_bf16 v[180:183], a[144:147], a[184:187], v[180:183]
  s_waitcnt lgkmcnt(5)
  v_mfma_f32_16x16x32_bf16 v[180:183], a[148:151], a[192:195], v[180:183]
  v_mfma_f32_16x16x32_bf16 v[188:191], a[148:151], a[196:199], v[188:191]
  ds_read_b128 a[208:211], v16 offset:6272
  v_mfma_f32_16x16x32_bf16 v[188:191], a[144:147], a[188:191], v[188:191]
  v_mfma_f32_16x16x32_bf16 v[160:163], a[152:155], v[48:51], 0
  v_cvt_pk_bf16_f32 v178, v180, v181
  v_cvt_pk_bf16_f32 v179, v182, v183
  v_mfma_f32_16x16x32_bf16 v[160:163], a[156:159], v[64:67], v[160:163]
  ds_read_b128 a[212:215], v17 offset:6272
  v_mfma_f32_16x16x32_bf16 v[160:163], a[160:163], v[80:83], v[160:163]
  s_waitcnt lgkmcnt(5)
  v_cvt_pk_bf16_f32 v186, v188, v189
  v_cvt_pk_bf16_f32 v187, v190, v191
  v_mfma_f32_16x16x32_bf16 v[160:163], a[164:167], v[96:99], v[160:163]
  s_add_u32 s64, s11, 12288
  v_and_b32 v176, -2, v176
  v_mfma_f32_16x16x32_bf16 v[160:163], a[248:251], v[112:115], v[160:163]
  s_waitcnt lgkmcnt(4)
  ds_read_b128 a[216:219], v16 offset:6400
  v_mfma_f32_16x16x32_bf16 v[160:163], a[252:255], v[128:131], v[160:163]
  buffer_store_dwordx4 v[176:179], v37, s[4:7], s64 offen sc1
  v_mfma_f32_16x16x32_bf16 v[164:167], a[252:255], v[132:135], 0
  v_mfma_f32_16x16x32_bf16 v[164:167], a[248:251], v[116:119], v[164:167]
  ds_read_b128 a[220:223], v17 offset:6400
  v_mfma_f32_16x16x32_bf16 v[164:167], a[164:167], v[100:103], v[164:167]
  v_mfma_f32_16x16x32_bf16 v[164:167], a[160:163], v[84:87], v[164:167]
  v_exp_f32 v160, v160
  v_mfma_f32_16x16x32_bf16 v[164:167], a[156:159], v[68:71], v[164:167]
  v_add_f32 v44, v44, v160
  v_mfma_f32_16x16x32_bf16 v[164:167], a[152:155], v[52:55], v[164:167]
  v_mfma_f32_16x16x32_bf16 v[168:171], a[152:155], v[56:59], 0
  v_exp_f32 v161, v161
  v_mfma_f32_16x16x32_bf16 v[168:171], a[156:159], v[72:75], v[168:171]
  v_add_f32 v44, v44, v161
  v_mfma_f32_16x16x32_bf16 v[168:171], a[160:163], v[88:91], v[168:171]
  v_cvt_pk_bf16_f32 v160, v160, v161
  v_mfma_f32_16x16x32_bf16 v[168:171], a[164:167], v[104:107], v[168:171]
  s_add_u32 s87, s13, 14336
  v_and_b32 v184, -2, v184
  v_mfma_f32_16x16x32_bf16 v[168:171], a[248:251], v[120:123], v[168:171]
  v_exp_f32 v162, v162
  v_mfma_f32_16x16x32_bf16 v[168:171], a[252:255], v[136:139], v[168:171]
  buffer_store_dwordx4 v[184:187], v37, s[4:7], s87 offen sc1
  v_mfma_f32_16x16x32_bf16 v[172:175], a[252:255], v[140:143], 0
  s_lshr_b32 s61, s2, 3
  v_exp_f32 v163, v163
  v_mfma_f32_16x16x32_bf16 v[172:175], a[248:251], v[124:127], v[172:175]
  s_waitcnt lgkmcnt(0)
  s_barrier
  v_add_f32 v44, v44, v162
  v_mfma_f32_16x16x32_bf16 v[172:175], a[164:167], v[108:111], v[172:175]
  s_lshl_b32 s61, s61, 2
  v_add_f32 v44, v44, v163
  v_cvt_pk_bf16_f32 v161, v162, v163
  v_mfma_f32_16x16x32_bf16 v[172:175], a[160:163], v[92:95], v[172:175]
  s_add_u32 s61, s61, s72
  v_exp_f32 v164, v164
  v_mfma_f32_16x16x32_bf16 v[172:175], a[156:159], v[76:79], v[172:175]
  s_lshl_b32 s61, s61, 7
  v_add_f32 v45, v45, v164
  v_mfma_f32_16x16x32_bf16 v[172:175], a[152:155], v[60:63], v[172:175]
  s_add_u32 s61, s61, 6144
  v_mfma_f32_16x16x32_bf16 v[176:179], a[200:203], v[48:51], 0
  s_mov_b32 s65, 122880
  v_mov_b32 v25, s61
  v_mfma_f32_16x16x32_bf16 v[176:179], a[204:207], v[64:67], v[176:179]
  s_add_u32 m0, s74, 0
  v_exp_f32 v165, v165
  v_mfma_f32_16x16x32_bf16 v[176:179], a[208:211], v[80:83], v[176:179]
  buffer_load_dwordx4 v31, s[20:23], s65 offen offset:0  lds
  v_mfma_f32_16x16x32_bf16 v[176:179], a[212:215], v[96:99], v[176:179]
  s_getpc_b64 s[82:83]
  v_exp_f32 v166, v166
  v_mfma_f32_16x16x32_bf16 v[176:179], a[216:219], v[112:115], v[176:179]
  global_load_dword v25, v25, s[82:83]
  v_mfma_f32_16x16x32_bf16 v[176:179], a[220:223], v[128:131], v[176:179]
  buffer_load_dwordx4 v32, s[20:23], s65 offen offset:1024  lds
  v_mfma_f32_16x16x32_bf16 v[180:183], a[220:223], v[132:135], 0
  v_exp_f32 v167, v167
  v_mfma_f32_16x16x32_bf16 v[180:183], a[216:219], v[116:119], v[180:183]
  v_add_f32 v45, v45, v165
  v_cvt_pk_bf16_f32 v164, v164, v165
  v_mfma_f32_16x16x32_bf16 v[180:183], a[212:215], v[100:103], v[180:183]
  ds_read_b64_tr_b16 a[224:225], v7 offset:24704
  v_add_f32 v45, v45, v166
  v_mfma_f32_16x16x32_bf16 v[180:183], a[208:211], v[84:87], v[180:183]
  ds_read_b64_tr_b16 a[226:227], v7 offset:30848
  v_add_f32 v45, v45, v167
  v_mfma_f32_16x16x32_bf16 v[180:183], a[204:207], v[68:71], v[180:183]
  ds_read_b64_tr_b16 a[228:229], v7 offset:128
  v_cvt_pk_bf16_f32 v165, v166, v167
  v_mfma_f32_16x16x32_bf16 v[180:183], a[200:203], v[52:55], v[180:183]
  ds_read_b64_tr_b16 a[230:231], v7 offset:6272
  v_mfma_f32_16x16x32_bf16 v[184:187], a[200:203], v[56:59], 0
  buffer_load_dwordx4 v33, s[20:23], s65 offen offset:2048  lds
  v_mfma_f32_16x16x32_bf16 v[184:187], a[204:207], v[72:75], v[184:187]
  v_exp_f32 v168, v168
  v_mfma_f32_16x16x32_bf16 v[184:187], a[208:211], v[88:91], v[184:187]
  v_exp_f32 v169, v169
  v_mfma_f32_16x16x32_bf16 v[184:187], a[212:215], v[104:107], v[184:187]
  v_exp_f32 v170, v170
  v_mfma_f32_16x16x32_bf16 v[184:187], a[216:219], v[120:123], v[184:187]
  s_add_u32 m0, s74, 24576
  ds_read_b64_tr_b16 a[144:145], v8 offset:24704
  v_add_f32 v46, v46, v168
  v_mfma_f32_16x16x32_bf16 v[184:187], a[220:223], v[136:139], v[184:187]
  s_mov_b32 s67, 147456
  ds_read_b64_tr_b16 a[146:147], v8 offset:30848
  v_add_f32 v46, v46, v169
  v_mfma_f32_16x16x32_bf16 v[188:191], a[220:223], v[140:143], 0
  ds_read_b64_tr_b16 a[148:149], v8 offset:128
  v_cvt_pk_bf16_f32 v168, v168, v169
  v_mfma_f32_16x16x32_bf16 v[188:191], a[216:219], v[124:127], v[188:191]
  ds_read_b64_tr_b16 a[150:151], v8 offset:6272
  v_add_f32 v46, v46, v170
  v_mfma_f32_16x16x32_bf16 v[188:191], a[212:215], v[108:111], v[188:191]
  buffer_load_dwordx4 v28, s[16:19], s67 offen offset:0  lds
  v_mfma_f32_16x16x32_bf16 v[188:191], a[208:211], v[92:95], v[188:191]
  v_exp_f32 v171, v171
  v_mfma_f32_16x16x32_bf16 v[188:191], a[204:207], v[76:79], v[188:191]
  s_waitcnt lgkmcnt(6)
  v_exp_f32 v172, v172
  v_mfma_f32_16x16x32_bf16 v[188:191], a[200:203], v[60:63], v[188:191]
  buffer_load_dwordx4 v29, s[16:19], s67 offen offset:1024  lds
  v_mfma_f32_16x16x32_bf16 a[44:47], a[224:227], v[204:207], a[44:47]
  s_waitcnt lgkmcnt(4)
  ds_read_b64_tr_b16 a[152:153], v5 offset:24832
  v_add_f32 v46, v46, v171
  v_mfma_f32_16x16x32_bf16 a[44:47], a[228:231], v[156:159], a[44:47]
  ds_read_b64_tr_b16 a[154:155], v5 offset:30976
  v_cvt_pk_bf16_f32 v169, v170, v171
  v_mfma_f32_16x16x32_bf16 a[40:43], a[228:231], v[152:155], a[40:43]
  ds_read_b64_tr_b16 a[156:157], v5 offset:256
  v_add_f32 v47, v47, v172
  v_mfma_f32_16x16x32_bf16 a[40:43], a[224:227], v[200:203], a[40:43]
  ds_read_b64_tr_b16 a[158:159], v5 offset:6400
  v_mfma_f32_16x16x32_bf16 a[36:39], a[224:227], v[196:199], a[36:39]
  v_exp_f32 v173, v173
  v_mfma_f32_16x16x32_bf16 a[36:39], a[228:231], v[148:151], a[36:39]
  buffer_load_dwordx4 v30, s[16:19], s67 offen offset:2048  lds
  v_mfma_f32_16x16x32_bf16 a[32:35], a[228:231], v[144:147], a[32:35]
  v_exp_f32 v174, v174
  v_mfma_f32_16x16x32_bf16 a[32:35], a[224:227], v[192:195], a[32:35]
  s_waitcnt lgkmcnt(6)
  v_exp_f32 v175, v175
  v_mfma_f32_16x16x32_bf16 a[48:51], a[144:147], v[192:195], a[48:51]
  s_waitcnt lgkmcnt(4)
  ds_read_b64_tr_b16 a[160:161], v6 offset:24832
  v_add_f32 v47, v47, v173
  v_mfma_f32_16x16x32_bf16 a[48:51], a[148:151], v[144:147], a[48:51]
  ds_read_b64_tr_b16 a[162:163], v6 offset:30976
  v_cvt_pk_bf16_f32 v172, v172, v173
  v_mfma_f32_16x16x32_bf16 a[52:55], a[148:151], v[148:151], a[52:55]
  ds_read_b64_tr_b16 a[164:165], v6 offset:256
  v_add_f32 v47, v47, v174
  v_mfma_f32_16x16x32_bf16 a[52:55], a[144:147], v[196:199], a[52:55]
  ds_read_b64_tr_b16 a[166:167], v6 offset:6400
  v_add_f32 v47, v47, v175
  v_mfma_f32_16x16x32_bf16 a[56:59], a[144:147], v[200:203], a[56:59]
  v_exp_f32 v176, v176
  v_mfma_f32_16x16x32_bf16 a[56:59], a[148:151], v[152:155], a[56:59]
  v_exp_f32 v177, v177
  v_mfma_f32_16x16x32_bf16 a[60:63], a[148:151], v[156:159], a[60:63]
  v_cvt_pk_bf16_f32 v173, v174, v175
  v_add_f32 v44, v44, v176
  v_mfma_f32_16x16x32_bf16 a[60:63], a[144:147], v[204:207], a[60:63]
  s_waitcnt lgkmcnt(6)
  v_exp_f32 v178, v178
  v_mfma_f32_16x16x32_bf16 a[76:79], a[152:155], v[204:207], a[76:79]
  s_waitcnt lgkmcnt(4)
  ds_read_b64_tr_b16 a[248:249], v7 offset:24832
  v_add_f32 v44, v44, v177
  v_mfma_f32_16x16x32_bf16 a[76:79], a[156:159], v[156:159], a[76:79]
  ds_read_b64_tr_b16 a[250:251], v7 offset:30976
  v_cvt_pk_bf16_f32 v162, v176, v177
  v_mfma_f32_16x16x32_bf16 a[72:75], a[156:159], v[152:155], a[72:75]
  ds_read_b64_tr_b16 a[252:253], v7 offset:256
  v_add_f32 v44, v44, v178
  v_mfma_f32_16x16x32_bf16 a[72:75], a[152:155], v[200:203], a[72:75]
  ds_read_b64_tr_b16 a[254:255], v7 offset:6400
  v_mfma_f32_16x16x32_bf16 a[68:71], a[152:155], v[196:199], a[68:71]
  v_exp_f32 v179, v179
  v_mfma_f32_16x16x32_bf16 a[68:71], a[156:159], v[148:151], a[68:71]
  v_exp_f32 v180, v180
  v_mfma_f32_16x16x32_bf16 a[64:67], a[156:159], v[144:147], a[64:67]
  v_add_f32 v44, v44, v179
  v_cvt_pk_bf16_f32 v163, v178, v179
  v_mfma_f32_16x16x32_bf16 a[64:67], a[152:155], v[192:195], a[64:67]
  s_waitcnt lgkmcnt(6)
  v_add_f32 v45, v45, v180
  v_mfma_f32_16x16x32_bf16 a[80:83], a[160:163], v[192:195], a[80:83]
  s_waitcnt lgkmcnt(4)
  ds_read_b64_tr_b16 a[200:201], v8 offset:24832
  v_mfma_f32_16x16x32_bf16 a[80:83], a[164:167], v[144:147], a[80:83]
  ds_read_b64_tr_b16 a[202:203], v8 offset:30976
  v_mfma_f32_16x16x32_bf16 a[84:87], a[164:167], v[148:151], a[84:87]
  ds_read_b64_tr_b16 a[204:205], v8 offset:256
  v_mfma_f32_16x16x32_bf16 a[84:87], a[160:163], v[196:199], a[84:87]
  ds_read_b64_tr_b16 a[206:207], v8 offset:6400
  v_mfma_f32_16x16x32_bf16 a[88:91], a[160:163], v[200:203], a[88:91]
  v_exp_f32 v181, v181
  v_mfma_f32_16x16x32_bf16 a[88:91], a[164:167], v[152:155], a[88:91]
  v_exp_f32 v182, v182
  v_mfma_f32_16x16x32_bf16 a[92:95], a[164:167], v[156:159], a[92:95]
  v_exp_f32 v183, v183
  v_mfma_f32_16x16x32_bf16 a[92:95], a[160:163], v[204:207], a[92:95]
  s_waitcnt lgkmcnt(6)
  v_add_f32 v45, v45, v181
  v_cvt_pk_bf16_f32 v166, v180, v181
  v_mfma_f32_16x16x32_bf16 a[108:111], a[248:251], v[204:207], a[108:111]
  s_waitcnt lgkmcnt(4)
  v_add_f32 v45, v45, v182
  v_cvt_pk_bf16_f32 v167, v182, v183
  v_mfma_f32_16x16x32_bf16 a[108:111], a[252:255], v[156:159], a[108:111]
  v_exp_f32 v184, v184
  v_mfma_f32_16x16x32_bf16 a[104:107], a[252:255], v[152:155], a[104:107]
  v_add_f32 v45, v45, v183
  v_add_f32 v46, v46, v184
  v_mfma_f32_16x16x32_bf16 a[104:107], a[248:251], v[200:203], a[104:107]
  v_mfma_f32_16x16x32_bf16 a[100:103], a[248:251], v[196:199], a[100:103]
  ds_read_b64_tr_b16 a[208:209], v12 offset:36992
  v_mfma_f32_16x16x32_bf16 a[100:103], a[252:255], v[148:151], a[100:103]
  ds_read_b64_tr_b16 a[210:211], v12 offset:43136
  v_mfma_f32_16x16x32_bf16 a[96:99], a[252:255], v[144:147], a[96:99]
  ds_read_b64_tr_b16 a[212:213], v12 offset:49280
  v_mfma_f32_16x16x32_bf16 a[96:99], a[248:251], v[192:195], a[96:99]
  s_waitcnt lgkmcnt(5)
  ds_read_b64_tr_b16 a[214:215], v12 offset:55424
  v_mfma_f32_16x16x32_bf16 a[112:115], a[200:203], v[192:195], a[112:115]
  s_waitcnt lgkmcnt(4)
  ds_read_b64_tr_b16 a[216:217], v4 offset:12416
  v_mfma_f32_16x16x32_bf16 a[112:115], a[204:207], v[144:147], a[112:115]
  ds_read_b64_tr_b16 a[218:219], v4 offset:18560
  v_mfma_f32_16x16x32_bf16 a[116:119], a[204:207], v[148:151], a[116:119]
  ds_read_b64_tr_b16 a[220:221], v4 offset:36992
  v_mfma_f32_16x16x32_bf16 a[116:119], a[200:203], v[196:199], a[116:119]
  ds_read_b64_tr_b16 a[222:223], v4 offset:43136
  v_mfma_f32_16x16x32_bf16 a[120:123], a[200:203], v[200:203], a[120:123]
  ds_read_b64_tr_b16 a[224:225], v8 offset:36992
  v_mfma_f32_16x16x32_bf16 a[120:123], a[204:207], v[152:155], a[120:123]
  ds_read_b64_tr_b16 a[226:227], v8 offset:43136
  v_mfma_f32_16x16x32_bf16 a[124:127], a[204:207], v[156:159], a[124:127]
  ds_read_b64_tr_b16 a[228:229], v12 offset:12416
  v_mfma_f32_16x16x32_bf16 a[124:127], a[200:203], v[204:207], a[124:127]
  s_waitcnt lgkmcnt(9)
  ds_read_b64_tr_b16 a[230:231], v12 offset:18560
  v_mfma_f32_16x16x32_bf16 v[192:195], a[208:211], a[128:131], 0
  s_waitcnt lgkmcnt(8)
  v_exp_f32 v185, v185
  v_mfma_f32_16x16x32_bf16 v[192:195], a[212:215], a[136:139], v[192:195]
  ds_read_b64_tr_b16 a[144:145], v11 offset:36992
  ds_read_b64_tr_b16 a[148:149], v11 offset:49280
  v_mfma_f32_16x16x32_bf16 v[200:203], a[212:215], a[140:143], 0
  ds_read_b64_tr_b16 a[146:147], v11 offset:43136
  v_add_f32 v46, v46, v185
  v_mfma_f32_16x16x32_bf16 v[200:203], a[208:211], a[132:135], v[200:203]
  s_waitcnt lgkmcnt(9)
  ds_read_b64_tr_b16 a[150:151], v11 offset:55424
  v_cvt_pk_bf16_f32 v170, v184, v185
  v_mfma_f32_16x16x32_bf16 v[200:203], a[216:219], a[172:175], v[200:203]
  s_waitcnt lgkmcnt(8)
  v_exp_f32 v186, v186
  v_mfma_f32_16x16x32_bf16 v[200:203], a[220:223], a[180:183], v[200:203]
  ds_read_b64_tr_b16 a[152:153], v3 offset:12416
  ds_read_b64_tr_b16 a[156:157], v3 offset:36992
  v_mfma_f32_16x16x32_bf16 v[192:195], a[220:223], a[176:179], v[192:195]
  ds_read_b64_tr_b16 a[154:155], v3 offset:18560
  v_add_f32 v46, v46, v186
  v_mfma_f32_16x16x32_bf16 v[192:195], a[216:219], a[168:171], v[192:195]
  s_waitcnt lgkmcnt(9)
  ds_read_b64_tr_b16 a[158:159], v3 offset:43136
  v_mfma_f32_16x16x32_bf16 v[192:195], a[224:227], a[184:187], v[192:195]
  s_waitcnt lgkmcnt(8)
  v_exp_f32 v187, v187
  v_mfma_f32_16x16x32_bf16 v[192:195], a[228:231], a[192:195], v[192:195]
  ds_read_b64_tr_b16 a[160:161], v7 offset:36992
  ds_read_b64_tr_b16 a[162:163], v7 offset:43136
  v_mfma_f32_16x16x32_bf16 v[200:203], a[228:231], a[196:199], v[200:203]
  ds_read_b64_tr_b16 a[164:165], v11 offset:12416
  v_cvt_pk_bf16_f32 v171, v186, v187
  v_mfma_f32_16x16x32_bf16 v[200:203], a[224:227], a[188:191], v[200:203]
  s_waitcnt lgkmcnt(8)
  ds_read_b64_tr_b16 a[166:167], v11 offset:18560
  v_add_f32 v46, v46, v187
  v_mfma_f32_16x16x32_bf16 v[196:199], a[144:147], a[128:131], 0
  s_waitcnt lgkmcnt(8)
  v_exp_f32 v188, v188
  v_mfma_f32_16x16x32_bf16 v[196:199], a[148:151], a[136:139], v[196:199]
L_pg12:
  s_cbranch_execz L_hop2
  ds_read_b64_tr_b16 a[248:249], v9 offset:37120
  ds_read_b64_tr_b16 a[252:253], v9 offset:49408
  v_mfma_f32_16x16x32_bf16 v[204:207], a[148:151], a[140:143], 0
  ds_read_b64_tr_b16 a[250:251], v9 offset:43264
  v_add_f32 v47, v47, v188
  v_mfma_f32_16x16x32_bf16 v[204:207], a[144:147], a[132:135], v[204:207]
  s_waitcnt lgkmcnt(8)
  ds_read_b64_tr_b16 a[254:255], v9 offset:55552
  v_cvt_pk_bf16_f32 v192, v192, v193
  v_mfma_f32_16x16x32_bf16 v[204:207], a[152:155], a[172:175], v[204:207]
  s_waitcnt lgkmcnt(8)
  v_exp_f32 v189, v189
  v_mfma_f32_16x16x32_bf16 v[204:207], a[156:159], a[180:183], v[204:207]
  ds_read_b64_tr_b16 a[200:201], v1 offset:12544
  ds_read_b64_tr_b16 a[204:205], v1 offset:37120
  v_mfma_f32_16x16x32_bf16 v[196:199], a[156:159], a[176:179], v[196:199]
  ds_read_b64_tr_b16 a[202:203], v1 offset:18688
  v_add_f32 v47, v47, v189
  v_mfma_f32_16x16x32_bf16 v[196:199], a[152:155], a[168:171], v[196:199]
  s_waitcnt lgkmcnt(9)
  ds_read_b64_tr_b16 a[206:207], v1 offset:43264
  v_cvt_pk_bf16_f32 v174, v188, v189
  v_mfma_f32_16x16x32_bf16 v[196:199], a[160:163], a[184:187], v[196:199]
  s_waitcnt lgkmcnt(8)
  v_exp_f32 v190, v190
  v_mfma_f32_16x16x32_bf16 v[196:199], a[164:167], a[192:195], v[196:199]
  ds_read_b64_tr_b16 a[208:209], v5 offset:37120
  ds_read_b64_tr_b16 a[210:211], v5 offset:43264
  v_mfma_f32_16x16x32_bf16 v[204:207], a[164:167], a[196:199], v[204:207]
  ds_read_b64_tr_b16 a[212:213], v9 offset:12544
  v_add_f32 v47, v47, v190
  v_mfma_f32_16x16x32_bf16 v[204:207], a[160:163], a[188:191], v[204:207]
  s_waitcnt lgkmcnt(8)
  ds_read_b64_tr_b16 a[214:215], v9 offset:18688
  v_cvt_pk_bf16_f32 v193, v194, v195
  v_mfma_f32_16x16x32_bf16 v[176:179], a[248:251], a[128:131], 0
  s_waitcnt lgkmcnt(8)
  v_exp_f32 v191, v191
  v_mfma_f32_16x16x32_bf16 v[176:179], a[252:255], a[136:139], v[176:179]
  ds_read_b64_tr_b16 a[216:217], v10 offset:37120
  ds_read_b64_tr_b16 a[220:221], v10 offset:49408
  v_mfma_f32_16x16x32_bf16 v[184:187], a[252:255], a[140:143], 0
  ds_read_b64_tr_b16 a[218:219], v10 offset:43264
  v_add_f32 v47, v47, v191
  v_mfma_f32_16x16x32_bf16 v[184:187], a[248:251], a[132:135], v[184:187]
  s_waitcnt lgkmcnt(8)
  ds_read_b64_tr_b16 a[222:223], v10 offset:55552
  v_cvt_pk_bf16_f32 v175, v190, v191
  v_mfma_f32_16x16x32_bf16 v[184:187], a[200:203], a[172:175], v[184:187]
  s_waitcnt lgkmcnt(8)
  ds_read_b64_tr_b16 a[224:225], v2 offset:12544
  v_cvt_pk_bf16_f32 v200, v200, v201
  v_mfma_f32_16x16x32_bf16 v[184:187], a[204:207], a[180:183], v[184:187]
  ds_read_b64_tr_b16 a[226:227], v2 offset:18688
  ds_read_b64_tr_b16 a[228:229], v2 offset:37120
  v_mfma_f32_16x16x32_bf16 v[176:179], a[204:207], a[176:179], v[176:179]
  v_cvt_pk_bf16_f32 v201, v202, v203
  v_and_b32 v192, -2, v192
  v_mfma_f32_16x16x32_bf16 v[176:179], a[200:203], a[168:171], v[176:179]
  s_waitcnt lgkmcnt(7)
  ds_read_b64_tr_b16 a[230:231], v2 offset:43264
  v_cvt_pk_bf16_f32 v194, v196, v197
  v_mfma_f32_16x16x32_bf16 v[176:179], a[208:211], a[184:187], v[176:179]
  s_add_u32 s66, s12, 13312
  ds_read_b64_tr_b16 a[144:145], v6 offset:37120
  v_cvt_pk_bf16_f32 v195, v198, v199
  v_mfma_f32_16x16x32_bf16 v[176:179], a[212:215], a[192:195], v[176:179]
  ds_read_b64_tr_b16 a[146:147], v6 offset:43264
  ds_read_b128 a[156:159], v19 offset:12288
  v_mfma_f32_16x16x32_bf16 v[184:187], a[212:215], a[196:199], v[184:187]
  ds_read_b64_tr_b16 a[148:149], v10 offset:12544
  v_cvt_pk_bf16_f32 v202, v204, v205
  v_mfma_f32_16x16x32_bf16 v[184:187], a[208:211], a[188:191], v[184:187]
  s_waitcnt lgkmcnt(8)
  ds_read_b64_tr_b16 a[150:151], v10 offset:18688
  ds_read_b128 a[152:155], v18 offset:12288
  v_mfma_f32_16x16x32_bf16 v[180:183], a[216:219], a[128:131], 0
  buffer_store_dwordx4 v[192:195], v37, s[4:7], s66 offen sc1
  v_mfma_f32_16x16x32_bf16 v[180:183], a[220:223], a[136:139], v[180:183]
  ds_read_b128 a[160:163], v18 offset:12416
  ds_read_b128 a[164:167], v19 offset:12416
  v_mfma_f32_16x16x32_bf16 v[188:191], a[220:223], a[140:143], 0
  s_waitcnt lgkmcnt(10)
  ds_read_b128 a[248:251], v18 offset:12544
  v_cvt_pk_bf16_f32 v203, v206, v207
  v_mfma_f32_16x16x32_bf16 v[188:191], a[216:219], a[132:135], v[188:191]
  s_add_u32 s62, s14, 15360
  ds_read_b128 a[252:255], v19 offset:12544
  v_and_b32 v200, -2, v200
  v_mfma_f32_16x16x32_bf16 v[188:191], a[224:227], a[172:175], v[188:191]
  s_waitcnt lgkmcnt(10)
  v_cvt_pk_bf16_f32 v176, v176, v177
  v_cvt_pk_bf16_f32 v177, v178, v179
  v_mfma_f32_16x16x32_bf16 v[188:191], a[228:231], a[180:183], v[188:191]
  buffer_store_dwordx4 v[200:203], v37, s[4:7], s62 offen sc1
  v_mfma_f32_16x16x32_bf16 v[180:183], a[228:231], a[176:179], v[180:183]
  ds_read_b128 a[200:203], v18 offset:18432
  v_cvt_pk_bf16_f32 v184, v184, v185
  v_mfma_f32_16x16x32_bf16 v[180:183], a[224:227], a[168:171], v[180:183]
  s_waitcnt lgkmcnt(9)
  ds_read_b128 a[204:207], v19 offset:18432
  v_cvt_pk_bf16_f32 v185, v186, v187
  v_mfma_f32_16x16x32_bf16 v[180:183], a[144:147], a[184:187], v[180:183]
  s_waitcnt lgkmcnt(7)
  v_mfma_f32_16x16x32_bf16 v[180:183], a[148:151], a[192:195], v[180:183]
  v_mfma_f32_16x16x32_bf16 v[188:191], a[148:151], a[196:199], v[188:191]
  ds_read_b128 a[208:211], v18 offset:18560
  v_mfma_f32_16x16x32_bf16 v[188:191], a[144:147], a[188:191], v[188:191]
  s_waitcnt lgkmcnt(7)
  v_mfma_f32_16x16x32_bf16 v[192:195], a[152:155], v[48:51], 0
  v_cvt_pk_bf16_f32 v178, v180, v181
  v_cvt_pk_bf16_f32 v179, v182, v183
  v_mfma_f32_16x16x32_bf16 v[192:195], a[156:159], v[64:67], v[192:195]
  s_waitcnt lgkmcnt(6)
  ds_read_b128 a[212:215], v19 offset:18560
  v_mfma_f32_16x16x32_bf16 v[192:195], a[160:163], v[80:83], v[192:195]
  s_waitcnt lgkmcnt(5)
  v_permlane32_swap_b32 v176, v178
  v_permlane32_swap_b32 v177, v179
  v_mfma_f32_16x16x32_bf16 v[192:195], a[164:167], v[96:99], v[192:195]
  s_add_u32 s50, s11, s86
  v_cvt_pk_bf16_f32 v186, v188, v189
  v_and_b32 v176, -2, v176
  v_mfma_f32_16x16x32_bf16 v[192:195], a[248:251], v[112:115], v[192:195]
  s_waitcnt lgkmcnt(4)
  ds_read_b128 a[216:219], v18 offset:18688
  v_cvt_pk_bf16_f32 v187, v190, v191
  v_mfma_f32_16x16x32_bf16 v[192:195], a[252:255], v[128:131], v[192:195]
  buffer_store_dwordx4 v[176:179], v13, s[4:7], s50 offen sc1
  v_mfma_f32_16x16x32_bf16 v[196:199], a[252:255], v[132:135], 0
  v_mfma_f32_16x16x32_bf16 v[196:199], a[248:251], v[116:119], v[196:199]
  ds_read_b128 a[220:223], v19 offset:18688
  v_mfma_f32_16x16x32_bf16 v[196:199], a[164:167], v[100:103], v[196:199]
  v_mfma_f32_16x16x32_bf16 v[196:199], a[160:163], v[84:87], v[196:199]
  v_exp_f32 v192, v192
  v_mfma_f32_16x16x32_bf16 v[196:199], a[156:159], v[68:71], v[196:199]
  v_add_f32 v44, v44, v192
  v_mfma_f32_16x16x32_bf16 v[196:199], a[152:155], v[52:55], v[196:199]
  v_mfma_f32_16x16x32_bf16 v[200:203], a[152:155], v[56:59], 0
  v_exp_f32 v193, v193
  v_mfma_f32_16x16x32_bf16 v[200:203], a[156:159], v[72:75], v[200:203]
  v_add_f32 v44, v44, v193
  v_mfma_f32_16x16x32_bf16 v[200:203], a[160:163], v[88:91], v[200:203]
  v_permlane32_swap_b32 v184, v186
  v_permlane32_swap_b32 v185, v187
  v_mfma_f32_16x16x32_bf16 v[200:203], a[164:167], v[104:107], v[200:203]
  s_add_u32 s63, s13, s86
  v_and_b32 v184, -2, v184
  v_cvt_pk_bf16_f32 v192, v192, v193
  v_mfma_f32_16x16x32_bf16 v[200:203], a[248:251], v[120:123], v[200:203]
  v_exp_f32 v194, v194
  v_mfma_f32_16x16x32_bf16 v[200:203], a[252:255], v[136:139], v[200:203]
  buffer_store_dwordx4 v[184:187], v13, s[4:7], s63 offen sc1
  v_mfma_f32_16x16x32_bf16 v[204:207], a[252:255], v[140:143], 0
  v_add_f32 v44, v44, v194
  v_mfma_f32_16x16x32_bf16 v[204:207], a[248:251], v[124:127], v[204:207]
  s_waitcnt vmcnt(17) lgkmcnt(0)
  s_barrier
  v_exp_f32 v195, v195
  v_mfma_f32_16x16x32_bf16 v[204:207], a[164:167], v[108:111], v[204:207]
  v_add_f32 v44, v44, v195
  v_cvt_pk_bf16_f32 v193, v194, v195
  v_mfma_f32_16x16x32_bf16 v[204:207], a[160:163], v[92:95], v[204:207]
  v_exp_f32 v196, v196
  v_mfma_f32_16x16x32_bf16 v[204:207], a[156:159], v[76:79], v[204:207]
  s_add_u32 m0, s74, 61440
  v_add_f32 v45, v45, v196
  v_mfma_f32_16x16x32_bf16 v[204:207], a[152:155], v[60:63], v[204:207]
  s_mov_b32 s48, 135168
  v_mfma_f32_16x16x32_bf16 v[176:179], a[200:203], v[48:51], 0
  buffer_load_dwordx4 v31, s[20:23], s48 offen offset:0  lds
  v_mfma_f32_16x16x32_bf16 v[176:179], a[204:207], v[64:67], v[176:179]
  v_exp_f32 v197, v197
  v_mfma_f32_16x16x32_bf16 v[176:179], a[208:211], v[80:83], v[176:179]
  v_add_f32 v45, v45, v197
  v_cvt_pk_bf16_f32 v196, v196, v197
  v_mfma_f32_16x16x32_bf16 v[176:179], a[212:215], v[96:99], v[176:179]
  v_exp_f32 v198, v198
  v_mfma_f32_16x16x32_bf16 v[176:179], a[216:219], v[112:115], v[176:179]
  v_add_f32 v45, v45, v198
  v_mfma_f32_16x16x32_bf16 v[176:179], a[220:223], v[128:131], v[176:179]
  buffer_load_dwordx4 v32, s[20:23], s48 offen offset:1024  lds
  v_mfma_f32_16x16x32_bf16 v[180:183], a[220:223], v[132:135], 0
  v_exp_f32 v199, v199
  v_mfma_f32_16x16x32_bf16 v[180:183], a[216:219], v[116:119], v[180:183]
  v_add_f32 v45, v45, v199
  v_mfma_f32_16x16x32_bf16 v[180:183], a[212:215], v[100:103], v[180:183]
  ds_read_b64_tr_b16 a[224:225], v5 offset:0
  v_cvt_pk_bf16_f32 v197, v198, v199
  v_mfma_f32_16x16x32_bf16 v[180:183], a[208:211], v[84:87], v[180:183]
  ds_read_b64_tr_b16 a[226:227], v5 offset:6144
  v_mfma_f32_16x16x32_bf16 v[180:183], a[204:207], v[68:71], v[180:183]
  ds_read_b64_tr_b16 a[228:229], v9 offset:24576
  v_mfma_f32_16x16x32_bf16 v[180:183], a[200:203], v[52:55], v[180:183]
  ds_read_b64_tr_b16 a[230:231], v9 offset:30720
  v_mfma_f32_16x16x32_bf16 v[184:187], a[200:203], v[56:59], 0
  buffer_load_dwordx4 v33, s[20:23], s48 offen offset:2048  lds
  v_mfma_f32_16x16x32_bf16 v[184:187], a[204:207], v[72:75], v[184:187]
  v_exp_f32 v200, v200
  v_mfma_f32_16x16x32_bf16 v[184:187], a[208:211], v[88:91], v[184:187]
  v_add_f32 v46, v46, v200
  v_mfma_f32_16x16x32_bf16 v[184:187], a[212:215], v[104:107], v[184:187]
  v_exp_f32 v201, v201
  v_mfma_f32_16x16x32_bf16 v[184:187], a[216:219], v[120:123], v[184:187]
  s_add_u32 m0, s74, 73728
  ds_read_b64_tr_b16 a[144:145], v6 offset:0
  v_add_f32 v46, v46, v201
  v_mfma_f32_16x16x32_bf16 v[184:187], a[220:223], v[136:139], v[184:187]
  s_mov_b32 s99, 159744
  ds_read_b64_tr_b16 a[146:147], v6 offset:6144
  v_lshrrev_b32 v26, 4, v37
  v_mfma_f32_16x16x32_bf16 v[188:191], a[220:223], v[140:143], 0
  v_and_b32 v27, 15, v26
  v_lshrrev_b32 v26, 4, v26
  v_mfma_f32_16x16x32_bf16 v[188:191], a[216:219], v[124:127], v[188:191]
  ds_read_b64_tr_b16 a[148:149], v10 offset:24576
  v_lshlrev_b32 v26, 2, v26
  v_mfma_f32_16x16x32_bf16 v[188:191], a[212:215], v[108:111], v[188:191]
  ds_read_b64_tr_b16 a[150:151], v10 offset:30720
  v_sub_u32 v26, v27, v26
  v_mfma_f32_16x16x32_bf16 v[188:191], a[208:211], v[92:95], v[188:191]
  buffer_load_dwordx4 v28, s[16:19], s99 offen offset:0  lds
  v_mfma_f32_16x16x32_bf16 v[188:191], a[204:207], v[76:79], v[188:191]
  s_waitcnt lgkmcnt(6)
  v_cvt_pk_bf16_f32 v200, v200, v201
  v_lshlrev_b32 v42, 3, v37
  v_mfma_f32_16x16x32_bf16 v[188:191], a[200:203], v[60:63], v[188:191]
  buffer_load_dwordx4 v29, s[16:19], s99 offen offset:1024  lds
  v_mfma_f32_16x16x32_bf16 v[220:223], a[224:227], v[156:159], v[220:223]
  s_waitcnt lgkmcnt(4)
  v_mov_b32 v27, 0x3f80
  v_min_u32 v42, 3968, v42
  v_mfma_f32_16x16x32_bf16 v[220:223], a[228:231], v[172:175], v[220:223]
  ds_read_b64_tr_b16 a[152:153], v7 offset:0
  ds_read_b64_tr_b16 a[154:155], v7 offset:6144
  v_mfma_f32_16x16x32_bf16 v[216:219], a[228:231], v[168:171], v[216:219]
  ds_read_b64_tr_b16 a[156:157], v11 offset:24576
  v_mfma_f32_16x16x32_bf16 v[216:219], a[224:227], v[152:155], v[216:219]
  ds_read_b64_tr_b16 a[158:159], v11 offset:30720
  v_mfma_f32_16x16x32_bf16 v[212:215], a[224:227], v[148:151], v[212:215]
  v_exp_f32 v202, v202
  v_mfma_f32_16x16x32_bf16 v[212:215], a[228:231], v[164:167], v[212:215]
  v_mov_b32 v41, s40
  v_add_f32 v46, v46, v202
  v_mfma_f32_16x16x32_bf16 v[208:211], a[228:231], v[160:163], v[208:211]
  s_waitcnt lgkmcnt(6)
  v_add_u32 v41, 1, v41
  v_mfma_f32_16x16x32_bf16 v[208:211], a[224:227], v[144:147], v[208:211]
  buffer_load_dwordx4 v30, s[16:19], s99 offen offset:2048  lds
  v_mfma_f32_16x16x32_bf16 v[224:227], a[144:147], v[144:147], v[224:227]
  s_waitcnt lgkmcnt(4)
  ds_read_b64_tr_b16 a[160:161], v8 offset:0
  v_mfma_f32_16x16x32_bf16 v[224:227], a[148:151], v[160:163], v[224:227]
  ds_read_b64_tr_b16 a[162:163], v8 offset:6144
  v_mfma_f32_16x16x32_bf16 v[228:231], a[148:151], v[164:167], v[228:231]
  s_lshr_b32 s49, s2, 3
  ds_read_b64_tr_b16 a[164:165], v12 offset:24576
  v_mfma_f32_16x16x32_bf16 v[228:231], a[144:147], v[148:151], v[228:231]
  s_lshl_b32 s49, s49, 2
  ds_read_b64_tr_b16 a[166:167], v12 offset:30720
  v_mfma_f32_16x16x32_bf16 v[232:235], a[144:147], v[152:155], v[232:235]
  s_add_u32 m0, s74, 135168
  v_exp_f32 v203, v203
  v_mfma_f32_16x16x32_bf16 v[232:235], a[148:151], v[168:171], v[232:235]
  s_mov_b32 s52, 147456
  v_add_f32 v46, v46, v203
  v_cvt_pk_bf16_f32 v201, v202, v203
  v_mfma_f32_16x16x32_bf16 v[236:239], a[148:151], v[172:175], v[236:239]
  s_lshr_b32 s54, s2, 3
  v_exp_f32 v204, v204
  v_mfma_f32_16x16x32_bf16 v[236:239], a[144:147], v[156:159], v[236:239]
  s_waitcnt lgkmcnt(4)
  buffer_load_dwordx4 v31, s[20:23], s52 offen offset:0  lds
  v_mfma_f32_16x16x32_bf16 v[252:255], a[152:155], v[156:159], v[252:255]
  s_lshl_b32 s54, s54, 2
  ds_read_b64_tr_b16 a[248:249], v5 offset:128
  v_add_f32 v47, v47, v204
  v_mfma_f32_16x16x32_bf16 v[252:255], a[156:159], v[172:175], v[252:255]
  s_add_u32 s49, s49, s72
  v_exp_f32 v205, v205
  v_mfma_f32_16x16x32_bf16 v[248:251], a[156:159], v[168:171], v[248:251]
  s_lshl_b32 s51, s44, 9
  ds_read_b64_tr_b16 a[250:251], v5 offset:6272
  v_add_f32 v47, v47, v205
  v_mfma_f32_16x16x32_bf16 v[248:251], a[152:155], v[152:155], v[248:251]
  s_add_u32 s49, s49, s51
  ds_read_b64_tr_b16 a[252:253], v9 offset:24704
  ds_read_b64_tr_b16 a[254:255], v9 offset:30848
  v_mfma_f32_16x16x32_bf16 v[244:247], a[152:155], v[148:151], v[244:247]
  s_mul_i32 s49, s49, 1920
  v_exp_f32 v206, v206
  v_mfma_f32_16x16x32_bf16 v[244:247], a[156:159], v[164:167], v[244:247]
  buffer_load_dwordx4 v32, s[20:23], s52 offen offset:1024  lds
  v_mfma_f32_16x16x32_bf16 v[240:243], a[156:159], v[160:163], v[240:243]
  v_cvt_pk_bf16_f32 v204, v204, v205
  v_add_f32 v47, v47, v206
  v_mfma_f32_16x16x32_bf16 v[240:243], a[152:155], v[144:147], v[240:243]
  s_waitcnt lgkmcnt(4)
  v_exp_f32 v207, v207
  v_mfma_f32_16x16x32_bf16 a[232:235], a[160:163], v[144:147], a[232:235]
  buffer_load_dword v23, v24, s[24:27], s49 offen
  v_mfma_f32_16x16x32_bf16 a[232:235], a[164:167], v[160:163], a[232:235]
  s_add_u32 s54, s54, s72
  ds_read_b64_tr_b16 a[200:201], v6 offset:128
  ds_read_b64_tr_b16 a[202:203], v6 offset:6272
  v_mfma_f32_16x16x32_bf16 a[236:239], a[164:167], v[164:167], a[236:239]
  s_lshl_b32 s53, s44, 9
  ds_read_b64_tr_b16 a[204:205], v10 offset:24704
  v_add_f32 v47, v47, v207
  v_mfma_f32_16x16x32_bf16 a[236:239], a[160:163], v[148:151], a[236:239]
  s_add_u32 s54, s54, s53
  ds_read_b64_tr_b16 a[206:207], v10 offset:30848
  v_cvt_pk_bf16_f32 v205, v206, v207
  v_mfma_f32_16x16x32_bf16 a[240:243], a[160:163], v[152:155], a[240:243]
  s_add_u32 s54, s54, 128
  v_exp_f32 v176, v176
  v_mfma_f32_16x16x32_bf16 a[240:243], a[164:167], v[168:171], a[240:243]
  s_mul_i32 s54, s54, 1920
  ds_read_b128 a[212:215], v21 offset:0
  v_add_f32 v44, v44, v176
  v_mfma_f32_16x16x32_bf16 a[244:247], a[164:167], v[172:175], a[244:247]
  buffer_load_dword v23, v24, s[24:27], s54 offen
  v_mfma_f32_16x16x32_bf16 a[244:247], a[160:163], v[156:159], a[244:247]
  s_waitcnt lgkmcnt(5)
  buffer_load_dwordx4 v33, s[20:23], s52 offen offset:2048  lds
  v_mfma_f32_16x16x32_bf16 a[12:15], a[248:251], v[156:159], a[12:15]
  s_add_u32 m0, s74, 147456
  v_exp_f32 v177, v177
  v_mfma_f32_16x16x32_bf16 a[12:15], a[252:255], v[172:175], a[12:15]
  s_mov_b32 s56, 172032
  v_add_f32 v44, v44, v177
  v_cvt_pk_bf16_f32 v194, v176, v177
  v_mfma_f32_16x16x32_bf16 a[8:11], a[252:255], v[168:171], a[8:11]
  v_exp_f32 v178, v178
  v_mfma_f32_16x16x32_bf16 a[8:11], a[248:251], v[152:155], a[8:11]
  buffer_load_dwordx4 v28, s[16:19], s56 offen offset:0  lds
  v_mfma_f32_16x16x32_bf16 a[4:7], a[248:251], v[148:151], a[4:7]
  ds_read_b128 a[208:211], v20 offset:0
  v_add_f32 v44, v44, v178
  v_mfma_f32_16x16x32_bf16 a[4:7], a[252:255], v[164:167], a[4:7]
  v_exp_f32 v179, v179
  v_mfma_f32_16x16x32_bf16 a[0:3], a[252:255], v[160:163], a[0:3]
  ds_read_b128 a[216:219], v20 offset:128
  v_add_f32 v44, v44, v179
  v_mfma_f32_16x16x32_bf16 a[0:3], a[248:251], v[144:147], a[0:3]
  s_waitcnt lgkmcnt(5)
  ds_read_b128 a[220:223], v21 offset:128
  ds_read_b128 a[224:227], v20 offset:256
  v_mfma_f32_16x16x32_bf16 a[16:19], a[200:203], v[144:147], a[16:19]
  s_waitcnt lgkmcnt(5)
  v_exp_f32 v180, v180
  v_mfma_f32_16x16x32_bf16 a[16:19], a[204:207], v[160:163], a[16:19]
  buffer_load_dwordx4 v29, s[16:19], s56 offen offset:1024  lds
  v_mfma_f32_16x16x32_bf16 a[20:23], a[204:207], v[164:167], a[20:23]
  ds_read_b128 a[228:231], v21 offset:256
  v_cvt_pk_bf16_f32 v195, v178, v179
  v_mfma_f32_16x16x32_bf16 a[20:23], a[200:203], v[148:151], a[20:23]
  s_waitcnt vmcnt(13)
  buffer_store_dword v41, v0, s[4:7], s42 offen offset:0 sc1
  v_mfma_f32_16x16x32_bf16 a[24:27], a[200:203], v[152:155], a[24:27]
  ds_read_b128 a[144:147], v20 offset:6144
  v_add_f32 v45, v45, v180
  v_mfma_f32_16x16x32_bf16 a[24:27], a[204:207], v[168:171], a[24:27]
  v_exp_f32 v181, v181
  v_mfma_f32_16x16x32_bf16 a[28:31], a[204:207], v[172:175], a[28:31]
  v_add_f32 v45, v45, v181
  v_cvt_pk_bf16_f32 v198, v180, v181
  v_mfma_f32_16x16x32_bf16 a[28:31], a[200:203], v[156:159], a[28:31]
  s_waitcnt lgkmcnt(5)
  v_exp_f32 v182, v182
  v_mfma_f32_16x16x32_bf16 v[144:147], a[208:211], v[48:51], 0
  buffer_load_dwordx4 v30, s[16:19], s56 offen offset:2048  lds
  v_mfma_f32_16x16x32_bf16 v[144:147], a[212:215], v[64:67], v[144:147]
  s_waitcnt lgkmcnt(4)
  ds_read_b128 a[148:151], v21 offset:6144
  v_add_f32 v45, v45, v182
  v_mfma_f32_16x16x32_bf16 v[144:147], a[216:219], v[80:83], v[144:147]
  s_waitcnt lgkmcnt(4)
  v_exp_f32 v183, v183
  v_mfma_f32_16x16x32_bf16 v[144:147], a[220:223], v[96:99], v[144:147]
  s_waitcnt lgkmcnt(3)
  v_add_f32 v45, v45, v183
  v_cvt_pk_bf16_f32 v199, v182, v183
  v_mfma_f32_16x16x32_bf16 v[144:147], a[224:227], v[112:115], v[144:147]
  s_waitcnt lgkmcnt(2)
  v_exp_f32 v184, v184
  v_mfma_f32_16x16x32_bf16 v[144:147], a[228:231], v[128:131], v[144:147]
  ds_read_b128 a[152:155], v20 offset:6272
  v_add_f32 v46, v46, v184
  v_mfma_f32_16x16x32_bf16 v[148:151], a[228:231], v[132:135], 0
  v_exp_f32 v185, v185
  v_mfma_f32_16x16x32_bf16 v[148:151], a[224:227], v[116:119], v[148:151]
  ds_read_b128 a[156:159], v21 offset:6272
  v_add_f32 v46, v46, v185
  v_mfma_f32_16x16x32_bf16 v[148:151], a[220:223], v[100:103], v[148:151]
  v_exp_f32 v186, v186
  v_mfma_f32_16x16x32_bf16 v[148:151], a[216:219], v[84:87], v[148:151]
  ds_read_b128 a[160:163], v20 offset:6400
  v_cvt_pk_bf16_f32 v202, v184, v185
  v_mfma_f32_16x16x32_bf16 v[148:151], a[212:215], v[68:71], v[148:151]
  v_add_f32 v46, v46, v186
  v_mfma_f32_16x16x32_bf16 v[148:151], a[208:211], v[52:55], v[148:151]
  ds_read_b128 a[164:167], v21 offset:6400
  v_mfma_f32_16x16x32_bf16 v[152:155], a[208:211], v[56:59], 0
  v_exp_f32 v187, v187
  v_mfma_f32_16x16x32_bf16 v[152:155], a[212:215], v[72:75], v[152:155]
  v_add_f32 v46, v46, v187
  v_cvt_pk_bf16_f32 v203, v186, v187
  v_mfma_f32_16x16x32_bf16 v[152:155], a[216:219], v[88:91], v[152:155]
  v_exp_f32 v188, v188
  v_mfma_f32_16x16x32_bf16 v[152:155], a[220:223], v[104:107], v[152:155]
  v_add_f32 v47, v47, v188
  v_mfma_f32_16x16x32_bf16 v[152:155], a[224:227], v[120:123], v[152:155]
  v_exp_f32 v189, v189
  v_mfma_f32_16x16x32_bf16 v[152:155], a[228:231], v[136:139], v[152:155]
  v_add_f32 v47, v47, v189
  v_cvt_pk_bf16_f32 v206, v188, v189
  v_mfma_f32_16x16x32_bf16 v[156:159], a[228:231], v[140:143], 0
  v_exp_f32 v190, v190
  v_mfma_f32_16x16x32_bf16 v[156:159], a[224:227], v[124:127], v[156:159]
  s_waitcnt lgkmcnt(0)
  s_barrier
  v_add_f32 v47, v47, v190
  v_mfma_f32_16x16x32_bf16 v[156:159], a[220:223], v[108:111], v[156:159]
  v_exp_f32 v191, v191
  v_mfma_f32_16x16x32_bf16 v[156:159], a[216:219], v[92:95], v[156:159]
  v_add_f32 v47, v47, v191
  v_cvt_pk_bf16_f32 v207, v190, v191
  v_mfma_f32_16x16x32_bf16 v[156:159], a[212:215], v[76:79], v[156:159]
  s_add_u32 m0, s74, 12288
  v_exp_f32 v144, v144
  v_mfma_f32_16x16x32_bf16 v[156:159], a[208:211], v[60:63], v[156:159]
  s_mov_b32 s58, 159744
  v_add_f32 v44, v44, v144
  v_mfma_f32_16x16x32_bf16 v[176:179], a[144:147], v[48:51], 0
  buffer_load_dwordx4 v31, s[20:23], s58 offen offset:0  lds
  v_mfma_f32_16x16x32_bf16 v[176:179], a[148:151], v[64:67], v[176:179]
  v_exp_f32 v145, v145
  v_mfma_f32_16x16x32_bf16 v[176:179], a[152:155], v[80:83], v[176:179]
  v_add_f32 v44, v44, v145
  v_cvt_pk_bf16_f32 v144, v144, v145
  v_mfma_f32_16x16x32_bf16 v[176:179], a[156:159], v[96:99], v[176:179]
  v_exp_f32 v146, v146
  v_mfma_f32_16x16x32_bf16 v[176:179], a[160:163], v[112:115], v[176:179]
  v_add_f32 v44, v44, v146
  v_mfma_f32_16x16x32_bf16 v[176:179], a[164:167], v[128:131], v[176:179]
  v_exp_f32 v147, v147
  v_mfma_f32_16x16x32_bf16 v[180:183], a[164:167], v[132:135], 0
  v_add_f32 v44, v44, v147
  v_cvt_pk_bf16_f32 v145, v146, v147
  v_mfma_f32_16x16x32_bf16 v[180:183], a[160:163], v[116:119], v[180:183]
  buffer_load_dwordx4 v32, s[20:23], s58 offen offset:1024  lds
  v_mfma_f32_16x16x32_bf16 v[180:183], a[156:159], v[100:103], v[180:183]
  ds_read_b64_tr_b16 a[248:249], v11 offset:24704
  v_mfma_f32_16x16x32_bf16 v[180:183], a[152:155], v[84:87], v[180:183]
  ds_read_b64_tr_b16 a[250:251], v11 offset:30848
  v_mfma_f32_16x16x32_bf16 v[180:183], a[148:151], v[68:71], v[180:183]
  ds_read_b64_tr_b16 a[252:253], v3 offset:128
  v_mfma_f32_16x16x32_bf16 v[180:183], a[144:147], v[52:55], v[180:183]
  ds_read_b64_tr_b16 a[254:255], v3 offset:6272
  v_mfma_f32_16x16x32_bf16 v[184:187], a[144:147], v[56:59], 0
  v_exp_f32 v148, v148
  v_mfma_f32_16x16x32_bf16 v[184:187], a[148:151], v[72:75], v[184:187]
  v_add_f32 v45, v45, v148
  v_mfma_f32_16x16x32_bf16 v[184:187], a[152:155], v[88:91], v[184:187]
  s_lshr_b32 s57, s2, 3
  v_exp_f32 v149, v149
  v_mfma_f32_16x16x32_bf16 v[184:187], a[156:159], v[104:107], v[184:187]
  s_lshl_b32 s57, s57, 2
  v_add_f32 v45, v45, v149
  v_cvt_pk_bf16_f32 v148, v148, v149
  v_mfma_f32_16x16x32_bf16 v[184:187], a[160:163], v[120:123], v[184:187]
  s_add_u32 s57, s57, s72
  ds_read_b64_tr_b16 a[208:209], v12 offset:24704
  v_mfma_f32_16x16x32_bf16 v[184:187], a[164:167], v[136:139], v[184:187]
  ds_read_b64_tr_b16 a[210:211], v12 offset:30848
  v_mfma_f32_16x16x32_bf16 v[188:191], a[164:167], v[140:143], 0
  s_lshl_b32 s57, s57, 7
  ds_read_b64_tr_b16 a[212:213], v4 offset:128
  v_mfma_f32_16x16x32_bf16 v[188:191], a[160:163], v[124:127], v[188:191]
  s_add_u32 s57, s57, 15000
  ds_read_b64_tr_b16 a[214:215], v4 offset:6272
  v_mfma_f32_16x16x32_bf16 v[188:191], a[156:159], v[108:111], v[188:191]
  v_mov_b32 v38, s57
  v_mfma_f32_16x16x32_bf16 v[188:191], a[152:155], v[92:95], v[188:191]
  buffer_load_dwordx4 v33, s[20:23], s58 offen offset:2048  lds
  v_mfma_f32_16x16x32_bf16 v[188:191], a[148:151], v[76:79], v[188:191]
  s_add_u32 m0, s74, 36864
  v_exp_f32 v150, v150
  v_mfma_f32_16x16x32_bf16 v[188:191], a[144:147], v[60:63], v[188:191]
  s_waitcnt lgkmcnt(6)
  s_mov_b32 s75, 184320
  v_add_f32 v45, v45, v150
  v_mfma_f32_16x16x32_bf16 a[44:47], a[248:251], v[172:175], a[44:47]
  s_waitcnt lgkmcnt(4)
  v_exp_f32 v151, v151
  v_mfma_f32_16x16x32_bf16 a[44:47], a[252:255], v[204:207], a[44:47]
  buffer_load_dword v40, v39, s[4:7], s79 offen offset:0 sc1
  v_mfma_f32_16x16x32_bf16 a[40:43], a[252:255], v[200:203], a[40:43]
  ds_read_b64_tr_b16 a[216:217], v9 offset:24832
  v_add_f32 v45, v45, v151
  v_mfma_f32_16x16x32_bf16 a[40:43], a[248:251], v[168:171], a[40:43]
  ds_read_b64_tr_b16 a[218:219], v9 offset:30976
  ds_read_b64_tr_b16 a[220:221], v1 offset:256
  v_mfma_f32_16x16x32_bf16 a[36:39], a[248:251], v[164:167], a[36:39]
  v_exp_f32 v152, v152
  v_mfma_f32_16x16x32_bf16 a[36:39], a[252:255], v[196:199], a[36:39]
  buffer_load_dwordx4 v28, s[16:19], s75 offen offset:0  lds
  v_mfma_f32_16x16x32_bf16 a[32:35], a[252:255], v[192:195], a[32:35]
  ds_read_b64_tr_b16 a[222:223], v1 offset:6400
  v_cvt_pk_bf16_f32 v149, v150, v151
  v_mfma_f32_16x16x32_bf16 a[32:35], a[248:251], v[160:163], a[32:35]
  s_waitcnt lgkmcnt(6)
  v_add_f32 v46, v46, v152
  v_mfma_f32_16x16x32_bf16 a[48:51], a[208:211], v[160:163], a[48:51]
  s_waitcnt lgkmcnt(4)
  v_exp_f32 v153, v153
  v_mfma_f32_16x16x32_bf16 a[48:51], a[212:215], v[192:195], a[48:51]
  ds_read_b64_tr_b16 a[224:225], v10 offset:24832
  v_add_f32 v46, v46, v153
  v_mfma_f32_16x16x32_bf16 a[52:55], a[212:215], v[196:199], a[52:55]
  s_lshr_b32 s55, s2, 3
  v_exp_f32 v154, v154
  v_mfma_f32_16x16x32_bf16 a[52:55], a[208:211], v[164:167], a[52:55]
  s_lshl_b32 s55, s55, 2
  ds_read_b64_tr_b16 a[226:227], v10 offset:30976
  v_cvt_pk_bf16_f32 v152, v152, v153
  v_mfma_f32_16x16x32_bf16 a[56:59], a[208:211], v[168:171], a[56:59]
  buffer_load_dwordx4 v29, s[16:19], s75 offen offset:1024  lds
  v_mfma_f32_16x16x32_bf16 a[56:59], a[212:215], v[200:203], a[56:59]
  s_mov_b32 s59, 172032
  ds_read_b64_tr_b16 a[228:229], v2 offset:256
  ds_read_b64_tr_b16 a[230:231], v2 offset:6400
  v_mfma_f32_16x16x32_bf16 a[60:63], a[212:215], v[204:207], a[60:63]
  s_lshr_b32 s60, s2, 3
  ds_read_b128 a[160:163], v16 offset:24576
  v_add_f32 v46, v46, v154
  v_mfma_f32_16x16x32_bf16 a[60:63], a[208:211], v[172:175], a[60:63]
  s_waitcnt lgkmcnt(5)
  s_lshl_b32 s60, s60, 2
  v_exp_f32 v155, v155
  v_mfma_f32_16x16x32_bf16 a[76:79], a[216:219], v[172:175], a[76:79]
  s_add_u32 s55, s55, s72
  v_add_f32 v46, v46, v155
  v_cvt_pk_bf16_f32 v153, v154, v155
  v_mfma_f32_16x16x32_bf16 a[76:79], a[220:223], v[204:207], a[76:79]
  s_lshl_b32 s81, s44, 9
  v_exp_f32 v156, v156
  v_mfma_f32_16x16x32_bf16 a[72:75], a[220:223], v[200:203], a[72:75]
  s_add_u32 s55, s55, s81
  ds_read_b64_tr_b16 a[144:145], v11 offset:24832
  v_add_f32 v47, v47, v156
  v_mfma_f32_16x16x32_bf16 a[72:75], a[216:219], v[168:171], a[72:75]
  s_add_u32 s55, s55, 256
  v_exp_f32 v157, v157
  v_mfma_f32_16x16x32_bf16 a[68:71], a[216:219], v[164:167], a[68:71]
  s_mul_i32 s55, s55, 1920
  ds_read_b64_tr_b16 a[146:147], v11 offset:30976
  v_add_f32 v47, v47, v157
  v_mfma_f32_16x16x32_bf16 a[68:71], a[220:223], v[196:199], a[68:71]
  buffer_load_dwordx4 v30, s[16:19], s75 offen offset:2048  lds
  v_mfma_f32_16x16x32_bf16 a[64:67], a[220:223], v[192:195], a[64:67]
  s_add_u32 m0, s74, 86016
  ds_read_b64_tr_b16 a[148:149], v3 offset:256
  v_cvt_pk_bf16_f32 v156, v156, v157
  v_mfma_f32_16x16x32_bf16 a[64:67], a[216:219], v[160:163], a[64:67]
  s_waitcnt lgkmcnt(4)
  ds_read_b64_tr_b16 a[150:151], v3 offset:6400
  ds_read_b128 a[164:167], v17 offset:24576
  v_mfma_f32_16x16x32_bf16 a[80:83], a[224:227], v[160:163], a[80:83]
  s_add_u32 s60, s60, s72
  v_exp_f32 v158, v158
  v_mfma_f32_16x16x32_bf16 a[80:83], a[228:231], v[192:195], a[80:83]
  s_lshl_b32 s3, s44, 9
  ds_read_b64_tr_b16 a[152:153], v12 offset:24832
  v_add_f32 v47, v47, v158
  v_mfma_f32_16x16x32_bf16 a[84:87], a[228:231], v[196:199], a[84:87]
  s_add_u32 s60, s60, s3
  v_exp_f32 v159, v159
  v_mfma_f32_16x16x32_bf16 a[84:87], a[224:227], v[164:167], a[84:87]
  s_add_u32 s60, s60, 384
  ds_read_b64_tr_b16 a[156:157], v4 offset:256
  ds_read_b64_tr_b16 a[158:159], v4 offset:6400
  v_mfma_f32_16x16x32_bf16 a[88:91], a[224:227], v[168:171], a[88:91]
  buffer_load_dword v23, v24, s[24:27], s55 offen
  v_mfma_f32_16x16x32_bf16 a[88:91], a[228:231], v[200:203], a[88:91]
  s_mul_i32 s60, s60, 1920
  ds_read_b64_tr_b16 a[154:155], v12 offset:30976
  v_add_f32 v47, v47, v159
  v_mfma_f32_16x16x32_bf16 a[92:95], a[228:231], v[204:207], a[92:95]
  buffer_load_dword v23, v24, s[24:27], s60 offen
  v_mfma_f32_16x16x32_bf16 a[92:95], a[224:227], v[172:175], a[92:95]
  s_waitcnt lgkmcnt(5)
  v_exp_f32 v176, v176
  v_mfma_f32_16x16x32_bf16 a[108:111], a[144:147], v[172:175], a[108:111]
  buffer_load_dwordx4 v31, s[20:23], s59 offen offset:0  lds
  v_mfma_f32_16x16x32_bf16 a[108:111], a[148:151], v[204:207], a[108:111]
  v_cvt_pk_bf16_f32 v157, v158, v159
  v_add_f32 v44, v44, v176
  v_mfma_f32_16x16x32_bf16 a[104:107], a[148:151], v[200:203], a[104:107]
  v_exp_f32 v177, v177
  v_mfma_f32_16x16x32_bf16 a[104:107], a[144:147], v[168:171], a[104:107]
  v_add_f32 v44, v44, v177
  v_cvt_pk_bf16_f32 v146, v176, v177
  v_mfma_f32_16x16x32_bf16 a[100:103], a[144:147], v[164:167], a[100:103]
L_pg13:
  s_cbranch_execz L_hop3
  v_exp_f32 v178, v178
  v_mfma_f32_16x16x32_bf16 a[100:103], a[148:151], v[196:199], a[100:103]
  ds_read_b128 a[252:255], v17 offset:24704
  v_add_f32 v44, v44, v178
  v_mfma_f32_16x16x32_bf16 a[96:99], a[148:151], v[192:195], a[96:99]
  buffer_load_dwordx4 v32, s[20:23], s59 offen offset:1024  lds
  v_mfma_f32_16x16x32_bf16 a[96:99], a[144:147], v[160:163], a[96:99]
  s_waitcnt lgkmcnt(1)
  ds_read_b128 a[248:251], v16 offset:24704
  ds_read_b128 a[208:211], v16 offset:24832
  v_mfma_f32_16x16x32_bf16 a[112:115], a[152:155], v[160:163], a[112:115]
  v_exp_f32 v179, v179
  v_mfma_f32_16x16x32_bf16 a[112:115], a[156:159], v[192:195], a[112:115]
  ds_read_b128 a[212:215], v17 offset:24832
  v_add_f32 v44, v44, v179
  v_mfma_f32_16x16x32_bf16 a[116:119], a[156:159], v[196:199], a[116:119]
  v_exp_f32 v180, v180
  v_mfma_f32_16x16x32_bf16 a[116:119], a[152:155], v[164:167], a[116:119]
  v_cvt_pk_bf16_f32 v147, v178, v179
  v_add_f32 v45, v45, v180
  v_mfma_f32_16x16x32_bf16 a[120:123], a[152:155], v[168:171], a[120:123]
  v_exp_f32 v181, v181
  v_mfma_f32_16x16x32_bf16 a[120:123], a[156:159], v[200:203], a[120:123]
  buffer_load_dwordx4 v33, s[20:23], s59 offen offset:2048  lds
  v_mfma_f32_16x16x32_bf16 a[124:127], a[156:159], v[204:207], a[124:127]
  v_add_f32 v45, v45, v181
  v_cvt_pk_bf16_f32 v150, v180, v181
  v_mfma_f32_16x16x32_bf16 a[124:127], a[152:155], v[172:175], a[124:127]
  v_exp_f32 v182, v182
  v_mfma_f32_16x16x32_bf16 v[160:163], a[160:163], v[48:51], 0
  v_exp_f32 v183, v183
  v_mfma_f32_16x16x32_bf16 v[160:163], a[164:167], v[64:67], v[160:163]
  s_waitcnt lgkmcnt(2)
  v_add_f32 v45, v45, v182
  v_cvt_pk_bf16_f32 v151, v182, v183
  v_mfma_f32_16x16x32_bf16 v[160:163], a[248:251], v[80:83], v[160:163]
  v_exp_f32 v184, v184
  v_mfma_f32_16x16x32_bf16 v[160:163], a[252:255], v[96:99], v[160:163]
  s_waitcnt lgkmcnt(0)
  v_exp_f32 v185, v185
  v_mfma_f32_16x16x32_bf16 v[160:163], a[208:211], v[112:115], v[160:163]
  s_add_u32 s43, s40, 1
  ds_read_b128 a[220:223], v17 offset:30720
  v_add_f32 v45, v45, v183
  v_mfma_f32_16x16x32_bf16 v[160:163], a[212:215], v[128:131], v[160:163]
  ds_read_b128 a[216:219], v16 offset:30720
  v_add_f32 v46, v46, v184
  v_mfma_f32_16x16x32_bf16 v[164:167], a[212:215], v[132:135], 0
  ds_read_b128 a[224:227], v16 offset:30848
  v_add_f32 v46, v46, v185
  v_mfma_f32_16x16x32_bf16 v[164:167], a[208:211], v[116:119], v[164:167]
  ds_read_b128 a[228:231], v17 offset:30848
  v_cvt_pk_bf16_f32 v154, v184, v185
  v_mfma_f32_16x16x32_bf16 v[164:167], a[252:255], v[100:103], v[164:167]
  v_exp_f32 v186, v186
  v_mfma_f32_16x16x32_bf16 v[164:167], a[248:251], v[84:87], v[164:167]
  v_exp_f32 v187, v187
  v_mfma_f32_16x16x32_bf16 v[164:167], a[164:167], v[68:71], v[164:167]
  ds_read_b128 a[144:147], v16 offset:30976
  v_add_f32 v46, v46, v186
  v_mfma_f32_16x16x32_bf16 v[164:167], a[160:163], v[52:55], v[164:167]
  ds_read_b128 a[148:151], v17 offset:30976
  v_cvt_pk_bf16_f32 v155, v186, v187
  v_mfma_f32_16x16x32_bf16 v[168:171], a[160:163], v[56:59], 0
  v_exp_f32 v188, v188
  v_mfma_f32_16x16x32_bf16 v[168:171], a[164:167], v[72:75], v[168:171]
  s_waitcnt vmcnt(8)
  v_subrev_u32 v40, s43, v40
  v_add_f32 v46, v46, v187
  v_mfma_f32_16x16x32_bf16 v[168:171], a[248:251], v[88:91], v[168:171]
  v_exp_f32 v189, v189
  v_mfma_f32_16x16x32_bf16 v[168:171], a[252:255], v[104:107], v[168:171]
  v_cmp_lt_u32 vcc, 7, v40
  v_add_f32 v47, v47, v188
  v_mfma_f32_16x16x32_bf16 v[168:171], a[208:211], v[120:123], v[168:171]
  s_cbranch_vccnz L_spin2
L_ret2:
  v_exp_f32 v190, v190
  v_mfma_f32_16x16x32_bf16 v[168:171], a[212:215], v[136:139], v[168:171]
  s_add_u32 s64, s15, 0
  v_exp_f32 v191, v191
  v_mfma_f32_16x16x32_bf16 v[172:175], a[212:215], v[140:143], 0
  buffer_load_dwordx4 a[168:171], v37, s[4:7], s64 offen offset:0 sc1
  v_mfma_f32_16x16x32_bf16 v[172:175], a[208:211], v[124:127], v[172:175]
  s_waitcnt lgkmcnt(0)
  s_barrier
  v_add_f32 v47, v47, v189
  v_cvt_pk_bf16_f32 v158, v188, v189
  v_mfma_f32_16x16x32_bf16 v[172:175], a[252:255], v[108:111], v[172:175]
  v_add_f32 v47, v47, v190
  v_cvt_pk_bf16_f32 v159, v190, v191
  v_mfma_f32_16x16x32_bf16 v[172:175], a[248:251], v[92:95], v[172:175]
  v_exp_f32 v160, v160
  v_mfma_f32_16x16x32_bf16 v[172:175], a[164:167], v[76:79], v[172:175]
  s_add_u32 m0, s74, 110592
  v_add_f32 v47, v47, v191
  v_add_f32 v44, v44, v160
  v_mfma_f32_16x16x32_bf16 v[172:175], a[160:163], v[60:63], v[172:175]
  s_mov_b32 s87, 184320
  v_exp_f32 v161, v161
  v_mfma_f32_16x16x32_bf16 v[176:179], a[216:219], v[48:51], 0
  v_exp_f32 v162, v162
  v_mfma_f32_16x16x32_bf16 v[176:179], a[220:223], v[64:67], v[176:179]
  v_exp_f32 v163, v163
  v_mfma_f32_16x16x32_bf16 v[176:179], a[224:227], v[80:83], v[176:179]
  buffer_load_dwordx4 v31, s[20:23], s87 offen offset:0  lds
  v_mfma_f32_16x16x32_bf16 v[176:179], a[228:231], v[96:99], v[176:179]
  v_add_f32 v44, v44, v161
  v_cvt_pk_bf16_f32 v160, v160, v161
  v_mfma_f32_16x16x32_bf16 v[176:179], a[144:147], v[112:115], v[176:179]
  v_cvt_pk_bf16_f32 v161, v162, v163
  v_mov_b32 v29, 0
  v_mfma_f32_16x16x32_bf16 v[176:179], a[148:151], v[128:131], v[176:179]
  buffer_load_dwordx4 a[172:175], v37, s[4:7], s64 offen offset:1024 sc1
  v_mfma_f32_16x16x32_bf16 v[180:183], a[148:151], v[132:135], 0
  v_add_f32 v44, v44, v162
  v_mfma_f32_16x16x32_bf16 v[180:183], a[144:147], v[116:119], v[180:183]
  buffer_load_dwordx4 v32, s[20:23], s87 offen offset:1024  lds
  v_mfma_f32_16x16x32_bf16 v[180:183], a[228:231], v[100:103], v[180:183]
  ds_read_b64_tr_b16 a[152:153], v1 offset:0
  v_add_f32 v44, v44, v163
  v_mfma_f32_16x16x32_bf16 v[180:183], a[224:227], v[84:87], v[180:183]
  ds_read_b64_tr_b16 a[154:155], v1 offset:6144
  v_mfma_f32_16x16x32_bf16 v[180:183], a[220:223], v[68:71], v[180:183]
  ds_read_b64_tr_b16 a[156:157], v5 offset:12288
  v_mfma_f32_16x16x32_bf16 v[180:183], a[216:219], v[52:55], v[180:183]
  ds_read_b64_tr_b16 a[158:159], v5 offset:18432
  v_mfma_f32_16x16x32_bf16 v[184:187], a[216:219], v[56:59], 0
  v_exp_f32 v164, v164
  v_mfma_f32_16x16x32_bf16 v[184:187], a[220:223], v[72:75], v[184:187]
  v_exp_f32 v165, v165
  v_mfma_f32_16x16x32_bf16 v[184:187], a[224:227], v[88:91], v[184:187]
  v_add_f32 v45, v45, v164
  v_cmp_gt_u32 vcc, 4, v26
  v_mfma_f32_16x16x32_bf16 v[184:187], a[228:231], v[104:107], v[184:187]
  s_getpc_b64 s[82:83]
  v_add_f32 v45, v45, v165
  v_lshlrev_b32 v26, 4, v26
  v_mfma_f32_16x16x32_bf16 v[184:187], a[144:147], v[120:123], v[184:187]
  ds_read_b64_tr_b16 a[160:161], v2 offset:0
  v_cndmask_b32 v28, v29, v27, vcc
  v_mfma_f32_16x16x32_bf16 v[184:187], a[148:151], v[136:139], v[184:187]
  buffer_load_dwordx4 v33, s[20:23], s87 offen offset:2048  lds
  v_mfma_f32_16x16x32_bf16 v[188:191], a[148:151], v[140:143], 0
  ds_read_b64_tr_b16 a[162:163], v2 offset:6144
  v_mov_b32 v27, 0
  v_mfma_f32_16x16x32_bf16 v[188:191], a[144:147], v[124:127], v[188:191]
  buffer_load_dwordx4 a[176:179], v37, s[4:7], s64 offen offset:2048 sc1
  v_mfma_f32_16x16x32_bf16 v[188:191], a[228:231], v[108:111], v[188:191]
  ds_read_b64_tr_b16 a[164:165], v6 offset:12288
  v_cvt_pk_bf16_f32 v164, v164, v165
  v_mfma_f32_16x16x32_bf16 v[188:191], a[224:227], v[92:95], v[188:191]
  s_waitcnt lgkmcnt(5)
  ds_read_b64_tr_b16 a[166:167], v6 offset:18432
  v_lshlrev_b64 v[28:29], v26, v[28:29]
  v_mfma_f32_16x16x32_bf16 v[188:191], a[220:223], v[76:79], v[188:191]
  s_add_u32 m0, s74, 98304
  v_mov_b32 v26, 0
  v_mfma_f32_16x16x32_bf16 v[188:191], a[216:219], v[60:63], v[188:191]
  global_load_dword v38, v38, s[82:83]
  v_mfma_f32_16x16x32_bf16 v[220:223], a[152:155], v[204:207], v[220:223]
  s_waitcnt lgkmcnt(4)
  s_add_u32 s61, s92, 0
  v_exp_f32 v166, v166
  v_mfma_f32_16x16x32_bf16 v[220:223], a[156:159], v[156:159], v[220:223]
  v_exp_f32 v167, v167
  v_mfma_f32_16x16x32_bf16 v[216:219], a[156:159], v[152:155], v[216:219]
  ds_read_b64_tr_b16 a[248:249], v3 offset:0
  v_add_f32 v45, v45, v166
  v_mfma_f32_16x16x32_bf16 v[216:219], a[152:155], v[200:203], v[216:219]
  ds_read_b64_tr_b16 a[250:251], v3 offset:6144
  v_add_f32 v45, v45, v167
  v_mfma_f32_16x16x32_bf16 v[212:215], a[152:155], v[196:199], v[212:215]
  v_exp_f32 v168, v168
  v_mfma_f32_16x16x32_bf16 v[212:215], a[156:159], v[148:151], v[212:215]
  ds_read_b64_tr_b16 a[252:253], v7 offset:12288
  v_mov_b32 v30, v28
  v_mfma_f32_16x16x32_bf16 v[208:211], a[156:159], v[144:147], v[208:211]
  s_waitcnt lgkmcnt(5)
  ds_read_b64_tr_b16 a[254:255], v7 offset:18432
  v_cvt_pk_bf16_f32 v165, v166, v167
  v_mfma_f32_16x16x32_bf16 v[208:211], a[152:155], v[192:195], v[208:211]
  buffer_load_dwordx4 v34, s[24:27], s61 offen offset:0  lds
  v_mfma_f32_16x16x32_bf16 v[224:227], a[160:163], v[192:195], v[224:227]
  s_waitcnt lgkmcnt(4)
  v_exp_f32 v169, v169
  v_mfma_f32_16x16x32_bf16 v[224:227], a[164:167], v[144:147], v[224:227]
  ds_read_b64_tr_b16 a[208:209], v4 offset:0
  v_add_f32 v46, v46, v168
  v_mfma_f32_16x16x32_bf16 v[228:231], a[164:167], v[148:151], v[228:231]
  v_exp_f32 v170, v170
  v_mfma_f32_16x16x32_bf16 v[228:231], a[160:163], v[196:199], v[228:231]
  v_add_f32 v46, v46, v169
  v_cvt_pk_bf16_f32 v168, v168, v169
  v_mfma_f32_16x16x32_bf16 v[232:235], a[160:163], v[200:203], v[232:235]
  buffer_load_dwordx4 a[180:183], v37, s[4:7], s64 offen offset:3072 sc1
  v_mfma_f32_16x16x32_bf16 v[232:235], a[164:167], v[152:155], v[232:235]
  ds_read_b64_tr_b16 a[210:211], v4 offset:6144
  ds_read_b64_tr_b16 a[212:213], v8 offset:12288
  v_mfma_f32_16x16x32_bf16 v[236:239], a[164:167], v[156:159], v[236:239]
  s_waitcnt lgkmcnt(5)
  ds_read_b64_tr_b16 a[214:215], v8 offset:18432
  v_add_f32 v46, v46, v170
  v_mfma_f32_16x16x32_bf16 v[236:239], a[160:163], v[204:207], v[236:239]
  buffer_load_dwordx4 v35, s[24:27], s61 offen offset:1024  lds
  v_mfma_f32_16x16x32_bf16 v[252:255], a[248:251], v[204:207], v[252:255]
  s_waitcnt lgkmcnt(4)
  v_exp_f32 v171, v171
  v_mfma_f32_16x16x32_bf16 v[252:255], a[252:255], v[156:159], v[252:255]
  v_add_f32 v46, v46, v171
  v_cvt_pk_bf16_f32 v169, v170, v171
  v_mfma_f32_16x16x32_bf16 v[248:251], a[252:255], v[152:155], v[248:251]
  v_exp_f32 v172, v172
  v_mfma_f32_16x16x32_bf16 v[248:251], a[248:251], v[200:203], v[248:251]
  s_add_u32 s65, s15, 4096
  ds_read_b64_tr_b16 a[216:217], v1 offset:128
  v_add_f32 v47, v47, v172
  v_mfma_f32_16x16x32_bf16 v[244:247], a[248:251], v[196:199], v[244:247]
  v_exp_f32 v173, v173
  v_mfma_f32_16x16x32_bf16 v[244:247], a[252:255], v[148:151], v[244:247]
  ds_read_b64_tr_b16 a[218:219], v1 offset:6272
  ds_read_b64_tr_b16 a[220:221], v5 offset:12416
  v_mfma_f32_16x16x32_bf16 v[240:243], a[252:255], v[144:147], v[240:243]
  s_waitcnt lgkmcnt(3)
  ds_read_b64_tr_b16 a[222:223], v5 offset:18560
  v_mov_b32 v31, v29
  v_mfma_f32_16x16x32_bf16 v[240:243], a[248:251], v[192:195], v[240:243]
  buffer_load_dwordx4 v36, s[24:27], s61 offen offset:2048  lds
  v_mfma_f32_16x16x32_bf16 a[232:235], a[208:211], v[192:195], a[232:235]
  s_add_u32 m0, s74, 49152
  v_add_f32 v47, v47, v173
  v_cvt_pk_bf16_f32 v172, v172, v173
  v_mfma_f32_16x16x32_bf16 a[232:235], a[212:215], v[144:147], a[232:235]
  s_add_u32 s67, s92, 40960
  v_exp_f32 v174, v174
  v_mfma_f32_16x16x32_bf16 a[236:239], a[212:215], v[148:151], a[236:239]
  ds_read_b64_tr_b16 a[224:225], v2 offset:128
  v_add_f32 v47, v47, v174
  v_mfma_f32_16x16x32_bf16 a[236:239], a[208:211], v[196:199], a[236:239]
  v_exp_f32 v175, v175
  v_mfma_f32_16x16x32_bf16 a[240:243], a[208:211], v[200:203], a[240:243]
  ds_read_b64_tr_b16 a[226:227], v2 offset:6272
  v_add_f32 v47, v47, v175
  v_mfma_f32_16x16x32_bf16 a[240:243], a[212:215], v[152:155], a[240:243]
  buffer_load_dwordx4 a[184:187], v37, s[4:7], s65 offen offset:0 sc1
  v_mfma_f32_16x16x32_bf16 a[244:247], a[212:215], v[156:159], a[244:247]
  ds_read_b64_tr_b16 a[228:229], v6 offset:12416
  v_cvt_pk_bf16_f32 v173, v174, v175
  v_mfma_f32_16x16x32_bf16 a[244:247], a[208:211], v[204:207], a[244:247]
  s_waitcnt lgkmcnt(3)
  ds_read_b64_tr_b16 a[230:231], v6 offset:18560
  ds_read_b128 a[144:147], v18 offset:24576
  v_mfma_f32_16x16x32_bf16 a[12:15], a[216:219], v[204:207], a[12:15]
  buffer_load_dwordx4 v34, s[24:27], s67 offen offset:0  lds
  v_mfma_f32_16x16x32_bf16 a[12:15], a[220:223], v[156:159], a[12:15]
  v_exp_f32 v176, v176
  v_mfma_f32_16x16x32_bf16 a[8:11], a[220:223], v[152:155], a[8:11]
  ds_read_b128 a[148:151], v19 offset:24576
  v_add_f32 v44, v44, v176
  v_mfma_f32_16x16x32_bf16 a[8:11], a[216:219], v[200:203], a[8:11]
  v_exp_f32 v177, v177
  v_mfma_f32_16x16x32_bf16 a[4:7], a[216:219], v[196:199], a[4:7]
  v_exp_f32 v178, v178
  v_mfma_f32_16x16x32_bf16 a[4:7], a[220:223], v[148:151], a[4:7]
  v_add_f32 v44, v44, v177
  v_cvt_pk_bf16_f32 v162, v176, v177
  v_mfma_f32_16x16x32_bf16 a[0:3], a[220:223], v[144:147], a[0:3]
  ds_read_b128 a[156:159], v19 offset:24704
  v_add_f32 v44, v44, v178
  v_mfma_f32_16x16x32_bf16 a[0:3], a[216:219], v[192:195], a[0:3]
  s_waitcnt lgkmcnt(3)
  ds_read_b128 a[152:155], v18 offset:24704
  ds_read_b128 a[160:163], v18 offset:24832
  v_mfma_f32_16x16x32_bf16 a[16:19], a[224:227], v[192:195], a[16:19]
  buffer_load_dwordx4 v35, s[24:27], s67 offen offset:1024  lds
  v_mfma_f32_16x16x32_bf16 a[16:19], a[228:231], v[144:147], a[16:19]
  v_exp_f32 v179, v179
  v_mfma_f32_16x16x32_bf16 a[20:23], a[228:231], v[148:151], a[20:23]
  ds_read_b128 a[164:167], v19 offset:24832
  v_add_f32 v44, v44, v179
  v_mfma_f32_16x16x32_bf16 a[20:23], a[224:227], v[196:199], a[20:23]
  buffer_load_dwordx4 a[188:191], v37, s[4:7], s65 offen offset:1024 sc1
  v_mfma_f32_16x16x32_bf16 a[24:27], a[224:227], v[200:203], a[24:27]
  v_exp_f32 v180, v180
  v_mfma_f32_16x16x32_bf16 a[24:27], a[228:231], v[152:155], a[24:27]
  v_cvt_pk_bf16_f32 v163, v178, v179
  v_mov_b32 v32, 0
  v_mfma_f32_16x16x32_bf16 a[28:31], a[228:231], v[156:159], a[28:31]
  v_add_f32 v45, v45, v180
  v_mov_b32 v33, 0
  v_mfma_f32_16x16x32_bf16 a[28:31], a[224:227], v[204:207], a[28:31]
  s_waitcnt lgkmcnt(4)
  v_exp_f32 v181, v181
  v_mfma_f32_16x16x32_bf16 v[192:195], a[144:147], v[48:51], 0
  buffer_load_dwordx4 v36, s[24:27], s67 offen offset:2048  lds
  v_mfma_f32_16x16x32_bf16 v[192:195], a[148:151], v[64:67], v[192:195]
  s_waitcnt lgkmcnt(2)
  v_add_f32 v45, v45, v181
  v_cvt_pk_bf16_f32 v166, v180, v181
  v_mfma_f32_16x16x32_bf16 v[192:195], a[152:155], v[80:83], v[192:195]
  s_add_u32 s66, s88, 20480
  v_exp_f32 v182, v182
  v_mfma_f32_16x16x32_bf16 v[192:195], a[156:159], v[96:99], v[192:195]
  s_waitcnt lgkmcnt(1)
  v_exp_f32 v183, v183
  v_mfma_f32_16x16x32_bf16 v[192:195], a[160:163], v[112:115], v[192:195]
  s_waitcnt lgkmcnt(0)
  v_add_f32 v45, v45, v182
  v_cvt_pk_bf16_f32 v167, v182, v183
  v_mfma_f32_16x16x32_bf16 v[192:195], a[164:167], v[128:131], v[192:195]
  ds_read_b128 a[252:255], v19 offset:30720
  v_add_f32 v45, v45, v183
  v_mfma_f32_16x16x32_bf16 v[196:199], a[164:167], v[132:135], 0
  v_exp_f32 v184, v184
  v_mfma_f32_16x16x32_bf16 v[196:199], a[160:163], v[116:119], v[196:199]
  buffer_load_dwordx4 a[192:195], v37, s[4:7], s65 offen offset:2048 sc1
  v_mfma_f32_16x16x32_bf16 v[196:199], a[156:159], v[100:103], v[196:199]
  ds_read_b128 a[248:251], v18 offset:30720
  v_add_f32 v46, v46, v184
  v_mfma_f32_16x16x32_bf16 v[196:199], a[152:155], v[84:87], v[196:199]
  v_exp_f32 v185, v185
  v_mfma_f32_16x16x32_bf16 v[196:199], a[148:151], v[68:71], v[196:199]
  ds_read_b128 a[208:211], v18 offset:30848
  v_add_f32 v46, v46, v185
  v_mfma_f32_16x16x32_bf16 v[196:199], a[144:147], v[52:55], v[196:199]
  ds_read_b128 a[212:215], v19 offset:30848
  ds_read_b128 a[220:223], v19 offset:30976
  v_mfma_f32_16x16x32_bf16 v[200:203], a[144:147], v[56:59], 0
  ds_read_b128 a[216:219], v18 offset:30976
  v_cvt_pk_bf16_f32 v170, v184, v185
  v_mfma_f32_16x16x32_bf16 v[200:203], a[148:151], v[72:75], v[200:203]
  buffer_load_dword v42, v42, s[4:7], s66 offen
  v_mfma_f32_16x16x32_bf16 v[200:203], a[152:155], v[88:91], v[200:203]
  v_exp_f32 v186, v186
  v_mfma_f32_16x16x32_bf16 v[200:203], a[156:159], v[104:107], v[200:203]
  v_add_f32 v46, v46, v186
  v_mfma_f32_16x16x32_bf16 v[200:203], a[160:163], v[120:123], v[200:203]
  v_exp_f32 v187, v187
  v_mfma_f32_16x16x32_bf16 v[200:203], a[164:167], v[136:139], v[200:203]
  v_add_f32 v46, v46, v187
  v_cvt_pk_bf16_f32 v171, v186, v187
  v_mfma_f32_16x16x32_bf16 v[204:207], a[164:167], v[140:143], 0
  v_exp_f32 v188, v188
  v_mfma_f32_16x16x32_bf16 v[204:207], a[160:163], v[124:127], v[204:207]
  s_waitcnt lgkmcnt(0)
  s_barrier
  v_exp_f32 v189, v189
  v_mfma_f32_16x16x32_bf16 v[204:207], a[156:159], v[108:111], v[204:207]
  v_exp_f32 v190, v190
  v_mfma_f32_16x16x32_bf16 v[204:207], a[152:155], v[92:95], v[204:207]
  v_add_f32 v47, v47, v188
  v_cvt_pk_bf16_f32 v174, v188, v189
  v_mfma_f32_16x16x32_bf16 v[204:207], a[148:151], v[76:79], v[204:207]
  buffer_load_dwordx4 a[196:199], v37, s[4:7], s65 offen offset:3072 sc1
  v_mfma_f32_16x16x32_bf16 v[204:207], a[144:147], v[60:63], v[204:207]
  s_add_u32 m0, s74, 24576
  v_exp_f32 v191, v191
  v_mfma_f32_16x16x32_bf16 v[176:179], a[248:251], v[48:51], 0
  s_add_u32 s62, s92, 81920
  v_add_f32 v47, v47, v189
  v_cvt_pk_bf16_f32 v175, v190, v191
  v_mfma_f32_16x16x32_bf16 v[176:179], a[252:255], v[64:67], v[176:179]
  v_add_f32 v47, v47, v190
  v_mfma_f32_16x16x32_bf16 v[176:179], a[208:211], v[80:83], v[176:179]
  v_exp_f32 v192, v192
  v_mfma_f32_16x16x32_bf16 v[176:179], a[212:215], v[96:99], v[176:179]
  s_add_u32 s50, s15, 16384
  v_add_f32 v47, v47, v191
  v_add_f32 v44, v44, v192
  v_mfma_f32_16x16x32_bf16 v[176:179], a[216:219], v[112:115], v[176:179]
  v_exp_f32 v193, v193
  v_mfma_f32_16x16x32_bf16 v[176:179], a[220:223], v[128:131], v[176:179]
  v_exp_f32 v194, v194
  v_mfma_f32_16x16x32_bf16 v[180:183], a[220:223], v[132:135], 0
  buffer_load_dwordx4 v34, s[24:27], s62 offen offset:0  lds
  v_mfma_f32_16x16x32_bf16 v[180:183], a[216:219], v[116:119], v[180:183]
  v_exp_f32 v195, v195
  v_mfma_f32_16x16x32_bf16 v[180:183], a[212:215], v[100:103], v[180:183]
  v_exp_f32 v196, v196
  v_mfma_f32_16x16x32_bf16 v[180:183], a[208:211], v[84:87], v[180:183]
  v_exp_f32 v197, v197
  v_mfma_f32_16x16x32_bf16 v[180:183], a[252:255], v[68:71], v[180:183]
  buffer_load_dwordx4 a[128:131], v37, s[4:7], s50 offen offset:0 sc1
  v_mfma_f32_16x16x32_bf16 v[180:183], a[248:251], v[52:55], v[180:183]
  v_add_f32 v44, v44, v193
  v_add_u32 v18, 159744, v37
  v_mfma_f32_16x16x32_bf16 v[184:187], a[248:251], v[56:59], 0
  v_exp_f32 v198, v198
  v_mfma_f32_16x16x32_bf16 v[184:187], a[252:255], v[72:75], v[184:187]
  v_cvt_pk_bf16_f32 v192, v192, v193
  v_add_f32 v44, v44, v194
  v_mfma_f32_16x16x32_bf16 v[184:187], a[208:211], v[88:91], v[184:187]
  buffer_load_dwordx4 v35, s[24:27], s62 offen offset:1024  lds
  v_mfma_f32_16x16x32_bf16 v[184:187], a[212:215], v[104:107], v[184:187]
  ds_read_b64_tr_b16 a[224:225], v7 offset:12416
  v_add_f32 v44, v44, v195
  v_mfma_f32_16x16x32_bf16 v[184:187], a[216:219], v[120:123], v[184:187]
  ds_read_b64_tr_b16 a[226:227], v7 offset:18560
  v_cvt_pk_bf16_f32 v193, v194, v195
  v_mfma_f32_16x16x32_bf16 v[184:187], a[220:223], v[136:139], v[184:187]
  v_exp_f32 v199, v199
  v_mfma_f32_16x16x32_bf16 v[188:191], a[220:223], v[140:143], 0
  ds_read_b64_tr_b16 a[228:229], v11 offset:36992
  v_add_f32 v45, v45, v196
  v_mfma_f32_16x16x32_bf16 v[188:191], a[216:219], v[124:127], v[188:191]
  ds_read_b64_tr_b16 a[230:231], v11 offset:43136
  v_add_f32 v45, v45, v197
  v_mfma_f32_16x16x32_bf16 v[188:191], a[212:215], v[108:111], v[188:191]
  s_mov_b64 exec, 0
  s_cmp_eq_u32 s72, 0
  s_cbranch_scc1 L_pg17
  s_cmp_eq_u32 s72, 1
  s_cbranch_scc1 L_pg18
  s_cmp_eq_u32 s72, 2
  s_cbranch_scc1 L_pg19
  s_branch L_pg20
L_hop4:
  s_mov_b64 exec, -1
  v_cvt_pk_bf16_f32 v196, v196, v197
  v_cvt_pk_bf16_f32 v197, v198, v199
  v_mfma_f32_16x16x32_bf16 v[188:191], a[208:211], v[92:95], v[188:191]
  buffer_load_dwordx4 v36, s[24:27], s62 offen offset:2048  lds
  v_mfma_f32_16x16x32_bf16 v[188:191], a[252:255], v[76:79], v[188:191]
  buffer_load_dwordx4 a[132:135], v37, s[4:7], s50 offen offset:1024 sc1
  v_mfma_f32_16x16x32_bf16 v[188:191], a[248:251], v[60:63], v[188:191]
  s_waitcnt vmcnt(18)
  s_add_u32 m0, s74, 122880
  ds_read_b64_tr_b16 a[144:145], v8 offset:12416
  ds_read_b64_tr_b16 a[148:149], v12 offset:36992
  v_mfma_f32_16x16x32_bf16 a[200:203], v[30:33], a[168:171], 0
  s_add_u32 s63, s92, 122880
  ds_read_b64_tr_b16 a[150:151], v12 offset:43136
  v_add_f32 v45, v45, v198
  v_mfma_f32_16x16x32_bf16 a[200:203], v[28:31], a[174:177], a[200:203]
  s_waitcnt vmcnt(15)
  v_exp_f32 v200, v200
  v_mfma_f32_16x16x32_bf16 a[200:203], v[26:29], a[180:183], a[200:203]
  ds_read_b64_tr_b16 a[146:147], v8 offset:18560
  v_add_f32 v45, v45, v199
  v_mfma_f32_16x16x32_bf16 a[204:207], v[28:31], a[170:173], 0
  v_exp_f32 v201, v201
  v_mfma_f32_16x16x32_bf16 a[204:207], v[28:31], a[178:181], a[204:207]
  s_waitcnt lgkmcnt(6)
  v_exp_f32 v202, v202
  v_mfma_f32_16x16x32_bf16 a[44:47], a[224:227], v[156:159], a[44:47]
  s_waitcnt lgkmcnt(4)
  v_exp_f32 v203, v203
  v_mfma_f32_16x16x32_bf16 a[44:47], a[228:231], v[172:175], a[44:47]
  buffer_load_dwordx4 v34, s[24:27], s63 offen offset:0  lds
  v_mfma_f32_16x16x32_bf16 a[40:43], a[228:231], v[168:171], a[40:43]
  ds_read_b64_tr_b16 a[152:153], v5 offset:12544
  v_add_f32 v46, v46, v200
  v_mfma_f32_16x16x32_bf16 a[40:43], a[224:227], v[152:155], a[40:43]
  ds_read_b64_tr_b16 a[154:155], v5 offset:18688
  ds_read_b64_tr_b16 a[156:157], v9 offset:37120
  v_mfma_f32_16x16x32_bf16 a[36:39], a[224:227], v[148:151], a[36:39]
  v_exp_f32 v204, v204
  v_mfma_f32_16x16x32_bf16 a[36:39], a[228:231], v[164:167], a[36:39]
  ds_read_b64_tr_b16 a[158:159], v9 offset:43264
  v_add_f32 v46, v46, v201
  v_mfma_f32_16x16x32_bf16 a[32:35], a[228:231], v[160:163], a[32:35]
  v_cvt_pk_bf16_f32 v200, v200, v201
  v_add_f32 v46, v46, v202
  v_mfma_f32_16x16x32_bf16 a[32:35], a[224:227], v[144:147], a[32:35]
  s_waitcnt lgkmcnt(4)
  v_exp_f32 v205, v205
  v_mfma_f32_16x16x32_bf16 a[48:51], a[144:147], v[144:147], a[48:51]
  buffer_load_dwordx4 v35, s[24:27], s63 offen offset:1024  lds
  v_mfma_f32_16x16x32_bf16 a[48:51], a[148:151], v[160:163], a[48:51]
  ds_read_b64_tr_b16 a[160:161], v6 offset:12544
  v_cvt_pk_bf16_f32 v201, v202, v203
  v_mfma_f32_16x16x32_bf16 a[52:55], a[148:151], v[164:167], a[52:55]
  buffer_load_dwordx4 a[136:139], v37, s[4:7], s50 offen offset:2048 sc1
  v_mfma_f32_16x16x32_bf16 a[52:55], a[144:147], v[148:151], a[52:55]
  ds_read_b64_tr_b16 a[162:163], v6 offset:18688
  v_add_f32 v46, v46, v203
  v_mfma_f32_16x16x32_bf16 a[56:59], a[144:147], v[152:155], a[56:59]
  v_exp_f32 v206, v206
  v_mfma_f32_16x16x32_bf16 a[56:59], a[148:151], v[168:171], a[56:59]
  v_exp_f32 v207, v207
  v_mfma_f32_16x16x32_bf16 a[60:63], a[148:151], v[172:175], a[60:63]
  ds_read_b64_tr_b16 a[164:165], v10 offset:37120
  v_add_f32 v47, v47, v204
  v_mfma_f32_16x16x32_bf16 a[60:63], a[144:147], v[156:159], a[60:63]
  s_waitcnt lgkmcnt(5)
  ds_read_b64_tr_b16 a[166:167], v10 offset:43264
  v_add_f32 v47, v47, v205
  v_mfma_f32_16x16x32_bf16 a[76:79], a[152:155], v[156:159], a[76:79]
  s_waitcnt lgkmcnt(4)
  v_exp_f32 v176, v176
  v_mfma_f32_16x16x32_bf16 a[76:79], a[156:159], v[172:175], a[76:79]
  buffer_load_dwordx4 v36, s[24:27], s63 offen offset:2048  lds
  v_mfma_f32_16x16x32_bf16 a[72:75], a[156:159], v[168:171], a[72:75]
  s_add_u32 m0, s74, 73728
  ds_read_b64_tr_b16 a[248:249], v7 offset:12544
  v_cvt_pk_bf16_f32 v204, v204, v205
  v_mfma_f32_16x16x32_bf16 a[72:75], a[152:155], v[152:155], a[72:75]
  s_add_u32 s48, s92, 163840
  v_exp_f32 v177, v177
  v_mfma_f32_16x16x32_bf16 a[68:71], a[152:155], v[148:151], a[68:71]
  ds_read_b64_tr_b16 a[250:251], v7 offset:18688
  v_add_f32 v47, v47, v206
  v_mfma_f32_16x16x32_bf16 a[68:71], a[156:159], v[164:167], a[68:71]
  v_exp_f32 v178, v178
  v_mfma_f32_16x16x32_bf16 a[64:67], a[156:159], v[160:163], a[64:67]
  ds_read_b64_tr_b16 a[252:253], v11 offset:37120
  v_add_f32 v47, v47, v207
  v_mfma_f32_16x16x32_bf16 a[64:67], a[152:155], v[144:147], a[64:67]
  s_waitcnt lgkmcnt(5)
  ds_read_b64_tr_b16 a[254:255], v11 offset:43264
  v_cvt_pk_bf16_f32 v205, v206, v207
  v_mfma_f32_16x16x32_bf16 a[80:83], a[160:163], v[144:147], a[80:83]
  s_waitcnt lgkmcnt(4)
  v_exp_f32 v179, v179
  v_mfma_f32_16x16x32_bf16 a[80:83], a[164:167], v[160:163], a[80:83]
  buffer_load_dwordx4 a[140:143], v37, s[4:7], s50 offen offset:3072 sc1
  v_mfma_f32_16x16x32_bf16 a[84:87], a[164:167], v[164:167], a[84:87]
  buffer_load_dwordx4 v34, s[24:27], s48 offen offset:0  lds
  v_mfma_f32_16x16x32_bf16 a[84:87], a[160:163], v[148:151], a[84:87]
  ds_read_b64_tr_b16 a[208:209], v8 offset:12544
  v_add_f32 v44, v44, v176
  v_mfma_f32_16x16x32_bf16 a[88:91], a[160:163], v[152:155], a[88:91]
  ds_read_b64_tr_b16 a[210:211], v8 offset:18688
  v_add_f32 v44, v44, v177
  v_mfma_f32_16x16x32_bf16 a[88:91], a[164:167], v[168:171], a[88:91]
  ds_read_b64_tr_b16 a[212:213], v12 offset:37120
  ds_read_b64_tr_b16 a[214:215], v12 offset:43264
  v_mfma_f32_16x16x32_bf16 a[92:95], a[164:167], v[172:175], a[92:95]
  s_add_u32 s99, s15, 8192
  v_cvt_pk_bf16_f32 v194, v176, v177
  v_add_f32 v44, v44, v178
  v_mfma_f32_16x16x32_bf16 a[92:95], a[160:163], v[156:159], a[92:95]
  s_waitcnt lgkmcnt(6)
  v_exp_f32 v180, v180
  v_mfma_f32_16x16x32_bf16 a[108:111], a[248:251], v[156:159], a[108:111]
  s_waitcnt lgkmcnt(4)
  v_add_f32 v44, v44, v179
  v_cvt_pk_bf16_f32 v195, v178, v179
  v_mfma_f32_16x16x32_bf16 a[108:111], a[252:255], v[172:175], a[108:111]
  buffer_load_dwordx4 v35, s[24:27], s48 offen offset:1024  lds
  v_mfma_f32_16x16x32_bf16 a[104:107], a[252:255], v[168:171], a[104:107]
  v_exp_f32 v181, v181
  v_mfma_f32_16x16x32_bf16 a[104:107], a[248:251], v[152:155], a[104:107]
  v_exp_f32 v182, v182
  v_mfma_f32_16x16x32_bf16 a[100:103], a[248:251], v[148:151], a[100:103]
  v_exp_f32 v183, v183
  v_mfma_f32_16x16x32_bf16 a[100:103], a[252:255], v[164:167], a[100:103]
  buffer_load_dwordx4 a[168:171], v37, s[4:7], s99 offen offset:0 sc1
  v_mfma_f32_16x16x32_bf16 a[96:99], a[252:255], v[160:163], a[96:99]
  ds_read_b128 a[216:219], v20 offset:49152
  v_add_f32 v45, v45, v180
  v_mfma_f32_16x16x32_bf16 a[96:99], a[248:251], v[144:147], a[96:99]
  s_waitcnt lgkmcnt(1)
  v_exp_f32 v184, v184
  v_mfma_f32_16x16x32_bf16 a[112:115], a[208:211], v[144:147], a[112:115]
  buffer_load_dwordx4 v36, s[24:27], s48 offen offset:2048  lds
  v_mfma_f32_16x16x32_bf16 a[112:115], a[212:215], v[160:163], a[112:115]
  ds_read_b128 a[220:223], v21 offset:49152
  v_add_f32 v45, v45, v181
  v_mfma_f32_16x16x32_bf16 a[116:119], a[212:215], v[164:167], a[116:119]
  ds_read_b128 a[224:227], v20 offset:49280
  v_cvt_pk_bf16_f32 v198, v180, v181
  v_mfma_f32_16x16x32_bf16 a[116:119], a[208:211], v[148:151], a[116:119]
  ds_read_b128 a[228:231], v21 offset:49280
  v_cvt_pk_bf16_f32 v199, v182, v183
  v_mfma_f32_16x16x32_bf16 a[120:123], a[208:211], v[152:155], a[120:123]
  ds_read_b128 a[144:147], v20 offset:49408
  v_add_f32 v45, v45, v182
  v_mfma_f32_16x16x32_bf16 a[120:123], a[212:215], v[168:171], a[120:123]
  v_exp_f32 v185, v185
  v_mfma_f32_16x16x32_bf16 a[124:127], a[212:215], v[172:175], a[124:127]
  v_exp_f32 v186, v186
  v_mfma_f32_16x16x32_bf16 a[124:127], a[208:211], v[156:159], a[124:127]
  s_waitcnt vmcnt(21)
  ds_read_b128 a[148:151], v21 offset:49408
  v_add_f32 v45, v45, v183
  v_mfma_f32_16x16x32_bf16 a[200:203], v[30:33], a[184:187], a[200:203]
  s_waitcnt vmcnt(16)
  v_exp_f32 v187, v187
  v_mfma_f32_16x16x32_bf16 a[200:203], v[28:31], a[190:193], a[200:203]
  s_waitcnt vmcnt(14)
  v_add_f32 v46, v46, v184
  v_cvt_pk_bf16_f32 v202, v184, v185
  v_mfma_f32_16x16x32_bf16 a[200:203], v[26:29], a[196:199], a[200:203]
  v_add_f32 v46, v46, v185
  v_cvt_pk_bf16_f32 v203, v186, v187
  v_mfma_f32_16x16x32_bf16 a[204:207], v[28:31], a[186:189], a[204:207]
  buffer_load_dwordx4 a[172:175], v37, s[4:7], s99 offen offset:1024 sc1
  v_mfma_f32_16x16x32_bf16 a[204:207], v[28:31], a[194:197], a[204:207]
  s_waitcnt lgkmcnt(5)
  ds_read_b128 a[156:159], v21 offset:55296
  v_add_f32 v46, v46, v186
  v_mfma_f32_16x16x32_bf16 v[144:147], a[216:219], v[48:51], 0
  s_waitcnt lgkmcnt(5)
  v_exp_f32 v188, v188
  v_mfma_f32_16x16x32_bf16 v[144:147], a[220:223], v[64:67], v[144:147]
  s_waitcnt lgkmcnt(4)
  v_exp_f32 v189, v189
  v_mfma_f32_16x16x32_bf16 v[144:147], a[224:227], v[80:83], v[144:147]
  s_waitcnt lgkmcnt(3)
  v_exp_f32 v190, v190
  v_mfma_f32_16x16x32_bf16 v[144:147], a[228:231], v[96:99], v[144:147]
  s_waitcnt lgkmcnt(2)
  v_exp_f32 v191, v191
  v_mfma_f32_16x16x32_bf16 v[144:147], a[144:147], v[112:115], v[144:147]
  s_waitcnt lgkmcnt(1)
  v_add_f32 v46, v46, v187
  v_add_f32 v47, v47, v188
  v_mfma_f32_16x16x32_bf16 v[144:147], a[148:151], v[128:131], v[144:147]
  v_cvt_pk_bf16_f32 v206, v188, v189
  v_cvt_pk_bf16_f32 v207, v190, v191
  v_mfma_f32_16x16x32_bf16 v[148:151], a[148:151], v[132:135], 0
  ds_read_b128 a[152:155], v20 offset:55296
  v_add_f32 v47, v47, v189
  v_mfma_f32_16x16x32_bf16 v[148:151], a[144:147], v[116:119], v[148:151]
  ds_read_b128 a[160:163], v20 offset:55424
  v_add_f32 v47, v47, v190
  v_mfma_f32_16x16x32_bf16 v[148:151], a[228:231], v[100:103], v[148:151]
  ds_read_b128 a[164:167], v21 offset:55424
  v_add_f32 v47, v47, v191
  v_mfma_f32_16x16x32_bf16 v[148:151], a[224:227], v[84:87], v[148:151]
  ds_read_b128 a[248:251], v20 offset:55552
  v_mfma_f32_16x16x32_bf16 v[148:151], a[220:223], v[68:71], v[148:151]
  v_exp_f32 v144, v144
  v_mfma_f32_16x16x32_bf16 v[148:151], a[216:219], v[52:55], v[148:151]
  ds_read_b128 a[252:255], v21 offset:55552
  v_add_f32 v44, v44, v144
  v_mfma_f32_16x16x32_bf16 v[152:155], a[216:219], v[56:59], 0
  buffer_load_dwordx4 a[176:179], v37, s[4:7], s99 offen offset:2048 sc1
  v_mfma_f32_16x16x32_bf16 v[152:155], a[220:223], v[72:75], v[152:155]
L_pg14:
  s_cbranch_execz L_hop3
  ds_read_b96 v[18:20], v18 offset:2048
  v_mfma_f32_16x16x32_bf16 v[152:155], a[224:227], v[88:91], v[152:155]
  v_permlane32_swap_b32 v28, v30
  v_permlane32_swap_b32 v29, v31
  v_mfma_f32_16x16x32_bf16 v[152:155], a[228:231], v[104:107], v[152:155]
  v_exp_f32 v145, v145
  v_mfma_f32_16x16x32_bf16 v[152:155], a[144:147], v[120:123], v[152:155]
  v_exp_f32 v146, v146
  v_mfma_f32_16x16x32_bf16 v[152:155], a[148:151], v[136:139], v[152:155]
  v_add_f32 v44, v44, v145
  v_cvt_pk_bf16_f32 v144, v144, v145
  v_mfma_f32_16x16x32_bf16 v[156:159], a[148:151], v[140:143], 0
  v_exp_f32 v147, v147
  v_mfma_f32_16x16x32_bf16 v[156:159], a[144:147], v[124:127], v[156:159]
  s_waitcnt lgkmcnt(1)
  s_barrier
  v_add_f32 v44, v44, v146
  v_mfma_f32_16x16x32_bf16 v[156:159], a[228:231], v[108:111], v[156:159]
  v_add_f32 v44, v44, v147
  v_cvt_pk_bf16_f32 v145, v146, v147
  v_mfma_f32_16x16x32_bf16 v[156:159], a[224:227], v[92:95], v[156:159]
  v_exp_f32 v148, v148
  v_mfma_f32_16x16x32_bf16 v[156:159], a[220:223], v[76:79], v[156:159]
  s_add_u32 m0, s74, 0
  v_add_f32 v45, v45, v148
  v_mfma_f32_16x16x32_bf16 v[156:159], a[216:219], v[60:63], v[156:159]
  s_add_u32 s51, s92, 204800
  v_exp_f32 v149, v149
  v_mfma_f32_16x16x32_bf16 v[176:179], a[152:155], v[48:51], 0
  s_lshl_b32 s76, s73, 2
  v_exp_f32 v150, v150
  v_mfma_f32_16x16x32_bf16 v[176:179], a[156:159], v[64:67], v[176:179]
  s_lshr_b32 s77, s44, 1
  v_exp_f32 v151, v151
  v_mfma_f32_16x16x32_bf16 v[176:179], a[160:163], v[80:83], v[176:179]
  s_add_u32 s76, s76, s77
  v_add_f32 v45, v45, v149
  v_cvt_pk_bf16_f32 v148, v148, v149
  v_mfma_f32_16x16x32_bf16 v[176:179], a[164:167], v[96:99], v[176:179]
  buffer_load_dwordx4 a[180:183], v37, s[4:7], s99 offen offset:3072 sc1
  v_mfma_f32_16x16x32_bf16 v[176:179], a[248:251], v[112:115], v[176:179]
  s_lshl_b32 s76, s76, 1
  v_add_f32 v45, v45, v150
  v_mfma_f32_16x16x32_bf16 v[176:179], a[252:255], v[128:131], v[176:179]
  s_mul_i32 s77, s44, 96
  v_add_f32 v45, v45, v151
  v_cvt_pk_bf16_f32 v149, v150, v151
  v_mfma_f32_16x16x32_bf16 v[180:183], a[252:255], v[132:135], 0
  buffer_load_dwordx4 v34, s[24:27], s51 offen offset:0  lds
  v_mfma_f32_16x16x32_bf16 v[180:183], a[248:251], v[116:119], v[180:183]
  s_lshr_b32 s49, s2, 3
  v_exp_f32 v152, v152
  v_mfma_f32_16x16x32_bf16 v[180:183], a[164:167], v[100:103], v[180:183]
  s_lshl_b32 s49, s49, 2
  v_exp_f32 v153, v153
  v_mfma_f32_16x16x32_bf16 v[180:183], a[160:163], v[84:87], v[180:183]
  buffer_load_dwordx4 v35, s[24:27], s51 offen offset:1024  lds
  v_mfma_f32_16x16x32_bf16 v[180:183], a[156:159], v[68:71], v[180:183]
  s_add_u32 s49, s49, s72
  v_exp_f32 v154, v154
  v_mfma_f32_16x16x32_bf16 v[180:183], a[152:155], v[52:55], v[180:183]
  s_add_u32 s53, s15, 12288
  v_exp_f32 v155, v155
  v_mfma_f32_16x16x32_bf16 v[184:187], a[152:155], v[56:59], 0
  s_lshl_b32 s49, s49, 7
  v_add_f32 v46, v46, v152
  v_cvt_pk_bf16_f32 v152, v152, v153
  v_mfma_f32_16x16x32_bf16 v[184:187], a[156:159], v[72:75], v[184:187]
  s_add_u32 s49, s49, 6144
  v_exp_f32 v156, v156
  v_mfma_f32_16x16x32_bf16 v[184:187], a[160:163], v[88:91], v[184:187]
  s_getpc_b64 s[82:83]
  v_exp_f32 v157, v157
  v_mfma_f32_16x16x32_bf16 v[184:187], a[164:167], v[104:107], v[184:187]
  s_add_u32 s77, s77, s72
  ds_read_b64_tr_b16 a[208:209], v9 offset:36864
  v_add_f32 v46, v46, v153
  v_mfma_f32_16x16x32_bf16 v[184:187], a[248:251], v[120:123], v[184:187]
  s_sub_u32 s76, s76, s77
  ds_read_b64_tr_b16 a[210:211], v9 offset:43008
  v_cvt_pk_bf16_f32 v153, v154, v155
  v_mfma_f32_16x16x32_bf16 v[184:187], a[252:255], v[136:139], v[184:187]
  s_mul_i32 s76, s76, 10240
  ds_read_b64_tr_b16 a[212:213], v1 offset:12288
  v_add_u32 v34, 159744, v37
  v_mfma_f32_16x16x32_bf16 v[188:191], a[252:255], v[140:143], 0
  s_lshl_b32 s77, s98, 5
  ds_read_b64_tr_b16 a[214:215], v1 offset:18432
  v_add_f32 v46, v46, v154
  v_mfma_f32_16x16x32_bf16 v[188:191], a[248:251], v[124:127], v[188:191]
  buffer_load_dwordx4 a[184:187], v37, s[4:7], s53 offen offset:0 sc1
  v_mfma_f32_16x16x32_bf16 v[188:191], a[164:167], v[108:111], v[188:191]
  s_add_u32 s77, s77, s76
  ds_read_b64_tr_b16 a[216:217], v10 offset:36864
  v_mov_b32 v38, s49
  v_mfma_f32_16x16x32_bf16 v[188:191], a[160:163], v[92:95], v[188:191]
  s_add_u32 s77, s77, s95
  v_exp_f32 v158, v158
  v_mfma_f32_16x16x32_bf16 v[188:191], a[156:159], v[76:79], v[188:191]
  s_add_u32 s76, s76, s93
  v_exp_f32 v159, v159
  v_mfma_f32_16x16x32_bf16 v[188:191], a[152:155], v[60:63], v[188:191]
  global_load_dword v38, v38, s[82:83]
  s_waitcnt vmcnt(19)
  v_mfma_f32_16x16x32_bf16 v[22:25], v[28:31], a[128:131], 0
  buffer_load_dwordx4 v36, s[24:27], s51 offen offset:2048  lds
  s_waitcnt vmcnt(17)
  v_mfma_f32_16x16x32_bf16 v[22:25], v[28:31], a[132:135], v[22:25]
  s_waitcnt vmcnt(12)
  s_add_u32 m0, s74, 147456
  ds_read_b96 v[34:36], v34 offset:1024
  v_add_f32 v46, v46, v155
  v_mfma_f32_16x16x32_bf16 v[22:25], v[28:31], a[136:139], v[22:25]
  s_add_u32 s54, s95, 0
  ds_read_b64_tr_b16 a[218:219], v10 offset:43008
  v_add_f32 v47, v47, v156
  v_mfma_f32_16x16x32_bf16 v[22:25], v[28:31], a[140:143], v[22:25]
  s_waitcnt lgkmcnt(5)
  ds_read_b64_tr_b16 a[220:221], v2 offset:12288
  ds_read_b64_tr_b16 a[222:223], v2 offset:18432
  v_mfma_f32_16x16x32_bf16 v[220:223], a[208:211], v[172:175], v[220:223]
  s_waitcnt lgkmcnt(5)
  v_add_f32 v47, v47, v157
  v_cvt_pk_bf16_f32 v156, v156, v157
  v_mfma_f32_16x16x32_bf16 v[220:223], a[212:215], v[204:207], v[220:223]
  ds_read_b64_tr_b16 a[224:225], v11 offset:36864
  v_add_f32 v47, v47, v158
  v_mfma_f32_16x16x32_bf16 v[216:219], a[212:215], v[200:203], v[216:219]
  v_exp_f32 v176, v176
  v_mfma_f32_16x16x32_bf16 v[216:219], a[208:211], v[168:171], v[216:219]
  ds_read_b64_tr_b16 a[226:227], v11 offset:43008
  v_cvt_pk_bf16_f32 v157, v158, v159
  v_mfma_f32_16x16x32_bf16 v[212:215], a[208:211], v[164:167], v[212:215]
  s_waitcnt lgkmcnt(5)
  buffer_load_dwordx4 v34, s[24:27], s54 offen offset:0  lds
  v_mfma_f32_16x16x32_bf16 v[212:215], a[212:215], v[196:199], v[212:215]
  buffer_load_dwordx4 a[188:191], v37, s[4:7], s53 offen offset:1024 sc1
  v_mfma_f32_16x16x32_bf16 v[208:211], a[212:215], v[192:195], v[208:211]
  ds_read_b64_tr_b16 a[228:229], v3 offset:12288
  v_add_f32 v47, v47, v159
  v_mfma_f32_16x16x32_bf16 v[208:211], a[208:211], v[160:163], v[208:211]
  s_waitcnt lgkmcnt(5)
  ds_read_b64_tr_b16 a[230:231], v3 offset:18432
  v_add_f32 v44, v44, v176
  v_mfma_f32_16x16x32_bf16 v[224:227], a[216:219], v[160:163], v[224:227]
  s_waitcnt lgkmcnt(4)
  v_exp_f32 v177, v177
  v_mfma_f32_16x16x32_bf16 v[224:227], a[220:223], v[192:195], v[224:227]
  v_exp_f32 v178, v178
  v_mfma_f32_16x16x32_bf16 v[228:231], a[220:223], v[196:199], v[228:231]
  v_exp_f32 v179, v179
  v_mfma_f32_16x16x32_bf16 v[228:231], a[216:219], v[164:167], v[228:231]
  ds_read_b64_tr_b16 a[144:145], v12 offset:36864
  v_cvt_pk_bf16_f32 v146, v176, v177
  v_mfma_f32_16x16x32_bf16 v[232:235], a[216:219], v[168:171], v[232:235]
  buffer_load_dwordx4 v35, s[24:27], s54 offen offset:1024  lds
  v_mfma_f32_16x16x32_bf16 v[232:235], a[220:223], v[200:203], v[232:235]
  ds_read_b64_tr_b16 a[146:147], v12 offset:43008
  ds_read_b64_tr_b16 a[148:149], v4 offset:12288
  v_mfma_f32_16x16x32_bf16 v[236:239], a[220:223], v[204:207], v[236:239]
  ds_read_b64_tr_b16 a[150:151], v4 offset:18432
  v_cvt_pk_bf16_f32 v147, v178, v179
  v_mfma_f32_16x16x32_bf16 v[236:239], a[216:219], v[172:175], v[236:239]
  s_waitcnt lgkmcnt(6)
  v_permlane32_swap_b32 v28, v30
  v_permlane32_swap_b32 v29, v31
  v_mfma_f32_16x16x32_bf16 v[252:255], a[224:227], v[172:175], v[252:255]
  s_waitcnt lgkmcnt(4)
  v_exp_f32 v180, v180
  v_mfma_f32_16x16x32_bf16 v[252:255], a[228:231], v[204:207], v[252:255]
  v_exp_f32 v181, v181
  v_mfma_f32_16x16x32_bf16 v[248:251], a[228:231], v[200:203], v[248:251]
  v_exp_f32 v182, v182
  v_mfma_f32_16x16x32_bf16 v[248:251], a[224:227], v[168:171], v[248:251]
  ds_read_b64_tr_b16 a[152:153], v9 offset:36992
  v_add_f32 v44, v44, v177
  v_mfma_f32_16x16x32_bf16 v[244:247], a[224:227], v[164:167], v[244:247]
  buffer_load_dwordx4 a[192:195], v37, s[4:7], s53 offen offset:2048 sc1
  v_mfma_f32_16x16x32_bf16 v[244:247], a[228:231], v[196:199], v[244:247]
  buffer_load_dwordx4 v36, s[24:27], s54 offen offset:2048  lds
  v_mfma_f32_16x16x32_bf16 v[240:243], a[228:231], v[192:195], v[240:243]
  s_add_u32 m0, s74, 61440
  ds_read_b64_tr_b16 a[154:155], v9 offset:43136
  v_add_f32 v44, v44, v178
  v_mfma_f32_16x16x32_bf16 v[240:243], a[224:227], v[160:163], v[240:243]
  s_waitcnt lgkmcnt(4)
  s_add_u32 s52, s95, 81920
  ds_read_b64_tr_b16 a[156:157], v1 offset:12416
  ds_read_b64_tr_b16 a[158:159], v1 offset:18560
  v_mfma_f32_16x16x32_bf16 a[232:235], a[144:147], v[160:163], a[232:235]
  s_waitcnt lgkmcnt(4)
  v_exp_f32 v183, v183
  v_mfma_f32_16x16x32_bf16 a[232:235], a[148:151], v[192:195], a[232:235]
  v_add_f32 v44, v44, v179
  v_add_f32 v45, v45, v180
  v_mfma_f32_16x16x32_bf16 a[236:239], a[148:151], v[196:199], a[236:239]
  v_cvt_pk_bf16_f32 v150, v180, v181
  v_cvt_pk_bf16_f32 v151, v182, v183
  v_mfma_f32_16x16x32_bf16 a[236:239], a[144:147], v[164:167], a[236:239]
  v_exp_f32 v184, v184
  v_mfma_f32_16x16x32_bf16 a[240:243], a[144:147], v[168:171], a[240:243]
  ds_read_b64_tr_b16 a[160:161], v10 offset:36992
  v_add_f32 v45, v45, v181
  v_mfma_f32_16x16x32_bf16 a[240:243], a[148:151], v[200:203], a[240:243]
  buffer_load_dwordx4 v34, s[24:27], s52 offen offset:0  lds
  v_mfma_f32_16x16x32_bf16 a[244:247], a[148:151], v[204:207], a[244:247]
  ds_read_b64_tr_b16 a[162:163], v10 offset:43136
  v_add_f32 v45, v45, v182
  v_mfma_f32_16x16x32_bf16 a[244:247], a[144:147], v[172:175], a[244:247]
  s_waitcnt lgkmcnt(4)
  ds_read_b64_tr_b16 a[164:165], v2 offset:12416
  ds_read_b64_tr_b16 a[166:167], v2 offset:18560
  v_mfma_f32_16x16x32_bf16 a[12:15], a[152:155], v[172:175], a[12:15]
  s_waitcnt lgkmcnt(4)
  v_exp_f32 v185, v185
  v_mfma_f32_16x16x32_bf16 a[12:15], a[156:159], v[204:207], a[12:15]
  v_exp_f32 v186, v186
  v_mfma_f32_16x16x32_bf16 a[8:11], a[156:159], v[200:203], a[8:11]
  buffer_load_dwordx4 a[196:199], v37, s[4:7], s53 offen offset:3072 sc1
  v_mfma_f32_16x16x32_bf16 a[8:11], a[152:155], v[168:171], a[8:11]
  v_exp_f32 v187, v187
  v_mfma_f32_16x16x32_bf16 a[4:7], a[152:155], v[164:167], a[4:7]
  v_add_f32 v45, v45, v183
  v_add_f32 v46, v46, v184
  v_mfma_f32_16x16x32_bf16 a[4:7], a[156:159], v[196:199], a[4:7]
  buffer_load_dwordx4 v35, s[24:27], s52 offen offset:1024  lds
  v_mfma_f32_16x16x32_bf16 a[0:3], a[156:159], v[192:195], a[0:3]
  v_cvt_pk_bf16_f32 v154, v184, v185
  v_cvt_pk_bf16_f32 v155, v186, v187
  v_mfma_f32_16x16x32_bf16 a[0:3], a[152:155], v[160:163], a[0:3]
  s_waitcnt lgkmcnt(2)
  v_exp_f32 v188, v188
  v_mfma_f32_16x16x32_bf16 a[16:19], a[160:163], v[160:163], a[16:19]
  s_waitcnt lgkmcnt(0)
  v_exp_f32 v189, v189
  v_mfma_f32_16x16x32_bf16 a[16:19], a[164:167], v[192:195], a[16:19]
  v_exp_f32 v190, v190
  v_mfma_f32_16x16x32_bf16 a[20:23], a[164:167], v[196:199], a[20:23]
  v_exp_f32 v191, v191
  v_mfma_f32_16x16x32_bf16 a[20:23], a[160:163], v[164:167], a[20:23]
  ds_read_b128 a[248:251], v16 offset:36864
  ds_read_b128 a[252:255], v17 offset:36864
  v_mfma_f32_16x16x32_bf16 a[24:27], a[160:163], v[168:171], a[24:27]
  ds_read_b128 a[208:211], v16 offset:36992
  v_add_u32 v42, 159744, v37
  v_mfma_f32_16x16x32_bf16 a[24:27], a[164:167], v[200:203], a[24:27]
  buffer_load_dwordx4 v36, s[24:27], s52 offen offset:2048  lds
  v_mfma_f32_16x16x32_bf16 a[28:31], a[164:167], v[204:207], a[28:31]
  ds_read_b128 a[212:215], v17 offset:36992
  v_add_f32 v46, v46, v185
  v_mfma_f32_16x16x32_bf16 a[28:31], a[160:163], v[172:175], a[28:31]
  s_waitcnt vmcnt(18)
  ds_read_b128 a[216:219], v16 offset:37120
  v_add_f32 v46, v46, v186
  v_mfma_f32_16x16x32_bf16 a[128:131], v[30:33], a[168:171], 0
  s_waitcnt vmcnt(15)
  ds_read_b128 a[220:223], v17 offset:37120
  v_add_f32 v46, v46, v187
  v_mfma_f32_16x16x32_bf16 a[128:131], v[28:31], a[174:177], a[128:131]
  s_waitcnt vmcnt(14)
  v_add_f32 v47, v47, v188
  v_cvt_pk_bf16_f32 v158, v188, v189
  v_mfma_f32_16x16x32_bf16 a[128:131], v[26:29], a[180:183], a[128:131]
  ds_read_b64 v[42:43], v42 offset:3072
  v_add_f32 v47, v47, v189
  v_mfma_f32_16x16x32_bf16 a[132:135], v[28:31], a[170:173], 0
  v_add_f32 v47, v47, v190
  v_cvt_pk_bf16_f32 v159, v190, v191
  v_mfma_f32_16x16x32_bf16 a[132:135], v[28:31], a[178:181], a[132:135]
  s_waitcnt lgkmcnt(6)
  ds_read_b128 a[224:227], v16 offset:43008
  ds_read_b128 a[228:231], v17 offset:43008
  v_mfma_f32_16x16x32_bf16 v[160:163], a[248:251], v[48:51], 0
  s_waitcnt lgkmcnt(7)
  ds_read_b128 a[148:151], v17 offset:43136
  v_add_f32 v47, v47, v191
  v_mfma_f32_16x16x32_bf16 v[160:163], a[252:255], v[64:67], v[160:163]
  s_waitcnt lgkmcnt(7)
  ds_read_b128 a[144:147], v16 offset:43136
  v_mfma_f32_16x16x32_bf16 v[160:163], a[208:211], v[80:83], v[160:163]
  s_waitcnt lgkmcnt(7)
  ds_read_b128 a[152:155], v16 offset:43264
  v_mfma_f32_16x16x32_bf16 v[160:163], a[212:215], v[96:99], v[160:163]
  s_waitcnt lgkmcnt(7)
  ds_read_b128 a[156:159], v17 offset:43264
  v_add_u32 v16, 159744, v37
  v_mfma_f32_16x16x32_bf16 v[160:163], a[216:219], v[112:115], v[160:163]
  s_waitcnt lgkmcnt(7)
  ds_read_b64 v[16:17], v16 offset:3072
  ds_read_b64_tr_b16 a[160:161], v3 offset:12416
  v_mfma_f32_16x16x32_bf16 v[160:163], a[220:223], v[128:131], v[160:163]
  s_waitcnt lgkmcnt(8)
  buffer_load_dwordx4 a[136:139], v42, s[32:35], s76 offen offset:0 nt
  v_mfma_f32_16x16x32_bf16 v[164:167], a[220:223], v[132:135], 0
  buffer_load_dwordx4 a[140:143], v42, s[32:35], s76 offen offset:64 nt
  v_mfma_f32_16x16x32_bf16 v[164:167], a[216:219], v[116:119], v[164:167]
  ds_read_b64_tr_b16 a[162:163], v3 offset:18560
  v_mfma_f32_16x16x32_bf16 v[164:167], a[212:215], v[100:103], v[164:167]
  v_exp_f32 v160, v160
  v_mfma_f32_16x16x32_bf16 v[164:167], a[208:211], v[84:87], v[164:167]
  v_exp_f32 v161, v161
  v_mfma_f32_16x16x32_bf16 v[164:167], a[252:255], v[68:71], v[164:167]
  v_exp_f32 v162, v162
  v_mfma_f32_16x16x32_bf16 v[164:167], a[248:251], v[52:55], v[164:167]
  v_exp_f32 v163, v163
  v_mfma_f32_16x16x32_bf16 v[168:171], a[248:251], v[56:59], 0
  v_add_f32 v44, v44, v160
  v_cvt_pk_bf16_f32 v160, v160, v161
  v_mfma_f32_16x16x32_bf16 v[168:171], a[252:255], v[72:75], v[168:171]
  v_add_f32 v44, v44, v161
  v_cvt_pk_bf16_f32 v161, v162, v163
  v_mfma_f32_16x16x32_bf16 v[168:171], a[208:211], v[88:91], v[168:171]
  v_add_f32 v44, v44, v162
  v_mfma_f32_16x16x32_bf16 v[168:171], a[212:215], v[104:107], v[168:171]
  v_exp_f32 v164, v164
  v_mfma_f32_16x16x32_bf16 v[168:171], a[216:219], v[120:123], v[168:171]
  buffer_load_dwordx2 v[42:43], v43, s[32:35], s77 offen nt
  v_mfma_f32_16x16x32_bf16 v[168:171], a[220:223], v[136:139], v[168:171]
  v_exp_f32 v165, v165
  v_mfma_f32_16x16x32_bf16 v[172:175], a[220:223], v[140:143], 0
  v_exp_f32 v166, v166
  v_mfma_f32_16x16x32_bf16 v[172:175], a[216:219], v[124:127], v[172:175]
  s_waitcnt lgkmcnt(2)
  s_barrier
  v_exp_f32 v167, v167
  v_mfma_f32_16x16x32_bf16 v[172:175], a[212:215], v[108:111], v[172:175]
  v_add_f32 v44, v44, v163
  v_add_f32 v45, v45, v164
  v_mfma_f32_16x16x32_bf16 v[172:175], a[208:211], v[92:95], v[172:175]
  v_add_f32 v45, v45, v165
  v_cvt_pk_bf16_f32 v164, v164, v165
  v_mfma_f32_16x16x32_bf16 v[172:175], a[252:255], v[76:79], v[172:175]
  s_add_u32 m0, s74, 36864
  v_add_f32 v45, v45, v166
  v_cvt_pk_bf16_f32 v165, v166, v167
  v_mfma_f32_16x16x32_bf16 v[172:175], a[248:251], v[60:63], v[172:175]
  s_add_u32 s56, s95, 163840
  ds_read_b64_tr_b16 a[216:217], v2 offset:12544
  v_add_f32 v45, v45, v167
  v_mfma_f32_16x16x32_bf16 v[176:179], a[224:227], v[48:51], 0
  ds_read_b64_tr_b16 a[164:165], v7 offset:36992
  ds_read_b64_tr_b16 a[218:219], v2 offset:18688
  v_mfma_f32_16x16x32_bf16 v[176:179], a[228:231], v[64:67], v[176:179]
  ds_read_b64_tr_b16 a[166:167], v7 offset:43136
  ds_read_b64_tr_b16 a[212:213], v5 offset:37120
  v_mfma_f32_16x16x32_bf16 v[176:179], a[144:147], v[80:83], v[176:179]
  ds_read_b64_tr_b16 a[214:215], v5 offset:43264
  ds_read_b64_tr_b16 a[220:221], v6 offset:37120
  v_mfma_f32_16x16x32_bf16 v[176:179], a[148:151], v[96:99], v[176:179]
  v_exp_f32 v168, v168
  v_mfma_f32_16x16x32_bf16 v[176:179], a[152:155], v[112:115], v[176:179]
  v_exp_f32 v169, v169
  v_mfma_f32_16x16x32_bf16 v[176:179], a[156:159], v[128:131], v[176:179]
  v_exp_f32 v170, v170
  v_mfma_f32_16x16x32_bf16 v[180:183], a[156:159], v[132:135], 0
  v_exp_f32 v171, v171
  v_mfma_f32_16x16x32_bf16 v[180:183], a[152:155], v[116:119], v[180:183]
  ds_read_b64_tr_b16 a[222:223], v6 offset:43264
  v_add_f32 v46, v46, v168
  v_mfma_f32_16x16x32_bf16 v[180:183], a[148:151], v[100:103], v[180:183]
  ds_read_b64_tr_b16 a[208:209], v1 offset:12544
  v_cvt_pk_bf16_f32 v168, v168, v169
  v_mfma_f32_16x16x32_bf16 v[180:183], a[144:147], v[84:87], v[180:183]
  ds_read_b64_tr_b16 a[210:211], v1 offset:18688
  v_add_f32 v46, v46, v169
  v_mfma_f32_16x16x32_bf16 v[180:183], a[228:231], v[68:71], v[180:183]
  ds_read_b64_tr_b16 a[252:253], v8 offset:36992
  v_cvt_pk_bf16_f32 v169, v170, v171
  v_mfma_f32_16x16x32_bf16 v[180:183], a[224:227], v[52:55], v[180:183]
  buffer_load_dwordx4 v34, s[24:27], s56 offen offset:0  lds
  v_mfma_f32_16x16x32_bf16 v[184:187], a[224:227], v[56:59], 0
  ds_read_b64_tr_b16 a[254:255], v8 offset:43136
  v_mov_b32 v34, v18
  v_mfma_f32_16x16x32_bf16 v[184:187], a[228:231], v[72:75], v[184:187]
  ds_read_b64_tr_b16 a[248:249], v4 offset:12416
  v_add_f32 v46, v46, v170
  v_mfma_f32_16x16x32_bf16 v[184:187], a[144:147], v[88:91], v[184:187]
  ds_read_b64_tr_b16 a[250:251], v4 offset:18560
  v_add_f32 v46, v46, v171
  v_mfma_f32_16x16x32_bf16 v[184:187], a[148:151], v[104:107], v[184:187]
  v_exp_f32 v172, v172
  v_mfma_f32_16x16x32_bf16 v[184:187], a[152:155], v[120:123], v[184:187]
  v_exp_f32 v173, v173
  v_mfma_f32_16x16x32_bf16 v[184:187], a[156:159], v[136:139], v[184:187]
  v_exp_f32 v174, v174
  v_mfma_f32_16x16x32_bf16 v[188:191], a[156:159], v[140:143], 0
  buffer_load_dwordx4 v35, s[24:27], s56 offen offset:1024  lds
  v_mfma_f32_16x16x32_bf16 v[188:191], a[152:155], v[124:127], v[188:191]
  v_exp_f32 v175, v175
  v_mfma_f32_16x16x32_bf16 v[188:191], a[148:151], v[108:111], v[188:191]
  v_add_f32 v47, v47, v172
  v_cvt_pk_bf16_f32 v172, v172, v173
  v_mfma_f32_16x16x32_bf16 v[188:191], a[144:147], v[92:95], v[188:191]
  v_add_f32 v47, v47, v173
  v_cvt_pk_bf16_f32 v173, v174, v175
  v_mfma_f32_16x16x32_bf16 v[188:191], a[228:231], v[76:79], v[188:191]
  v_mov_b32 v35, v19
  v_add_f32 v47, v47, v174
  v_mfma_f32_16x16x32_bf16 v[188:191], a[224:227], v[60:63], v[188:191]
  s_waitcnt vmcnt(16)
  v_exp_f32 v176, v176
  v_mfma_f32_16x16x32_bf16 a[128:131], v[30:33], a[184:187], a[128:131]
  buffer_load_dwordx4 v36, s[24:27], s56 offen offset:2048  lds
  s_waitcnt vmcnt(11)
  v_mfma_f32_16x16x32_bf16 a[128:131], v[28:31], a[190:193], a[128:131]
  s_waitcnt vmcnt(8)
  s_add_u32 s57, s93, 0
  v_exp_f32 v177, v177
  v_mfma_f32_16x16x32_bf16 a[128:131], v[26:29], a[196:199], a[128:131]
  s_add_u32 m0, s74, 135168
  v_exp_f32 v178, v178
  v_mfma_f32_16x16x32_bf16 a[132:135], v[28:31], a[186:189], a[132:135]
  v_exp_f32 v179, v179
  v_mfma_f32_16x16x32_bf16 a[132:135], v[28:31], a[194:197], a[132:135]
  s_waitcnt lgkmcnt(14)
  v_add_f32 v47, v47, v175
  v_add_f32 v44, v44, v176
  v_mfma_f32_16x16x32_bf16 a[44:47], a[160:163], v[204:207], a[44:47]
  s_waitcnt lgkmcnt(10)
  v_cvt_pk_bf16_f32 v162, v176, v177
  v_cvt_pk_bf16_f32 v163, v178, v179
  v_mfma_f32_16x16x32_bf16 a[44:47], a[164:167], v[156:159], a[44:47]
  buffer_load_dwordx4 v34, s[24:27], s57 offen offset:0  lds
  v_mfma_f32_16x16x32_bf16 a[40:43], a[164:167], v[152:155], a[40:43]
  v_mov_b32 v36, v20
  v_add_f32 v44, v44, v177
  v_mfma_f32_16x16x32_bf16 a[40:43], a[160:163], v[200:203], a[40:43]
  v_exp_f32 v180, v180
  v_mfma_f32_16x16x32_bf16 a[36:39], a[160:163], v[196:199], a[36:39]
  v_exp_f32 v181, v181
  v_mfma_f32_16x16x32_bf16 a[36:39], a[164:167], v[148:151], a[36:39]
  v_exp_f32 v182, v182
  v_mfma_f32_16x16x32_bf16 a[32:35], a[164:167], v[144:147], a[32:35]
  s_waitcnt lgkmcnt(0)
  v_exp_f32 v183, v183
  v_mfma_f32_16x16x32_bf16 a[32:35], a[160:163], v[192:195], a[32:35]
  buffer_load_dwordx4 v35, s[24:27], s57 offen offset:1024  lds
  v_mfma_f32_16x16x32_bf16 a[48:51], a[248:251], v[192:195], a[48:51]
  v_add_f32 v44, v44, v178
  v_add_f32 v45, v45, v180
  v_mfma_f32_16x16x32_bf16 a[48:51], a[252:255], v[144:147], a[48:51]
  v_add_f32 v44, v44, v179
  v_add_f32 v45, v45, v181
  v_mfma_f32_16x16x32_bf16 a[52:55], a[252:255], v[148:151], a[52:55]
  v_cvt_pk_bf16_f32 v166, v180, v181
  v_add_f32 v45, v45, v182
  v_mfma_f32_16x16x32_bf16 a[52:55], a[248:251], v[196:199], a[52:55]
  v_add_f32 v45, v45, v183
  v_cvt_pk_bf16_f32 v167, v182, v183
  v_mfma_f32_16x16x32_bf16 a[56:59], a[248:251], v[200:203], a[56:59]
  v_exp_f32 v184, v184
  v_mfma_f32_16x16x32_bf16 a[56:59], a[252:255], v[152:155], a[56:59]
  buffer_load_dwordx4 v36, s[24:27], s57 offen offset:2048  lds
  v_mfma_f32_16x16x32_bf16 a[60:63], a[252:255], v[156:159], a[60:63]
  v_exp_f32 v185, v185
  v_mfma_f32_16x16x32_bf16 a[60:63], a[248:251], v[204:207], a[60:63]
  v_exp_f32 v186, v186
  v_mfma_f32_16x16x32_bf16 a[76:79], a[208:211], v[204:207], a[76:79]
  v_exp_f32 v187, v187
  v_mfma_f32_16x16x32_bf16 a[76:79], a[212:215], v[156:159], a[76:79]
  v_add_f32 v46, v46, v184
  v_permlane32_swap_b32 v44, v45
  v_mfma_f32_16x16x32_bf16 a[72:75], a[212:215], v[152:155], a[72:75]
  v_add_f32 v46, v46, v185
  v_add_f32 v44, v44, v45
  v_mfma_f32_16x16x32_bf16 a[72:75], a[208:211], v[200:203], a[72:75]
  ds_read_b64_tr_b16 a[228:229], v9 offset:12288
  ds_read_b64_tr_b16 a[230:231], v9 offset:18432
  v_mfma_f32_16x16x32_bf16 a[68:71], a[208:211], v[196:199], a[68:71]
  v_exp_f32 v188, v188
  v_mfma_f32_16x16x32_bf16 a[68:71], a[212:215], v[148:151], a[68:71]
  v_exp_f32 v189, v189
  v_mfma_f32_16x16x32_bf16 a[64:67], a[212:215], v[144:147], a[64:67]
  v_exp_f32 v190, v190
  v_mfma_f32_16x16x32_bf16 a[64:67], a[208:211], v[192:195], a[64:67]
  v_exp_f32 v191, v191
  v_mfma_f32_16x16x32_bf16 a[80:83], a[216:219], v[192:195], a[80:83]
  ds_read_b64_tr_b16 a[224:225], v5 offset:36864
  v_add_f32 v47, v47, v188
  v_mfma_f32_16x16x32_bf16 a[80:83], a[220:223], v[144:147], a[80:83]
  ds_read_b64_tr_b16 a[226:227], v5 offset:43008
  v_add_f32 v47, v47, v189
  v_mfma_f32_16x16x32_bf16 a[84:87], a[220:223], v[148:151], a[84:87]
  v_add_f32 v46, v46, v186
  v_add_f32 v47, v47, v190
  v_mfma_f32_16x16x32_bf16 a[84:87], a[216:219], v[196:199], a[84:87]
  v_add_f32 v46, v46, v187
  v_add_f32 v47, v47, v191
  v_mfma_f32_16x16x32_bf16 a[88:91], a[216:219], v[200:203], a[88:91]
  v_cvt_pk_bf16_f32 v170, v184, v185
  v_permlane32_swap_b32 v46, v47
  v_mfma_f32_16x16x32_bf16 a[88:91], a[220:223], v[152:155], a[88:91]
  v_cvt_pk_bf16_f32 v171, v186, v187
  v_add_f32 v46, v46, v47
  v_mfma_f32_16x16x32_bf16 a[92:95], a[220:223], v[156:159], a[92:95]
  v_cvt_pk_bf16_f32 v174, v188, v189
  v_permlane16_swap_b32 v44, v46
  v_mfma_f32_16x16x32_bf16 a[92:95], a[216:219], v[204:207], a[92:95]
  v_cvt_pk_bf16_f32 v175, v190, v191
  v_add_f32 v44, v44, v46
  v_subrev_u32 v45, 0x33800000, v44
  v_cmp_lt_u32 vcc, 0x18000000, v45
  s_nop 0
  s_cbranch_vccnz L_exact
L_exact_ret:
  s_waitcnt lgkmcnt(0)
  v_mfma_f32_16x16x32_bf16 v[220:223], a[224:227], v[156:159], v[220:223]
  ds_read_b64_tr_b16 a[144:145], v6 offset:36864
  ds_read_b64_tr_b16 a[148:149], v10 offset:12288
  v_mfma_f32_16x16x32_bf16 v[220:223], a[228:231], v[172:175], v[220:223]
  ds_read_b64_tr_b16 a[146:147], v6 offset:43008
  ds_read_b64_tr_b16 a[150:151], v10 offset:18432
  v_mfma_f32_16x16x32_bf16 v[216:219], a[228:231], v[168:171], v[216:219]
  ds_read_b64_tr_b16 a[156:157], v11 offset:12288
  v_mov_b32 v41, s40
  v_mfma_f32_16x16x32_bf16 v[216:219], a[224:227], v[152:155], v[216:219]
  ds_read_b64_tr_b16 a[152:153], v7 offset:36864
  v_add_u32 v41, 2, v41
  v_mfma_f32_16x16x32_bf16 v[212:215], a[224:227], v[148:151], v[212:215]
  v_rcp_f32 v44, v44
  v_mfma_f32_16x16x32_bf16 v[212:215], a[228:231], v[164:167], v[212:215]
  ds_read_b64_tr_b16 a[154:155], v7 offset:43008
  v_mov_b32 v46, v44
  v_mfma_f32_16x16x32_bf16 v[208:211], a[228:231], v[160:163], v[208:211]
  ds_read_b64_tr_b16 a[158:159], v11 offset:18432
  v_permlane16_swap_b32 v44, v46
  v_mfma_f32_16x16x32_bf16 v[208:211], a[224:227], v[144:147], v[208:211]
  s_waitcnt lgkmcnt(5)
  v_mov_b32 v18, v44
  v_mov_b32 v20, v46
  v_mfma_f32_16x16x32_bf16 v[224:227], a[144:147], v[144:147], v[224:227]
  s_waitcnt lgkmcnt(4)
  v_permlane32_swap_b32 v44, v18
  v_permlane32_swap_b32 v46, v20
  v_mfma_f32_16x16x32_bf16 v[224:227], a[148:151], v[160:163], v[224:227]
  v_mov_b32 v45, v44
  v_mov_b32 v19, v18
  v_mfma_f32_16x16x32_bf16 v[228:231], a[148:151], v[164:167], v[228:231]
  v_mov_b32 v47, v46
  v_mov_b32 v21, v20
  v_mfma_f32_16x16x32_bf16 v[228:231], a[144:147], v[148:151], v[228:231]
  v_mul_f32 v220, v20, v220
  v_mul_f32 v221, v20, v221
  v_mfma_f32_16x16x32_bf16 v[232:235], a[144:147], v[152:155], v[232:235]
  ds_read_b64_tr_b16 a[164:165], v12 offset:12288
  v_mul_f32 v222, v20, v222
  v_mfma_f32_16x16x32_bf16 v[232:235], a[148:151], v[168:171], v[232:235]
  ds_read_b64_tr_b16 a[160:161], v8 offset:36864
  v_mul_f32 v223, v20, v223
  v_mfma_f32_16x16x32_bf16 v[236:239], a[148:151], v[172:175], v[236:239]
  ds_read_b64_tr_b16 a[162:163], v8 offset:43008
  v_mul_f32 v216, v46, v216
  v_mfma_f32_16x16x32_bf16 v[236:239], a[144:147], v[156:159], v[236:239]
  s_waitcnt lgkmcnt(4)
  ds_read_b64_tr_b16 a[166:167], v12 offset:18432
  v_mul_f32 v217, v46, v217
  v_mfma_f32_16x16x32_bf16 v[252:255], a[152:155], v[156:159], v[252:255]
  s_waitcnt lgkmcnt(4)
  v_mul_f32 v218, v46, v218
  v_mul_f32 v219, v46, v219
  v_mfma_f32_16x16x32_bf16 v[252:255], a[156:159], v[172:175], v[252:255]
  v_cvt_pk_bf16_f32 v60, v220, v221
  v_cvt_pk_bf16_f32 v61, v222, v223
  v_mfma_f32_16x16x32_bf16 v[248:251], a[156:159], v[168:171], v[248:251]
  v_cvt_pk_bf16_f32 v56, v216, v217
  v_cvt_pk_bf16_f32 v57, v218, v219
  v_mfma_f32_16x16x32_bf16 v[248:251], a[152:155], v[152:155], v[248:251]
  v_mul_f32 v212, v18, v212
  v_and_b32 v60, -2, v60
  v_mfma_f32_16x16x32_bf16 v[244:247], a[152:155], v[148:151], v[244:247]
  ds_read_b64_tr_b16 a[252:253], v9 offset:12416
  v_mul_f32 v213, v18, v213
  v_mfma_f32_16x16x32_bf16 v[244:247], a[156:159], v[164:167], v[244:247]
  ds_read_b64_tr_b16 a[248:249], v5 offset:36992
  v_mul_f32 v214, v18, v214
  v_mfma_f32_16x16x32_bf16 v[240:243], a[156:159], v[160:163], v[240:243]
  ds_read_b64_tr_b16 a[250:251], v5 offset:43136
  v_mul_f32 v215, v18, v215
  v_mfma_f32_16x16x32_bf16 v[240:243], a[152:155], v[144:147], v[240:243]
  s_waitcnt lgkmcnt(4)
  ds_read_b64_tr_b16 a[254:255], v9 offset:18560
  v_mul_f32 v208, v44, v208
  v_cvt_pk_bf16_f32 v52, v212, v213
  v_cvt_pk_bf16_f32 v53, v214, v215
  v_and_b32 v56, -2, v56
  v_pk_mul_f32 v[224:225], v[224:225], v[44:45]
  v_pk_mul_f32 v[226:227], v[226:227], v[44:45]
  v_pk_mul_f32 v[228:229], v[228:229], v[18:19]
  v_pk_mul_f32 v[230:231], v[230:231], v[18:19]
  v_pk_mul_f32 v[232:233], v[232:233], v[46:47]
  v_pk_mul_f32 v[234:235], v[234:235], v[46:47]
  v_pk_mul_f32 v[236:237], v[236:237], v[20:21]
  v_pk_mul_f32 v[238:239], v[238:239], v[20:21]
  s_nop 0
  v_mfma_f32_16x16x32_bf16 a[232:235], a[160:163], v[144:147], a[232:235]
  s_waitcnt lgkmcnt(4)
  v_mul_f32 v209, v44, v209
  v_mul_f32 v210, v44, v210
  v_mfma_f32_16x16x32_bf16 a[232:235], a[164:167], v[160:163], a[232:235]
  v_mul_f32 v211, v44, v211
  v_and_b32 v52, -2, v52
  v_mfma_f32_16x16x32_bf16 a[236:239], a[164:167], v[164:167], a[236:239]
  v_cvt_pk_bf16_f32 v48, v208, v209
  v_cvt_pk_bf16_f32 v49, v210, v211
  v_mfma_f32_16x16x32_bf16 a[236:239], a[160:163], v[148:151], a[236:239]
  v_cvt_pk_bf16_f32 v50, v224, v225
  v_and_b32 v48, -2, v48
  v_mfma_f32_16x16x32_bf16 a[240:243], a[160:163], v[152:155], a[240:243]
  s_add_u32 s58, s88, 0
  ds_read_b64_tr_b16 a[212:213], v10 offset:12416
  v_cvt_pk_bf16_f32 v51, v226, v227
  v_mfma_f32_16x16x32_bf16 a[240:243], a[164:167], v[168:171], a[240:243]
  ds_read_b64_tr_b16 a[208:209], v6 offset:36992
  v_cvt_pk_bf16_f32 v54, v228, v229
  v_mfma_f32_16x16x32_bf16 a[244:247], a[164:167], v[172:175], a[244:247]
  ds_read_b64_tr_b16 a[210:211], v6 offset:43136
  v_cvt_pk_bf16_f32 v55, v230, v231
  v_mfma_f32_16x16x32_bf16 a[244:247], a[160:163], v[156:159], a[244:247]
  s_waitcnt lgkmcnt(4)
  ds_read_b64_tr_b16 a[214:215], v10 offset:18560
  v_cvt_pk_bf16_f32 v58, v232, v233
  v_cvt_pk_bf16_f32 v59, v234, v235
  v_cvt_pk_bf16_f32 v62, v236, v237
  v_cvt_pk_bf16_f32 v63, v238, v239
  v_pk_mul_f32 v[240:241], v[240:241], v[44:45]
  v_pk_mul_f32 v[242:243], v[242:243], v[44:45]
  v_pk_mul_f32 v[244:245], v[244:245], v[18:19]
  v_pk_mul_f32 v[246:247], v[246:247], v[18:19]
  v_pk_mul_f32 v[248:249], v[248:249], v[46:47]
  v_pk_mul_f32 v[250:251], v[250:251], v[46:47]
  v_pk_mul_f32 v[252:253], v[252:253], v[20:21]
  v_pk_mul_f32 v[254:255], v[254:255], v[20:21]
  s_nop 0
  v_mfma_f32_16x16x32_bf16 a[12:15], a[248:251], v[156:159], a[12:15]
L_pg15:
  s_cbranch_execz L_hop3
  s_waitcnt lgkmcnt(4)
  v_accvgpr_read_b32 v64, a232
  v_accvgpr_read_b32 v65, a233
  v_mfma_f32_16x16x32_bf16 a[12:15], a[252:255], v[172:175], a[12:15]
  v_accvgpr_read_b32 v66, a234
  v_accvgpr_read_b32 v67, a235
  v_mfma_f32_16x16x32_bf16 a[8:11], a[252:255], v[168:171], a[8:11]
  v_accvgpr_read_b32 v68, a236
  v_accvgpr_read_b32 v69, a237
  v_mfma_f32_16x16x32_bf16 a[8:11], a[248:251], v[152:155], a[8:11]
  v_accvgpr_read_b32 v70, a238
  v_accvgpr_read_b32 v71, a239
  v_mfma_f32_16x16x32_bf16 a[4:7], a[248:251], v[148:151], a[4:7]
  buffer_store_dwordx4 v[48:51], v37, s[4:7], s58 offen offset:0
  v_mfma_f32_16x16x32_bf16 a[4:7], a[252:255], v[164:167], a[4:7]
  ds_read_b64_tr_b16 a[216:217], v11 offset:12416
  v_accvgpr_read_b32 v72, a240
  v_mfma_f32_16x16x32_bf16 a[0:3], a[252:255], v[160:163], a[0:3]
  ds_read_b64_tr_b16 a[218:219], v11 offset:18560
  v_accvgpr_read_b32 v73, a241
  v_mfma_f32_16x16x32_bf16 a[0:3], a[248:251], v[144:147], a[0:3]
  s_waitcnt lgkmcnt(3)
  v_accvgpr_read_b32 v74, a242
  v_accvgpr_read_b32 v75, a243
  v_mfma_f32_16x16x32_bf16 a[16:19], a[208:211], v[144:147], a[16:19]
  s_waitcnt lgkmcnt(2)
  v_accvgpr_read_b32 v76, a244
  v_accvgpr_read_b32 v77, a245
  v_mfma_f32_16x16x32_bf16 a[16:19], a[212:215], v[160:163], a[16:19]
  ds_read_b64_tr_b16 a[220:221], v12 offset:12416
  v_accvgpr_read_b32 v78, a246
  v_mfma_f32_16x16x32_bf16 a[20:23], a[212:215], v[164:167], a[20:23]
  ds_read_b64_tr_b16 a[222:223], v12 offset:18560
  v_accvgpr_read_b32 v79, a247
  v_mfma_f32_16x16x32_bf16 a[20:23], a[208:211], v[148:151], a[20:23]
  buffer_store_dwordx4 v[52:55], v37, s[4:7], s58 offen offset:1024
  v_mfma_f32_16x16x32_bf16 a[24:27], a[208:211], v[152:155], a[24:27]
  buffer_store_dwordx4 v[56:59], v37, s[4:7], s58 offen offset:2048
  v_mfma_f32_16x16x32_bf16 a[24:27], a[212:215], v[168:171], a[24:27]
  ds_read_b64_tr_b16 a[224:225], v9 offset:12544
  v_accvgpr_read_b32 v92, a12
  v_mfma_f32_16x16x32_bf16 a[28:31], a[212:215], v[172:175], a[28:31]
  ds_read_b64_tr_b16 a[226:227], v9 offset:18688
  v_accvgpr_read_b32 v93, a13
  v_mfma_f32_16x16x32_bf16 a[28:31], a[208:211], v[156:159], a[28:31]
  s_waitcnt lgkmcnt(4)
  v_accvgpr_read_b32 v94, a14
  v_accvgpr_read_b32 v95, a15
  v_mfma_f32_16x16x32_bf16 a[32:35], a[216:219], v[160:163], a[32:35]
  ds_read_b64_tr_b16 a[228:229], v10 offset:12544
  v_accvgpr_read_b32 v88, a8
  v_mfma_f32_16x16x32_bf16 a[36:39], a[216:219], v[164:167], a[36:39]
  ds_read_b64_tr_b16 a[230:231], v10 offset:18688
  v_accvgpr_read_b32 v89, a9
  v_mfma_f32_16x16x32_bf16 a[40:43], a[216:219], v[168:171], a[40:43]
  buffer_store_dwordx4 v[60:63], v37, s[4:7], s58 offen offset:3072
  v_mfma_f32_16x16x32_bf16 a[44:47], a[216:219], v[172:175], a[44:47]
  s_waitcnt lgkmcnt(4)
  ds_read_b64_tr_b16 a[148:149], v7 offset:37120
  v_accvgpr_read_b32 v84, a4
  v_accvgpr_read_b32 v85, a5
  v_accvgpr_read_b32 v90, a10
  v_accvgpr_read_b32 v91, a11
  v_pk_mul_f32 v[64:65], v[64:65], v[44:45]
  v_pk_mul_f32 v[66:67], v[66:67], v[44:45]
  v_pk_mul_f32 v[68:69], v[68:69], v[18:19]
  v_pk_mul_f32 v[70:71], v[70:71], v[18:19]
  v_pk_mul_f32 v[72:73], v[72:73], v[46:47]
  v_pk_mul_f32 v[74:75], v[74:75], v[46:47]
  v_pk_mul_f32 v[76:77], v[76:77], v[20:21]
  v_pk_mul_f32 v[78:79], v[78:79], v[20:21]
  s_nop 0
  v_mfma_f32_16x16x32_bf16 a[60:63], a[220:223], v[172:175], a[60:63]
  ds_read_b64_tr_b16 a[150:151], v7 offset:43264
  v_accvgpr_read_b32 v86, a6
  v_mfma_f32_16x16x32_bf16 a[56:59], a[220:223], v[168:171], a[56:59]
  ds_read_b64_tr_b16 a[144:145], v3 offset:12544
  v_accvgpr_read_b32 v87, a7
  v_mfma_f32_16x16x32_bf16 a[52:55], a[220:223], v[164:167], a[52:55]
  ds_read_b64_tr_b16 a[146:147], v3 offset:18688
  v_accvgpr_read_b32 v80, a0
  v_mfma_f32_16x16x32_bf16 a[48:51], a[220:223], v[160:163], a[48:51]
  s_waitcnt lgkmcnt(6)
  ds_read_b64_tr_b16 a[152:153], v11 offset:12544
  v_accvgpr_read_b32 v81, a1
  v_mfma_f32_16x16x32_bf16 a[64:67], a[224:227], v[160:163], a[64:67]
  ds_read_b64_tr_b16 a[154:155], v11 offset:18688
  v_accvgpr_read_b32 v82, a2
  v_mfma_f32_16x16x32_bf16 a[68:71], a[224:227], v[164:167], a[68:71]
  v_accvgpr_read_b32 v83, a3
  v_accvgpr_read_b32 v112, a16
  v_mfma_f32_16x16x32_bf16 a[72:75], a[224:227], v[168:171], a[72:75]
  v_accvgpr_read_b32 v113, a17
  v_accvgpr_read_b32 v114, a18
  v_mfma_f32_16x16x32_bf16 a[76:79], a[224:227], v[172:175], a[76:79]
  s_waitcnt lgkmcnt(6)
  v_accvgpr_read_b32 v115, a19
  v_accvgpr_read_b32 v116, a20
  v_mfma_f32_16x16x32_bf16 a[92:95], a[228:231], v[172:175], a[92:95]
  ds_read_b64_tr_b16 a[156:157], v4 offset:12544
  v_accvgpr_read_b32 v117, a21
  v_mfma_f32_16x16x32_bf16 a[88:91], a[228:231], v[168:171], a[88:91]
  ds_read_b64_tr_b16 a[158:159], v4 offset:18688
  v_cvt_pk_bf16_f32 v67, v66, v67
  v_mfma_f32_16x16x32_bf16 a[84:87], a[228:231], v[164:167], a[84:87]
  ds_read_b64_tr_b16 a[164:165], v12 offset:12544
  v_cvt_pk_bf16_f32 v66, v64, v65
  v_mfma_f32_16x16x32_bf16 a[80:83], a[228:231], v[160:163], a[80:83]
  s_waitcnt lgkmcnt(5)
  ds_read_b64_tr_b16 a[166:167], v12 offset:18688
  v_cvt_pk_bf16_f32 v64, v240, v241
  v_mfma_f32_16x16x32_bf16 a[108:111], a[144:147], v[204:207], a[108:111]
  s_waitcnt lgkmcnt(4)
  ds_read_b64_tr_b16 a[160:161], v8 offset:37120
  v_cvt_pk_bf16_f32 v65, v242, v243
  v_mfma_f32_16x16x32_bf16 a[108:111], a[148:151], v[156:159], a[108:111]
  s_add_u32 s81, s88, 4096
  ds_read_b64_tr_b16 a[162:163], v8 offset:43264
  v_and_b32 v64, -2, v64
  v_mfma_f32_16x16x32_bf16 a[108:111], a[152:155], v[172:175], a[108:111]
  buffer_store_dwordx4 v[64:67], v37, s[4:7], s81 offen offset:0
  v_mfma_f32_16x16x32_bf16 a[104:107], a[152:155], v[168:171], a[104:107]
  v_accvgpr_read_b32 v118, a22
  v_accvgpr_read_b32 v119, a23
  v_mfma_f32_16x16x32_bf16 a[104:107], a[148:151], v[152:155], a[104:107]
  v_accvgpr_read_b32 v120, a24
  v_accvgpr_read_b32 v121, a25
  v_mfma_f32_16x16x32_bf16 a[104:107], a[144:147], v[200:203], a[104:107]
  v_cvt_pk_bf16_f32 v71, v70, v71
  v_cvt_pk_bf16_f32 v70, v68, v69
  v_cvt_pk_bf16_f32 v68, v244, v245
  v_cvt_pk_bf16_f32 v69, v246, v247
  v_accvgpr_read_b32 v122, a26
  v_pk_mul_f32 v[80:81], v[80:81], v[44:45]
  v_pk_mul_f32 v[82:83], v[82:83], v[44:45]
  v_pk_mul_f32 v[84:85], v[84:85], v[18:19]
  v_pk_mul_f32 v[86:87], v[86:87], v[18:19]
  v_pk_mul_f32 v[88:89], v[88:89], v[46:47]
  v_pk_mul_f32 v[90:91], v[90:91], v[46:47]
  v_pk_mul_f32 v[92:93], v[92:93], v[20:21]
  v_pk_mul_f32 v[94:95], v[94:95], v[20:21]
  s_nop 0
  v_mfma_f32_16x16x32_bf16 a[100:103], a[144:147], v[196:199], a[100:103]
  v_cvt_pk_bf16_f32 v75, v74, v75
  v_cvt_pk_bf16_f32 v74, v72, v73
  v_mfma_f32_16x16x32_bf16 a[100:103], a[148:151], v[148:151], a[100:103]
  s_waitcnt vmcnt(5) lgkmcnt(0)
  s_barrier
  v_cvt_pk_bf16_f32 v72, v248, v249
  v_cvt_pk_bf16_f32 v73, v250, v251
  v_mfma_f32_16x16x32_bf16 a[100:103], a[152:155], v[164:167], a[100:103]
  v_and_b32 v68, -2, v68
  v_and_b32 v72, -2, v72
  v_mfma_f32_16x16x32_bf16 a[96:99], a[152:155], v[160:163], a[96:99]
  buffer_store_dwordx4 v[68:71], v37, s[4:7], s81 offen offset:1024
  v_mfma_f32_16x16x32_bf16 a[96:99], a[148:151], v[144:147], a[96:99]
  buffer_store_dwordx4 v[72:75], v37, s[4:7], s81 offen offset:2048
  v_mfma_f32_16x16x32_bf16 a[96:99], a[144:147], v[192:195], a[96:99]
  v_cvt_pk_bf16_f32 v79, v78, v79
  v_accvgpr_read_b32 v123, a27
  v_mfma_f32_16x16x32_bf16 a[112:115], a[156:159], v[192:195], a[112:115]
  ds_read_b64_tr_b16 a[208:209], v10 offset:256
  v_cvt_pk_bf16_f32 v78, v76, v77
  v_mfma_f32_16x16x32_bf16 a[112:115], a[160:163], v[144:147], a[112:115]
  s_add_u32 m0, s74, 12288
  ds_read_b64_tr_b16 a[210:211], v10 offset:6400
  v_cvt_pk_bf16_f32 v76, v252, v253
  v_mfma_f32_16x16x32_bf16 a[112:115], a[164:167], v[160:163], a[112:115]
  s_add_u32 s75, s94, 0
  ds_read_b64_tr_b16 a[212:213], v6 offset:256
  v_cvt_pk_bf16_f32 v77, v254, v255
  v_mfma_f32_16x16x32_bf16 a[116:119], a[164:167], v[164:167], a[116:119]
  ds_read_b64_tr_b16 a[214:215], v6 offset:6400
  v_and_b32 v76, -2, v76
  v_mfma_f32_16x16x32_bf16 a[116:119], a[160:163], v[148:151], a[116:119]
  buffer_store_dwordx4 v[76:79], v37, s[4:7], s81 offen offset:3072
  v_mfma_f32_16x16x32_bf16 a[116:119], a[156:159], v[196:199], a[116:119]
  v_accvgpr_read_b32 v124, a28
  v_accvgpr_read_b32 v125, a29
  v_mfma_f32_16x16x32_bf16 a[120:123], a[156:159], v[200:203], a[120:123]
  v_accvgpr_read_b32 v126, a30
  v_accvgpr_read_b32 v127, a31
  v_mfma_f32_16x16x32_bf16 a[120:123], a[160:163], v[152:155], a[120:123]
  v_accvgpr_read_b32 v96, a32
  v_accvgpr_read_b32 v97, a33
  v_mfma_f32_16x16x32_bf16 a[120:123], a[164:167], v[168:171], a[120:123]
  ds_read_b64_tr_b16 a[216:217], v10 offset:128
  v_accvgpr_read_b32 v98, a34
  v_mfma_f32_16x16x32_bf16 a[124:127], a[164:167], v[172:175], a[124:127]
  ds_read_b64_tr_b16 a[218:219], v10 offset:6272
  v_accvgpr_read_b32 v99, a35
  v_mfma_f32_16x16x32_bf16 a[124:127], a[160:163], v[156:159], a[124:127]
  ds_read_b64_tr_b16 a[220:221], v6 offset:128
  v_accvgpr_read_b32 v100, a36
  v_mfma_f32_16x16x32_bf16 a[124:127], a[156:159], v[204:207], a[124:127]
  s_waitcnt lgkmcnt(3)
  ds_read_b64_tr_b16 a[222:223], v6 offset:6272
  v_accvgpr_read_b32 v101, a37
  v_accvgpr_read_b32 v102, a38
  v_accvgpr_read_b32 v103, a39
  v_accvgpr_read_b32 v104, a40
  v_pk_mul_f32 v[112:113], v[112:113], v[44:45]
  v_pk_mul_f32 v[114:115], v[114:115], v[44:45]
  v_pk_mul_f32 v[116:117], v[116:117], v[18:19]
  v_pk_mul_f32 v[118:119], v[118:119], v[18:19]
  v_pk_mul_f32 v[120:121], v[120:121], v[46:47]
  v_pk_mul_f32 v[122:123], v[122:123], v[46:47]
  v_pk_mul_f32 v[124:125], v[124:125], v[20:21]
  v_pk_mul_f32 v[126:127], v[126:127], v[20:21]
  s_nop 0
  v_mfma_f32_16x16x32_bf16 a[156:159], a[208:211], v[60:63], 0
  buffer_load_dwordx4 v34, s[24:27], s75 offen offset:0  lds
  v_mfma_f32_16x16x32_bf16 a[156:159], a[212:215], v[76:79], a[156:159]
  v_accvgpr_read_b32 v105, a41
  v_accvgpr_read_b32 v106, a42
  v_mfma_f32_16x16x32_bf16 a[152:155], a[212:215], v[72:75], 0
  v_accvgpr_read_b32 v107, a43
  v_accvgpr_read_b32 v108, a44
  v_mfma_f32_16x16x32_bf16 a[152:155], a[208:211], v[56:59], a[152:155]
  v_accvgpr_read_b32 v109, a45
  v_accvgpr_read_b32 v110, a46
  v_mfma_f32_16x16x32_bf16 a[148:151], a[208:211], v[52:55], 0
  ds_read_b64_tr_b16 a[224:225], v12 offset:128
  v_accvgpr_read_b32 v111, a47
  v_mfma_f32_16x16x32_bf16 a[148:151], a[212:215], v[68:71], a[148:151]
  ds_read_b64_tr_b16 a[226:227], v12 offset:6272
  v_accvgpr_read_b32 v140, a60
  v_mfma_f32_16x16x32_bf16 a[144:147], a[212:215], v[64:67], 0
  ds_read_b64_tr_b16 a[228:229], v8 offset:128
  v_accvgpr_read_b32 v141, a61
  v_mfma_f32_16x16x32_bf16 a[144:147], a[208:211], v[48:51], a[144:147]
  s_waitcnt lgkmcnt(5)
  ds_read_b64_tr_b16 a[230:231], v8 offset:6272
  v_accvgpr_read_b32 v142, a62
  v_mfma_f32_16x16x32_bf16 a[160:163], a[216:219], v[48:51], 0
  s_waitcnt lgkmcnt(4)
  v_accvgpr_read_b32 v136, a56
  v_accvgpr_read_b32 v143, a63
  v_mfma_f32_16x16x32_bf16 a[160:163], a[220:223], v[64:67], a[160:163]
  v_accvgpr_read_b32 v137, a57
  v_accvgpr_read_b32 v138, a58
  v_mfma_f32_16x16x32_bf16 a[164:167], a[220:223], v[68:71], 0
  ds_read_b64_tr_b16 a[212:213], v5 offset:256
  v_accvgpr_read_b32 v139, a59
  v_mfma_f32_16x16x32_bf16 a[164:167], a[216:219], v[52:55], a[164:167]
  buffer_load_dwordx4 v35, s[24:27], s75 offen offset:1024  lds
  v_mfma_f32_16x16x32_bf16 a[168:171], a[216:219], v[56:59], 0
  s_waitcnt vmcnt(6)
  s_cmp_lg_u32 s97, 0
  s_cbranch_scc1 L_slow2
  buffer_store_dword v41, v0, s[4:7], s41 offen
L_fast2:
  v_mfma_f32_16x16x32_bf16 a[168:171], a[220:223], v[72:75], a[168:171]
  ds_read_b64_tr_b16 a[208:209], v9 offset:256
  v_accvgpr_read_b32 v132, a52
  v_mfma_f32_16x16x32_bf16 a[172:175], a[220:223], v[76:79], 0
  ds_read_b64_tr_b16 a[210:211], v9 offset:6400
  v_accvgpr_read_b32 v133, a53
  v_mfma_f32_16x16x32_bf16 a[172:175], a[216:219], v[60:63], a[172:175]
  s_waitcnt lgkmcnt(5)
  ds_read_b64_tr_b16 a[214:215], v5 offset:6400
  v_accvgpr_read_b32 v134, a54
  v_mfma_f32_16x16x32_bf16 a[188:191], a[224:227], v[60:63], 0
  s_waitcnt lgkmcnt(4)
  v_accvgpr_read_b32 v128, a48
  v_accvgpr_read_b32 v135, a55
  v_mfma_f32_16x16x32_bf16 a[188:191], a[228:231], v[76:79], a[188:191]
  v_accvgpr_read_b32 v129, a49
  v_accvgpr_read_b32 v130, a50
  v_mfma_f32_16x16x32_bf16 a[184:187], a[228:231], v[72:75], 0
  ds_read_b64_tr_b16 a[220:221], v5 offset:128
  v_cvt_pk_bf16_f32 v80, v80, v81
  v_mfma_f32_16x16x32_bf16 a[184:187], a[224:227], v[56:59], a[184:187]
  ds_read_b64_tr_b16 a[216:217], v9 offset:128
  v_cvt_pk_bf16_f32 v81, v82, v83
  v_cvt_pk_bf16_f32 v82, v112, v113
  v_and_b32 v80, -2, v80
  v_accvgpr_read_b32 v131, a51
  v_pk_mul_f32 v[96:97], v[96:97], v[44:45]
  v_pk_mul_f32 v[98:99], v[98:99], v[44:45]
  v_pk_mul_f32 v[100:101], v[100:101], v[18:19]
  v_pk_mul_f32 v[102:103], v[102:103], v[18:19]
  v_pk_mul_f32 v[104:105], v[104:105], v[46:47]
  v_pk_mul_f32 v[106:107], v[106:107], v[46:47]
  v_pk_mul_f32 v[108:109], v[108:109], v[20:21]
  v_pk_mul_f32 v[110:111], v[110:111], v[20:21]
  s_nop 0
  v_mfma_f32_16x16x32_bf16 a[180:183], a[224:227], v[52:55], 0
  s_add_u32 s3, s88, 8192
  ds_read_b64_tr_b16 a[218:219], v9 offset:6272
  v_cvt_pk_bf16_f32 v83, v114, v115
  v_mfma_f32_16x16x32_bf16 a[180:183], a[228:231], v[68:71], a[180:183]
  buffer_store_dwordx4 v[80:83], v37, s[4:7], s3 offen offset:0
  v_mfma_f32_16x16x32_bf16 a[176:179], a[228:231], v[64:67], 0
  buffer_load_dwordx4 v36, s[24:27], s75 offen offset:2048  lds
  v_mfma_f32_16x16x32_bf16 a[176:179], a[224:227], v[48:51], a[176:179]
  s_waitcnt lgkmcnt(3)
  s_add_u32 m0, s74, 86016
  ds_read_b64_tr_b16 a[222:223], v5 offset:6272
  v_cvt_pk_bf16_f32 v84, v84, v85
  v_mfma_f32_16x16x32_bf16 v[176:179], a[208:211], v[48:51], 0
  s_add_u32 s55, s94, 40960
  v_cvt_pk_bf16_f32 v85, v86, v87
  v_cvt_pk_bf16_f32 v88, v88, v89
  v_mfma_f32_16x16x32_bf16 v[176:179], a[212:215], v[64:67], v[176:179]
  v_cvt_pk_bf16_f32 v89, v90, v91
  v_cvt_pk_bf16_f32 v92, v92, v93
  v_mfma_f32_16x16x32_bf16 v[180:183], a[212:215], v[68:71], 0
  v_and_b32 v84, -2, v84
  v_cvt_pk_bf16_f32 v93, v94, v95
  v_mfma_f32_16x16x32_bf16 v[180:183], a[208:211], v[52:55], v[180:183]
  ds_read_b64_tr_b16 a[228:229], v7 offset:128
  v_and_b32 v88, -2, v88
  v_mfma_f32_16x16x32_bf16 v[184:187], a[208:211], v[56:59], 0
  ds_read_b64_tr_b16 a[224:225], v11 offset:128
  v_cvt_pk_bf16_f32 v86, v116, v117
  v_mfma_f32_16x16x32_bf16 v[184:187], a[212:215], v[72:75], v[184:187]
  ds_read_b64_tr_b16 a[226:227], v11 offset:6272
  v_cvt_pk_bf16_f32 v87, v118, v119
  v_mfma_f32_16x16x32_bf16 v[188:191], a[212:215], v[76:79], 0
  buffer_store_dwordx4 v[84:87], v37, s[4:7], s3 offen offset:1024
  v_mfma_f32_16x16x32_bf16 v[188:191], a[208:211], v[60:63], v[188:191]
  s_waitcnt lgkmcnt(4)
  ds_read_b64_tr_b16 a[230:231], v7 offset:6272
  v_and_b32 v92, -2, v92
  v_mfma_f32_16x16x32_bf16 v[204:207], a[216:219], v[60:63], 0
  s_waitcnt lgkmcnt(4)
  v_cvt_pk_bf16_f32 v90, v120, v121
  v_cvt_pk_bf16_f32 v91, v122, v123
  v_mfma_f32_16x16x32_bf16 v[204:207], a[220:223], v[76:79], v[204:207]
  buffer_load_dwordx4 v34, s[24:27], s55 offen offset:0  lds
  v_mfma_f32_16x16x32_bf16 v[200:203], a[220:223], v[72:75], 0
  v_cvt_pk_bf16_f32 v94, v124, v125
  v_cvt_pk_bf16_f32 v95, v126, v127
  v_mfma_f32_16x16x32_bf16 v[200:203], a[216:219], v[56:59], v[200:203]
  ds_read_b64_tr_b16 a[212:213], v5 offset:0
  v_accvgpr_read_b32 v112, a64
  v_mfma_f32_16x16x32_bf16 v[196:199], a[216:219], v[52:55], 0
  ds_read_b64_tr_b16 a[208:209], v9 offset:0
  v_accvgpr_read_b32 v113, a65
  v_mfma_f32_16x16x32_bf16 v[196:199], a[220:223], v[68:71], v[196:199]
  ds_read_b64_tr_b16 a[210:211], v9 offset:6144
  v_accvgpr_read_b32 v114, a66
  v_mfma_f32_16x16x32_bf16 v[192:195], a[220:223], v[64:67], 0
  buffer_store_dwordx4 v[88:91], v37, s[4:7], s3 offen offset:2048
  v_mfma_f32_16x16x32_bf16 v[192:195], a[216:219], v[48:51], v[192:195]
  s_waitcnt lgkmcnt(4)
  ds_read_b64_tr_b16 a[214:215], v5 offset:6144
  v_accvgpr_read_b32 v115, a67
  v_accvgpr_read_b32 v116, a68
  v_accvgpr_read_b32 v117, a69
  v_accvgpr_read_b32 v118, a70
  v_pk_mul_f32 v[128:129], v[128:129], v[44:45]
  v_pk_mul_f32 v[130:131], v[130:131], v[44:45]
  v_pk_mul_f32 v[132:133], v[132:133], v[18:19]
  v_pk_mul_f32 v[134:135], v[134:135], v[18:19]
  v_pk_mul_f32 v[136:137], v[136:137], v[46:47]
  v_pk_mul_f32 v[138:139], v[138:139], v[46:47]
  v_pk_mul_f32 v[140:141], v[140:141], v[20:21]
  v_pk_mul_f32 v[142:143], v[142:143], v[20:21]
  s_nop 0
  v_mfma_f32_16x16x32_bf16 v[144:147], a[224:227], v[48:51], 0
  s_waitcnt lgkmcnt(4)
  v_accvgpr_read_b32 v119, a71
  v_mov_b32 v41, s40
  v_mfma_f32_16x16x32_bf16 v[144:147], a[228:231], v[64:67], v[144:147]
  ds_read_b64_tr_b16 a[220:221], v6 offset:0
  v_add_u32 v41, 3, v41
  v_mfma_f32_16x16x32_bf16 v[148:151], a[228:231], v[68:71], 0
  s_waitcnt vmcnt(8)
  s_cmp_lg_u32 s97, 0
  s_cbranch_scc1 L_slow3
  buffer_store_dword v41, v0, s[4:7], s41 offen
L_fast3:
  v_mfma_f32_16x16x32_bf16 v[148:151], a[224:227], v[52:55], v[148:151]
  ds_read_b64_tr_b16 a[216:217], v10 offset:0
  v_accvgpr_read_b32 v120, a72
  v_mfma_f32_16x16x32_bf16 v[152:155], a[224:227], v[56:59], 0
  buffer_load_dwordx4 v35, s[24:27], s55 offen offset:1024  lds
  v_mfma_f32_16x16x32_bf16 v[152:155], a[228:231], v[72:75], v[152:155]
  ds_read_b64_tr_b16 a[218:219], v10 offset:6144
  v_accvgpr_read_b32 v121, a73
  v_mfma_f32_16x16x32_bf16 v[156:159], a[228:231], v[76:79], 0
  buffer_store_dwordx4 v[92:95], v37, s[4:7], s3 offen offset:3072
  v_mfma_f32_16x16x32_bf16 v[156:159], a[224:227], v[60:63], v[156:159]
  s_waitcnt lgkmcnt(4)
  ds_read_b64_tr_b16 a[222:223], v6 offset:6144
  v_accvgpr_read_b32 v122, a74
  v_mfma_f32_16x16x32_bf16 v[172:175], a[208:211], v[60:63], 0
  s_waitcnt lgkmcnt(4)
  v_accvgpr_read_b32 v123, a75
  v_accvgpr_read_b32 v124, a76
  v_mfma_f32_16x16x32_bf16 v[172:175], a[212:215], v[76:79], v[172:175]
  buffer_load_dword v40, v14, s[4:7], s78 offen offset:0 sc1
  v_mfma_f32_16x16x32_bf16 v[168:171], a[212:215], v[72:75], 0
  v_accvgpr_read_b32 v125, a77
  v_accvgpr_read_b32 v126, a78
  v_mfma_f32_16x16x32_bf16 v[168:171], a[208:211], v[56:59], v[168:171]
  ds_read_b64_tr_b16 a[228:229], v7 offset:0
  v_accvgpr_read_b32 v127, a79
  v_mfma_f32_16x16x32_bf16 v[164:167], a[208:211], v[52:55], 0
  ds_read_b64_tr_b16 a[230:231], v7 offset:6144
  v_cvt_pk_bf16_f32 v96, v96, v97
  v_mfma_f32_16x16x32_bf16 v[164:167], a[212:215], v[68:71], v[164:167]
  ds_read_b64_tr_b16 a[224:225], v11 offset:0
  v_cvt_pk_bf16_f32 v97, v98, v99
  v_mfma_f32_16x16x32_bf16 v[160:163], a[212:215], v[64:67], 0
  s_waitcnt lgkmcnt(3)
  ds_read_b64_tr_b16 a[226:227], v11 offset:6144
  v_cvt_pk_bf16_f32 v100, v100, v101
  v_mfma_f32_16x16x32_bf16 v[160:163], a[208:211], v[48:51], v[160:163]
  buffer_load_dwordx4 v36, s[24:27], s55 offen offset:2048  lds
  v_mfma_f32_16x16x32_bf16 v[208:211], a[216:219], v[48:51], 0
  s_add_u32 m0, s74, 110592
  v_cvt_pk_bf16_f32 v101, v102, v103
  v_cvt_pk_bf16_f32 v104, v104, v105
  v_mfma_f32_16x16x32_bf16 v[208:211], a[220:223], v[64:67], v[208:211]
  s_add_u32 s60, s94, 81920
  v_cvt_pk_bf16_f32 v105, v106, v107
  v_cvt_pk_bf16_f32 v108, v108, v109
  v_mfma_f32_16x16x32_bf16 v[212:215], a[220:223], v[68:71], 0
  v_and_b32 v96, -2, v96
  v_cvt_pk_bf16_f32 v109, v110, v111
  v_mfma_f32_16x16x32_bf16 v[212:215], a[216:219], v[52:55], v[212:215]
  ds_read_b64_tr_b16 a[212:213], v8 offset:0
  v_and_b32 v100, -2, v100
  v_mfma_f32_16x16x32_bf16 v[216:219], a[216:219], v[56:59], 0
  ds_read_b64_tr_b16 a[208:209], v12 offset:0
  v_and_b32 v104, -2, v104
  v_mfma_f32_16x16x32_bf16 v[216:219], a[220:223], v[72:75], v[216:219]
  s_add_u32 s59, s88, 12288
  ds_read_b64_tr_b16 a[210:211], v12 offset:6144
  v_cvt_pk_bf16_f32 v98, v128, v129
  v_cvt_pk_bf16_f32 v99, v130, v131
  v_cvt_pk_bf16_f32 v102, v132, v133
  v_and_b32 v108, -2, v108
  v_pk_mul_f32 v[112:113], v[112:113], v[44:45]
  v_pk_mul_f32 v[114:115], v[114:115], v[44:45]
  v_pk_mul_f32 v[116:117], v[116:117], v[18:19]
  v_pk_mul_f32 v[118:119], v[118:119], v[18:19]
  v_pk_mul_f32 v[120:121], v[120:121], v[46:47]
  v_pk_mul_f32 v[122:123], v[122:123], v[46:47]
  v_pk_mul_f32 v[124:125], v[124:125], v[20:21]
  v_pk_mul_f32 v[126:127], v[126:127], v[20:21]
  s_nop 0
  v_mfma_f32_16x16x32_bf16 v[220:223], a[220:223], v[76:79], 0
  buffer_store_dwordx4 v[96:99], v37, s[4:7], s59 offen offset:0
  v_mfma_f32_16x16x32_bf16 v[220:223], a[216:219], v[60:63], v[220:223]
  s_waitcnt lgkmcnt(3)
  ds_read_b64_tr_b16 a[214:215], v8 offset:6144
  v_cvt_pk_bf16_f32 v103, v134, v135
  v_mfma_f32_16x16x32_bf16 v[236:239], a[224:227], v[60:63], 0
  v_cvt_pk_bf16_f32 v106, v136, v137
  v_cvt_pk_bf16_f32 v107, v138, v139
  v_mfma_f32_16x16x32_bf16 v[236:239], a[228:231], v[76:79], v[236:239]
  ds_read_b64_tr_b16 a[220:221], v10 offset:24832
  v_cvt_pk_bf16_f32 v110, v140, v141
  v_mfma_f32_16x16x32_bf16 v[232:235], a[228:231], v[72:75], 0
  buffer_load_dwordx4 v34, s[24:27], s60 offen offset:0  lds
  v_mfma_f32_16x16x32_bf16 v[232:235], a[224:227], v[56:59], v[232:235]
  ds_read_b64_tr_b16 a[216:217], v2 offset:24832
  v_cvt_pk_bf16_f32 v111, v142, v143
  v_mfma_f32_16x16x32_bf16 v[228:231], a[224:227], v[52:55], 0
  ds_read_b64_tr_b16 a[218:219], v2 offset:30976
  v_accvgpr_read_b32 v128, a80
  v_mfma_f32_16x16x32_bf16 v[228:231], a[228:231], v[68:71], v[228:231]
  buffer_store_dwordx4 v[100:103], v37, s[4:7], s59 offen offset:1024
  v_mfma_f32_16x16x32_bf16 v[224:227], a[228:231], v[64:67], 0
  buffer_store_dwordx4 v[104:107], v37, s[4:7], s59 offen offset:2048
  v_mfma_f32_16x16x32_bf16 v[224:227], a[224:227], v[48:51], v[224:227]
  s_waitcnt lgkmcnt(4)
  ds_read_b64_tr_b16 a[222:223], v10 offset:30976
  v_accvgpr_read_b32 v129, a81
  v_mfma_f32_16x16x32_bf16 v[240:243], a[208:211], v[48:51], 0
  s_waitcnt lgkmcnt(4)
  v_accvgpr_read_b32 v130, a82
  v_accvgpr_read_b32 v131, a83
  v_mfma_f32_16x16x32_bf16 v[240:243], a[212:215], v[64:67], v[240:243]
  v_accvgpr_read_b32 v132, a84
  v_accvgpr_read_b32 v133, a85
  v_mfma_f32_16x16x32_bf16 v[244:247], a[212:215], v[68:71], 0
  ds_read_b64_tr_b16 a[228:229], v10 offset:24704
  v_accvgpr_read_b32 v134, a86
  v_mfma_f32_16x16x32_bf16 v[244:247], a[208:211], v[52:55], v[244:247]
  s_add_u32 s43, s40, 2
  ds_read_b64_tr_b16 a[224:225], v2 offset:24704
  v_accvgpr_read_b32 v135, a87
  v_mfma_f32_16x16x32_bf16 v[248:251], a[208:211], v[56:59], 0
  buffer_store_dwordx4 v[108:111], v37, s[4:7], s59 offen offset:3072
  v_mfma_f32_16x16x32_bf16 v[248:251], a[212:215], v[72:75], v[248:251]
  buffer_load_dwordx4 v35, s[24:27], s60 offen offset:1024  lds
  v_mfma_f32_16x16x32_bf16 v[252:255], a[212:215], v[76:79], 0
  ds_read_b64_tr_b16 a[226:227], v2 offset:30848
  v_accvgpr_read_b32 v136, a88
  v_mfma_f32_16x16x32_bf16 v[252:255], a[208:211], v[60:63], v[252:255]
  s_waitcnt lgkmcnt(4)
  ds_read_b64_tr_b16 a[230:231], v10 offset:30848
  v_accvgpr_read_b32 v137, a89
  v_mfma_f32_16x16x32_bf16 a[156:159], a[216:219], v[92:95], a[156:159]
  s_waitcnt lgkmcnt(4)
  v_accvgpr_read_b32 v138, a90
  v_accvgpr_read_b32 v139, a91
  v_mfma_f32_16x16x32_bf16 a[156:159], a[220:223], v[108:111], a[156:159]
  v_accvgpr_read_b32 v140, a92
  v_accvgpr_read_b32 v141, a93
  v_mfma_f32_16x16x32_bf16 a[152:155], a[220:223], v[104:107], a[152:155]
  v_accvgpr_read_b32 v142, a94
  v_accvgpr_read_b32 v143, a95
  v_mfma_f32_16x16x32_bf16 a[152:155], a[216:219], v[88:91], a[152:155]
  ds_read_b64_tr_b16 a[212:213], v12 offset:24704
  v_cvt_pk_bf16_f32 v112, v112, v113
  v_cvt_pk_bf16_f32 v113, v114, v115
  v_cvt_pk_bf16_f32 v116, v116, v117
  v_cvt_pk_bf16_f32 v117, v118, v119
  v_pk_mul_f32 v[128:129], v[128:129], v[44:45]
  v_pk_mul_f32 v[130:131], v[130:131], v[44:45]
  v_pk_mul_f32 v[132:133], v[132:133], v[18:19]
  v_pk_mul_f32 v[134:135], v[134:135], v[18:19]
  v_pk_mul_f32 v[136:137], v[136:137], v[46:47]
  v_pk_mul_f32 v[138:139], v[138:139], v[46:47]
  v_pk_mul_f32 v[140:141], v[140:141], v[20:21]
  v_pk_mul_f32 v[142:143], v[142:143], v[20:21]
  s_nop 0
  v_mfma_f32_16x16x32_bf16 a[148:151], a[216:219], v[84:87], a[148:151]
  ds_read_b64_tr_b16 a[208:209], v4 offset:24704
  v_cvt_pk_bf16_f32 v120, v120, v121
  v_mfma_f32_16x16x32_bf16 a[148:151], a[220:223], v[100:103], a[148:151]
  ds_read_b64_tr_b16 a[210:211], v4 offset:30848
  v_cvt_pk_bf16_f32 v121, v122, v123
  v_mfma_f32_16x16x32_bf16 a[144:147], a[220:223], v[96:99], a[144:147]
  s_waitcnt lgkmcnt(4)
  ds_read_b64_tr_b16 a[214:215], v12 offset:30848
  v_and_b32 v112, -2, v112
  v_mfma_f32_16x16x32_bf16 a[144:147], a[216:219], v[80:83], a[144:147]
  buffer_load_dwordx4 v36, s[24:27], s60 offen offset:2048  lds
  v_mfma_f32_16x16x32_bf16 a[160:163], a[224:227], v[80:83], a[160:163]
  s_waitcnt vmcnt(8) lgkmcnt(4)
  v_and_b32 v116, -2, v116
  v_subrev_u32 v40, s43, v40
  v_mfma_f32_16x16x32_bf16 a[160:163], a[228:231], v[96:99], a[160:163]
L_pg16:
  s_cbranch_execz L_hop3
  v_cmp_lt_u32 vcc, 7, v40
  v_accvgpr_read_b32 v48, a112
  v_mfma_f32_16x16x32_bf16 a[164:167], a[228:231], v[100:103], a[164:167]
  s_add_u32 s87, s89, 0
  ds_read_b64_tr_b16 a[220:221], v9 offset:24832
  v_accvgpr_read_b32 v49, a113
  v_mfma_f32_16x16x32_bf16 a[164:167], a[224:227], v[84:87], a[164:167]
  s_cbranch_vccnz L_spin3
L_ret3:
  v_cvt_pk_bf16_f32 v124, v124, v125
  v_cvt_pk_bf16_f32 v125, v126, v127
  v_mfma_f32_16x16x32_bf16 a[168:171], a[224:227], v[88:91], a[168:171]
  buffer_load_dwordx4 a[232:235], v37, s[4:7], s87 offen offset:0 sc1
  v_mfma_f32_16x16x32_bf16 a[168:171], a[228:231], v[104:107], a[168:171]
  ds_read_b64_tr_b16 a[216:217], v1 offset:24832
  v_accvgpr_read_b32 v50, a114
  v_mfma_f32_16x16x32_bf16 a[172:175], a[228:231], v[108:111], a[172:175]
  ds_read_b64_tr_b16 a[218:219], v1 offset:30976
  v_accvgpr_read_b32 v51, a115
  v_mfma_f32_16x16x32_bf16 a[172:175], a[224:227], v[92:95], a[172:175]
  s_waitcnt lgkmcnt(4)
  ds_read_b64_tr_b16 a[222:223], v9 offset:30976
  v_accvgpr_read_b32 v52, a116
  v_mfma_f32_16x16x32_bf16 a[188:191], a[208:211], v[92:95], a[188:191]
  s_waitcnt lgkmcnt(4)
  v_accvgpr_read_b32 v53, a117
  v_accvgpr_read_b32 v54, a118
  v_mfma_f32_16x16x32_bf16 a[188:191], a[212:215], v[108:111], a[188:191]
  v_accvgpr_read_b32 v55, a119
  v_accvgpr_read_b32 v56, a120
  v_mfma_f32_16x16x32_bf16 a[184:187], a[212:215], v[104:107], a[184:187]
  ds_read_b64_tr_b16 a[228:229], v9 offset:24704
  v_accvgpr_read_b32 v57, a121
  v_mfma_f32_16x16x32_bf16 a[184:187], a[208:211], v[88:91], a[184:187]
  buffer_load_dwordx4 a[236:239], v37, s[4:7], s87 offen offset:1024 sc1
  v_mfma_f32_16x16x32_bf16 a[180:183], a[208:211], v[84:87], a[180:183]
  ds_read_b64_tr_b16 a[224:225], v1 offset:24704
  v_cvt_pk_bf16_f32 v114, v128, v129
  v_mfma_f32_16x16x32_bf16 a[180:183], a[212:215], v[100:103], a[180:183]
  s_add_u32 s64, s88, 16384
  ds_read_b64_tr_b16 a[226:227], v1 offset:30848
  v_cvt_pk_bf16_f32 v115, v130, v131
  v_mfma_f32_16x16x32_bf16 a[176:179], a[212:215], v[96:99], a[176:179]
  buffer_store_dwordx4 v[112:115], v37, s[4:7], s64 offen offset:0
  v_mfma_f32_16x16x32_bf16 a[176:179], a[208:211], v[80:83], a[176:179]
  s_waitcnt lgkmcnt(4)
  ds_read_b64_tr_b16 a[230:231], v9 offset:30848
  v_accvgpr_read_b32 v58, a122
  v_mfma_f32_16x16x32_bf16 v[176:179], a[216:219], v[80:83], v[176:179]
  s_waitcnt lgkmcnt(4)
  v_accvgpr_read_b32 v59, a123
  v_accvgpr_read_b32 v60, a124
  v_mfma_f32_16x16x32_bf16 v[176:179], a[220:223], v[96:99], v[176:179]
  v_accvgpr_read_b32 v61, a125
  v_accvgpr_read_b32 v62, a126
  v_mfma_f32_16x16x32_bf16 v[180:183], a[220:223], v[100:103], v[180:183]
  buffer_load_dwordx4 a[240:243], v37, s[4:7], s87 offen offset:2048 sc1
  v_mfma_f32_16x16x32_bf16 v[180:183], a[216:219], v[84:87], v[180:183]
  ds_read_b64_tr_b16 a[212:213], v11 offset:24704
  v_accvgpr_read_b32 v63, a127
  v_mfma_f32_16x16x32_bf16 v[184:187], a[216:219], v[88:91], v[184:187]
  ds_read_b64_tr_b16 a[208:209], v3 offset:24704
  v_cvt_pk_bf16_f32 v118, v132, v133
  v_mfma_f32_16x16x32_bf16 v[184:187], a[220:223], v[104:107], v[184:187]
  s_add_u32 s61, s90, 0
  ds_read_b64_tr_b16 a[210:211], v3 offset:30848
  v_cvt_pk_bf16_f32 v119, v134, v135
  v_mfma_f32_16x16x32_bf16 v[188:191], a[220:223], v[108:111], v[188:191]
  buffer_store_dwordx4 v[116:119], v37, s[4:7], s64 offen offset:1024
  v_mfma_f32_16x16x32_bf16 v[188:191], a[216:219], v[92:95], v[188:191]
  s_waitcnt lgkmcnt(3)
  ds_read_b64_tr_b16 a[214:215], v11 offset:30848
  v_cvt_pk_bf16_f32 v122, v136, v137
  v_cvt_pk_bf16_f32 v123, v138, v139
  v_cvt_pk_bf16_f32 v126, v140, v141
  v_cvt_pk_bf16_f32 v127, v142, v143
  v_pk_mul_f32 v[48:49], v[48:49], v[44:45]
  v_pk_mul_f32 v[50:51], v[50:51], v[44:45]
  v_pk_mul_f32 v[52:53], v[52:53], v[18:19]
  v_pk_mul_f32 v[54:55], v[54:55], v[18:19]
  v_pk_mul_f32 v[56:57], v[56:57], v[46:47]
  v_pk_mul_f32 v[58:59], v[58:59], v[46:47]
  v_pk_mul_f32 v[60:61], v[60:61], v[20:21]
  v_pk_mul_f32 v[62:63], v[62:63], v[20:21]
  s_nop 0
  v_mfma_f32_16x16x32_bf16 v[204:207], a[224:227], v[92:95], v[204:207]
  buffer_load_dwordx4 a[244:247], v37, s[4:7], s87 offen offset:3072 sc1
  v_mfma_f32_16x16x32_bf16 v[204:207], a[228:231], v[108:111], v[204:207]
  ds_read_b64_tr_b16 a[216:217], v1 offset:24576
  v_mov_b32 v41, s40
  v_mfma_f32_16x16x32_bf16 v[200:203], a[228:231], v[104:107], v[200:203]
  ds_read_b64_tr_b16 a[220:221], v9 offset:24576
  v_add_u32 v41, 4, v41
  v_mfma_f32_16x16x32_bf16 v[200:203], a[224:227], v[88:91], v[200:203]
  buffer_store_dwordx4 v[120:123], v37, s[4:7], s64 offen offset:2048
  v_mfma_f32_16x16x32_bf16 v[196:199], a[224:227], v[84:87], v[196:199]
  ds_read_b64_tr_b16 a[218:219], v1 offset:30720
  v_accvgpr_read_b32 v128, a96
  v_mfma_f32_16x16x32_bf16 v[196:199], a[228:231], v[100:103], v[196:199]
  buffer_load_dwordx4 a[248:251], v37, s[4:7], s61 offen offset:0 sc1
  v_mfma_f32_16x16x32_bf16 v[192:195], a[228:231], v[96:99], v[192:195]
  s_waitcnt lgkmcnt(4)
  ds_read_b64_tr_b16 a[222:223], v9 offset:30720
  v_accvgpr_read_b32 v129, a97
  v_mfma_f32_16x16x32_bf16 v[192:195], a[224:227], v[80:83], v[192:195]
  buffer_store_dwordx4 v[124:127], v37, s[4:7], s64 offen offset:3072
  v_mfma_f32_16x16x32_bf16 v[144:147], a[208:211], v[80:83], v[144:147]
  s_waitcnt lgkmcnt(4)
  ds_read_b64_tr_b16 a[224:225], v2 offset:24576
  v_accvgpr_read_b32 v130, a98
  v_mfma_f32_16x16x32_bf16 v[144:147], a[212:215], v[96:99], v[144:147]
  ds_read_b64_tr_b16 a[228:229], v10 offset:24576
  v_accvgpr_read_b32 v131, a99
  v_mfma_f32_16x16x32_bf16 v[148:151], a[212:215], v[100:103], v[148:151]
  ds_read_b64_tr_b16 a[230:231], v10 offset:30720
  v_accvgpr_read_b32 v132, a100
  v_mfma_f32_16x16x32_bf16 v[148:151], a[208:211], v[84:87], v[148:151]
  ds_read_b64_tr_b16 a[226:227], v2 offset:30720
  v_accvgpr_read_b32 v133, a101
  v_mfma_f32_16x16x32_bf16 v[152:155], a[208:211], v[88:91], v[152:155]
  s_waitcnt vmcnt(11)
  s_cmp_lg_u32 s97, 0
  s_cbranch_scc1 L_slow4
  buffer_store_dword v41, v0, s[4:7], s41 offen
L_fast4:
  v_mfma_f32_16x16x32_bf16 v[152:155], a[212:215], v[104:107], v[152:155]
  buffer_load_dwordx4 a[252:255], v37, s[4:7], s61 offen offset:1024 sc1
  v_mfma_f32_16x16x32_bf16 v[156:159], a[212:215], v[108:111], v[156:159]
  buffer_load_dwordx4 a[192:195], v37, s[4:7], s61 offen offset:2048 sc1
  v_mfma_f32_16x16x32_bf16 v[156:159], a[208:211], v[92:95], v[156:159]
  s_waitcnt lgkmcnt(5)
  v_accvgpr_read_b32 v134, a102
  v_accvgpr_read_b32 v135, a103
  v_mfma_f32_16x16x32_bf16 v[172:175], a[216:219], v[92:95], v[172:175]
  s_waitcnt lgkmcnt(4)
  ds_read_b64_tr_b16 a[208:209], v3 offset:24576
  v_accvgpr_read_b32 v136, a104
  v_mfma_f32_16x16x32_bf16 v[172:175], a[220:223], v[108:111], v[172:175]
  buffer_load_dword v40, v14, s[4:7], s78 offen offset:0 sc1
  v_mfma_f32_16x16x32_bf16 v[168:171], a[220:223], v[104:107], v[168:171]
  ds_read_b64_tr_b16 a[212:213], v11 offset:24576
  v_accvgpr_read_b32 v137, a105
  v_mfma_f32_16x16x32_bf16 v[168:171], a[216:219], v[88:91], v[168:171]
  ds_read_b64_tr_b16 a[214:215], v11 offset:30720
  v_accvgpr_read_b32 v138, a106
  v_mfma_f32_16x16x32_bf16 v[164:167], a[216:219], v[84:87], v[164:167]
  ds_read_b64_tr_b16 a[210:211], v3 offset:30720
  v_accvgpr_read_b32 v139, a107
  v_mfma_f32_16x16x32_bf16 v[164:167], a[220:223], v[100:103], v[164:167]
  v_accvgpr_read_b32 v140, a108
  v_accvgpr_read_b32 v141, a109
  v_mfma_f32_16x16x32_bf16 v[160:163], a[220:223], v[96:99], v[160:163]
  s_waitcnt lgkmcnt(4)
  v_accvgpr_read_b32 v142, a110
  v_accvgpr_read_b32 v143, a111
  v_mfma_f32_16x16x32_bf16 v[160:163], a[216:219], v[80:83], v[160:163]
  buffer_load_dwordx4 a[196:199], v37, s[4:7], s61 offen offset:3072 sc1
  v_mfma_f32_16x16x32_bf16 v[208:211], a[224:227], v[80:83], v[208:211]
  ds_read_b64_tr_b16 a[216:217], v4 offset:24576
  v_mfma_f32_16x16x32_bf16 v[208:211], a[228:231], v[96:99], v[208:211]
  ds_read_b64_tr_b16 a[218:219], v4 offset:30720
  v_mfma_f32_16x16x32_bf16 v[212:215], a[228:231], v[100:103], v[212:215]
  s_add_u32 s67, s91, 0
  ds_read_b64_tr_b16 a[220:221], v12 offset:24576
  v_mfma_f32_16x16x32_bf16 v[212:215], a[224:227], v[84:87], v[212:215]
  ds_read_b64_tr_b16 a[222:223], v12 offset:30720
  v_mfma_f32_16x16x32_bf16 v[216:219], a[224:227], v[88:91], v[216:219]
  buffer_load_dwordx4 a[0:3], v37, s[4:7], s67 offen offset:0 sc1
  v_mfma_f32_16x16x32_bf16 v[216:219], a[228:231], v[104:107], v[216:219]
  v_pk_mul_f32 v[128:129], v[128:129], v[44:45]
  v_pk_mul_f32 v[130:131], v[130:131], v[44:45]
  v_pk_mul_f32 v[132:133], v[132:133], v[18:19]
  v_pk_mul_f32 v[134:135], v[134:135], v[18:19]
  v_pk_mul_f32 v[136:137], v[136:137], v[46:47]
  v_pk_mul_f32 v[138:139], v[138:139], v[46:47]
  v_pk_mul_f32 v[140:141], v[140:141], v[20:21]
  v_pk_mul_f32 v[142:143], v[142:143], v[20:21]
  s_nop 0
  v_mfma_f32_16x16x32_bf16 v[220:223], a[228:231], v[108:111], v[220:223]
  v_cvt_pk_bf16_f32 v128, v128, v129
  v_cvt_pk_bf16_f32 v129, v130, v131
  v_mfma_f32_16x16x32_bf16 v[220:223], a[224:227], v[92:95], v[220:223]
  s_waitcnt lgkmcnt(4)
  v_cvt_pk_bf16_f32 v132, v132, v133
  v_cvt_pk_bf16_f32 v133, v134, v135
  v_mfma_f32_16x16x32_bf16 v[236:239], a[208:211], v[92:95], v[236:239]
  v_cvt_pk_bf16_f32 v136, v136, v137
  v_cvt_pk_bf16_f32 v137, v138, v139
  v_mfma_f32_16x16x32_bf16 v[236:239], a[212:215], v[108:111], v[236:239]
  v_cvt_pk_bf16_f32 v140, v140, v141
  v_cvt_pk_bf16_f32 v141, v142, v143
  v_mfma_f32_16x16x32_bf16 v[232:235], a[212:215], v[104:107], v[232:235]
  ds_read_b64_tr_b16 a[228:229], v2 offset:256
  v_cvt_pk_bf16_f32 v130, v48, v49
  v_mfma_f32_16x16x32_bf16 v[232:235], a[208:211], v[88:91], v[232:235]
  s_add_u32 s66, s88, 20480
  ds_read_b64_tr_b16 a[224:225], v6 offset:24832
  v_cvt_pk_bf16_f32 v131, v50, v51
  v_mfma_f32_16x16x32_bf16 v[228:231], a[208:211], v[84:87], v[228:231]
  ds_read_b64_tr_b16 a[226:227], v6 offset:30976
  v_cvt_pk_bf16_f32 v142, v60, v61
  v_mfma_f32_16x16x32_bf16 v[228:231], a[212:215], v[100:103], v[228:231]
  s_waitcnt lgkmcnt(5)
  ds_read_b64_tr_b16 a[230:231], v2 offset:6400
  v_cvt_pk_bf16_f32 v143, v62, v63
  v_mfma_f32_16x16x32_bf16 v[224:227], a[212:215], v[96:99], v[224:227]
  buffer_load_dwordx4 a[4:7], v37, s[4:7], s67 offen offset:1024 sc1
  v_mfma_f32_16x16x32_bf16 v[224:227], a[208:211], v[80:83], v[224:227]
  buffer_store_dwordx4 v[128:131], v37, s[4:7], s66 offen offset:0
  v_mfma_f32_16x16x32_bf16 v[240:243], a[216:219], v[80:83], v[240:243]
  s_waitcnt lgkmcnt(4)
  ds_read_b64_tr_b16 a[208:209], v6 offset:24704
  v_cvt_pk_bf16_f32 v138, v56, v57
  v_mfma_f32_16x16x32_bf16 v[240:243], a[220:223], v[96:99], v[240:243]
  ds_read_b64_tr_b16 a[210:211], v6 offset:30848
  v_cvt_pk_bf16_f32 v139, v58, v59
  v_mfma_f32_16x16x32_bf16 v[244:247], a[220:223], v[100:103], v[244:247]
  ds_read_b64_tr_b16 a[212:213], v2 offset:128
  v_cvt_pk_bf16_f32 v134, v52, v53
  v_mfma_f32_16x16x32_bf16 v[244:247], a[216:219], v[84:87], v[244:247]
  ds_read_b64_tr_b16 a[214:215], v2 offset:6272
  v_cvt_pk_bf16_f32 v135, v54, v55
  v_mfma_f32_16x16x32_bf16 v[248:251], a[216:219], v[88:91], v[248:251]
  buffer_load_dwordx4 a[8:11], v37, s[4:7], s67 offen offset:2048 sc1
  v_mfma_f32_16x16x32_bf16 v[248:251], a[220:223], v[104:107], v[248:251]
  buffer_store_dwordx4 v[132:135], v37, s[4:7], s66 offen offset:1024
  v_mfma_f32_16x16x32_bf16 v[252:255], a[220:223], v[108:111], v[252:255]
  v_mfma_f32_16x16x32_bf16 v[252:255], a[216:219], v[92:95], v[252:255]
  s_waitcnt lgkmcnt(5)
  v_mfma_f32_16x16x32_bf16 a[156:159], a[224:227], v[124:127], a[156:159]
  s_waitcnt lgkmcnt(4)
  ds_read_b64_tr_b16 a[216:217], v8 offset:24704
  v_mfma_f32_16x16x32_bf16 a[156:159], a[228:231], v[140:143], a[156:159]
  s_add_u32 s43, s40, 3
  ds_read_b64_tr_b16 a[220:221], v4 offset:128
  v_mfma_f32_16x16x32_bf16 a[152:155], a[228:231], v[136:139], a[152:155]
  ds_read_b64_tr_b16 a[218:219], v8 offset:30848
  v_mfma_f32_16x16x32_bf16 a[152:155], a[224:227], v[120:123], a[152:155]
  buffer_store_dwordx4 v[136:139], v37, s[4:7], s66 offen offset:2048
  v_mfma_f32_16x16x32_bf16 a[148:151], a[224:227], v[116:119], a[148:151]
  ds_read_b64_tr_b16 a[222:223], v4 offset:6272
  v_mfma_f32_16x16x32_bf16 a[148:151], a[228:231], v[132:135], a[148:151]
  buffer_load_dwordx4 a[12:15], v37, s[4:7], s67 offen offset:3072 sc1
  v_mfma_f32_16x16x32_bf16 a[144:147], a[228:231], v[128:131], a[144:147]
  s_waitcnt vmcnt(8)
  v_subrev_u32 v40, s43, v40
  v_mfma_f32_16x16x32_bf16 a[144:147], a[224:227], v[112:115], a[144:147]
  s_waitcnt lgkmcnt(6)
  v_cmp_lt_u32 vcc, 7, v40
  v_mfma_f32_16x16x32_bf16 a[160:163], a[208:211], v[112:115], a[160:163]
  s_cbranch_vccnz L_spin4
L_ret4:
  ds_read_b64_tr_b16 a[224:225], v5 offset:24832
  s_waitcnt lgkmcnt(5)
  v_mfma_f32_16x16x32_bf16 a[160:163], a[212:215], v[128:131], a[160:163]
  s_add_u32 s65, s89, 4096
  ds_read_b64_tr_b16 a[226:227], v5 offset:30976
  v_mfma_f32_16x16x32_bf16 a[164:167], a[212:215], v[132:135], a[164:167]
  ds_read_b64_tr_b16 a[228:229], v1 offset:256
  v_mfma_f32_16x16x32_bf16 a[164:167], a[208:211], v[116:119], a[164:167]
  buffer_store_dwordx4 v[140:143], v37, s[4:7], s66 offen offset:3072
  v_mfma_f32_16x16x32_bf16 a[168:171], a[208:211], v[120:123], a[168:171]
  ds_read_b64_tr_b16 a[230:231], v1 offset:6400
  v_mfma_f32_16x16x32_bf16 a[168:171], a[212:215], v[136:139], a[168:171]
  buffer_load_dwordx4 a[16:19], v37, s[4:7], s65 offen offset:0 sc1
  v_mfma_f32_16x16x32_bf16 a[172:175], a[212:215], v[140:143], a[172:175]
  buffer_load_dwordx4 a[20:23], v37, s[4:7], s65 offen offset:1024 sc1
  v_mfma_f32_16x16x32_bf16 a[172:175], a[208:211], v[124:127], a[172:175]
  s_waitcnt lgkmcnt(5)
  v_mfma_f32_16x16x32_bf16 a[188:191], a[216:219], v[124:127], a[188:191]
  s_waitcnt lgkmcnt(4)
  ds_read_b64_tr_b16 a[208:209], v5 offset:24704
  v_mfma_f32_16x16x32_bf16 a[188:191], a[220:223], v[140:143], a[188:191]
  ds_read_b64_tr_b16 a[210:211], v5 offset:30848
  v_mfma_f32_16x16x32_bf16 a[184:187], a[220:223], v[136:139], a[184:187]
  ds_read_b64_tr_b16 a[212:213], v1 offset:128
  v_mfma_f32_16x16x32_bf16 a[184:187], a[216:219], v[120:123], a[184:187]
  ds_read_b64_tr_b16 a[214:215], v1 offset:6272
  v_mfma_f32_16x16x32_bf16 a[180:183], a[216:219], v[116:119], a[180:183]
  buffer_load_dwordx4 a[24:27], v37, s[4:7], s65 offen offset:2048 sc1
  v_mfma_f32_16x16x32_bf16 a[180:183], a[220:223], v[132:135], a[180:183]
  v_mfma_f32_16x16x32_bf16 a[176:179], a[220:223], v[128:131], a[176:179]
  s_waitcnt lgkmcnt(6)
  v_mfma_f32_16x16x32_bf16 a[176:179], a[216:219], v[112:115], a[176:179]
  buffer_load_dwordx4 a[28:31], v37, s[4:7], s65 offen offset:3072 sc1
  v_mfma_f32_16x16x32_bf16 v[176:179], a[224:227], v[112:115], v[176:179]
  s_waitcnt lgkmcnt(4)
  ds_read_b64_tr_b16 a[216:217], v7 offset:24704
  v_mfma_f32_16x16x32_bf16 v[176:179], a[228:231], v[128:131], v[176:179]
  ds_read_b64_tr_b16 a[218:219], v7 offset:30848
  v_mfma_f32_16x16x32_bf16 v[180:183], a[228:231], v[132:135], v[180:183]
  ds_read_b64_tr_b16 a[220:221], v3 offset:128
  v_mfma_f32_16x16x32_bf16 v[180:183], a[224:227], v[116:119], v[180:183]
  s_add_u32 s62, s90, 4096
  ds_read_b64_tr_b16 a[222:223], v3 offset:6272
  v_mfma_f32_16x16x32_bf16 v[184:187], a[224:227], v[120:123], v[184:187]
  buffer_load_dword v40, v14, s[4:7], s78 offen offset:0 sc1
  v_mfma_f32_16x16x32_bf16 v[184:187], a[228:231], v[136:139], v[184:187]
  buffer_load_dwordx4 a[32:35], v37, s[4:7], s62 offen offset:0 sc1
  v_mfma_f32_16x16x32_bf16 v[188:191], a[228:231], v[140:143], v[188:191]
  v_mfma_f32_16x16x32_bf16 v[188:191], a[224:227], v[124:127], v[188:191]
  s_waitcnt lgkmcnt(6)
  v_mfma_f32_16x16x32_bf16 v[204:207], a[208:211], v[124:127], v[204:207]
  s_waitcnt lgkmcnt(4)
  ds_read_b64_tr_b16 a[224:225], v5 offset:24576
  v_mfma_f32_16x16x32_bf16 v[204:207], a[212:215], v[140:143], v[204:207]
  ds_read_b64_tr_b16 a[226:227], v5 offset:30720
  v_mfma_f32_16x16x32_bf16 v[200:203], a[212:215], v[136:139], v[200:203]
  ds_read_b64_tr_b16 a[228:229], v1 offset:0
  v_mfma_f32_16x16x32_bf16 v[200:203], a[208:211], v[120:123], v[200:203]
  ds_read_b64_tr_b16 a[230:231], v1 offset:6144
  v_mfma_f32_16x16x32_bf16 v[196:199], a[208:211], v[116:119], v[196:199]
  buffer_load_dwordx4 a[36:39], v37, s[4:7], s62 offen offset:1024 sc1
  v_mfma_f32_16x16x32_bf16 v[196:199], a[212:215], v[132:135], v[196:199]
  v_mfma_f32_16x16x32_bf16 v[192:195], a[212:215], v[128:131], v[192:195]
  buffer_load_dwordx4 a[40:43], v37, s[4:7], s62 offen offset:2048 sc1
  v_mfma_f32_16x16x32_bf16 v[192:195], a[208:211], v[112:115], v[192:195]
  s_waitcnt lgkmcnt(6)
  v_mfma_f32_16x16x32_bf16 v[144:147], a[216:219], v[112:115], v[144:147]
  s_waitcnt lgkmcnt(4)
  ds_read_b64_tr_b16 a[208:209], v6 offset:24576
  v_mfma_f32_16x16x32_bf16 v[144:147], a[220:223], v[128:131], v[144:147]
  ds_read_b64_tr_b16 a[210:211], v6 offset:30720
  v_mfma_f32_16x16x32_bf16 v[148:151], a[220:223], v[132:135], v[148:151]
  ds_read_b64_tr_b16 a[212:213], v2 offset:0
  v_mfma_f32_16x16x32_bf16 v[148:151], a[216:219], v[116:119], v[148:151]
  ds_read_b64_tr_b16 a[214:215], v2 offset:6144
  v_mfma_f32_16x16x32_bf16 v[152:155], a[216:219], v[120:123], v[152:155]
  buffer_load_dwordx4 a[44:47], v37, s[4:7], s62 offen offset:3072 sc1
  v_mfma_f32_16x16x32_bf16 v[152:155], a[220:223], v[136:139], v[152:155]
  v_mfma_f32_16x16x32_bf16 v[156:159], a[220:223], v[140:143], v[156:159]
  s_waitcnt lgkmcnt(6)
  v_mfma_f32_16x16x32_bf16 v[156:159], a[216:219], v[124:127], v[156:159]
  s_add_u32 s63, s91, 4096
  v_mfma_f32_16x16x32_bf16 v[172:175], a[224:227], v[124:127], v[172:175]
  s_waitcnt lgkmcnt(4)
  ds_read_b64_tr_b16 a[216:217], v7 offset:24576
  v_mov_b32 v41, s40
  v_mfma_f32_16x16x32_bf16 v[172:175], a[228:231], v[140:143], v[172:175]
  ds_read_b64_tr_b16 a[218:219], v7 offset:30720
  v_add_u32 v41, 5, v41
  v_mfma_f32_16x16x32_bf16 v[168:171], a[228:231], v[136:139], v[168:171]
  ds_read_b64_tr_b16 a[220:221], v3 offset:0
  v_mfma_f32_16x16x32_bf16 v[168:171], a[224:227], v[120:123], v[168:171]
  ds_read_b64_tr_b16 a[222:223], v3 offset:6144
  v_mfma_f32_16x16x32_bf16 v[164:167], a[224:227], v[116:119], v[164:167]
  buffer_load_dwordx4 a[48:51], v37, s[4:7], s63 offen offset:0 sc1
  v_mfma_f32_16x16x32_bf16 v[164:167], a[228:231], v[132:135], v[164:167]
  s_waitcnt vmcnt(10)
  s_cmp_lg_u32 s97, 0
  s_cbranch_scc1 L_slow5
  buffer_store_dword v41, v0, s[4:7], s41 offen
L_fast5:
  v_mfma_f32_16x16x32_bf16 v[160:163], a[228:231], v[128:131], v[160:163]
  buffer_load_dwordx4 a[52:55], v37, s[4:7], s63 offen offset:1024 sc1
  v_mfma_f32_16x16x32_bf16 v[160:163], a[224:227], v[112:115], v[160:163]
  s_waitcnt lgkmcnt(6)
  v_mfma_f32_16x16x32_bf16 v[208:211], a[208:211], v[112:115], v[208:211]
  s_waitcnt lgkmcnt(4)
  ds_read_b64_tr_b16 a[224:225], v8 offset:24576
  v_mfma_f32_16x16x32_bf16 v[208:211], a[212:215], v[128:131], v[208:211]
  ds_read_b64_tr_b16 a[228:229], v4 offset:0
  v_mfma_f32_16x16x32_bf16 v[212:215], a[212:215], v[132:135], v[212:215]
  ds_read_b64_tr_b16 a[226:227], v8 offset:30720
  v_mfma_f32_16x16x32_bf16 v[212:215], a[208:211], v[116:119], v[212:215]
  ds_read_b64_tr_b16 a[230:231], v4 offset:6144
  v_mfma_f32_16x16x32_bf16 v[216:219], a[208:211], v[120:123], v[216:219]
  buffer_load_dwordx4 a[56:59], v37, s[4:7], s63 offen offset:2048 sc1
  v_mfma_f32_16x16x32_bf16 v[216:219], a[212:215], v[136:139], v[216:219]
  s_add_u32 s43, s40, 4
  v_mfma_f32_16x16x32_bf16 v[220:223], a[212:215], v[140:143], v[220:223]
  s_waitcnt lgkmcnt(6)
  v_mfma_f32_16x16x32_bf16 v[220:223], a[208:211], v[124:127], v[220:223]
  buffer_load_dwordx4 a[60:63], v37, s[4:7], s63 offen offset:3072 sc1
  v_mfma_f32_16x16x32_bf16 v[236:239], a[216:219], v[124:127], v[236:239]
  s_waitcnt lgkmcnt(4)
  v_mfma_f32_16x16x32_bf16 v[236:239], a[220:223], v[140:143], v[236:239]
  s_waitcnt vmcnt(9)
  v_subrev_u32 v40, s43, v40
  v_mfma_f32_16x16x32_bf16 v[232:235], a[220:223], v[136:139], v[232:235]
  ds_read_b64_tr_b16 a[212:213], v10 offset:49280
  v_cmp_lt_u32 vcc, 7, v40
  v_mfma_f32_16x16x32_bf16 v[232:235], a[216:219], v[120:123], v[232:235]
  s_cbranch_vccnz L_spin5
L_ret5:
  ds_read_b64_tr_b16 a[214:215], v10 offset:55424
  v_mfma_f32_16x16x32_bf16 v[228:231], a[216:219], v[116:119], v[228:231]
  s_add_u32 s50, s89, 8192
  ds_read_b64_tr_b16 a[208:209], v10 offset:49152
  v_mfma_f32_16x16x32_bf16 v[228:231], a[220:223], v[132:135], v[228:231]
  ds_read_b64_tr_b16 a[210:211], v10 offset:55296
  v_mfma_f32_16x16x32_bf16 v[224:227], a[220:223], v[128:131], v[224:227]
  buffer_load_dwordx4 v[48:51], v37, s[4:7], s50 offen offset:0 sc1
  v_mfma_f32_16x16x32_bf16 v[224:227], a[216:219], v[112:115], v[224:227]
  s_waitcnt lgkmcnt(5)
  ds_read_b64_tr_b16 a[216:217], v10 offset:49408
  v_mfma_f32_16x16x32_bf16 v[240:243], a[224:227], v[112:115], v[240:243]
  s_waitcnt lgkmcnt(5)
  ds_read_b64_tr_b16 a[218:219], v10 offset:55552
  v_mfma_f32_16x16x32_bf16 v[240:243], a[228:231], v[128:131], v[240:243]
  buffer_load_dwordx4 v[52:55], v37, s[4:7], s50 offen offset:1024 sc1
  v_mfma_f32_16x16x32_bf16 v[244:247], a[228:231], v[132:135], v[244:247]
  v_mfma_f32_16x16x32_bf16 v[244:247], a[224:227], v[116:119], v[244:247]
  v_mfma_f32_16x16x32_bf16 v[248:251], a[224:227], v[120:123], v[248:251]
  buffer_load_dwordx4 v[56:59], v37, s[4:7], s50 offen offset:2048 sc1
  v_mfma_f32_16x16x32_bf16 v[248:251], a[228:231], v[136:139], v[248:251]
  v_mfma_f32_16x16x32_bf16 v[252:255], a[228:231], v[140:143], v[252:255]
  v_mfma_f32_16x16x32_bf16 v[252:255], a[224:227], v[124:127], v[252:255]
  s_barrier
  s_waitcnt lgkmcnt(2)
  v_mfma_f32_16x16x32_bf16 a[156:159], a[208:211], a[244:247], a[156:159]
  ds_read_b64_tr_b16 a[220:221], v2 offset:12288
  ds_read_b64_tr_b16 a[222:223], v2 offset:18432
  v_mfma_f32_16x16x32_bf16 a[156:159], a[212:215], a[196:199], a[156:159]
  s_waitcnt lgkmcnt(2)
  ds_read_b64_tr_b16 a[224:225], v2 offset:12416
  v_mfma_f32_16x16x32_bf16 a[156:159], a[216:219], a[12:15], a[156:159]
  ds_read_b64_tr_b16 a[226:227], v2 offset:18560
  v_mfma_f32_16x16x32_bf16 a[152:155], a[216:219], a[8:11], a[152:155]
  ds_read_b64_tr_b16 a[228:229], v2 offset:12544
  v_mfma_f32_16x16x32_bf16 a[152:155], a[212:215], a[192:195], a[152:155]
  s_add_u32 s48, s90, 8192
  ds_read_b64_tr_b16 a[230:231], v2 offset:18688
  v_accvgpr_read_b32 v128, a200
  v_mfma_f32_16x16x32_bf16 a[152:155], a[208:211], a[240:243], a[152:155]
  buffer_load_dwordx4 v[60:63], v37, s[4:7], s50 offen offset:3072 sc1
  v_mfma_f32_16x16x32_bf16 a[148:151], a[208:211], a[236:239], a[148:151]
  buffer_load_dwordx4 v[64:67], v37, s[4:7], s48 offen offset:0 sc1
  v_mfma_f32_16x16x32_bf16 a[148:151], a[212:215], a[252:255], a[148:151]
  v_accvgpr_read_b32 v129, a201
  v_mfma_f32_16x16x32_bf16 a[148:151], a[216:219], a[4:7], a[148:151]
  v_accvgpr_read_b32 v130, a202
  v_mfma_f32_16x16x32_bf16 a[144:147], a[216:219], a[0:3], a[144:147]
  ds_read_b64_tr_b16 a[216:217], v4 offset:12544
  v_mfma_f32_16x16x32_bf16 a[144:147], a[212:215], a[248:251], a[144:147]
  buffer_load_dwordx4 v[68:71], v37, s[4:7], s48 offen offset:1024 sc1
  v_mfma_f32_16x16x32_bf16 a[144:147], a[208:211], a[232:235], a[144:147]
  s_waitcnt lgkmcnt(5)
  ds_read_b64_tr_b16 a[212:213], v4 offset:12416
  v_accvgpr_read_b32 v131, a203
  v_mfma_f32_16x16x32_bf16 a[160:163], a[220:223], a[232:235], a[160:163]
  s_waitcnt lgkmcnt(4)
  ds_read_b64_tr_b16 a[214:215], v4 offset:18560
  v_accvgpr_read_b32 v132, a204
  v_mfma_f32_16x16x32_bf16 a[160:163], a[224:227], a[248:251], a[160:163]
  s_waitcnt lgkmcnt(3)
  ds_read_b64_tr_b16 a[208:209], v4 offset:12288
  v_mfma_f32_16x16x32_bf16 a[160:163], a[228:231], a[0:3], a[160:163]
  ds_read_b64_tr_b16 a[210:211], v4 offset:18432
  v_accvgpr_read_b32 v133, a205
  v_mfma_f32_16x16x32_bf16 a[164:167], a[228:231], a[4:7], a[164:167]
  buffer_load_dwordx4 v[72:75], v37, s[4:7], s48 offen offset:2048 sc1
  v_mfma_f32_16x16x32_bf16 a[164:167], a[224:227], a[252:255], a[164:167]
  ds_read_b64_tr_b16 a[218:219], v4 offset:18688
  v_accvgpr_read_b32 v134, a206
  v_mfma_f32_16x16x32_bf16 a[164:167], a[220:223], a[236:239], a[164:167]
  buffer_load_dwordx4 v[76:79], v37, s[4:7], s48 offen offset:3072 sc1
  v_mfma_f32_16x16x32_bf16 a[168:171], a[220:223], a[240:243], a[168:171]
  v_accvgpr_read_b32 v135, a207
  v_mfma_f32_16x16x32_bf16 a[168:171], a[224:227], a[192:195], a[168:171]
  v_mfma_f32_16x16x32_bf16 a[168:171], a[228:231], a[8:11], a[168:171]
  v_accvgpr_read_b32 v136, a128
  v_mfma_f32_16x16x32_bf16 a[172:175], a[228:231], a[12:15], a[172:175]
  s_waitcnt lgkmcnt(1)
  ds_read_b64_tr_b16 a[228:229], v9 offset:49408
  v_mfma_f32_16x16x32_bf16 a[172:175], a[224:227], a[196:199], a[172:175]
  s_add_u32 s99, s91, 8192
  ds_read_b64_tr_b16 a[224:225], v9 offset:49280
  v_accvgpr_read_b32 v137, a129
  v_mfma_f32_16x16x32_bf16 a[172:175], a[220:223], a[244:247], a[172:175]
  buffer_load_dwordx4 a[64:67], v37, s[4:7], s99 offen offset:0 sc1
  v_mfma_f32_16x16x32_bf16 a[188:191], a[208:211], a[244:247], a[188:191]
  ds_read_b64_tr_b16 a[226:227], v9 offset:55424
  v_accvgpr_read_b32 v138, a130
  v_mfma_f32_16x16x32_bf16 a[188:191], a[212:215], a[196:199], a[188:191]
  s_waitcnt lgkmcnt(3)
  ds_read_b64_tr_b16 a[220:221], v9 offset:49152
  v_mfma_f32_16x16x32_bf16 a[188:191], a[216:219], a[12:15], a[188:191]
  ds_read_b64_tr_b16 a[222:223], v9 offset:55296
  v_accvgpr_read_b32 v139, a131
  v_mfma_f32_16x16x32_bf16 a[184:187], a[216:219], a[8:11], a[184:187]
  buffer_load_dwordx4 a[68:71], v37, s[4:7], s99 offen offset:1024 sc1
  v_mfma_f32_16x16x32_bf16 a[184:187], a[212:215], a[192:195], a[184:187]
  ds_read_b64_tr_b16 a[230:231], v9 offset:55552
  v_accvgpr_read_b32 v140, a132
  v_mfma_f32_16x16x32_bf16 a[184:187], a[208:211], a[240:243], a[184:187]
  v_mfma_f32_16x16x32_bf16 a[180:183], a[208:211], a[236:239], a[180:183]
  v_accvgpr_read_b32 v141, a133
  v_mfma_f32_16x16x32_bf16 a[180:183], a[212:215], a[252:255], a[180:183]
  buffer_load_dwordx4 a[72:75], v37, s[4:7], s99 offen offset:2048 sc1
  v_mfma_f32_16x16x32_bf16 a[180:183], a[216:219], a[4:7], a[180:183]
  v_accvgpr_read_b32 v142, a134
  v_mfma_f32_16x16x32_bf16 a[176:179], a[216:219], a[0:3], a[176:179]
  v_mfma_f32_16x16x32_bf16 a[176:179], a[212:215], a[248:251], a[176:179]
  ds_read_b64_tr_b16 a[216:217], v1 offset:12544
  v_accvgpr_read_b32 v143, a135
  v_mfma_f32_16x16x32_bf16 a[176:179], a[208:211], a[232:235], a[176:179]
  s_waitcnt lgkmcnt(2)
  ds_read_b64_tr_b16 a[212:213], v1 offset:12416
  v_mfma_f32_16x16x32_bf16 v[176:179], a[220:223], a[232:235], v[176:179]
  ds_read_b64_tr_b16 a[208:209], v1 offset:12288
  v_mfma_f32_16x16x32_bf16 v[176:179], a[224:227], a[248:251], v[176:179]
  s_waitcnt lgkmcnt(3)
  ds_read_b64_tr_b16 a[210:211], v1 offset:18432
  v_mfma_f32_16x16x32_bf16 v[176:179], a[228:231], a[0:3], v[176:179]
  buffer_load_dwordx4 a[76:79], v37, s[4:7], s99 offen offset:3072 sc1
  v_mfma_f32_16x16x32_bf16 v[180:183], a[228:231], a[4:7], v[180:183]
  ds_read_b64_tr_b16 a[214:215], v1 offset:18560
  v_mfma_f32_16x16x32_bf16 v[180:183], a[224:227], a[252:255], v[180:183]
  s_add_u32 s49, s89, 12288
  ds_read_b64_tr_b16 a[218:219], v1 offset:18688
  v_mfma_f32_16x16x32_bf16 v[180:183], a[220:223], a[236:239], v[180:183]
  buffer_load_dwordx4 a[80:83], v37, s[4:7], s49 offen offset:0 sc1
  v_mfma_f32_16x16x32_bf16 v[184:187], a[220:223], a[240:243], v[184:187]
  v_mfma_f32_16x16x32_bf16 v[184:187], a[224:227], a[192:195], v[184:187]
  v_mfma_f32_16x16x32_bf16 v[184:187], a[228:231], a[8:11], v[184:187]
  v_mfma_f32_16x16x32_bf16 v[188:191], a[228:231], a[12:15], v[188:191]
  buffer_load_dwordx4 a[84:87], v37, s[4:7], s49 offen offset:1024 sc1
  v_mfma_f32_16x16x32_bf16 v[188:191], a[224:227], a[196:199], v[188:191]
  ds_read_b64_tr_b16 a[228:229], v3 offset:12544
  v_mfma_f32_16x16x32_bf16 v[188:191], a[220:223], a[244:247], v[188:191]
  s_waitcnt lgkmcnt(3)
  ds_read_b64_tr_b16 a[224:225], v3 offset:12416
  v_mfma_f32_16x16x32_bf16 v[204:207], a[208:211], a[244:247], v[204:207]
  s_waitcnt lgkmcnt(3)
  ds_read_b64_tr_b16 a[226:227], v3 offset:18560
  v_mfma_f32_16x16x32_bf16 v[204:207], a[212:215], a[196:199], v[204:207]
  s_waitcnt lgkmcnt(3)
  ds_read_b64_tr_b16 a[220:221], v3 offset:12288
  v_mfma_f32_16x16x32_bf16 v[204:207], a[216:219], a[12:15], v[204:207]
  ds_read_b64_tr_b16 a[222:223], v3 offset:18432
  v_mfma_f32_16x16x32_bf16 v[200:203], a[216:219], a[8:11], v[200:203]
  buffer_load_dwordx4 a[88:91], v37, s[4:7], s49 offen offset:2048 sc1
  v_mfma_f32_16x16x32_bf16 v[200:203], a[212:215], a[192:195], v[200:203]
  ds_read_b64_tr_b16 a[230:231], v3 offset:18688
  v_mfma_f32_16x16x32_bf16 v[200:203], a[208:211], a[240:243], v[200:203]
  buffer_load_dword v40, v14, s[4:7], s78 offen offset:0 sc1
  v_mfma_f32_16x16x32_bf16 v[196:199], a[208:211], a[236:239], v[196:199]
  buffer_load_dwordx4 a[92:95], v37, s[4:7], s49 offen offset:3072 sc1
  v_mfma_f32_16x16x32_bf16 v[196:199], a[212:215], a[252:255], v[196:199]
  v_mfma_f32_16x16x32_bf16 v[196:199], a[216:219], a[4:7], v[196:199]
  v_mfma_f32_16x16x32_bf16 v[192:195], a[216:219], a[0:3], v[192:195]
  s_add_u32 s51, s90, 12288
  ds_read_b64_tr_b16 a[216:217], v9 offset:37120
  v_mfma_f32_16x16x32_bf16 v[192:195], a[212:215], a[248:251], v[192:195]
  ds_read_b64_tr_b16 a[212:213], v9 offset:36992
  v_mfma_f32_16x16x32_bf16 v[192:195], a[208:211], a[232:235], v[192:195]
  s_waitcnt lgkmcnt(3)
  ds_read_b64_tr_b16 a[214:215], v9 offset:43136
  v_mfma_f32_16x16x32_bf16 v[144:147], a[220:223], a[232:235], v[144:147]
  ds_read_b64_tr_b16 a[208:209], v9 offset:36864
  v_mfma_f32_16x16x32_bf16 v[144:147], a[224:227], a[248:251], v[144:147]
  s_waitcnt lgkmcnt(4)
  ds_read_b64_tr_b16 a[210:211], v9 offset:43008
  v_mfma_f32_16x16x32_bf16 v[144:147], a[228:231], a[0:3], v[144:147]
  buffer_load_dwordx4 a[96:99], v37, s[4:7], s51 offen offset:0 sc1
  v_mfma_f32_16x16x32_bf16 v[148:151], a[228:231], a[4:7], v[148:151]
  buffer_load_dwordx4 a[100:103], v37, s[4:7], s51 offen offset:1024 sc1
  v_mfma_f32_16x16x32_bf16 v[148:151], a[224:227], a[252:255], v[148:151]
  ds_read_b64_tr_b16 a[218:219], v9 offset:43264
  v_mfma_f32_16x16x32_bf16 v[148:151], a[220:223], a[236:239], v[148:151]
L_pg17:
  s_cbranch_execz L_hop4
  v_mfma_f32_16x16x32_bf16 v[152:155], a[220:223], a[240:243], v[152:155]
  buffer_load_dwordx4 a[104:107], v37, s[4:7], s51 offen offset:2048 sc1
  v_mfma_f32_16x16x32_bf16 v[152:155], a[224:227], a[192:195], v[152:155]
  v_mfma_f32_16x16x32_bf16 v[152:155], a[228:231], a[8:11], v[152:155]
  v_mfma_f32_16x16x32_bf16 v[156:159], a[228:231], a[12:15], v[156:159]
  ds_read_b64_tr_b16 a[228:229], v10 offset:37120
  v_mfma_f32_16x16x32_bf16 v[156:159], a[224:227], a[196:199], v[156:159]
  ds_read_b64_tr_b16 a[230:231], v10 offset:43264
  v_mfma_f32_16x16x32_bf16 v[156:159], a[220:223], a[244:247], v[156:159]
  s_waitcnt lgkmcnt(3)
  ds_read_b64_tr_b16 a[224:225], v10 offset:36992
  v_mfma_f32_16x16x32_bf16 v[172:175], a[208:211], a[244:247], v[172:175]
  ds_read_b64_tr_b16 a[220:221], v10 offset:36864
  v_mfma_f32_16x16x32_bf16 v[172:175], a[212:215], a[196:199], v[172:175]
  s_waitcnt lgkmcnt(4)
  ds_read_b64_tr_b16 a[222:223], v10 offset:43008
  v_mfma_f32_16x16x32_bf16 v[172:175], a[216:219], a[12:15], v[172:175]
  buffer_load_dwordx4 a[108:111], v37, s[4:7], s51 offen offset:3072 sc1
  v_mfma_f32_16x16x32_bf16 v[168:171], a[216:219], a[8:11], v[168:171]
  s_add_u32 s54, s91, 12288
  ds_read_b64_tr_b16 a[226:227], v10 offset:43136
  v_mfma_f32_16x16x32_bf16 v[168:171], a[212:215], a[192:195], v[168:171]
  buffer_load_dwordx4 a[112:115], v37, s[4:7], s54 offen offset:0 sc1
  v_mfma_f32_16x16x32_bf16 v[168:171], a[208:211], a[240:243], v[168:171]
  v_mfma_f32_16x16x32_bf16 v[164:167], a[208:211], a[236:239], v[164:167]
  v_mov_b32 v41, s40
  v_mfma_f32_16x16x32_bf16 v[164:167], a[212:215], a[252:255], v[164:167]
  v_add_u32 v41, 6, v41
  v_mfma_f32_16x16x32_bf16 v[164:167], a[216:219], a[4:7], v[164:167]
  buffer_load_dwordx4 a[116:119], v37, s[4:7], s54 offen offset:1024 sc1
  v_mfma_f32_16x16x32_bf16 v[160:163], a[216:219], a[0:3], v[160:163]
  s_waitcnt vmcnt(11)
  s_cmp_lg_u32 s97, 0
  s_cbranch_scc1 L_slow6
  buffer_store_dword v41, v0, s[4:7], s41 offen
L_fast6:
  v_mfma_f32_16x16x32_bf16 v[160:163], a[212:215], a[248:251], v[160:163]
  ds_read_b64_tr_b16 a[216:217], v11 offset:37120
  v_mfma_f32_16x16x32_bf16 v[160:163], a[208:211], a[232:235], v[160:163]
  s_waitcnt lgkmcnt(2)
  ds_read_b64_tr_b16 a[212:213], v11 offset:36992
  v_mfma_f32_16x16x32_bf16 v[208:211], a[220:223], a[232:235], v[208:211]
  s_waitcnt lgkmcnt(2)
  ds_read_b64_tr_b16 a[208:209], v11 offset:36864
  v_mfma_f32_16x16x32_bf16 v[208:211], a[224:227], a[248:251], v[208:211]
  ds_read_b64_tr_b16 a[210:211], v11 offset:43008
  v_mfma_f32_16x16x32_bf16 v[208:211], a[228:231], a[0:3], v[208:211]
  buffer_load_dwordx4 a[120:123], v37, s[4:7], s54 offen offset:2048 sc1
  v_mfma_f32_16x16x32_bf16 v[212:215], a[228:231], a[4:7], v[212:215]
  s_add_u32 s43, s40, 5
  ds_read_b64_tr_b16 a[214:215], v11 offset:43136
  v_mfma_f32_16x16x32_bf16 v[212:215], a[224:227], a[252:255], v[212:215]
  ds_read_b64_tr_b16 a[218:219], v11 offset:43264
  v_mfma_f32_16x16x32_bf16 v[212:215], a[220:223], a[236:239], v[212:215]
  buffer_load_dwordx4 a[124:127], v37, s[4:7], s54 offen offset:3072 sc1
  v_mfma_f32_16x16x32_bf16 v[216:219], a[220:223], a[240:243], v[216:219]
  v_mfma_f32_16x16x32_bf16 v[216:219], a[224:227], a[192:195], v[216:219]
  s_waitcnt vmcnt(10)
  v_subrev_u32 v40, s43, v40
  v_mfma_f32_16x16x32_bf16 v[216:219], a[228:231], a[8:11], v[216:219]
  v_cmp_lt_u32 vcc, 7, v40
  v_mfma_f32_16x16x32_bf16 v[220:223], a[228:231], a[12:15], v[220:223]
  s_cbranch_vccnz L_spin6
L_ret6:
  ds_read_b64_tr_b16 a[228:229], v12 offset:37120
  v_mfma_f32_16x16x32_bf16 v[220:223], a[224:227], a[196:199], v[220:223]
  s_add_u32 s53, s89, 16384
  v_mfma_f32_16x16x32_bf16 v[220:223], a[220:223], a[244:247], v[220:223]
  s_waitcnt lgkmcnt(3)
  ds_read_b64_tr_b16 a[224:225], v12 offset:36992
  v_mfma_f32_16x16x32_bf16 v[236:239], a[208:211], a[244:247], v[236:239]
  s_waitcnt lgkmcnt(3)
  ds_read_b64_tr_b16 a[220:221], v12 offset:36864
  v_mfma_f32_16x16x32_bf16 v[236:239], a[212:215], a[196:199], v[236:239]
  s_waitcnt lgkmcnt(3)
  ds_read_b64_tr_b16 a[222:223], v12 offset:43008
  v_mfma_f32_16x16x32_bf16 v[236:239], a[216:219], a[12:15], v[236:239]
  buffer_load_dwordx4 v[80:83], v37, s[4:7], s53 offen offset:0 sc1
  v_mfma_f32_16x16x32_bf16 v[232:235], a[216:219], a[8:11], v[232:235]
  ds_read_b64_tr_b16 a[226:227], v12 offset:43136
  v_mfma_f32_16x16x32_bf16 v[232:235], a[212:215], a[192:195], v[232:235]
  ds_read_b64_tr_b16 a[230:231], v12 offset:43264
  v_mfma_f32_16x16x32_bf16 v[232:235], a[208:211], a[240:243], v[232:235]
  buffer_load_dwordx4 v[84:87], v37, s[4:7], s53 offen offset:1024 sc1
  v_mfma_f32_16x16x32_bf16 v[228:231], a[208:211], a[236:239], v[228:231]
  buffer_load_dwordx4 v[88:91], v37, s[4:7], s53 offen offset:2048 sc1
  v_mfma_f32_16x16x32_bf16 v[228:231], a[212:215], a[252:255], v[228:231]
  v_mfma_f32_16x16x32_bf16 v[228:231], a[216:219], a[4:7], v[228:231]
  v_mfma_f32_16x16x32_bf16 v[224:227], a[216:219], a[0:3], v[224:227]
  v_mfma_f32_16x16x32_bf16 v[224:227], a[212:215], a[248:251], v[224:227]
  buffer_load_dwordx4 v[92:95], v37, s[4:7], s53 offen offset:3072 sc1
  v_mfma_f32_16x16x32_bf16 v[224:227], a[208:211], a[232:235], v[224:227]
  s_waitcnt lgkmcnt(2)
  ds_read_b64_tr_b16 a[216:217], v11 offset:49408
  ds_read_b64_tr_b16 a[218:219], v11 offset:55552
  v_mfma_f32_16x16x32_bf16 v[240:243], a[220:223], a[232:235], v[240:243]
  s_waitcnt lgkmcnt(3)
  ds_read_b64_tr_b16 a[208:209], v11 offset:49152
  v_mfma_f32_16x16x32_bf16 v[240:243], a[224:227], a[248:251], v[240:243]
  s_waitcnt lgkmcnt(3)
  ds_read_b64_tr_b16 a[212:213], v11 offset:49280
  v_mfma_f32_16x16x32_bf16 v[240:243], a[228:231], a[0:3], v[240:243]
  s_add_u32 s52, s90, 16384
  ds_read_b64_tr_b16 a[210:211], v11 offset:55296
  v_mfma_f32_16x16x32_bf16 v[244:247], a[228:231], a[4:7], v[244:247]
  ds_read_b64_tr_b16 a[214:215], v11 offset:55424
  v_mfma_f32_16x16x32_bf16 v[244:247], a[224:227], a[252:255], v[244:247]
  buffer_load_dwordx4 v[96:99], v37, s[4:7], s52 offen offset:0 sc1
  v_mfma_f32_16x16x32_bf16 v[244:247], a[220:223], a[236:239], v[244:247]
  v_mfma_f32_16x16x32_bf16 v[248:251], a[220:223], a[240:243], v[248:251]
  v_mfma_f32_16x16x32_bf16 v[248:251], a[224:227], a[192:195], v[248:251]
  buffer_load_dwordx4 v[100:103], v37, s[4:7], s52 offen offset:1024 sc1
  v_mfma_f32_16x16x32_bf16 v[248:251], a[228:231], a[8:11], v[248:251]
  v_mfma_f32_16x16x32_bf16 v[252:255], a[228:231], a[12:15], v[252:255]
  v_mfma_f32_16x16x32_bf16 v[252:255], a[224:227], a[196:199], v[252:255]
  v_mfma_f32_16x16x32_bf16 v[252:255], a[220:223], a[244:247], v[252:255]
  s_waitcnt lgkmcnt(1)
  ds_read_b64_tr_b16 a[228:229], v12 offset:49408
  v_mfma_f32_16x16x32_bf16 v[188:191], a[208:211], a[28:31], v[188:191]
  s_waitcnt lgkmcnt(1)
  ds_read_b64_tr_b16 a[224:225], v12 offset:49280
  v_mfma_f32_16x16x32_bf16 v[188:191], a[212:215], a[44:47], v[188:191]
  ds_read_b64_tr_b16 a[220:221], v12 offset:49152
  v_mfma_f32_16x16x32_bf16 v[188:191], a[216:219], a[60:63], v[188:191]
  ds_read_b64_tr_b16 a[222:223], v12 offset:55296
  v_mfma_f32_16x16x32_bf16 v[184:187], a[216:219], a[56:59], v[184:187]
  ds_read_b64_tr_b16 a[226:227], v12 offset:55424
  v_mfma_f32_16x16x32_bf16 v[184:187], a[212:215], a[40:43], v[184:187]
  ds_read_b64_tr_b16 a[230:231], v12 offset:55552
  v_mfma_f32_16x16x32_bf16 v[184:187], a[208:211], a[24:27], v[184:187]
  buffer_load_dwordx4 v[104:107], v37, s[4:7], s52 offen offset:2048 sc1
  v_mfma_f32_16x16x32_bf16 v[180:183], a[208:211], a[20:23], v[180:183]
  buffer_load_dwordx4 v[108:111], v37, s[4:7], s52 offen offset:3072 sc1
  v_mfma_f32_16x16x32_bf16 v[180:183], a[212:215], a[36:39], v[180:183]
  s_add_u32 s56, s91, 16384
  v_mfma_f32_16x16x32_bf16 v[180:183], a[216:219], a[52:55], v[180:183]
  buffer_load_dwordx4 a[200:203], v37, s[4:7], s56 offen offset:0 sc1
  v_mfma_f32_16x16x32_bf16 v[176:179], a[216:219], a[48:51], v[176:179]
  v_mfma_f32_16x16x32_bf16 v[176:179], a[212:215], a[32:35], v[176:179]
  v_mfma_f32_16x16x32_bf16 v[176:179], a[208:211], a[16:19], v[176:179]
  s_waitcnt lgkmcnt(2)
  ds_read_b64_tr_b16 a[216:217], v5 offset:37120
  v_mfma_f32_16x16x32_bf16 a[144:147], a[220:223], a[16:19], a[144:147]
  s_waitcnt lgkmcnt(2)
  ds_read_b64_tr_b16 a[212:213], v5 offset:36992
  v_mfma_f32_16x16x32_bf16 a[144:147], a[224:227], a[32:35], a[144:147]
  s_waitcnt lgkmcnt(2)
  ds_read_b64_tr_b16 a[208:209], v5 offset:36864
  v_mfma_f32_16x16x32_bf16 a[144:147], a[228:231], a[48:51], a[144:147]
  ds_read_b64_tr_b16 a[210:211], v5 offset:43008
  v_mfma_f32_16x16x32_bf16 a[148:151], a[228:231], a[52:55], a[148:151]
  ds_read_b64_tr_b16 a[214:215], v5 offset:43136
  v_mfma_f32_16x16x32_bf16 a[148:151], a[224:227], a[36:39], a[148:151]
  ds_read_b64_tr_b16 a[218:219], v5 offset:43264
  v_mfma_f32_16x16x32_bf16 a[148:151], a[220:223], a[20:23], a[148:151]
  buffer_load_dwordx4 a[204:207], v37, s[4:7], s56 offen offset:1024 sc1
  v_mfma_f32_16x16x32_bf16 a[152:155], a[220:223], a[24:27], a[152:155]
  buffer_load_dwordx4 a[128:131], v37, s[4:7], s56 offen offset:2048 sc1
  v_mfma_f32_16x16x32_bf16 a[152:155], a[224:227], a[40:43], a[152:155]
  v_mfma_f32_16x16x32_bf16 a[152:155], a[228:231], a[56:59], a[152:155]
  buffer_load_dwordx4 a[132:135], v37, s[4:7], s56 offen offset:3072 sc1
  v_mfma_f32_16x16x32_bf16 a[156:159], a[228:231], a[60:63], a[156:159]
  v_mfma_f32_16x16x32_bf16 a[156:159], a[224:227], a[44:47], a[156:159]
  v_mfma_f32_16x16x32_bf16 a[156:159], a[220:223], a[28:31], a[156:159]
  s_waitcnt lgkmcnt(2)
  ds_read_b64_tr_b16 a[224:225], v6 offset:36992
  ds_read_b64_tr_b16 a[228:229], v6 offset:37120
  v_mfma_f32_16x16x32_bf16 v[204:207], a[208:211], a[28:31], v[204:207]
  s_waitcnt lgkmcnt(2)
  ds_read_b64_tr_b16 a[220:221], v6 offset:36864
  v_mfma_f32_16x16x32_bf16 v[204:207], a[212:215], a[44:47], v[204:207]
  s_add_u32 s57, s89, 20480
  ds_read_b64_tr_b16 a[222:223], v6 offset:43008
  v_mfma_f32_16x16x32_bf16 v[204:207], a[216:219], a[60:63], v[204:207]
  buffer_load_dwordx4 a[232:235], v37, s[4:7], s57 offen offset:0 sc1
  v_mfma_f32_16x16x32_bf16 v[200:203], a[216:219], a[56:59], v[200:203]
  ds_read_b64_tr_b16 a[226:227], v6 offset:43136
  v_mfma_f32_16x16x32_bf16 v[200:203], a[212:215], a[40:43], v[200:203]
  ds_read_b64_tr_b16 a[230:231], v6 offset:43264
  v_mfma_f32_16x16x32_bf16 v[200:203], a[208:211], a[24:27], v[200:203]
  v_mfma_f32_16x16x32_bf16 v[196:199], a[208:211], a[20:23], v[196:199]
  buffer_load_dwordx4 a[236:239], v37, s[4:7], s57 offen offset:1024 sc1
  v_mfma_f32_16x16x32_bf16 v[196:199], a[212:215], a[36:39], v[196:199]
  v_mfma_f32_16x16x32_bf16 v[196:199], a[216:219], a[52:55], v[196:199]
  v_mfma_f32_16x16x32_bf16 v[192:195], a[216:219], a[48:51], v[192:195]
  v_mfma_f32_16x16x32_bf16 v[192:195], a[212:215], a[32:35], v[192:195]
  buffer_load_dwordx4 a[240:243], v37, s[4:7], s57 offen offset:2048 sc1
  v_mfma_f32_16x16x32_bf16 v[192:195], a[208:211], a[16:19], v[192:195]
  s_waitcnt lgkmcnt(2)
  ds_read_b64_tr_b16 a[216:217], v5 offset:12544
  ds_read_b64_tr_b16 a[218:219], v5 offset:18688
  v_mfma_f32_16x16x32_bf16 a[160:163], a[220:223], a[16:19], a[160:163]
  s_waitcnt lgkmcnt(3)
  ds_read_b64_tr_b16 a[208:209], v5 offset:12288
  v_mfma_f32_16x16x32_bf16 a[160:163], a[224:227], a[32:35], a[160:163]
  s_waitcnt lgkmcnt(3)
  ds_read_b64_tr_b16 a[212:213], v5 offset:12416
  v_mfma_f32_16x16x32_bf16 a[160:163], a[228:231], a[48:51], a[160:163]
  ds_read_b64_tr_b16 a[210:211], v5 offset:18432
  v_mfma_f32_16x16x32_bf16 a[164:167], a[228:231], a[52:55], a[164:167]
  ds_read_b64_tr_b16 a[214:215], v5 offset:18560
  v_mfma_f32_16x16x32_bf16 a[164:167], a[224:227], a[36:39], a[164:167]
  buffer_load_dwordx4 a[244:247], v37, s[4:7], s57 offen offset:3072 sc1
  v_mfma_f32_16x16x32_bf16 a[164:167], a[220:223], a[20:23], a[164:167]
  v_mfma_f32_16x16x32_bf16 a[168:171], a[220:223], a[24:27], a[168:171]
  s_add_u32 s58, s90, 20480
  v_mfma_f32_16x16x32_bf16 a[168:171], a[224:227], a[40:43], a[168:171]
  buffer_load_dwordx4 a[248:251], v37, s[4:7], s58 offen offset:0 sc1
  v_mfma_f32_16x16x32_bf16 a[168:171], a[228:231], a[56:59], a[168:171]
  v_mfma_f32_16x16x32_bf16 a[172:175], a[228:231], a[60:63], a[172:175]
  v_mfma_f32_16x16x32_bf16 a[172:175], a[224:227], a[44:47], a[172:175]
  v_mfma_f32_16x16x32_bf16 a[172:175], a[220:223], a[28:31], a[172:175]
  s_waitcnt lgkmcnt(1)
  ds_read_b64_tr_b16 a[228:229], v6 offset:12544
  v_mfma_f32_16x16x32_bf16 v[188:191], a[208:211], v[60:63], v[188:191]
  s_waitcnt lgkmcnt(1)
  ds_read_b64_tr_b16 a[220:221], v6 offset:12288
  v_mfma_f32_16x16x32_bf16 v[188:191], a[212:215], v[76:79], v[188:191]
  ds_read_b64_tr_b16 a[224:225], v6 offset:12416
  v_mfma_f32_16x16x32_bf16 v[188:191], a[216:219], a[76:79], v[188:191]
  ds_read_b64_tr_b16 a[222:223], v6 offset:18432
  v_mfma_f32_16x16x32_bf16 v[184:187], a[216:219], a[72:75], v[184:187]
  ds_read_b64_tr_b16 a[226:227], v6 offset:18560
  v_mfma_f32_16x16x32_bf16 v[184:187], a[212:215], v[72:75], v[184:187]
  ds_read_b64_tr_b16 a[230:231], v6 offset:18688
  v_mfma_f32_16x16x32_bf16 v[184:187], a[208:211], v[56:59], v[184:187]
  buffer_load_dwordx4 a[252:255], v37, s[4:7], s58 offen offset:1024 sc1
  v_mfma_f32_16x16x32_bf16 v[180:183], a[208:211], v[52:55], v[180:183]
  buffer_load_dwordx4 a[192:195], v37, s[4:7], s58 offen offset:2048 sc1
  v_mfma_f32_16x16x32_bf16 v[180:183], a[212:215], v[68:71], v[180:183]
  buffer_load_dwordx4 a[196:199], v37, s[4:7], s58 offen offset:3072 sc1
  v_mfma_f32_16x16x32_bf16 v[180:183], a[216:219], a[68:71], v[180:183]
  v_mfma_f32_16x16x32_bf16 v[176:179], a[216:219], a[64:67], v[176:179]
  v_mfma_f32_16x16x32_bf16 v[176:179], a[212:215], v[64:67], v[176:179]
  s_waitcnt lgkmcnt(2)
  v_mfma_f32_16x16x32_bf16 v[176:179], a[208:211], v[48:51], v[176:179]
  s_add_u32 s81, s91, 20480
  ds_read_b64_tr_b16 a[216:217], v7 offset:12544
  v_mfma_f32_16x16x32_bf16 a[144:147], a[220:223], v[48:51], a[144:147]
  s_waitcnt lgkmcnt(2)
  ds_read_b64_tr_b16 a[212:213], v7 offset:12416
  v_mfma_f32_16x16x32_bf16 a[144:147], a[224:227], v[64:67], a[144:147]
  s_waitcnt lgkmcnt(2)
  ds_read_b64_tr_b16 a[208:209], v7 offset:12288
  v_mfma_f32_16x16x32_bf16 a[144:147], a[228:231], a[64:67], a[144:147]
  ds_read_b64_tr_b16 a[210:211], v7 offset:18432
  v_mfma_f32_16x16x32_bf16 a[148:151], a[228:231], a[68:71], a[148:151]
  ds_read_b64_tr_b16 a[214:215], v7 offset:18560
  v_mov_b32 v41, s40
  v_mfma_f32_16x16x32_bf16 a[148:151], a[224:227], v[68:71], a[148:151]
  ds_read_b64_tr_b16 a[218:219], v7 offset:18688
  v_add_u32 v41, 7, v41
  v_mfma_f32_16x16x32_bf16 a[148:151], a[220:223], v[52:55], a[148:151]
  buffer_load_dwordx4 a[0:3], v37, s[4:7], s81 offen offset:0 sc1
  v_mfma_f32_16x16x32_bf16 a[152:155], a[220:223], v[56:59], a[152:155]
  buffer_load_dwordx4 a[4:7], v37, s[4:7], s81 offen offset:1024 sc1
  v_mfma_f32_16x16x32_bf16 a[152:155], a[224:227], v[72:75], a[152:155]
  s_waitcnt vmcnt(10)
  s_cmp_lg_u32 s97, 0
  s_cbranch_scc1 L_slow7
  buffer_store_dword v41, v0, s[4:7], s41 offen
L_fast7:
  v_mfma_f32_16x16x32_bf16 a[152:155], a[228:231], a[72:75], a[152:155]
  buffer_load_dwordx4 a[8:11], v37, s[4:7], s81 offen offset:2048 sc1
  v_mfma_f32_16x16x32_bf16 a[156:159], a[228:231], a[76:79], a[156:159]
  ds_read_b64_tr_b16 a[228:229], v8 offset:12544
  v_mfma_f32_16x16x32_bf16 a[156:159], a[224:227], v[76:79], a[156:159]
  v_mfma_f32_16x16x32_bf16 a[156:159], a[220:223], v[60:63], a[156:159]
  s_waitcnt lgkmcnt(3)
  ds_read_b64_tr_b16 a[224:225], v8 offset:12416
  ds_read_b64_tr_b16 a[230:231], v8 offset:18688
  v_mfma_f32_16x16x32_bf16 v[188:191], a[208:211], a[92:95], v[188:191]
  s_waitcnt lgkmcnt(3)
  ds_read_b64_tr_b16 a[220:221], v8 offset:12288
  v_mfma_f32_16x16x32_bf16 v[188:191], a[212:215], a[108:111], v[188:191]
  s_add_u32 m0, s74, 98304
  ds_read_b64_tr_b16 a[222:223], v8 offset:18432
  v_mfma_f32_16x16x32_bf16 v[188:191], a[216:219], a[124:127], v[188:191]
  buffer_load_dwordx4 a[12:15], v37, s[4:7], s81 offen offset:3072 sc1
  v_mfma_f32_16x16x32_bf16 v[184:187], a[216:219], a[120:123], v[184:187]
  s_add_u32 s75, s94, 122880
  ds_read_b64_tr_b16 a[226:227], v8 offset:18560
  v_mfma_f32_16x16x32_bf16 v[184:187], a[212:215], a[104:107], v[184:187]
  buffer_load_dwordx4 v34, s[24:27], s75 offen offset:0  lds
  v_mfma_f32_16x16x32_bf16 v[184:187], a[208:211], a[88:91], v[184:187]
  v_mfma_f32_16x16x32_bf16 v[180:183], a[208:211], a[84:87], v[180:183]
  buffer_load_dwordx4 v35, s[24:27], s75 offen offset:1024  lds
  v_mfma_f32_16x16x32_bf16 v[180:183], a[212:215], a[100:103], v[180:183]
  v_mfma_f32_16x16x32_bf16 v[180:183], a[216:219], a[116:119], v[180:183]
  v_mfma_f32_16x16x32_bf16 v[176:179], a[216:219], a[112:115], v[176:179]
  v_mfma_f32_16x16x32_bf16 v[176:179], a[212:215], a[96:99], v[176:179]
  buffer_load_dwordx4 v36, s[24:27], s75 offen offset:2048  lds
  v_mfma_f32_16x16x32_bf16 v[176:179], a[208:211], a[80:83], v[176:179]
  s_waitcnt lgkmcnt(1)
  ds_read_b64_tr_b16 a[216:217], v1 offset:37120
  ds_read_b64_tr_b16 a[218:219], v1 offset:43264
  v_mfma_f32_16x16x32_bf16 a[144:147], a[220:223], a[80:83], a[144:147]
  s_waitcnt lgkmcnt(2)
  ds_read_b64_tr_b16 a[208:209], v1 offset:36864
  v_mfma_f32_16x16x32_bf16 a[144:147], a[224:227], a[96:99], a[144:147]
  s_add_u32 m0, s74, 49152
  ds_read_b64_tr_b16 a[212:213], v1 offset:36992
  v_mfma_f32_16x16x32_bf16 a[144:147], a[228:231], a[112:115], a[144:147]
  s_add_u32 s3, s94, 163840
  ds_read_b64_tr_b16 a[210:211], v1 offset:43008
  v_mfma_f32_16x16x32_bf16 a[148:151], a[228:231], a[116:119], a[148:151]
  ds_read_b64_tr_b16 a[214:215], v1 offset:43136
  v_mfma_f32_16x16x32_bf16 a[148:151], a[224:227], a[100:103], a[148:151]
  buffer_load_dword v40, v14, s[4:7], s78 offen offset:0 sc1
  v_mfma_f32_16x16x32_bf16 a[148:151], a[220:223], a[84:87], a[148:151]
  buffer_load_dwordx4 v34, s[24:27], s3 offen offset:0  lds
  v_mfma_f32_16x16x32_bf16 a[152:155], a[220:223], a[88:91], a[152:155]
  buffer_load_dwordx4 v35, s[24:27], s3 offen offset:1024  lds
  v_mfma_f32_16x16x32_bf16 a[152:155], a[224:227], a[104:107], a[152:155]
  v_mfma_f32_16x16x32_bf16 a[152:155], a[228:231], a[120:123], a[152:155]
  v_mfma_f32_16x16x32_bf16 a[156:159], a[228:231], a[124:127], a[156:159]
  v_mfma_f32_16x16x32_bf16 a[156:159], a[224:227], a[108:111], a[156:159]
  buffer_load_dwordx4 v36, s[24:27], s3 offen offset:2048  lds
  v_mfma_f32_16x16x32_bf16 a[156:159], a[220:223], a[92:95], a[156:159]
  s_waitcnt lgkmcnt(1)
  ds_read_b64_tr_b16 a[228:229], v2 offset:37120
  ds_read_b64_tr_b16 a[230:231], v2 offset:43264
  v_mfma_f32_16x16x32_bf16 v[188:191], a[208:211], v[92:95], v[188:191]
  s_waitcnt lgkmcnt(2)
  ds_read_b64_tr_b16 a[220:221], v2 offset:36864
  v_mfma_f32_16x16x32_bf16 v[188:191], a[212:215], v[108:111], v[188:191]
  s_add_u32 m0, s74, 24576
  ds_read_b64_tr_b16 a[224:225], v2 offset:36992
  v_mfma_f32_16x16x32_bf16 v[188:191], a[216:219], a[132:135], v[188:191]
  s_add_u32 s55, s94, 204800
  ds_read_b64_tr_b16 a[222:223], v2 offset:43008
  v_mfma_f32_16x16x32_bf16 v[184:187], a[216:219], a[128:131], v[184:187]
  ds_read_b64_tr_b16 a[226:227], v2 offset:43136
  v_mfma_f32_16x16x32_bf16 v[184:187], a[212:215], v[104:107], v[184:187]
  buffer_load_dwordx4 v34, s[24:27], s55 offen offset:0  lds
  v_mfma_f32_16x16x32_bf16 v[184:187], a[208:211], v[88:91], v[184:187]
  v_mfma_f32_16x16x32_bf16 v[180:183], a[208:211], v[84:87], v[180:183]
  buffer_load_dwordx4 v35, s[24:27], s55 offen offset:1024  lds
  v_mfma_f32_16x16x32_bf16 v[180:183], a[212:215], v[100:103], v[180:183]
  v_mfma_f32_16x16x32_bf16 v[180:183], a[216:219], a[204:207], v[180:183]
  v_mfma_f32_16x16x32_bf16 v[176:179], a[216:219], a[200:203], v[176:179]
  v_mfma_f32_16x16x32_bf16 v[176:179], a[212:215], v[96:99], v[176:179]
  buffer_load_dwordx4 v36, s[24:27], s55 offen offset:2048  lds
  v_mfma_f32_16x16x32_bf16 v[176:179], a[208:211], v[80:83], v[176:179]
  s_waitcnt lgkmcnt(1)
  ds_read_b64_tr_b16 a[216:217], v3 offset:37120
  ds_read_b64_tr_b16 a[218:219], v3 offset:43264
  v_mfma_f32_16x16x32_bf16 a[144:147], a[220:223], v[80:83], a[144:147]
  s_waitcnt lgkmcnt(2)
  ds_read_b64_tr_b16 a[208:209], v3 offset:36864
  v_mfma_f32_16x16x32_bf16 a[144:147], a[224:227], v[96:99], a[144:147]
  ds_read_b64_tr_b16 a[212:213], v3 offset:36992
  v_mfma_f32_16x16x32_bf16 a[144:147], a[228:231], a[200:203], a[144:147]
  ds_read_b64_tr_b16 a[210:211], v3 offset:43008
  v_mfma_f32_16x16x32_bf16 a[148:151], a[228:231], a[204:207], a[148:151]
  ds_read_b64_tr_b16 a[214:215], v3 offset:43136
  v_mfma_f32_16x16x32_bf16 a[148:151], a[224:227], v[100:103], a[148:151]
  v_mfma_f32_16x16x32_bf16 a[148:151], a[220:223], v[84:87], a[148:151]
  v_mfma_f32_16x16x32_bf16 a[152:155], a[220:223], v[88:91], a[152:155]
  v_mfma_f32_16x16x32_bf16 a[152:155], a[224:227], v[104:107], a[152:155]
  s_add_u32 m0, s74, 122880
  v_mfma_f32_16x16x32_bf16 a[152:155], a[228:231], a[128:131], a[152:155]
  s_add_u32 s59, s93, 40960
  v_mfma_f32_16x16x32_bf16 a[156:159], a[228:231], a[132:135], a[156:159]
  buffer_load_dwordx4 v34, s[24:27], s59 offen offset:0  lds
  v_mfma_f32_16x16x32_bf16 a[156:159], a[224:227], v[108:111], a[156:159]
  v_mfma_f32_16x16x32_bf16 a[156:159], a[220:223], v[92:95], a[156:159]
  s_waitcnt vmcnt(16) lgkmcnt(0)
  v_mfma_f32_16x16x32_bf16 v[188:191], a[208:211], a[244:247], v[188:191]
  s_add_u32 s43, s40, 6
  ds_read_b64_tr_b16 a[228:229], v4 offset:37120
  v_mfma_f32_16x16x32_bf16 v[188:191], a[212:215], a[196:199], v[188:191]
  s_waitcnt vmcnt(11)
  ds_read_b64_tr_b16 a[224:225], v4 offset:36992
  v_mfma_f32_16x16x32_bf16 v[188:191], a[216:219], a[12:15], v[188:191]
  ds_read_b64_tr_b16 a[220:221], v4 offset:36864
  ds_read_b64_tr_b16 a[222:223], v4 offset:43008
  v_mfma_f32_16x16x32_bf16 v[184:187], a[216:219], a[8:11], v[184:187]
  ds_read_b64_tr_b16 a[226:227], v4 offset:43136
  v_mfma_f32_16x16x32_bf16 v[184:187], a[212:215], a[192:195], v[184:187]
  s_waitcnt vmcnt(7)
  ds_read_b64_tr_b16 a[230:231], v4 offset:43264
  v_subrev_u32 v40, s43, v40
  v_mfma_f32_16x16x32_bf16 v[184:187], a[208:211], a[240:243], v[184:187]
  buffer_load_dwordx4 v35, s[24:27], s59 offen offset:1024  lds
  v_mfma_f32_16x16x32_bf16 v[180:183], a[208:211], a[236:239], v[180:183]
  buffer_load_dwordx4 v36, s[24:27], s59 offen offset:2048  lds
  v_mfma_f32_16x16x32_bf16 v[180:183], a[212:215], a[252:255], v[180:183]
  v_cmp_lt_u32 vcc, 7, v40
  v_mfma_f32_16x16x32_bf16 v[180:183], a[216:219], a[4:7], v[180:183]
  s_cbranch_vccnz L_spin7
L_ret7:
  v_mfma_f32_16x16x32_bf16 v[176:179], a[216:219], a[0:3], v[176:179]
  s_waitcnt lgkmcnt(2)
  v_mfma_f32_16x16x32_bf16 v[176:179], a[212:215], a[248:251], v[176:179]
  s_add_u32 m0, s74, 73728
  ds_read_b64_tr_b16 a[216:217], v9 offset:12544
  v_mfma_f32_16x16x32_bf16 v[176:179], a[208:211], a[232:235], v[176:179]
  s_add_u32 s60, s93, 81920
  v_mfma_f32_16x16x32_bf16 a[144:147], a[220:223], a[232:235], a[144:147]
  s_waitcnt lgkmcnt(2)
  ds_read_b64_tr_b16 a[218:219], v9 offset:18688
  v_cvt_pk_bf16_f32 v180, v180, v181
  v_mfma_f32_16x16x32_bf16 a[144:147], a[224:227], a[248:251], a[144:147]
  s_waitcnt lgkmcnt(2)
  ds_read_b64_tr_b16 a[212:213], v9 offset:12416
  v_cvt_pk_bf16_f32 v181, v182, v183
  v_mfma_f32_16x16x32_bf16 a[144:147], a[228:231], a[0:3], a[144:147]
  ds_read_b64_tr_b16 a[208:209], v9 offset:12288
  ds_read_b64_tr_b16 a[210:211], v9 offset:18432
  v_mfma_f32_16x16x32_bf16 a[148:151], a[228:231], a[4:7], a[148:151]
  ds_read_b64_tr_b16 a[214:215], v9 offset:18560
  v_cvt_pk_bf16_f32 v176, v176, v177
  v_mfma_f32_16x16x32_bf16 a[148:151], a[224:227], a[252:255], a[148:151]
  buffer_load_dwordx4 v34, s[24:27], s60 offen offset:0  lds
  v_mfma_f32_16x16x32_bf16 a[148:151], a[220:223], a[236:239], a[148:151]
  buffer_load_dwordx4 v35, s[24:27], s60 offen offset:1024  lds
  v_mfma_f32_16x16x32_bf16 a[152:155], a[220:223], a[240:243], a[152:155]
  v_cvt_pk_bf16_f32 v177, v178, v179
  v_cvt_pk_bf16_f32 v188, v188, v189
  v_mfma_f32_16x16x32_bf16 a[152:155], a[224:227], a[192:195], a[152:155]
  v_cvt_pk_bf16_f32 v184, v184, v185
  v_cvt_pk_bf16_f32 v185, v186, v187
  v_mfma_f32_16x16x32_bf16 a[152:155], a[228:231], a[8:11], a[152:155]
  v_cvt_pk_bf16_f32 v189, v190, v191
  v_mov_b32 v41, s40
  v_mfma_f32_16x16x32_bf16 a[156:159], a[228:231], a[12:15], a[156:159]
  buffer_load_dwordx4 v36, s[24:27], s60 offen offset:2048  lds
  v_mfma_f32_16x16x32_bf16 a[156:159], a[224:227], a[196:199], a[156:159]
  v_accvgpr_read_b32 v178, a144
  v_add_u32 v41, 2, v41
  v_mfma_f32_16x16x32_bf16 a[156:159], a[220:223], a[244:247], a[156:159]
  s_waitcnt lgkmcnt(1)
  ds_read_b64_tr_b16 a[224:225], v10 offset:12416
  ds_read_b64_tr_b16 a[228:229], v10 offset:12544
  v_mfma_f32_16x16x32_bf16 v[204:207], a[208:211], v[60:63], v[204:207]
  s_waitcnt lgkmcnt(2)
  ds_read_b64_tr_b16 a[220:221], v10 offset:12288
  v_accvgpr_read_b32 v179, a145
  v_mfma_f32_16x16x32_bf16 v[204:207], a[212:215], v[76:79], v[204:207]
  s_add_u32 m0, s74, 0
  ds_read_b64_tr_b16 a[222:223], v10 offset:18432
  v_accvgpr_read_b32 v20, a147
  v_mfma_f32_16x16x32_bf16 v[204:207], a[216:219], a[76:79], v[204:207]
  s_add_u32 s87, s93, 122880
  v_cvt_pk_bf16_f32 v178, v178, v179
  v_accvgpr_read_b32 v179, a146
  v_mfma_f32_16x16x32_bf16 v[200:203], a[216:219], a[72:75], v[200:203]
  ds_read_b64_tr_b16 a[226:227], v10 offset:18560
  v_cvt_pk_bf16_f32 v179, v179, v20
  v_mfma_f32_16x16x32_bf16 v[200:203], a[212:215], v[72:75], v[200:203]
  ds_read_b64_tr_b16 a[230:231], v10 offset:18688
  v_permlane32_swap_b32 v176, v178
  v_mfma_f32_16x16x32_bf16 v[200:203], a[208:211], v[56:59], v[200:203]
  buffer_load_dwordx4 v34, s[24:27], s87 offen offset:0  lds
  v_mfma_f32_16x16x32_bf16 v[196:199], a[208:211], v[52:55], v[196:199]
  s_add_u32 s64, s15, 0
  v_permlane32_swap_b32 v177, v179
  v_or_b32 v176, 1, v176
  v_mfma_f32_16x16x32_bf16 v[196:199], a[212:215], v[68:71], v[196:199]
  buffer_store_dwordx4 v[176:179], v37, s[4:7], s64 offen sc1
  v_mfma_f32_16x16x32_bf16 v[196:199], a[216:219], a[68:71], v[196:199]
  buffer_load_dwordx4 v35, s[24:27], s87 offen offset:1024  lds
  v_mfma_f32_16x16x32_bf16 v[192:195], a[216:219], a[64:67], v[192:195]
  v_accvgpr_read_b32 v182, a148
  v_accvgpr_read_b32 v183, a149
  v_mfma_f32_16x16x32_bf16 v[192:195], a[212:215], v[64:67], v[192:195]
  v_accvgpr_read_b32 v21, a151
  v_cvt_pk_bf16_f32 v182, v182, v183
  v_mfma_f32_16x16x32_bf16 v[192:195], a[208:211], v[48:51], v[192:195]
  s_waitcnt vmcnt(9)
  s_barrier
  v_accvgpr_read_b32 v183, a150
  s_waitcnt lgkmcnt(2)
  v_mfma_f32_16x16x32_bf16 a[160:163], a[220:223], v[48:51], a[160:163]
  s_waitcnt lgkmcnt(1)
  ds_read_b64_tr_b16 a[208:209], v9 offset:0
  ds_read_b64_tr_b16 a[210:211], v9 offset:6144
  v_mfma_f32_16x16x32_bf16 a[160:163], a[224:227], v[64:67], a[160:163]
  s_waitcnt lgkmcnt(2)
  ds_read_b64_tr_b16 a[212:213], v9 offset:128
  v_cvt_pk_bf16_f32 v183, v183, v21
  v_mfma_f32_16x16x32_bf16 a[160:163], a[228:231], a[64:67], a[160:163]
  ds_read_b64_tr_b16 a[214:215], v9 offset:6272
  ds_read_b64_tr_b16 a[216:217], v9 offset:256
  v_mfma_f32_16x16x32_bf16 a[164:167], a[228:231], a[68:71], a[164:167]
  buffer_load_dwordx4 v36, s[24:27], s87 offen offset:2048  lds
  v_mfma_f32_16x16x32_bf16 a[164:167], a[224:227], v[68:71], a[164:167]
  ds_read_b64_tr_b16 a[218:219], v9 offset:6400
  v_permlane32_swap_b32 v180, v182
  v_mfma_f32_16x16x32_bf16 a[164:167], a[220:223], v[52:55], a[164:167]
  s_add_u32 s61, s15, 1024
  v_permlane32_swap_b32 v181, v183
  v_or_b32 v180, 1, v180
  v_mfma_f32_16x16x32_bf16 a[168:171], a[220:223], v[56:59], a[168:171]
  buffer_store_dwordx4 v[180:183], v37, s[4:7], s61 offen sc1
  v_mfma_f32_16x16x32_bf16 a[168:171], a[224:227], v[72:75], a[168:171]
  v_accvgpr_read_b32 v186, a152
  v_accvgpr_read_b32 v187, a153
  v_mfma_f32_16x16x32_bf16 a[168:171], a[228:231], a[72:75], a[168:171]
  v_accvgpr_read_b32 v20, a155
  v_cvt_pk_bf16_f32 v186, v186, v187
  v_mfma_f32_16x16x32_bf16 a[172:175], a[228:231], a[76:79], a[172:175]
  s_add_u32 m0, s74, 135168
  v_accvgpr_read_b32 v187, a154
  v_mfma_f32_16x16x32_bf16 a[172:175], a[224:227], v[76:79], a[172:175]
  s_add_u32 s67, s93, 163840
  v_cvt_pk_bf16_f32 v187, v187, v20
  v_mfma_f32_16x16x32_bf16 a[172:175], a[220:223], v[60:63], a[172:175]
  s_waitcnt lgkmcnt(4)
  ds_read_b64_tr_b16 a[224:225], v10 offset:128
  ds_read_b64_tr_b16 a[228:229], v10 offset:256
  v_mfma_f32_16x16x32_bf16 v[204:207], a[208:211], a[92:95], v[204:207]
  s_waitcnt lgkmcnt(4)
  ds_read_b64_tr_b16 a[220:221], v10 offset:0
  v_permlane32_swap_b32 v184, v186
  v_mfma_f32_16x16x32_bf16 v[204:207], a[212:215], a[108:111], v[204:207]
  s_waitcnt lgkmcnt(3)
  ds_read_b64_tr_b16 a[222:223], v10 offset:6144
  v_permlane32_swap_b32 v185, v187
  v_mfma_f32_16x16x32_bf16 v[204:207], a[216:219], a[124:127], v[204:207]
  buffer_load_dwordx4 v34, s[24:27], s67 offen offset:0  lds
  v_mfma_f32_16x16x32_bf16 v[200:203], a[216:219], a[120:123], v[200:203]
  s_add_u32 s66, s15, 2048
  ds_read_b64_tr_b16 a[226:227], v10 offset:6272
  v_or_b32 v184, 1, v184
  v_mfma_f32_16x16x32_bf16 v[200:203], a[212:215], a[104:107], v[200:203]
  ds_read_b64_tr_b16 a[230:231], v10 offset:6400
  v_mfma_f32_16x16x32_bf16 v[200:203], a[208:211], a[88:91], v[200:203]
  buffer_store_dwordx4 v[184:187], v37, s[4:7], s66 offen sc1
  v_mfma_f32_16x16x32_bf16 v[196:199], a[208:211], a[84:87], v[196:199]
  buffer_load_dwordx4 v35, s[24:27], s67 offen offset:1024  lds
  v_mfma_f32_16x16x32_bf16 v[196:199], a[212:215], a[100:103], v[196:199]
  buffer_store_dword v41, v0, s[4:7], s42 offen offset:0 sc1
  v_mfma_f32_16x16x32_bf16 v[196:199], a[216:219], a[116:119], v[196:199]
  v_accvgpr_read_b32 v190, a156
  v_accvgpr_read_b32 v191, a157
  v_mfma_f32_16x16x32_bf16 v[192:195], a[216:219], a[112:115], v[192:195]
  buffer_load_dwordx4 v36, s[24:27], s67 offen offset:2048  lds
  v_mfma_f32_16x16x32_bf16 v[192:195], a[212:215], a[96:99], v[192:195]
  ds_read_b64_tr_b16 a[216:217], v5 offset:256
  v_accvgpr_read_b32 v21, a159
  v_mfma_f32_16x16x32_bf16 v[192:195], a[208:211], a[80:83], v[192:195]
  s_waitcnt lgkmcnt(1)
  ds_read_b64_tr_b16 a[212:213], v5 offset:128
  ds_read_b64_tr_b16 a[214:215], v5 offset:6272
  v_mfma_f32_16x16x32_bf16 a[160:163], a[220:223], a[80:83], a[160:163]
  s_add_u32 m0, s74, 12288
  ds_read_b64_tr_b16 a[208:209], v5 offset:0
  v_cvt_pk_bf16_f32 v190, v190, v191
  v_mfma_f32_16x16x32_bf16 a[160:163], a[224:227], a[96:99], a[160:163]
  s_add_u32 s65, s93, 204800
  ds_read_b64_tr_b16 a[210:211], v5 offset:6144
  v_accvgpr_read_b32 v191, a158
  v_mfma_f32_16x16x32_bf16 a[160:163], a[228:231], a[112:115], a[160:163]
L_pg18:
  s_cbranch_execz L_hop4
  v_cvt_pk_bf16_f32 v191, v191, v21
  v_permlane32_swap_b32 v188, v190
  v_mfma_f32_16x16x32_bf16 a[164:167], a[228:231], a[116:119], a[164:167]
  s_add_u32 s62, s15, 3072
  v_permlane32_swap_b32 v189, v191
  v_or_b32 v188, 1, v188
  v_mfma_f32_16x16x32_bf16 a[164:167], a[224:227], a[100:103], a[164:167]
  ds_read_b64_tr_b16 a[218:219], v5 offset:6400
  v_mfma_f32_16x16x32_bf16 a[164:167], a[220:223], a[84:87], a[164:167]
  buffer_load_dwordx4 v34, s[24:27], s65 offen offset:0  lds
  v_mfma_f32_16x16x32_bf16 a[168:171], a[220:223], a[88:91], a[168:171]
  buffer_store_dwordx4 v[188:191], v37, s[4:7], s62 offen sc1
  v_mfma_f32_16x16x32_bf16 a[168:171], a[224:227], a[104:107], a[168:171]
  buffer_load_dwordx4 v35, s[24:27], s65 offen offset:1024  lds
  v_mfma_f32_16x16x32_bf16 a[168:171], a[228:231], a[120:123], a[168:171]
  v_mfma_f32_16x16x32_bf16 a[172:175], a[228:231], a[124:127], a[172:175]
  ds_read_b64_tr_b16 a[228:229], v6 offset:256
  v_mfma_f32_16x16x32_bf16 a[172:175], a[224:227], a[108:111], a[172:175]
  s_waitcnt lgkmcnt(2)
  ds_read_b64_tr_b16 a[230:231], v6 offset:6400
  v_mfma_f32_16x16x32_bf16 a[172:175], a[220:223], a[92:95], a[172:175]
  buffer_load_dwordx4 v36, s[24:27], s65 offen offset:2048  lds
  v_mfma_f32_16x16x32_bf16 v[204:207], a[208:211], v[92:95], v[204:207]
  ds_read_b64_tr_b16 a[220:221], v6 offset:0
  v_mfma_f32_16x16x32_bf16 v[204:207], a[212:215], v[108:111], v[204:207]
  s_waitcnt lgkmcnt(3)
  ds_read_b64_tr_b16 a[224:225], v6 offset:128
  v_mfma_f32_16x16x32_bf16 v[204:207], a[216:219], a[132:135], v[204:207]
  ds_read_b64_tr_b16 a[222:223], v6 offset:6144
  v_mfma_f32_16x16x32_bf16 v[200:203], a[216:219], a[128:131], v[200:203]
  ds_read_b64_tr_b16 a[226:227], v6 offset:6272
  v_mfma_f32_16x16x32_bf16 v[200:203], a[212:215], v[104:107], v[200:203]
  v_mfma_f32_16x16x32_bf16 v[200:203], a[208:211], v[88:91], v[200:203]
  v_mfma_f32_16x16x32_bf16 v[196:199], a[208:211], v[84:87], v[196:199]
  v_mfma_f32_16x16x32_bf16 v[196:199], a[212:215], v[100:103], v[196:199]
  v_mfma_f32_16x16x32_bf16 v[196:199], a[216:219], a[204:207], v[196:199]
  v_mfma_f32_16x16x32_bf16 v[192:195], a[216:219], a[200:203], v[192:195]
  v_mfma_f32_16x16x32_bf16 v[192:195], a[212:215], v[96:99], v[192:195]
  v_mfma_f32_16x16x32_bf16 v[192:195], a[208:211], v[80:83], v[192:195]
  s_waitcnt lgkmcnt(1)
  v_mfma_f32_16x16x32_bf16 a[160:163], a[220:223], v[80:83], a[160:163]
  s_waitcnt lgkmcnt(0)
  ds_read_b64_tr_b16 a[216:217], v1 offset:24832
  v_mfma_f32_16x16x32_bf16 a[160:163], a[224:227], v[96:99], a[160:163]
  ds_read_b64_tr_b16 a[212:213], v1 offset:24704
  v_mfma_f32_16x16x32_bf16 a[160:163], a[228:231], a[200:203], a[160:163]
  ds_read_b64_tr_b16 a[208:209], v1 offset:24576
  ds_read_b64_tr_b16 a[210:211], v1 offset:30720
  v_mfma_f32_16x16x32_bf16 a[164:167], a[228:231], a[204:207], a[164:167]
  ds_read_b64_tr_b16 a[214:215], v1 offset:30848
  v_mfma_f32_16x16x32_bf16 a[164:167], a[224:227], v[100:103], a[164:167]
  ds_read_b64_tr_b16 a[218:219], v1 offset:30976
  v_mfma_f32_16x16x32_bf16 a[164:167], a[220:223], v[84:87], a[164:167]
  v_mfma_f32_16x16x32_bf16 a[168:171], a[220:223], v[88:91], a[168:171]
  v_mfma_f32_16x16x32_bf16 a[168:171], a[224:227], v[104:107], a[168:171]
  v_mfma_f32_16x16x32_bf16 a[168:171], a[228:231], a[128:131], a[168:171]
  v_mfma_f32_16x16x32_bf16 a[172:175], a[228:231], a[132:135], a[172:175]
  v_mfma_f32_16x16x32_bf16 a[172:175], a[224:227], v[108:111], a[172:175]
  v_mfma_f32_16x16x32_bf16 a[172:175], a[220:223], v[92:95], a[172:175]
  s_waitcnt lgkmcnt(2)
  v_mfma_f32_16x16x32_bf16 v[204:207], a[208:211], a[244:247], v[204:207]
  s_waitcnt lgkmcnt(1)
  ds_read_b64_tr_b16 a[228:229], v2 offset:24832
  v_mfma_f32_16x16x32_bf16 v[204:207], a[212:215], a[196:199], v[204:207]
  s_waitcnt lgkmcnt(1)
  ds_read_b64_tr_b16 a[224:225], v2 offset:24704
  v_mfma_f32_16x16x32_bf16 v[204:207], a[216:219], a[12:15], v[204:207]
  ds_read_b64_tr_b16 a[220:221], v2 offset:24576
  ds_read_b64_tr_b16 a[222:223], v2 offset:30720
  v_mfma_f32_16x16x32_bf16 v[200:203], a[216:219], a[8:11], v[200:203]
  ds_read_b64_tr_b16 a[226:227], v2 offset:30848
  v_mfma_f32_16x16x32_bf16 v[200:203], a[212:215], a[192:195], v[200:203]
  ds_read_b64_tr_b16 a[230:231], v2 offset:30976
  v_mfma_f32_16x16x32_bf16 v[200:203], a[208:211], a[240:243], v[200:203]
  buffer_load_dword v40, v39, s[4:7], s79 offen offset:0 sc1
  v_mfma_f32_16x16x32_bf16 v[196:199], a[208:211], a[236:239], v[196:199]
  v_mfma_f32_16x16x32_bf16 v[196:199], a[212:215], a[252:255], v[196:199]
  v_mfma_f32_16x16x32_bf16 v[196:199], a[216:219], a[4:7], v[196:199]
  v_mfma_f32_16x16x32_bf16 v[192:195], a[216:219], a[0:3], v[192:195]
  v_mfma_f32_16x16x32_bf16 v[192:195], a[212:215], a[248:251], v[192:195]
  v_mfma_f32_16x16x32_bf16 v[192:195], a[208:211], a[232:235], v[192:195]
  s_waitcnt lgkmcnt(2)
  ds_read_b64_tr_b16 a[216:217], v7 offset:37120
  v_mfma_f32_16x16x32_bf16 a[160:163], a[220:223], a[232:235], a[160:163]
  s_waitcnt lgkmcnt(2)
  ds_read_b64_tr_b16 a[208:209], v7 offset:36864
  v_cvt_pk_bf16_f32 v199, v198, v199
  v_mfma_f32_16x16x32_bf16 a[160:163], a[224:227], a[248:251], a[160:163]
  s_waitcnt lgkmcnt(2)
  ds_read_b64_tr_b16 a[212:213], v7 offset:36992
  v_cvt_pk_bf16_f32 v198, v196, v197
  v_mfma_f32_16x16x32_bf16 a[160:163], a[228:231], a[0:3], a[160:163]
  ds_read_b64_tr_b16 a[210:211], v7 offset:43008
  v_cvt_pk_bf16_f32 v192, v192, v193
  v_mfma_f32_16x16x32_bf16 a[164:167], a[228:231], a[4:7], a[164:167]
  ds_read_b64_tr_b16 a[214:215], v7 offset:43136
  v_cvt_pk_bf16_f32 v193, v194, v195
  v_mfma_f32_16x16x32_bf16 a[164:167], a[224:227], a[252:255], a[164:167]
  ds_read_b64_tr_b16 a[218:219], v7 offset:43264
  v_cvt_pk_bf16_f32 v200, v200, v201
  v_mfma_f32_16x16x32_bf16 a[164:167], a[220:223], a[236:239], a[164:167]
  v_cvt_pk_bf16_f32 v201, v202, v203
  v_mfma_f32_16x16x32_bf16 a[168:171], a[220:223], a[240:243], a[168:171]
  v_cvt_pk_bf16_f32 v207, v206, v207
  v_cvt_pk_bf16_f32 v206, v204, v205
  v_mfma_f32_16x16x32_bf16 a[168:171], a[224:227], a[192:195], a[168:171]
  v_mfma_f32_16x16x32_bf16 a[168:171], a[228:231], a[8:11], a[168:171]
  v_mfma_f32_16x16x32_bf16 a[172:175], a[228:231], a[12:15], a[172:175]
  v_accvgpr_read_b32 v194, a160
  v_accvgpr_read_b32 v195, a161
  v_mfma_f32_16x16x32_bf16 a[172:175], a[224:227], a[196:199], a[172:175]
  v_accvgpr_read_b32 v20, a163
  v_cvt_pk_bf16_f32 v194, v194, v195
  v_mfma_f32_16x16x32_bf16 a[172:175], a[220:223], a[244:247], a[172:175]
  s_waitcnt lgkmcnt(2)
  v_accvgpr_read_b32 v195, a162
  v_mfma_f32_16x16x32_bf16 v[156:159], a[208:211], a[28:31], v[156:159]
  s_waitcnt lgkmcnt(1)
  ds_read_b64_tr_b16 a[228:229], v8 offset:37120
  v_cvt_pk_bf16_f32 v195, v195, v20
  v_mfma_f32_16x16x32_bf16 v[156:159], a[212:215], a[44:47], v[156:159]
  s_waitcnt lgkmcnt(1)
  ds_read_b64_tr_b16 a[224:225], v8 offset:36992
  v_mfma_f32_16x16x32_bf16 v[156:159], a[216:219], a[60:63], v[156:159]
  ds_read_b64_tr_b16 a[220:221], v8 offset:36864
  ds_read_b64_tr_b16 a[222:223], v8 offset:43008
  v_mfma_f32_16x16x32_bf16 v[152:155], a[216:219], a[56:59], v[152:155]
  s_add_u32 s63, s15, 4096
  ds_read_b64_tr_b16 a[226:227], v8 offset:43136
  v_or_b32 v192, 1, v192
  v_mfma_f32_16x16x32_bf16 v[152:155], a[212:215], a[40:43], v[152:155]
  ds_read_b64_tr_b16 a[230:231], v8 offset:43264
  v_mfma_f32_16x16x32_bf16 v[152:155], a[208:211], a[24:27], v[152:155]
  buffer_store_dwordx4 v[192:195], v37, s[4:7], s63 offen sc1
  v_mfma_f32_16x16x32_bf16 v[148:151], a[208:211], a[20:23], v[148:151]
  v_mfma_f32_16x16x32_bf16 v[148:151], a[212:215], a[36:39], v[148:151]
  v_mfma_f32_16x16x32_bf16 v[148:151], a[216:219], a[52:55], v[148:151]
  v_accvgpr_read_b32 v196, a164
  v_accvgpr_read_b32 v197, a165
  v_mfma_f32_16x16x32_bf16 v[144:147], a[216:219], a[48:51], v[144:147]
  v_accvgpr_read_b32 v21, a167
  v_cvt_pk_bf16_f32 v196, v196, v197
  v_mfma_f32_16x16x32_bf16 v[144:147], a[212:215], a[32:35], v[144:147]
  v_accvgpr_read_b32 v197, a166
  v_mfma_f32_16x16x32_bf16 v[144:147], a[208:211], a[16:19], v[144:147]
  s_waitcnt lgkmcnt(2)
  ds_read_b64_tr_b16 a[216:217], v11 offset:12544
  v_cvt_pk_bf16_f32 v197, v197, v21
  v_mfma_f32_16x16x32_bf16 a[176:179], a[220:223], a[16:19], a[176:179]
  s_waitcnt lgkmcnt(2)
  ds_read_b64_tr_b16 a[212:213], v11 offset:12416
  v_mfma_f32_16x16x32_bf16 a[176:179], a[224:227], a[32:35], a[176:179]
  s_waitcnt lgkmcnt(2)
  ds_read_b64_tr_b16 a[214:215], v11 offset:18560
  v_mfma_f32_16x16x32_bf16 a[176:179], a[228:231], a[48:51], a[176:179]
  ds_read_b64_tr_b16 a[208:209], v11 offset:12288
  ds_read_b64_tr_b16 a[210:211], v11 offset:18432
  v_mfma_f32_16x16x32_bf16 a[180:183], a[228:231], a[52:55], a[180:183]
  s_add_u32 s50, s15, 5120
  v_or_b32 v196, 1, v196
  v_mfma_f32_16x16x32_bf16 a[180:183], a[224:227], a[36:39], a[180:183]
  ds_read_b64_tr_b16 a[218:219], v11 offset:18688
  v_mfma_f32_16x16x32_bf16 a[180:183], a[220:223], a[20:23], a[180:183]
  buffer_store_dwordx4 v[196:199], v37, s[4:7], s50 offen sc1
  v_mfma_f32_16x16x32_bf16 a[184:187], a[220:223], a[24:27], a[184:187]
  v_mfma_f32_16x16x32_bf16 a[184:187], a[224:227], a[40:43], a[184:187]
  s_add_u32 s43, s40, 2
  v_accvgpr_read_b32 v202, a168
  v_accvgpr_read_b32 v203, a169
  v_mfma_f32_16x16x32_bf16 a[184:187], a[228:231], a[56:59], a[184:187]
  v_accvgpr_read_b32 v20, a171
  v_cvt_pk_bf16_f32 v202, v202, v203
  v_mfma_f32_16x16x32_bf16 a[188:191], a[228:231], a[60:63], a[188:191]
  v_accvgpr_read_b32 v203, a170
  v_mfma_f32_16x16x32_bf16 a[188:191], a[224:227], a[44:47], a[188:191]
  v_cvt_pk_bf16_f32 v203, v203, v20
  v_mfma_f32_16x16x32_bf16 a[188:191], a[220:223], a[28:31], a[188:191]
  s_waitcnt lgkmcnt(1)
  ds_read_b64_tr_b16 a[224:225], v12 offset:12416
  ds_read_b64_tr_b16 a[228:229], v12 offset:12544
  v_mfma_f32_16x16x32_bf16 v[156:159], a[208:211], v[60:63], v[156:159]
  s_waitcnt vmcnt(2) lgkmcnt(2)
  ds_read_b64_tr_b16 a[220:221], v12 offset:12288
  v_subrev_u32 v40, s43, v40
  v_mfma_f32_16x16x32_bf16 v[156:159], a[212:215], v[76:79], v[156:159]
  s_add_u32 s48, s15, 6144
  ds_read_b64_tr_b16 a[222:223], v12 offset:18432
  v_or_b32 v200, 1, v200
  v_mfma_f32_16x16x32_bf16 v[156:159], a[216:219], a[76:79], v[156:159]
  v_cmp_lt_u32 vcc, 7, v40
  v_mfma_f32_16x16x32_bf16 v[152:155], a[216:219], a[72:75], v[152:155]
  s_cbranch_vccnz L_spin8
L_ret8:
  ds_read_b64_tr_b16 a[226:227], v12 offset:18560
  v_mfma_f32_16x16x32_bf16 v[152:155], a[212:215], v[72:75], v[152:155]
  ds_read_b64_tr_b16 a[230:231], v12 offset:18688
  v_mfma_f32_16x16x32_bf16 v[152:155], a[208:211], v[56:59], v[152:155]
  buffer_store_dwordx4 v[200:203], v37, s[4:7], s48 offen sc1
  v_mfma_f32_16x16x32_bf16 v[148:151], a[208:211], v[52:55], v[148:151]
  s_add_u32 s99, s15, s96
  v_accvgpr_read_b32 v204, a172
  v_accvgpr_read_b32 v205, a173
  v_mfma_f32_16x16x32_bf16 v[148:151], a[212:215], v[68:71], v[148:151]
  v_accvgpr_read_b32 v21, a175
  v_cvt_pk_bf16_f32 v204, v204, v205
  v_mfma_f32_16x16x32_bf16 v[148:151], a[216:219], a[68:71], v[148:151]
  buffer_load_dwordx4 v[176:179], v13, s[4:7], s99 offen offset:0 sc1
  v_mfma_f32_16x16x32_bf16 v[144:147], a[216:219], a[64:67], v[144:147]
  v_accvgpr_read_b32 v205, a174
  v_mfma_f32_16x16x32_bf16 v[144:147], a[212:215], v[64:67], v[144:147]
  v_cvt_pk_bf16_f32 v205, v205, v21
  v_mfma_f32_16x16x32_bf16 v[144:147], a[208:211], v[48:51], v[144:147]
  s_waitcnt lgkmcnt(1)
  ds_read_b64_tr_b16 a[216:217], v11 offset:256
  v_mfma_f32_16x16x32_bf16 a[176:179], a[220:223], v[48:51], a[176:179]
  s_add_u32 s49, s15, 7168
  ds_read_b64_tr_b16 a[212:213], v11 offset:128
  v_or_b32 v204, 1, v204
  v_mfma_f32_16x16x32_bf16 a[176:179], a[224:227], v[64:67], a[176:179]
  s_waitcnt lgkmcnt(2)
  ds_read_b64_tr_b16 a[208:209], v11 offset:0
  v_mfma_f32_16x16x32_bf16 a[176:179], a[228:231], a[64:67], a[176:179]
  ds_read_b64_tr_b16 a[210:211], v11 offset:6144
  v_mfma_f32_16x16x32_bf16 a[180:183], a[228:231], a[68:71], a[180:183]
  ds_read_b64_tr_b16 a[214:215], v11 offset:6272
  v_mfma_f32_16x16x32_bf16 a[180:183], a[224:227], v[68:71], a[180:183]
  ds_read_b64_tr_b16 a[218:219], v11 offset:6400
  v_mfma_f32_16x16x32_bf16 a[180:183], a[220:223], v[52:55], a[180:183]
  buffer_store_dwordx4 v[204:207], v37, s[4:7], s49 offen sc1
  v_mfma_f32_16x16x32_bf16 a[184:187], a[220:223], v[56:59], a[184:187]
  s_add_u32 s51, s9, s96
  v_mfma_f32_16x16x32_bf16 a[184:187], a[224:227], v[72:75], a[184:187]
  buffer_load_dwordx4 v[180:183], v13, s[4:7], s51 offen offset:1024 sc1
  v_mfma_f32_16x16x32_bf16 a[184:187], a[228:231], a[72:75], a[184:187]
  v_mfma_f32_16x16x32_bf16 a[188:191], a[228:231], a[76:79], a[188:191]
  v_mfma_f32_16x16x32_bf16 a[188:191], a[224:227], v[76:79], a[188:191]
  v_mfma_f32_16x16x32_bf16 a[188:191], a[220:223], v[60:63], a[188:191]
  s_waitcnt lgkmcnt(2)
  ds_read_b64_tr_b16 a[228:229], v12 offset:256
  v_mfma_f32_16x16x32_bf16 v[156:159], a[208:211], a[92:95], v[156:159]
  s_waitcnt lgkmcnt(2)
  ds_read_b64_tr_b16 a[220:221], v12 offset:0
  v_mfma_f32_16x16x32_bf16 v[156:159], a[212:215], a[108:111], v[156:159]
  s_waitcnt lgkmcnt(2)
  ds_read_b64_tr_b16 a[224:225], v12 offset:128
  v_mfma_f32_16x16x32_bf16 v[156:159], a[216:219], a[124:127], v[156:159]
  ds_read_b64_tr_b16 a[222:223], v12 offset:6144
  v_mfma_f32_16x16x32_bf16 v[152:155], a[216:219], a[120:123], v[152:155]
  ds_read_b64_tr_b16 a[226:227], v12 offset:6272
  v_mfma_f32_16x16x32_bf16 v[152:155], a[212:215], a[104:107], v[152:155]
  s_add_u32 s54, s11, s96
  ds_read_b64_tr_b16 a[230:231], v12 offset:6400
  v_mfma_f32_16x16x32_bf16 v[152:155], a[208:211], a[88:91], v[152:155]
  v_mfma_f32_16x16x32_bf16 v[148:151], a[208:211], a[84:87], v[148:151]
  buffer_load_dwordx4 v[184:187], v13, s[4:7], s54 offen offset:2048 sc1
  v_mfma_f32_16x16x32_bf16 v[148:151], a[212:215], a[100:103], v[148:151]
  v_mfma_f32_16x16x32_bf16 v[148:151], a[216:219], a[116:119], v[148:151]
  ds_read_b64_tr_b16 a[168:169], v7 offset:0
  v_mfma_f32_16x16x32_bf16 v[144:147], a[216:219], a[112:115], v[144:147]
  ds_read_b64_tr_b16 a[170:171], v7 offset:6144
  v_mfma_f32_16x16x32_bf16 v[144:147], a[212:215], a[96:99], v[144:147]
  ds_read_b64_tr_b16 a[172:173], v7 offset:128
  v_mfma_f32_16x16x32_bf16 v[144:147], a[208:211], a[80:83], v[144:147]
  s_waitcnt lgkmcnt(5)
  ds_read_b64_tr_b16 a[174:175], v7 offset:6272
  ds_read_b64_tr_b16 a[144:145], v7 offset:256
  v_mfma_f32_16x16x32_bf16 a[176:179], a[220:223], a[80:83], a[176:179]
  s_waitcnt lgkmcnt(6)
  ds_read_b64_tr_b16 a[146:147], v7 offset:6400
  v_mfma_f32_16x16x32_bf16 a[176:179], a[224:227], a[96:99], a[176:179]
  s_waitcnt lgkmcnt(6)
  v_mfma_f32_16x16x32_bf16 a[176:179], a[228:231], a[112:115], a[176:179]
  v_mfma_f32_16x16x32_bf16 a[180:183], a[228:231], a[116:119], a[180:183]
  s_add_u32 s53, s13, s96
  v_mfma_f32_16x16x32_bf16 a[180:183], a[224:227], a[100:103], a[180:183]
  v_mfma_f32_16x16x32_bf16 a[180:183], a[220:223], a[84:87], a[180:183]
  buffer_load_dwordx4 v[188:191], v13, s[4:7], s53 offen offset:3072 sc1
  v_mfma_f32_16x16x32_bf16 a[184:187], a[220:223], a[88:91], a[184:187]
  v_mfma_f32_16x16x32_bf16 a[184:187], a[224:227], a[104:107], a[184:187]
  v_mfma_f32_16x16x32_bf16 a[184:187], a[228:231], a[120:123], a[184:187]
  ds_read_b64_tr_b16 a[148:149], v8 offset:0
  v_mfma_f32_16x16x32_bf16 a[188:191], a[228:231], a[124:127], a[188:191]
  ds_read_b64_tr_b16 a[150:151], v8 offset:6144
  v_mfma_f32_16x16x32_bf16 a[188:191], a[224:227], a[108:111], a[188:191]
  ds_read_b64_tr_b16 a[152:153], v8 offset:128
  v_mfma_f32_16x16x32_bf16 a[188:191], a[220:223], a[92:95], a[188:191]
  s_waitcnt lgkmcnt(7)
  ds_read_b64_tr_b16 a[154:155], v8 offset:6272
  v_mfma_f32_16x16x32_bf16 v[156:159], a[168:171], v[92:95], v[156:159]
  s_waitcnt lgkmcnt(6)
  ds_read_b64_tr_b16 a[156:157], v8 offset:256
  v_mfma_f32_16x16x32_bf16 v[156:159], a[172:175], v[108:111], v[156:159]
  s_waitcnt lgkmcnt(5)
  ds_read_b64_tr_b16 a[158:159], v8 offset:6400
  v_mfma_f32_16x16x32_bf16 v[156:159], a[144:147], a[132:135], v[156:159]
  v_mfma_f32_16x16x32_bf16 v[152:155], a[144:147], a[128:131], v[152:155]
  v_mfma_f32_16x16x32_bf16 v[152:155], a[172:175], v[104:107], v[152:155]
  v_mfma_f32_16x16x32_bf16 v[152:155], a[168:171], v[88:91], v[152:155]
  v_mfma_f32_16x16x32_bf16 v[148:151], a[168:171], v[84:87], v[148:151]
  v_mfma_f32_16x16x32_bf16 v[148:151], a[172:175], v[100:103], v[148:151]
  v_mfma_f32_16x16x32_bf16 v[148:151], a[144:147], a[204:207], v[148:151]
  ds_read_b64_tr_b16 a[160:161], v3 offset:24576
  v_mfma_f32_16x16x32_bf16 v[144:147], a[144:147], a[200:203], v[144:147]
  ds_read_b64_tr_b16 a[162:163], v3 offset:30720
  v_mfma_f32_16x16x32_bf16 v[144:147], a[172:175], v[96:99], v[144:147]
  ds_read_b64_tr_b16 a[164:165], v3 offset:24704
  v_mfma_f32_16x16x32_bf16 v[144:147], a[168:171], v[80:83], v[144:147]
  s_waitcnt lgkmcnt(7)
  ds_read_b64_tr_b16 a[166:167], v3 offset:30848
  v_mfma_f32_16x16x32_bf16 a[176:179], a[148:151], v[80:83], a[176:179]
  s_waitcnt lgkmcnt(6)
  ds_read_b64_tr_b16 a[208:209], v3 offset:24832
  v_mfma_f32_16x16x32_bf16 a[176:179], a[152:155], v[96:99], a[176:179]
  s_waitcnt lgkmcnt(5)
  ds_read_b64_tr_b16 a[210:211], v3 offset:30976
  v_mfma_f32_16x16x32_bf16 a[176:179], a[156:159], a[200:203], a[176:179]
  v_mfma_f32_16x16x32_bf16 a[180:183], a[156:159], a[204:207], a[180:183]
  v_mfma_f32_16x16x32_bf16 a[180:183], a[152:155], v[100:103], a[180:183]
  v_mfma_f32_16x16x32_bf16 a[180:183], a[148:151], v[84:87], a[180:183]
  v_mfma_f32_16x16x32_bf16 a[184:187], a[148:151], v[88:91], a[184:187]
  v_mfma_f32_16x16x32_bf16 a[184:187], a[152:155], v[104:107], a[184:187]
  v_mfma_f32_16x16x32_bf16 a[184:187], a[156:159], a[128:131], a[184:187]
  ds_read_b64_tr_b16 a[212:213], v4 offset:24576
  v_mfma_f32_16x16x32_bf16 a[188:191], a[156:159], a[132:135], a[188:191]
  ds_read_b64_tr_b16 a[214:215], v4 offset:30720
  v_mfma_f32_16x16x32_bf16 a[188:191], a[152:155], v[108:111], a[188:191]
  ds_read_b64_tr_b16 a[216:217], v4 offset:24704
  v_mfma_f32_16x16x32_bf16 a[188:191], a[148:151], v[92:95], a[188:191]
  s_waitcnt lgkmcnt(7)
  ds_read_b64_tr_b16 a[218:219], v4 offset:30848
  v_mfma_f32_16x16x32_bf16 v[156:159], a[160:163], a[244:247], v[156:159]
  s_waitcnt lgkmcnt(6)
  ds_read_b64_tr_b16 a[220:221], v4 offset:24832
  v_mfma_f32_16x16x32_bf16 v[156:159], a[164:167], a[196:199], v[156:159]
  s_waitcnt lgkmcnt(5)
  ds_read_b64_tr_b16 a[222:223], v4 offset:30976
  v_mfma_f32_16x16x32_bf16 v[156:159], a[208:211], a[12:15], v[156:159]
  v_mfma_f32_16x16x32_bf16 v[152:155], a[208:211], a[8:11], v[152:155]
  v_mfma_f32_16x16x32_bf16 v[152:155], a[164:167], a[192:195], v[152:155]
  v_mfma_f32_16x16x32_bf16 v[152:155], a[160:163], a[240:243], v[152:155]
  v_mfma_f32_16x16x32_bf16 v[148:151], a[160:163], a[236:239], v[148:151]
  v_mfma_f32_16x16x32_bf16 v[148:151], a[164:167], a[252:255], v[148:151]
  v_mfma_f32_16x16x32_bf16 v[148:151], a[208:211], a[4:7], v[148:151]
  v_mfma_f32_16x16x32_bf16 v[144:147], a[208:211], a[0:3], v[144:147]
  v_mfma_f32_16x16x32_bf16 v[144:147], a[164:167], a[248:251], v[144:147]
  s_add_u32 s52, s8, 4096
  v_mfma_f32_16x16x32_bf16 v[144:147], a[160:163], a[232:235], v[144:147]
  s_barrier
  s_waitcnt lgkmcnt(4)
  v_mfma_f32_16x16x32_bf16 a[176:179], a[212:215], a[232:235], a[176:179]
  s_waitcnt lgkmcnt(2)
  ds_read_b64_tr_b16 a[224:225], v9 offset:24576
  v_cvt_pk_bf16_f32 v151, v150, v151
  v_mfma_f32_16x16x32_bf16 a[176:179], a[216:219], a[248:251], a[176:179]
  s_waitcnt lgkmcnt(1)
  ds_read_b64_tr_b16 a[226:227], v9 offset:30720
  v_cvt_pk_bf16_f32 v150, v148, v149
  v_mfma_f32_16x16x32_bf16 a[176:179], a[220:223], a[0:3], a[176:179]
  ds_read_b64_tr_b16 a[228:229], v9 offset:24704
  ds_read_b64_tr_b16 a[230:231], v9 offset:30848
  v_mfma_f32_16x16x32_bf16 a[180:183], a[220:223], a[4:7], a[180:183]
  ds_read_b64_tr_b16 a[168:169], v9 offset:24832
  v_cvt_pk_bf16_f32 v144, v144, v145
  v_mfma_f32_16x16x32_bf16 a[180:183], a[216:219], a[252:255], a[180:183]
  ds_read_b64_tr_b16 a[170:171], v9 offset:30976
  v_cvt_pk_bf16_f32 v145, v146, v147
  v_mfma_f32_16x16x32_bf16 a[180:183], a[212:215], a[236:239], a[180:183]
  buffer_load_dwordx4 v[192:195], v37, s[4:7], s52 offen offset:0 sc1
  v_mfma_f32_16x16x32_bf16 a[184:187], a[212:215], a[240:243], a[184:187]
  ds_read_b64_tr_b16 a[172:173], v10 offset:24576
  v_cvt_pk_bf16_f32 v152, v152, v153
  v_mfma_f32_16x16x32_bf16 a[184:187], a[216:219], a[192:195], a[184:187]
  ds_read_b64_tr_b16 a[174:175], v10 offset:30720
  v_cvt_pk_bf16_f32 v153, v154, v155
  v_mfma_f32_16x16x32_bf16 a[184:187], a[220:223], a[8:11], a[184:187]
  ds_read_b64_tr_b16 a[144:145], v10 offset:24704
  ds_read_b64_tr_b16 a[146:147], v10 offset:30848
  v_mfma_f32_16x16x32_bf16 a[188:191], a[220:223], a[12:15], a[188:191]
  s_add_u32 s56, s10, 5120
  ds_read_b64_tr_b16 a[148:149], v10 offset:24832
  v_accvgpr_read_b32 v146, a176
  v_mfma_f32_16x16x32_bf16 a[188:191], a[216:219], a[196:199], a[188:191]
  s_waitcnt lgkmcnt(9)
  ds_read_b64_tr_b16 a[150:151], v10 offset:30976
  v_accvgpr_read_b32 v147, a177
  v_mfma_f32_16x16x32_bf16 a[188:191], a[212:215], a[244:247], a[188:191]
  buffer_load_dwordx4 v[196:199], v37, s[4:7], s56 offen offset:0 sc1
  v_mfma_f32_16x16x32_bf16 v[172:175], a[224:227], a[28:31], v[172:175]
  s_waitcnt lgkmcnt(8)
  v_accvgpr_read_b32 v20, a179
  v_cvt_pk_bf16_f32 v146, v146, v147
  v_mfma_f32_16x16x32_bf16 v[172:175], a[228:231], a[44:47], v[172:175]
  s_waitcnt lgkmcnt(6)
  v_accvgpr_read_b32 v147, a178
  v_cvt_pk_bf16_f32 v159, v158, v159
  v_mfma_f32_16x16x32_bf16 v[172:175], a[168:171], a[60:63], v[172:175]
  ds_read_b64_tr_b16 a[152:153], v5 offset:24576
  v_cvt_pk_bf16_f32 v147, v147, v20
  v_mfma_f32_16x16x32_bf16 v[168:171], a[168:171], a[56:59], v[168:171]
  s_add_u32 s57, s15, 8192
  ds_read_b64_tr_b16 a[154:155], v5 offset:30720
  v_or_b32 v144, 1, v144
  v_mfma_f32_16x16x32_bf16 v[168:171], a[228:231], a[40:43], v[168:171]
  ds_read_b64_tr_b16 a[156:157], v5 offset:24704
  v_cvt_pk_bf16_f32 v158, v156, v157
  v_mfma_f32_16x16x32_bf16 v[168:171], a[224:227], a[24:27], v[168:171]
  ds_read_b64_tr_b16 a[158:159], v5 offset:30848
  v_mfma_f32_16x16x32_bf16 v[164:167], a[224:227], a[20:23], v[164:167]
  ds_read_b64_tr_b16 a[160:161], v5 offset:24832
  v_mfma_f32_16x16x32_bf16 v[164:167], a[228:231], a[36:39], v[164:167]
  s_waitcnt lgkmcnt(7)
  ds_read_b64_tr_b16 a[162:163], v5 offset:30976
  v_mfma_f32_16x16x32_bf16 v[164:167], a[168:171], a[52:55], v[164:167]
  buffer_store_dwordx4 v[144:147], v37, s[4:7], s57 offen sc1
  v_mfma_f32_16x16x32_bf16 v[212:215], a[172:175], a[20:23], v[212:215]
  s_add_u32 s58, s12, 6144
  v_accvgpr_read_b32 v148, a180
  v_accvgpr_read_b32 v149, a181
  v_mfma_f32_16x16x32_bf16 v[212:215], a[144:147], a[36:39], v[212:215]
  s_waitcnt lgkmcnt(6)
  buffer_load_dwordx4 v[200:203], v37, s[4:7], s58 offen offset:0 sc1
  v_mfma_f32_16x16x32_bf16 v[212:215], a[148:151], a[52:55], v[212:215]
  ds_read_b64_tr_b16 a[164:165], v6 offset:24576
  v_accvgpr_read_b32 v21, a183
  v_mfma_f32_16x16x32_bf16 v[216:219], a[148:151], a[56:59], v[216:219]
  ds_read_b64_tr_b16 a[166:167], v6 offset:30720
  v_cvt_pk_bf16_f32 v148, v148, v149
  v_mfma_f32_16x16x32_bf16 v[216:219], a[144:147], a[40:43], v[216:219]
  ds_read_b64_tr_b16 a[208:209], v6 offset:24704
  v_accvgpr_read_b32 v149, a182
  v_mfma_f32_16x16x32_bf16 v[216:219], a[172:175], a[24:27], v[216:219]
  ds_read_b64_tr_b16 a[210:211], v6 offset:30848
  v_cvt_pk_bf16_f32 v149, v149, v21
  v_mfma_f32_16x16x32_bf16 v[220:223], a[172:175], a[28:31], v[220:223]
  s_add_u32 s81, s15, 9216
  ds_read_b64_tr_b16 a[212:213], v6 offset:24832
  v_or_b32 v148, 1, v148
  v_mfma_f32_16x16x32_bf16 v[220:223], a[144:147], a[44:47], v[220:223]
  s_waitcnt lgkmcnt(9)
  ds_read_b64_tr_b16 a[214:215], v6 offset:30976
  v_mfma_f32_16x16x32_bf16 v[220:223], a[148:151], a[60:63], v[220:223]
  buffer_store_dwordx4 v[148:151], v37, s[4:7], s81 offen sc1
  v_mfma_f32_16x16x32_bf16 v[172:175], a[152:155], v[60:63], v[172:175]
  s_waitcnt lgkmcnt(6)
  v_mfma_f32_16x16x32_bf16 v[172:175], a[156:159], v[76:79], v[172:175]
  s_add_u32 s75, s14, 7168
  v_accvgpr_read_b32 v154, a184
  v_accvgpr_read_b32 v155, a185
  v_mfma_f32_16x16x32_bf16 v[172:175], a[160:163], a[76:79], v[172:175]
  ds_read_b64_tr_b16 a[216:217], v1 offset:0
  v_accvgpr_read_b32 v20, a187
  v_mfma_f32_16x16x32_bf16 v[168:171], a[160:163], a[72:75], v[168:171]
  ds_read_b64_tr_b16 a[218:219], v1 offset:6144
  v_cvt_pk_bf16_f32 v154, v154, v155
  v_mfma_f32_16x16x32_bf16 v[168:171], a[156:159], v[72:75], v[168:171]
  ds_read_b64_tr_b16 a[220:221], v1 offset:128
  v_accvgpr_read_b32 v155, a186
  v_mfma_f32_16x16x32_bf16 v[168:171], a[152:155], v[56:59], v[168:171]
  ds_read_b64_tr_b16 a[222:223], v1 offset:6272
  v_cvt_pk_bf16_f32 v155, v155, v20
  v_mfma_f32_16x16x32_bf16 v[164:167], a[152:155], v[52:55], v[164:167]
  s_waitcnt lgkmcnt(8)
  ds_read_b64_tr_b16 a[224:225], v1 offset:256
  v_mfma_f32_16x16x32_bf16 v[164:167], a[156:159], v[68:71], v[164:167]
  s_add_u32 s3, s15, 10240
  ds_read_b64_tr_b16 a[226:227], v1 offset:6400
  v_or_b32 v152, 1, v152
  v_mfma_f32_16x16x32_bf16 v[164:167], a[160:163], a[68:71], v[164:167]
  buffer_load_dwordx4 v[204:207], v37, s[4:7], s75 offen offset:0 sc1
  v_mfma_f32_16x16x32_bf16 v[212:215], a[164:167], v[52:55], v[212:215]
  s_waitcnt lgkmcnt(8)
  buffer_store_dwordx4 v[152:155], v37, s[4:7], s3 offen sc1
  v_mfma_f32_16x16x32_bf16 v[212:215], a[208:211], v[68:71], v[212:215]
  s_waitcnt lgkmcnt(6)
  v_mfma_f32_16x16x32_bf16 v[212:215], a[212:215], a[68:71], v[212:215]
  ds_read_b64_tr_b16 a[228:229], v2 offset:0
  v_mfma_f32_16x16x32_bf16 v[216:219], a[212:215], a[72:75], v[216:219]
  ds_read_b64_tr_b16 a[230:231], v2 offset:6144
  v_accvgpr_read_b32 v156, a188
  v_mfma_f32_16x16x32_bf16 v[216:219], a[208:211], v[72:75], v[216:219]
  ds_read_b64_tr_b16 a[168:169], v2 offset:128
  v_accvgpr_read_b32 v157, a189
  v_mfma_f32_16x16x32_bf16 v[216:219], a[164:167], v[56:59], v[216:219]
  ds_read_b64_tr_b16 a[170:171], v2 offset:6272
  v_accvgpr_read_b32 v21, a191
  v_mfma_f32_16x16x32_bf16 v[220:223], a[164:167], v[60:63], v[220:223]
  ds_read_b64_tr_b16 a[172:173], v2 offset:256
  v_cvt_pk_bf16_f32 v156, v156, v157
  v_mfma_f32_16x16x32_bf16 v[220:223], a[208:211], v[76:79], v[220:223]
  s_waitcnt lgkmcnt(7)
  ds_read_b64_tr_b16 a[174:175], v2 offset:6400
  v_accvgpr_read_b32 v157, a190
  v_mfma_f32_16x16x32_bf16 v[220:223], a[212:215], a[76:79], v[220:223]
  buffer_load_dword v40, v14, s[4:7], s78 offen offset:0 sc1
  v_mfma_f32_16x16x32_bf16 v[172:175], a[216:219], a[92:95], v[172:175]
  s_add_u32 s55, s15, 11264
  v_cvt_pk_bf16_f32 v157, v157, v21
  v_or_b32 v156, 1, v156
  v_mfma_f32_16x16x32_bf16 v[172:175], a[220:223], a[108:111], v[172:175]
  s_waitcnt lgkmcnt(6)
  v_mfma_f32_16x16x32_bf16 v[172:175], a[224:227], a[124:127], v[172:175]
  ds_read_b64_tr_b16 a[144:145], v9 offset:36864
  v_mfma_f32_16x16x32_bf16 v[168:171], a[224:227], a[120:123], v[168:171]
  ds_read_b64_tr_b16 a[146:147], v9 offset:43008
  v_mfma_f32_16x16x32_bf16 v[168:171], a[220:223], a[104:107], v[168:171]
  ds_read_b64_tr_b16 a[148:149], v9 offset:36992
  v_mfma_f32_16x16x32_bf16 v[168:171], a[216:219], a[88:91], v[168:171]
  ds_read_b64_tr_b16 a[150:151], v9 offset:43136
  v_mfma_f32_16x16x32_bf16 v[164:167], a[216:219], a[84:87], v[164:167]
  ds_read_b64_tr_b16 a[152:153], v9 offset:37120
  v_mfma_f32_16x16x32_bf16 v[164:167], a[220:223], a[100:103], v[164:167]
  buffer_store_dwordx4 v[156:159], v37, s[4:7], s55 offen sc1
  v_mfma_f32_16x16x32_bf16 v[164:167], a[224:227], a[116:119], v[164:167]
  s_waitcnt lgkmcnt(9)
  ds_read_b64_tr_b16 a[154:155], v9 offset:43264
  v_mfma_f32_16x16x32_bf16 v[212:215], a[228:231], a[84:87], v[212:215]
  s_waitcnt lgkmcnt(8)
  v_mfma_f32_16x16x32_bf16 v[212:215], a[168:171], a[100:103], v[212:215]
  s_waitcnt lgkmcnt(6)
  v_mfma_f32_16x16x32_bf16 v[212:215], a[172:175], a[116:119], v[212:215]
  ds_read_b64_tr_b16 a[156:157], v10 offset:36864
  v_mfma_f32_16x16x32_bf16 v[216:219], a[172:175], a[120:123], v[216:219]
  ds_read_b64_tr_b16 a[158:159], v10 offset:43008
  v_mfma_f32_16x16x32_bf16 v[216:219], a[168:171], a[104:107], v[216:219]
  ds_read_b64_tr_b16 a[160:161], v10 offset:36992
  v_mfma_f32_16x16x32_bf16 v[216:219], a[228:231], a[88:91], v[216:219]
  ds_read_b64_tr_b16 a[162:163], v10 offset:43136
  v_mfma_f32_16x16x32_bf16 v[220:223], a[228:231], a[92:95], v[220:223]
  ds_read_b64_tr_b16 a[164:165], v10 offset:37120
  v_mfma_f32_16x16x32_bf16 v[220:223], a[168:171], a[108:111], v[220:223]
  ds_read_b64_tr_b16 a[166:167], v10 offset:43264
  v_mfma_f32_16x16x32_bf16 v[220:223], a[172:175], a[124:127], v[220:223]
  s_waitcnt lgkmcnt(10)
  v_mfma_f32_16x16x32_bf16 v[172:175], a[144:147], v[92:95], v[172:175]
  s_waitcnt lgkmcnt(8)
  v_mfma_f32_16x16x32_bf16 v[172:175], a[148:151], v[108:111], v[172:175]
  s_waitcnt lgkmcnt(6)
  v_mfma_f32_16x16x32_bf16 v[172:175], a[152:155], a[132:135], v[172:175]
  ds_read_b64_tr_b16 a[208:209], v1 offset:12288
  v_mfma_f32_16x16x32_bf16 v[168:171], a[152:155], a[128:131], v[168:171]
  ds_read_b64_tr_b16 a[210:211], v1 offset:18432
  v_mfma_f32_16x16x32_bf16 v[168:171], a[148:151], v[104:107], v[168:171]
  ds_read_b64_tr_b16 a[212:213], v1 offset:12416
  v_mfma_f32_16x16x32_bf16 v[168:171], a[144:147], v[88:91], v[168:171]
  ds_read_b64_tr_b16 a[214:215], v1 offset:18560
  v_mfma_f32_16x16x32_bf16 v[164:167], a[144:147], v[84:87], v[164:167]
L_pg19:
  s_cbranch_execz L_hop4
  ds_read_b64_tr_b16 a[216:217], v1 offset:12544
  v_mfma_f32_16x16x32_bf16 v[164:167], a[148:151], v[100:103], v[164:167]
  ds_read_b64_tr_b16 a[218:219], v1 offset:18688
  v_mfma_f32_16x16x32_bf16 v[164:167], a[152:155], a[204:207], v[164:167]
  s_waitcnt lgkmcnt(10)
  v_mfma_f32_16x16x32_bf16 v[212:215], a[156:159], v[84:87], v[212:215]
  s_waitcnt lgkmcnt(8)
  v_mfma_f32_16x16x32_bf16 v[212:215], a[160:163], v[100:103], v[212:215]
  s_waitcnt lgkmcnt(6)
  v_mfma_f32_16x16x32_bf16 v[212:215], a[164:167], a[204:207], v[212:215]
  ds_read_b64_tr_b16 a[220:221], v2 offset:12288
  v_mfma_f32_16x16x32_bf16 v[216:219], a[164:167], a[128:131], v[216:219]
  ds_read_b64_tr_b16 a[222:223], v2 offset:18432
  v_mfma_f32_16x16x32_bf16 v[216:219], a[160:163], v[104:107], v[216:219]
  ds_read_b64_tr_b16 a[224:225], v2 offset:12416
  v_mfma_f32_16x16x32_bf16 v[216:219], a[156:159], v[88:91], v[216:219]
  ds_read_b64_tr_b16 a[226:227], v2 offset:18560
  v_mfma_f32_16x16x32_bf16 v[220:223], a[156:159], v[92:95], v[220:223]
  ds_read_b64_tr_b16 a[228:229], v2 offset:12544
  v_mfma_f32_16x16x32_bf16 v[220:223], a[160:163], v[108:111], v[220:223]
  s_add_u32 s43, s40, 7
  ds_read_b64_tr_b16 a[230:231], v2 offset:18688
  v_mfma_f32_16x16x32_bf16 v[220:223], a[164:167], a[132:135], v[220:223]
  s_waitcnt lgkmcnt(10)
  v_mfma_f32_16x16x32_bf16 v[172:175], a[208:211], a[244:247], v[172:175]
  s_waitcnt lgkmcnt(8)
  v_mfma_f32_16x16x32_bf16 v[172:175], a[212:215], a[196:199], v[172:175]
  s_waitcnt lgkmcnt(6)
  v_mfma_f32_16x16x32_bf16 v[172:175], a[216:219], a[12:15], v[172:175]
  s_waitcnt vmcnt(1)
  ds_read_b64_tr_b16 a[176:177], v11 offset:24576
  v_subrev_u32 v40, s43, v40
  v_mfma_f32_16x16x32_bf16 v[168:171], a[216:219], a[8:11], v[168:171]
  ds_read_b64_tr_b16 a[178:179], v11 offset:30720
  v_cmp_lt_u32 vcc, 7, v40
  v_mfma_f32_16x16x32_bf16 v[168:171], a[212:215], a[192:195], v[168:171]
  s_cbranch_vccnz L_spin9
L_ret9:
  ds_read_b64_tr_b16 a[180:181], v11 offset:24704
  v_mfma_f32_16x16x32_bf16 v[168:171], a[208:211], a[240:243], v[168:171]
  ds_read_b64_tr_b16 a[182:183], v11 offset:30848
  v_mfma_f32_16x16x32_bf16 v[164:167], a[208:211], a[236:239], v[164:167]
  ds_read_b64_tr_b16 a[184:185], v11 offset:24832
  v_mfma_f32_16x16x32_bf16 v[164:167], a[212:215], a[252:255], v[164:167]
  ds_read_b64_tr_b16 a[186:187], v11 offset:30976
  v_mfma_f32_16x16x32_bf16 v[164:167], a[216:219], a[4:7], v[164:167]
  s_waitcnt lgkmcnt(10)
  v_mfma_f32_16x16x32_bf16 v[212:215], a[220:223], a[236:239], v[212:215]
  s_waitcnt lgkmcnt(8)
  v_cvt_pk_bf16_f32 v171, v170, v171
  v_cvt_pk_bf16_f32 v170, v168, v169
  v_mfma_f32_16x16x32_bf16 v[212:215], a[224:227], a[252:255], v[212:215]
  s_waitcnt lgkmcnt(6)
  v_mfma_f32_16x16x32_bf16 v[212:215], a[228:231], a[4:7], v[212:215]
  ds_read_b64_tr_b16 a[188:189], v12 offset:24576
  v_cvt_pk_bf16_f32 v164, v164, v165
  v_mfma_f32_16x16x32_bf16 v[216:219], a[228:231], a[8:11], v[216:219]
  ds_read_b64_tr_b16 a[190:191], v12 offset:30720
  v_cvt_pk_bf16_f32 v165, v166, v167
  v_mfma_f32_16x16x32_bf16 v[216:219], a[224:227], a[192:195], v[216:219]
  ds_read_b64_tr_b16 a[168:169], v12 offset:24704
  v_cvt_pk_bf16_f32 v172, v172, v173
  v_mfma_f32_16x16x32_bf16 v[216:219], a[220:223], a[240:243], v[216:219]
  ds_read_b64_tr_b16 a[170:171], v12 offset:30848
  v_cvt_pk_bf16_f32 v173, v174, v175
  v_mfma_f32_16x16x32_bf16 v[220:223], a[220:223], a[244:247], v[220:223]
  ds_read_b64_tr_b16 a[172:173], v12 offset:24832
  v_mfma_f32_16x16x32_bf16 v[220:223], a[224:227], a[196:199], v[220:223]
  ds_read_b64_tr_b16 a[174:175], v12 offset:30976
  v_mfma_f32_16x16x32_bf16 v[220:223], a[228:231], a[12:15], v[220:223]
  s_waitcnt lgkmcnt(10)
  v_cvt_pk_bf16_f32 v166, v212, v213
  v_cvt_pk_bf16_f32 v167, v214, v215
  v_mfma_f32_16x16x32_bf16 v[236:239], a[176:179], a[28:31], v[236:239]
  s_waitcnt lgkmcnt(8)
  v_mfma_f32_16x16x32_bf16 v[236:239], a[180:183], a[44:47], v[236:239]
  s_waitcnt lgkmcnt(6)
  v_cvt_pk_bf16_f32 v168, v216, v217
  v_cvt_pk_bf16_f32 v169, v218, v219
  v_mfma_f32_16x16x32_bf16 v[236:239], a[184:187], a[60:63], v[236:239]
  ds_read_b64_tr_b16 a[144:145], v7 offset:24576
  v_mfma_f32_16x16x32_bf16 v[232:235], a[184:187], a[56:59], v[232:235]
  s_add_u32 s59, s15, 12288
  ds_read_b64_tr_b16 a[146:147], v7 offset:30720
  v_or_b32 v164, 1, v164
  v_mfma_f32_16x16x32_bf16 v[232:235], a[180:183], a[40:43], v[232:235]
  ds_read_b64_tr_b16 a[148:149], v7 offset:24704
  v_cvt_pk_bf16_f32 v174, v220, v221
  v_mfma_f32_16x16x32_bf16 v[232:235], a[176:179], a[24:27], v[232:235]
  ds_read_b64_tr_b16 a[150:151], v7 offset:30848
  v_cvt_pk_bf16_f32 v175, v222, v223
  v_mfma_f32_16x16x32_bf16 v[228:231], a[176:179], a[20:23], v[228:231]
  ds_read_b64_tr_b16 a[152:153], v7 offset:24832
  v_mfma_f32_16x16x32_bf16 v[228:231], a[180:183], a[36:39], v[228:231]
  s_waitcnt lgkmcnt(9)
  ds_read_b64_tr_b16 a[154:155], v7 offset:30976
  v_mfma_f32_16x16x32_bf16 v[228:231], a[184:187], a[52:55], v[228:231]
  buffer_store_dwordx4 v[164:167], v37, s[4:7], s59 offen sc1
  v_mfma_f32_16x16x32_bf16 v[244:247], a[188:191], a[20:23], v[244:247]
  s_waitcnt lgkmcnt(8)
  v_mfma_f32_16x16x32_bf16 v[244:247], a[168:171], a[36:39], v[244:247]
  s_waitcnt lgkmcnt(6)
  v_mfma_f32_16x16x32_bf16 v[244:247], a[172:175], a[52:55], v[244:247]
  s_add_u32 s60, s15, 13312
  ds_read_b64_tr_b16 a[156:157], v8 offset:24576
  v_or_b32 v168, 1, v168
  v_mfma_f32_16x16x32_bf16 v[248:251], a[172:175], a[56:59], v[248:251]
  s_add_u32 s64, s8, 8192
  ds_read_b64_tr_b16 a[158:159], v8 offset:30720
  v_mfma_f32_16x16x32_bf16 v[248:251], a[168:171], a[40:43], v[248:251]
  ds_read_b64_tr_b16 a[160:161], v8 offset:24704
  v_mfma_f32_16x16x32_bf16 v[248:251], a[188:191], a[24:27], v[248:251]
  ds_read_b64_tr_b16 a[162:163], v8 offset:30848
  v_mfma_f32_16x16x32_bf16 v[252:255], a[188:191], a[28:31], v[252:255]
  ds_read_b64_tr_b16 a[164:165], v8 offset:24832
  v_mfma_f32_16x16x32_bf16 v[252:255], a[168:171], a[44:47], v[252:255]
  s_waitcnt lgkmcnt(7)
  ds_read_b64_tr_b16 a[166:167], v8 offset:30976
  v_mfma_f32_16x16x32_bf16 v[252:255], a[172:175], a[60:63], v[252:255]
  buffer_store_dwordx4 v[168:171], v37, s[4:7], s60 offen sc1
  v_mfma_f32_16x16x32_bf16 v[236:239], a[144:147], v[60:63], v[236:239]
  buffer_load_dwordx4 v[144:147], v37, s[4:7], s64 offen offset:0 sc1
  v_mfma_f32_16x16x32_bf16 v[236:239], a[148:151], v[76:79], v[236:239]
  s_waitcnt lgkmcnt(6)
  s_add_u32 s87, s15, 14336
  v_or_b32 v172, 1, v172
  v_mfma_f32_16x16x32_bf16 v[236:239], a[152:155], a[76:79], v[236:239]
  ds_read_b64_tr_b16 a[208:209], v3 offset:0
  v_mfma_f32_16x16x32_bf16 v[232:235], a[152:155], a[72:75], v[232:235]
  ds_read_b64_tr_b16 a[210:211], v3 offset:6144
  v_mfma_f32_16x16x32_bf16 v[232:235], a[148:151], v[72:75], v[232:235]
  ds_read_b64_tr_b16 a[212:213], v3 offset:128
  v_mfma_f32_16x16x32_bf16 v[232:235], a[144:147], v[56:59], v[232:235]
  s_add_u32 s61, s10, 9216
  ds_read_b64_tr_b16 a[214:215], v3 offset:6272
  v_mfma_f32_16x16x32_bf16 v[228:231], a[144:147], v[52:55], v[228:231]
  ds_read_b64_tr_b16 a[216:217], v3 offset:256
  v_mfma_f32_16x16x32_bf16 v[228:231], a[148:151], v[68:71], v[228:231]
  s_waitcnt lgkmcnt(7)
  ds_read_b64_tr_b16 a[218:219], v3 offset:6400
  v_mfma_f32_16x16x32_bf16 v[228:231], a[152:155], a[68:71], v[228:231]
  buffer_store_dwordx4 v[172:175], v37, s[4:7], s87 offen sc1
  v_mfma_f32_16x16x32_bf16 v[244:247], a[156:159], v[52:55], v[244:247]
  buffer_load_dwordx4 v[148:151], v37, s[4:7], s61 offen offset:0 sc1
  v_mfma_f32_16x16x32_bf16 v[244:247], a[160:163], v[68:71], v[244:247]
  s_waitcnt lgkmcnt(6)
  v_mfma_f32_16x16x32_bf16 v[244:247], a[164:167], a[68:71], v[244:247]
  ds_read_b64_tr_b16 a[220:221], v4 offset:0
  v_mfma_f32_16x16x32_bf16 v[248:251], a[164:167], a[72:75], v[248:251]
  ds_read_b64_tr_b16 a[222:223], v4 offset:6144
  v_mfma_f32_16x16x32_bf16 v[248:251], a[160:163], v[72:75], v[248:251]
  ds_read_b64_tr_b16 a[224:225], v4 offset:128
  v_mfma_f32_16x16x32_bf16 v[248:251], a[156:159], v[56:59], v[248:251]
  ds_read_b64_tr_b16 a[226:227], v4 offset:6272
  v_mfma_f32_16x16x32_bf16 v[252:255], a[156:159], v[60:63], v[252:255]
  ds_read_b64_tr_b16 a[228:229], v4 offset:256
  v_mfma_f32_16x16x32_bf16 v[252:255], a[160:163], v[76:79], v[252:255]
  s_add_u32 s66, s12, 10240
  ds_read_b64_tr_b16 a[230:231], v4 offset:6400
  v_mfma_f32_16x16x32_bf16 v[252:255], a[164:167], a[76:79], v[252:255]
  s_waitcnt lgkmcnt(8)
  v_mfma_f32_16x16x32_bf16 v[236:239], a[208:211], a[92:95], v[236:239]
  buffer_load_dwordx4 v[152:155], v37, s[4:7], s66 offen offset:0 sc1
  v_mfma_f32_16x16x32_bf16 v[236:239], a[212:215], a[108:111], v[236:239]
  s_waitcnt lgkmcnt(6)
  v_mfma_f32_16x16x32_bf16 v[236:239], a[216:219], a[124:127], v[236:239]
  ds_read_b64_tr_b16 a[20:21], v11 offset:36864
  v_mfma_f32_16x16x32_bf16 v[232:235], a[216:219], a[120:123], v[232:235]
  ds_read_b64_tr_b16 a[22:23], v11 offset:43008
  v_mfma_f32_16x16x32_bf16 v[232:235], a[212:215], a[104:107], v[232:235]
  ds_read_b64_tr_b16 a[36:37], v11 offset:36992
  v_mfma_f32_16x16x32_bf16 v[232:235], a[208:211], a[88:91], v[232:235]
  ds_read_b64_tr_b16 a[38:39], v11 offset:43136
  v_mfma_f32_16x16x32_bf16 v[228:231], a[208:211], a[84:87], v[228:231]
  ds_read_b64_tr_b16 a[52:53], v11 offset:37120
  v_mfma_f32_16x16x32_bf16 v[228:231], a[212:215], a[100:103], v[228:231]
  ds_read_b64_tr_b16 a[54:55], v11 offset:43264
  v_mfma_f32_16x16x32_bf16 v[228:231], a[216:219], a[116:119], v[228:231]
  s_waitcnt lgkmcnt(8)
  v_mfma_f32_16x16x32_bf16 v[244:247], a[220:223], a[84:87], v[244:247]
  s_add_u32 s67, s14, 11264
  v_mfma_f32_16x16x32_bf16 v[244:247], a[224:227], a[100:103], v[244:247]
  s_waitcnt lgkmcnt(6)
  v_mfma_f32_16x16x32_bf16 v[244:247], a[228:231], a[116:119], v[244:247]
  ds_read_b64_tr_b16 a[24:25], v12 offset:36864
  v_mfma_f32_16x16x32_bf16 v[248:251], a[228:231], a[120:123], v[248:251]
  ds_read_b64_tr_b16 a[26:27], v12 offset:43008
  v_mfma_f32_16x16x32_bf16 v[248:251], a[224:227], a[104:107], v[248:251]
  ds_read_b64_tr_b16 a[40:41], v12 offset:36992
  v_mfma_f32_16x16x32_bf16 v[248:251], a[220:223], a[88:91], v[248:251]
  ds_read_b64_tr_b16 a[42:43], v12 offset:43136
  v_mfma_f32_16x16x32_bf16 v[252:255], a[220:223], a[92:95], v[252:255]
  ds_read_b64_tr_b16 a[56:57], v12 offset:37120
  v_mfma_f32_16x16x32_bf16 v[252:255], a[224:227], a[108:111], v[252:255]
  buffer_load_dwordx4 v[156:159], v37, s[4:7], s67 offen offset:0 sc1
  v_mfma_f32_16x16x32_bf16 v[252:255], a[228:231], a[124:127], v[252:255]
  s_waitcnt lgkmcnt(9)
  ds_read_b64_tr_b16 a[58:59], v12 offset:43264
  v_mfma_f32_16x16x32_bf16 v[236:239], a[20:23], v[92:95], v[236:239]
  s_waitcnt lgkmcnt(8)
  v_mfma_f32_16x16x32_bf16 v[236:239], a[36:39], v[108:111], v[236:239]
  s_waitcnt lgkmcnt(6)
  v_mfma_f32_16x16x32_bf16 v[236:239], a[52:55], a[132:135], v[236:239]
  ds_read_b64_tr_b16 a[28:29], v3 offset:12288
  v_mfma_f32_16x16x32_bf16 v[232:235], a[52:55], a[128:131], v[232:235]
  ds_read_b64_tr_b16 a[30:31], v3 offset:18432
  v_mfma_f32_16x16x32_bf16 v[232:235], a[36:39], v[104:107], v[232:235]
  ds_read_b64_tr_b16 a[44:45], v3 offset:12416
  v_mfma_f32_16x16x32_bf16 v[232:235], a[20:23], v[88:91], v[232:235]
  ds_read_b64_tr_b16 a[46:47], v3 offset:18560
  v_mfma_f32_16x16x32_bf16 v[228:231], a[20:23], v[84:87], v[228:231]
  ds_read_b64_tr_b16 a[60:61], v3 offset:12544
  v_mfma_f32_16x16x32_bf16 v[228:231], a[36:39], v[100:103], v[228:231]
  ds_read_b64_tr_b16 a[62:63], v3 offset:18688
  v_mfma_f32_16x16x32_bf16 v[228:231], a[52:55], a[204:207], v[228:231]
  s_waitcnt lgkmcnt(10)
  v_mfma_f32_16x16x32_bf16 v[244:247], a[24:27], v[84:87], v[244:247]
  s_waitcnt lgkmcnt(8)
  v_mfma_f32_16x16x32_bf16 v[244:247], a[40:43], v[100:103], v[244:247]
  s_waitcnt lgkmcnt(6)
  v_mfma_f32_16x16x32_bf16 v[244:247], a[56:59], a[204:207], v[244:247]
  ds_read_b64_tr_b16 v[52:53], v4 offset:12288
  v_mfma_f32_16x16x32_bf16 v[248:251], a[56:59], a[128:131], v[248:251]
  ds_read_b64_tr_b16 v[54:55], v4 offset:18432
  v_mfma_f32_16x16x32_bf16 v[248:251], a[40:43], v[104:107], v[248:251]
  ds_read_b64_tr_b16 v[68:69], v4 offset:12416
  v_mfma_f32_16x16x32_bf16 v[248:251], a[24:27], v[88:91], v[248:251]
  ds_read_b64_tr_b16 v[70:71], v4 offset:18560
  v_mfma_f32_16x16x32_bf16 v[252:255], a[24:27], v[92:95], v[252:255]
  ds_read_b64_tr_b16 a[68:69], v4 offset:12544
  v_mfma_f32_16x16x32_bf16 v[252:255], a[40:43], v[108:111], v[252:255]
  ds_read_b64_tr_b16 a[70:71], v4 offset:18688
  v_mfma_f32_16x16x32_bf16 v[252:255], a[56:59], a[132:135], v[252:255]
  s_waitcnt lgkmcnt(10)
  v_mfma_f32_16x16x32_bf16 v[236:239], a[28:31], a[244:247], v[236:239]
  s_waitcnt lgkmcnt(8)
  v_mfma_f32_16x16x32_bf16 v[236:239], a[44:47], a[196:199], v[236:239]
  s_waitcnt lgkmcnt(6)
  v_mfma_f32_16x16x32_bf16 v[236:239], a[60:63], a[12:15], v[236:239]
  v_mfma_f32_16x16x32_bf16 v[232:235], a[60:63], a[8:11], v[232:235]
  v_mfma_f32_16x16x32_bf16 v[232:235], a[44:47], a[192:195], v[232:235]
  ds_read_b64_tr_b16 v[56:57], v9 offset:24576
  v_mfma_f32_16x16x32_bf16 v[232:235], a[28:31], a[240:243], v[232:235]
  ds_read_b64_tr_b16 v[58:59], v9 offset:30720
  v_mfma_f32_16x16x32_bf16 v[228:231], a[28:31], a[236:239], v[228:231]
  ds_read_b64_tr_b16 v[72:73], v9 offset:24704
  v_mfma_f32_16x16x32_bf16 v[228:231], a[44:47], a[252:255], v[228:231]
  v_cvt_pk_bf16_f32 v236, v236, v237
  v_cvt_pk_bf16_f32 v237, v238, v239
  v_mfma_f32_16x16x32_bf16 v[228:231], a[60:63], a[4:7], v[228:231]
  s_waitcnt lgkmcnt(7)
  v_cvt_pk_bf16_f32 v235, v234, v235
  v_cvt_pk_bf16_f32 v234, v232, v233
  v_mfma_f32_16x16x32_bf16 v[244:247], v[52:55], a[236:239], v[244:247]
  s_waitcnt lgkmcnt(5)
  ds_read_b64_tr_b16 v[74:75], v9 offset:30848
  v_mfma_f32_16x16x32_bf16 v[244:247], v[68:71], a[252:255], v[244:247]
  s_waitcnt lgkmcnt(4)
  ds_read_b64_tr_b16 a[72:73], v9 offset:24832
  v_mfma_f32_16x16x32_bf16 v[244:247], a[68:71], a[4:7], v[244:247]
  v_cvt_pk_bf16_f32 v228, v228, v229
  v_cvt_pk_bf16_f32 v229, v230, v231
  v_mfma_f32_16x16x32_bf16 v[248:251], a[68:71], a[8:11], v[248:251]
  ds_read_b64_tr_b16 a[74:75], v9 offset:30976
  v_mfma_f32_16x16x32_bf16 v[248:251], v[68:71], a[192:195], v[248:251]
  ds_read_b64_tr_b16 v[60:61], v5 offset:24576
  v_or_b32 v236, 1, v236
  v_mfma_f32_16x16x32_bf16 v[248:251], v[52:55], a[240:243], v[248:251]
  v_cvt_pk_bf16_f32 v230, v244, v245
  v_cvt_pk_bf16_f32 v231, v246, v247
  v_mfma_f32_16x16x32_bf16 v[252:255], v[52:55], a[244:247], v[252:255]
  ds_read_b64_tr_b16 v[62:63], v5 offset:30720
  v_or_b32 v228, 1, v228
  v_mfma_f32_16x16x32_bf16 v[252:255], v[68:71], a[196:199], v[252:255]
  s_add_u32 s62, s15, 17408
  ds_read_b64_tr_b16 v[76:77], v5 offset:24704
  v_mfma_f32_16x16x32_bf16 v[252:255], a[68:71], a[12:15], v[252:255]
  s_add_u32 s65, s15, 15360
  v_cvt_pk_bf16_f32 v232, v248, v249
  v_cvt_pk_bf16_f32 v233, v250, v251
  v_mfma_f32_16x16x32_bf16 v[224:227], a[176:179], a[16:19], v[224:227]
  buffer_store_dwordx4 v[228:231], v37, s[4:7], s65 offen sc1
  v_mfma_f32_16x16x32_bf16 v[224:227], a[180:183], a[32:35], v[224:227]
  s_add_u32 s63, s15, 16384
  ds_read_b64_tr_b16 v[78:79], v5 offset:30848
  v_or_b32 v232, 1, v232
  v_mfma_f32_16x16x32_bf16 v[224:227], a[184:187], a[48:51], v[224:227]
  buffer_store_dwordx4 v[232:235], v37, s[4:7], s63 offen sc1
  v_mfma_f32_16x16x32_bf16 v[224:227], a[144:147], v[48:51], v[224:227]
  v_cvt_pk_bf16_f32 v238, v252, v253
  v_cvt_pk_bf16_f32 v239, v254, v255
  v_mfma_f32_16x16x32_bf16 v[224:227], a[148:151], v[64:67], v[224:227]
  buffer_store_dwordx4 v[236:239], v37, s[4:7], s62 offen sc1
  v_mfma_f32_16x16x32_bf16 v[224:227], a[152:155], a[64:67], v[224:227]
  ds_read_b64_tr_b16 a[76:77], v5 offset:24832
  v_mfma_f32_16x16x32_bf16 v[224:227], a[208:211], a[80:83], v[224:227]
  ds_read_b64_tr_b16 a[78:79], v5 offset:30976
  v_mul_f32 v112, 0xbfb8aa3b, v128
  v_mfma_f32_16x16x32_bf16 v[224:227], a[212:215], a[96:99], v[224:227]
  v_exp_f32 v112, v112
  v_mfma_f32_16x16x32_bf16 v[224:227], a[216:219], a[112:115], v[224:227]
  v_add_f32 v112, 1.0, v112
  v_mul_f32 v113, 0xbfb8aa3b, v129
  v_mfma_f32_16x16x32_bf16 v[224:227], a[20:23], v[80:83], v[224:227]
  v_rcp_f32 v112, v112
  v_exp_f32 v113, v113
  v_mfma_f32_16x16x32_bf16 v[224:227], a[36:39], v[96:99], v[224:227]
  ds_read_b64_tr_b16 a[84:85], v1 offset:0
  v_mul_f32 v128, v128, v112
  v_add_f32 v113, 1.0, v113
  v_mul_f32 v114, 0xbfb8aa3b, v130
  v_mfma_f32_16x16x32_bf16 v[224:227], a[52:55], a[200:203], v[224:227]
  v_rcp_f32 v113, v113
  v_exp_f32 v114, v114
  v_mfma_f32_16x16x32_bf16 v[224:227], a[28:31], a[232:235], v[224:227]
  ds_read_b64_tr_b16 a[86:87], v1 offset:6144
  v_mul_f32 v129, v129, v113
  v_add_f32 v114, 1.0, v114
  v_mul_f32 v115, 0xbfb8aa3b, v131
  v_mfma_f32_16x16x32_bf16 v[224:227], a[44:47], a[248:251], v[224:227]
  s_add_u32 s50, s9, 12288
  v_rcp_f32 v114, v114
  v_exp_f32 v115, v115
  v_mfma_f32_16x16x32_bf16 v[224:227], a[60:63], a[0:3], v[224:227]
  ds_read_b64_tr_b16 a[100:101], v1 offset:128
  v_mul_f32 v130, v130, v114
  v_add_f32 v115, 1.0, v115
  v_mul_f32 v116, 0xbfb8aa3b, v132
  v_mfma_f32_16x16x32_bf16 v[240:243], a[188:191], a[16:19], v[240:243]
  v_rcp_f32 v115, v115
  v_exp_f32 v116, v116
  v_mfma_f32_16x16x32_bf16 v[240:243], a[168:171], a[32:35], v[240:243]
  ds_read_b64_tr_b16 a[102:103], v1 offset:6272
  v_mul_f32 v131, v131, v115
  v_add_f32 v116, 1.0, v116
  v_mul_f32 v117, 0xbfb8aa3b, v133
  v_mfma_f32_16x16x32_bf16 v[240:243], a[172:175], a[48:51], v[240:243]
  v_rcp_f32 v116, v116
  v_exp_f32 v117, v117
  v_mfma_f32_16x16x32_bf16 v[240:243], a[156:159], v[48:51], v[240:243]
  ds_read_b64_tr_b16 a[116:117], v1 offset:256
  v_mul_f32 v132, v132, v116
  v_add_f32 v117, 1.0, v117
  v_mul_f32 v118, 0xbfb8aa3b, v134
  v_mfma_f32_16x16x32_bf16 v[240:243], a[160:163], v[64:67], v[240:243]
  v_rcp_f32 v117, v117
  v_exp_f32 v118, v118
  v_mfma_f32_16x16x32_bf16 v[240:243], a[164:167], a[64:67], v[240:243]
  ds_read_b64_tr_b16 a[118:119], v1 offset:6400
  v_mul_f32 v133, v133, v117
  v_add_f32 v118, 1.0, v118
  v_mul_f32 v119, 0xbfb8aa3b, v135
  v_mfma_f32_16x16x32_bf16 v[240:243], a[220:223], a[80:83], v[240:243]
  ds_read_b64_tr_b16 a[88:89], v9 offset:36864
  ds_read_b64_tr_b16 a[90:91], v9 offset:43008
  v_exp_f32 v119, v119
  v_mfma_f32_16x16x32_bf16 v[240:243], a[224:227], a[96:99], v[240:243]
  v_rcp_f32 v118, v118
  v_add_f32 v119, 1.0, v119
  v_mul_f32 v112, 0xbfb8aa3b, v136
  v_mfma_f32_16x16x32_bf16 v[240:243], a[228:231], a[112:115], v[240:243]
  ds_read_b64_tr_b16 a[104:105], v9 offset:36992
  ds_read_b64_tr_b16 a[106:107], v9 offset:43136
  v_exp_f32 v112, v112
  v_mfma_f32_16x16x32_bf16 v[240:243], a[24:27], v[80:83], v[240:243]
  s_add_u32 s48, s11, 13312
  v_mul_f32 v134, v134, v118
  v_rcp_f32 v119, v119
  v_add_f32 v112, 1.0, v112
  v_mfma_f32_16x16x32_bf16 v[240:243], a[40:43], v[96:99], v[240:243]
  ds_read_b64_tr_b16 a[120:121], v9 offset:37120
  v_rcp_f32 v112, v112
  v_mul_f32 v113, 0xbfb8aa3b, v137
  v_mfma_f32_16x16x32_bf16 v[240:243], a[56:59], a[200:203], v[240:243]
  ds_read_b64_tr_b16 a[122:123], v9 offset:43264
  v_mul_f32 v135, v135, v119
  v_exp_f32 v113, v113
  v_mfma_f32_16x16x32_bf16 v[240:243], v[52:55], a[232:235], v[240:243]
  ds_read_b64_tr_b16 a[92:93], v1 offset:12288
  v_mul_f32 v136, v136, v112
  v_add_f32 v113, 1.0, v113
  v_mul_f32 v114, 0xbfb8aa3b, v138
  v_mfma_f32_16x16x32_bf16 v[240:243], v[68:71], a[248:251], v[240:243]
  ds_read_b64_tr_b16 a[94:95], v1 offset:18432
  ds_read_b64_tr_b16 a[108:109], v1 offset:12416
  v_exp_f32 v114, v114
  v_mfma_f32_16x16x32_bf16 v[240:243], a[68:71], a[0:3], v[240:243]
  s_waitcnt lgkmcnt(15)
  ds_read_b64_tr_b16 a[110:111], v1 offset:18560
  v_rcp_f32 v113, v113
  v_add_f32 v114, 1.0, v114
  v_mfma_f32_16x16x32_bf16 v[160:163], v[56:59], a[16:19], v[160:163]
  v_mul_f32 v137, v137, v113
  v_rcp_f32 v114, v114
  v_mul_f32 v115, 0xbfb8aa3b, v139
  v_mfma_f32_16x16x32_bf16 v[160:163], v[72:75], a[32:35], v[160:163]
  ds_read_b64_tr_b16 a[124:125], v1 offset:12544
  ds_read_b64_tr_b16 a[126:127], v1 offset:18688
  v_exp_f32 v115, v115
  v_mfma_f32_16x16x32_bf16 v[160:163], a[72:75], a[48:51], v[160:163]
  buffer_load_dwordx4 v[164:167], v37, s[4:7], s50 offen offset:0 sc1
  v_add_f32 v115, 1.0, v115
  v_mul_f32 v116, 0xbfb8aa3b, v140
  v_mfma_f32_16x16x32_bf16 v[160:163], v[60:63], v[48:51], v[160:163]
  ds_read_b64_tr_b16 v[84:85], v10 offset:24576
  ds_read_b64_tr_b16 v[86:87], v10 offset:30720
  v_exp_f32 v116, v116
  v_mfma_f32_16x16x32_bf16 v[160:163], v[76:79], v[64:67], v[160:163]
  s_waitcnt lgkmcnt(15)
  v_mul_f32 v138, v138, v114
  v_rcp_f32 v115, v115
  v_add_f32 v116, 1.0, v116
  v_mfma_f32_16x16x32_bf16 v[160:163], a[76:79], a[64:67], v[160:163]
  s_add_u32 s99, s13, 14336
  ds_read_b64_tr_b16 v[100:101], v10 offset:24704
  ds_read_b64_tr_b16 v[102:103], v10 offset:30848
  v_rcp_f32 v116, v116
  v_mfma_f32_16x16x32_bf16 v[160:163], a[84:87], a[80:83], v[160:163]
  ds_read_b64_tr_b16 a[204:205], v10 offset:24832
  ds_read_b64_tr_b16 a[206:207], v10 offset:30976
  ds_read_b64_tr_b16 v[88:89], v6 offset:24576
  v_mul_f32 v117, 0xbfb8aa3b, v141
  v_mfma_f32_16x16x32_bf16 v[160:163], a[100:103], a[96:99], v[160:163]
  s_waitcnt lgkmcnt(15)
  ds_read_b64_tr_b16 v[90:91], v6 offset:30720
  v_mul_f32 v139, v139, v115
  v_exp_f32 v117, v117
  v_mfma_f32_16x16x32_bf16 v[160:163], a[116:119], a[112:115], v[160:163]
  ds_read_b64_tr_b16 v[104:105], v6 offset:24704
  v_mul_f32 v140, v140, v116
  v_add_f32 v117, 1.0, v117
  v_mul_f32 v118, 0xbfb8aa3b, v142
  v_mfma_f32_16x16x32_bf16 v[160:163], a[88:91], v[80:83], v[160:163]
  ds_read_b64_tr_b16 v[106:107], v6 offset:30848
  ds_read_b64_tr_b16 a[128:129], v6 offset:24832
  v_exp_f32 v118, v118
  v_mfma_f32_16x16x32_bf16 v[160:163], a[104:107], v[96:99], v[160:163]
  s_waitcnt lgkmcnt(15)
  ds_read_b64_tr_b16 a[130:131], v6 offset:30976
  v_rcp_f32 v117, v117
  v_add_f32 v118, 1.0, v118
  v_mfma_f32_16x16x32_bf16 v[160:163], a[120:123], a[200:203], v[160:163]
  v_mul_f32 v141, v141, v117
  v_rcp_f32 v118, v118
  v_mul_f32 v119, 0xbfb8aa3b, v143
  v_mfma_f32_16x16x32_bf16 v[160:163], a[92:95], a[232:235], v[160:163]
  s_waitcnt lgkmcnt(12)
  ds_read_b64_tr_b16 v[92:93], v2 offset:0
  ds_read_b64_tr_b16 v[94:95], v2 offset:6144
  v_exp_f32 v119, v119
  v_mfma_f32_16x16x32_bf16 v[160:163], a[108:111], a[248:251], v[160:163]
  buffer_load_dwordx4 v[168:171], v37, s[4:7], s48 offen offset:0 sc1
  v_add_f32 v119, 1.0, v119
  v_mul_f32 v112, 0xbfb8aa3b, v22
  v_mfma_f32_16x16x32_bf16 v[160:163], a[124:127], a[0:3], v[160:163]
  s_waitcnt lgkmcnt(12)
  ds_read_b64_tr_b16 v[108:109], v2 offset:128
  ds_read_b64_tr_b16 v[110:111], v2 offset:6272
  v_exp_f32 v112, v112
  v_mfma_f32_16x16x32_bf16 v[208:211], v[84:87], a[16:19], v[208:211]
  s_waitcnt lgkmcnt(12)
  v_rcp_f32 v119, v119
  v_add_f32 v112, 1.0, v112
  v_mul_f32 v113, 0xbfb8aa3b, v23
  v_mfma_f32_16x16x32_bf16 v[208:211], v[100:103], a[32:35], v[208:211]
  s_waitcnt lgkmcnt(10)
  ds_read_b64_tr_b16 a[132:133], v2 offset:256
  ds_read_b64_tr_b16 a[134:135], v2 offset:6400
  v_exp_f32 v113, v113
  v_mfma_f32_16x16x32_bf16 v[208:211], a[204:207], a[48:51], v[208:211]
  s_waitcnt lgkmcnt(10)
  v_rcp_f32 v112, v112
  v_add_f32 v113, 1.0, v113
  v_mul_f32 v114, 0xbfb8aa3b, v24
  v_mfma_f32_16x16x32_bf16 v[208:211], v[88:91], v[48:51], v[208:211]
  s_waitcnt lgkmcnt(6)
  ds_read_b64_tr_b16 a[236:237], v10 offset:36864
  ds_read_b64_tr_b16 a[238:239], v10 offset:43008
  v_exp_f32 v114, v114
  v_mfma_f32_16x16x32_bf16 v[208:211], v[104:107], v[64:67], v[208:211]
  s_add_u32 s49, s9, 15360
  v_rcp_f32 v113, v113
  v_add_f32 v114, 1.0, v114
  v_mul_f32 v115, 0xbfb8aa3b, v25
  v_mfma_f32_16x16x32_bf16 v[208:211], a[128:131], a[64:67], v[208:211]
  s_waitcnt lgkmcnt(4)
  ds_read_b64_tr_b16 a[252:253], v10 offset:36992
  ds_read_b64_tr_b16 a[254:255], v10 offset:43136
  v_exp_f32 v115, v115
  v_mfma_f32_16x16x32_bf16 v[208:211], v[92:95], a[80:83], v[208:211]
  s_add_u32 s51, s11, 16384
  ds_read_b64_tr_b16 a[4:5], v10 offset:37120
  ds_read_b64_tr_b16 a[6:7], v10 offset:43264
  ds_read_b64_tr_b16 a[240:241], v2 offset:12288
  v_add_f32 v115, 1.0, v115
  v_mfma_f32_16x16x32_bf16 v[208:211], v[108:111], a[96:99], v[208:211]
  s_waitcnt lgkmcnt(3)
  ds_read_b64_tr_b16 a[242:243], v2 offset:18432
  v_mul_f32 v142, v142, v118
  v_rcp_f32 v114, v114
  v_mfma_f32_16x16x32_bf16 v[208:211], a[132:135], a[112:115], v[208:211]
  s_add_u32 s54, s13, 17408
  ds_read_b64_tr_b16 a[192:193], v2 offset:12416
  v_mul_f32 v143, v143, v119
  v_rcp_f32 v115, v115
  v_mfma_f32_16x16x32_bf16 v[208:211], a[236:239], v[80:83], v[208:211]
  buffer_load_dwordx4 v[172:175], v37, s[4:7], s99 offen offset:0 sc1
  ds_read_b64_tr_b16 a[194:195], v2 offset:18560
  v_mul_f32 v23, v23, v113
  v_mfma_f32_16x16x32_bf16 v[208:211], a[252:255], v[96:99], v[208:211]
  s_waitcnt lgkmcnt(4)
  ds_read_b64_tr_b16 a[8:9], v2 offset:12544
  v_mul_f32 v25, v25, v115
  v_accvgpr_read_b32 v113, a136
  v_accvgpr_read_b32 v115, a137
  v_mfma_f32_16x16x32_bf16 v[208:211], a[4:7], a[200:203], v[208:211]
  s_waitcnt lgkmcnt(3)
  ds_read_b64_tr_b16 a[10:11], v2 offset:18688
  v_mul_f32 v22, v22, v112
  v_accvgpr_read_b32 v117, a138
  v_accvgpr_read_b32 v119, a139
  v_mfma_f32_16x16x32_bf16 v[208:211], a[240:243], a[232:235], v[208:211]
  s_waitcnt lgkmcnt(2)
  v_mul_f32 v24, v24, v114
  v_permlane16_swap_b32 v113, v117
  v_permlane16_swap_b32 v115, v119
  v_accvgpr_read_b32 v121, a140
  v_mfma_f32_16x16x32_bf16 v[208:211], a[192:195], a[248:251], v[208:211]
  v_lshlrev_b32 v112, 16, v113
  v_and_b32 v113, 0xffff0000, v113
  v_lshlrev_b32 v114, 16, v115
  v_and_b32 v115, 0xffff0000, v115
  v_lshlrev_b32 v116, 16, v117
  v_and_b32 v117, 0xffff0000, v117
  v_lshlrev_b32 v118, 16, v119
  v_and_b32 v119, 0xffff0000, v119
  v_accvgpr_read_b32 v123, a141
  v_accvgpr_read_b32 v125, a142
  v_accvgpr_read_b32 v127, a143
  s_nop 0
  v_permlane16_swap_b32 v121, v125
  v_permlane16_swap_b32 v123, v127
  v_lshlrev_b32 v120, 16, v121
  v_and_b32 v121, 0xffff0000, v121
  v_lshlrev_b32 v122, 16, v123
  v_and_b32 v123, 0xffff0000, v123
  v_lshlrev_b32 v124, 16, v125
  v_and_b32 v125, 0xffff0000, v125
  v_lshlrev_b32 v126, 16, v127
  v_and_b32 v127, 0xffff0000, v127
  v_lshlrev_b32 v44, 16, v42
  v_and_b32 v45, 0xffff0000, v42
  v_lshlrev_b32 v46, 16, v43
  v_and_b32 v47, 0xffff0000, v43
  buffer_load_dwordx4 v[228:231], v37, s[4:7], s49 offen offset:0 sc1
  buffer_load_dwordx4 v[232:235], v37, s[4:7], s51 offen offset:0 sc1
  buffer_load_dwordx4 v[236:239], v37, s[4:7], s54 offen offset:0 sc1
  s_waitcnt lgkmcnt(0)
  v_mfma_f32_16x16x32_bf16 v[208:211], a[8:11], a[0:3], v[208:211]
  v_bitop3_b32 v40, v176, v180, v184 bitop3:0x80
  v_bitop3_b32 v40, v40, v188, 1 bitop3:0x80
  v_cmp_eq_u32 vcc, 0, v40
  s_nop 0
  s_cbranch_vccnz L_tag4
L_tagok4:
  v_permlane32_swap_b32 v28, v30
  v_permlane32_swap_b32 v29, v31
  s_nop 1
  v_mfma_f32_16x16x32_bf16 v[100:103], v[28:31], v[176:179], 0
  v_mfma_f32_16x16x32_bf16 v[100:103], v[28:31], v[180:183], v[100:103]
  v_mfma_f32_16x16x32_bf16 v[100:103], v[28:31], v[184:187], v[100:103]
  v_mfma_f32_16x16x32_bf16 v[100:103], v[28:31], v[188:191], v[100:103]
  v_permlane32_swap_b32 v28, v30
  v_permlane32_swap_b32 v29, v31
  s_nop 5
  v_fma_f32 v100, v100, v22, v44
  v_fma_f32 v101, v101, v23, v45
  v_fma_f32 v102, v102, v24, v46
  v_fma_f32 v103, v103, v25, v47
  v_cvt_pk_bf16_f32 v44, v100, v101
  v_cvt_pk_bf16_f32 v45, v102, v103
  buffer_store_dwordx2 v[44:45], v17, s[36:39], s77 offen
  v_bitop3_b32 v40, v192, v196, v200 bitop3:0x80
  v_bitop3_b32 v40, v40, v204, 1 bitop3:0x80
  v_cmp_eq_u32 vcc, 0, v40
  s_nop 0
  s_cbranch_vccnz L_tag1
L_tagok1:
  v_mfma_f32_16x16x32_bf16 v[160:163], v[30:33], v[192:195], v[160:163]
  v_mfma_f32_16x16x32_bf16 v[160:163], v[28:31], v[198:201], v[160:163]
  v_mfma_f32_16x16x32_bf16 v[160:163], v[26:29], v[204:207], v[160:163]
  v_mfma_f32_16x16x32_bf16 v[208:211], v[28:31], v[194:197], v[208:211]
  v_mfma_f32_16x16x32_bf16 v[208:211], v[28:31], v[202:205], v[208:211]
  s_waitcnt vmcnt(10)
  v_bitop3_b32 v40, v144, v148, v152 bitop3:0x80
  v_bitop3_b32 v40, v40, v156, 1 bitop3:0x80
  v_cmp_eq_u32 vcc, 0, v40
  s_nop 0
  s_cbranch_vccnz L_tag3
L_tagok3:
  v_mfma_f32_16x16x32_bf16 v[224:227], v[30:33], v[144:147], v[224:227]
L_pg20:
  s_cbranch_execz L_hop4
  v_mfma_f32_16x16x32_bf16 v[224:227], v[28:31], v[150:153], v[224:227]
  v_mfma_f32_16x16x32_bf16 v[224:227], v[26:29], v[156:159], v[224:227]
  v_mfma_f32_16x16x32_bf16 v[240:243], v[28:31], v[146:149], v[240:243]
  v_mfma_f32_16x16x32_bf16 v[240:243], v[28:31], v[154:157], v[240:243]
  s_waitcnt vmcnt(4)
  v_bitop3_b32 v40, v164, v168, v172 bitop3:0x80
  v_and_b32 v40, 1, v40
  v_cmp_eq_u32 vcc, 0, v40
  s_nop 0
  s_cbranch_vccnz L_tag0
L_tagok0:
  v_mfma_f32_16x16x32_bf16 v[160:163], v[30:33], v[164:167], v[160:163]
  v_mfma_f32_16x16x32_bf16 v[160:163], v[28:31], v[170:173], v[160:163]
  v_mfma_f32_16x16x32_bf16 v[208:211], v[28:31], v[166:169], v[208:211]
  v_mfma_f32_16x16x32_bf16 v[208:211], v[26:29], v[172:175], v[208:211]
  v_fma_f32 v160, v160, v128, v112
  v_fma_f32 v161, v161, v129, v113
  v_fma_f32 v162, v162, v130, v114
  v_fma_f32 v163, v163, v131, v115
  v_cvt_pk_bf16_f32 v112, v160, v161
  v_cvt_pk_bf16_f32 v113, v162, v163
  s_nop 1
  v_fma_f32 v208, v208, v132, v116
  v_fma_f32 v209, v209, v133, v117
  v_fma_f32 v210, v210, v134, v118
  v_fma_f32 v211, v211, v135, v119
  v_cvt_pk_bf16_f32 v114, v208, v209
  v_cvt_pk_bf16_f32 v115, v210, v211
  s_nop 0
  v_permlane16_swap_b32 v112, v114
  v_permlane16_swap_b32 v113, v115
  buffer_store_dwordx4 v[112:115], v16, s[36:39], s76 offen offset:0
  s_waitcnt vmcnt(2)
  v_bitop3_b32 v40, v228, v232, v236 bitop3:0x80
  v_and_b32 v40, 1, v40
  v_cmp_eq_u32 vcc, 0, v40
  s_nop 0
  s_cbranch_vccnz L_tag2
L_tagok2:
  v_mfma_f32_16x16x32_bf16 v[224:227], v[30:33], v[228:231], v[224:227]
  v_mfma_f32_16x16x32_bf16 v[224:227], v[28:31], v[234:237], v[224:227]
  v_mfma_f32_16x16x32_bf16 v[240:243], v[28:31], v[230:233], v[240:243]
  v_mfma_f32_16x16x32_bf16 v[240:243], v[26:29], v[236:239], v[240:243]
  v_fma_f32 v224, v224, v136, v120
  v_fma_f32 v225, v225, v137, v121
  v_fma_f32 v226, v226, v138, v122
  v_fma_f32 v227, v227, v139, v123
  v_cvt_pk_bf16_f32 v120, v224, v225
  v_cvt_pk_bf16_f32 v121, v226, v227
  s_nop 1
  v_fma_f32 v240, v240, v140, v124
  v_fma_f32 v241, v241, v141, v125
  v_fma_f32 v242, v242, v142, v126
  v_fma_f32 v243, v243, v143, v127
  v_cvt_pk_bf16_f32 v122, v240, v241
  v_cvt_pk_bf16_f32 v123, v242, v243
  s_nop 0
  v_permlane16_swap_b32 v120, v122
  v_permlane16_swap_b32 v121, v123
  buffer_store_dwordx4 v[120:123], v16, s[36:39], s76 offen offset:64
L_end:
  s_endpgm
L_tag4:
  s_mov_b32 s84, 0x40000
L_tg4:
  v_and_b32 v40, 1, v176
  v_cmp_eq_u32 s[16:17], 0, v40
  v_and_b32 v40, 1, v180
  v_cmp_eq_u32 s[18:19], 0, v40
  v_and_b32 v40, 1, v184
  v_cmp_eq_u32 s[20:21], 0, v40
  v_and_b32 v40, 1, v188
  v_cmp_eq_u32 s[22:23], 0, v40
  s_add_u32 s100, s15, s96
  s_mov_b64 exec, s[16:17]
  s_cbranch_execz L_ts4_0
  buffer_load_dwordx4 v[176:179], v13, s[4:7], s100 offen offset:0 sc1
  L_ts4_0:
  s_add_u32 s100, s9, s96
  s_mov_b64 exec, s[18:19]
  s_cbranch_execz L_ts4_1
  buffer_load_dwordx4 v[180:183], v13, s[4:7], s100 offen offset:1024 sc1
  L_ts4_1:
  s_add_u32 s100, s11, s96
  s_mov_b64 exec, s[20:21]
  s_cbranch_execz L_ts4_2
  buffer_load_dwordx4 v[184:187], v13, s[4:7], s100 offen offset:2048 sc1
  L_ts4_2:
  s_add_u32 s100, s13, s96
  s_mov_b64 exec, s[22:23]
  s_cbranch_execz L_ts4_3
  buffer_load_dwordx4 v[188:191], v13, s[4:7], s100 offen offset:3072 sc1
  L_ts4_3:
  s_mov_b64 exec, -1
  s_waitcnt vmcnt(0)
  v_bitop3_b32 v40, v176, v180, v184 bitop3:0x80
  v_bitop3_b32 v40, v40, v188, 1 bitop3:0x80
  v_cmp_eq_u32 vcc, 0, v40
  s_nop 1
  s_cbranch_vccz L_tagok4
  s_sub_u32 s84, s84, 1
  s_cmp_lg_u32 s84, 0
  s_cbranch_scc1 L_tg4
  s_branch L_tagok4
L_tag1:
  s_mov_b32 s84, 0x40000
L_tg1:
  v_and_b32 v40, 1, v192
  v_cmp_eq_u32 s[16:17], 0, v40
  v_and_b32 v40, 1, v196
  v_cmp_eq_u32 s[18:19], 0, v40
  v_and_b32 v40, 1, v200
  v_cmp_eq_u32 s[20:21], 0, v40
  v_and_b32 v40, 1, v204
  v_cmp_eq_u32 s[22:23], 0, v40
  s_add_u32 s100, s8, 4096
  s_mov_b64 exec, s[16:17]
  s_cbranch_execz L_ts1_0
  buffer_load_dwordx4 v[192:195], v37, s[4:7], s100 offen offset:0 sc1
  L_ts1_0:
  s_add_u32 s100, s10, 5120
  s_mov_b64 exec, s[18:19]
  s_cbranch_execz L_ts1_1
  buffer_load_dwordx4 v[196:199], v37, s[4:7], s100 offen offset:0 sc1
  L_ts1_1:
  s_add_u32 s100, s12, 6144
  s_mov_b64 exec, s[20:21]
  s_cbranch_execz L_ts1_2
  buffer_load_dwordx4 v[200:203], v37, s[4:7], s100 offen offset:0 sc1
  L_ts1_2:
  s_add_u32 s100, s14, 7168
  s_mov_b64 exec, s[22:23]
  s_cbranch_execz L_ts1_3
  buffer_load_dwordx4 v[204:207], v37, s[4:7], s100 offen offset:0 sc1
  L_ts1_3:
  s_mov_b64 exec, -1
  s_waitcnt vmcnt(0)
  v_bitop3_b32 v40, v192, v196, v200 bitop3:0x80
  v_bitop3_b32 v40, v40, v204, 1 bitop3:0x80
  v_cmp_eq_u32 vcc, 0, v40
  s_nop 1
  s_cbranch_vccz L_tagok1
  s_sub_u32 s84, s84, 1
  s_cmp_lg_u32 s84, 0
  s_cbranch_scc1 L_tg1
  s_branch L_tagok1
L_tag3:
  s_mov_b32 s84, 0x40000
L_tg3:
  v_and_b32 v40, 1, v144
  v_cmp_eq_u32 s[16:17], 0, v40
  v_and_b32 v40, 1, v148
  v_cmp_eq_u32 s[18:19], 0, v40
  v_and_b32 v40, 1, v152
  v_cmp_eq_u32 s[20:21], 0, v40
  v_and_b32 v40, 1, v156
  v_cmp_eq_u32 s[22:23], 0, v40
  s_add_u32 s100, s8, 8192
  s_mov_b64 exec, s[16:17]
  s_cbranch_execz L_ts3_0
  buffer_load_dwordx4 v[144:147], v37, s[4:7], s100 offen offset:0 sc1
  L_ts3_0:
  s_add_u32 s100, s10, 9216
  s_mov_b64 exec, s[18:19]
  s_cbranch_execz L_ts3_1
  buffer_load_dwordx4 v[148:151], v37, s[4:7], s100 offen offset:0 sc1
  L_ts3_1:
  s_add_u32 s100, s12, 10240
  s_mov_b64 exec, s[20:21]
  s_cbranch_execz L_ts3_2
  buffer_load_dwordx4 v[152:155], v37, s[4:7], s100 offen offset:0 sc1
  L_ts3_2:
  s_add_u32 s100, s14, 11264
  s_mov_b64 exec, s[22:23]
  s_cbranch_execz L_ts3_3
  buffer_load_dwordx4 v[156:159], v37, s[4:7], s100 offen offset:0 sc1
  L_ts3_3:
  s_mov_b64 exec, -1
  s_waitcnt vmcnt(0)
  v_bitop3_b32 v40, v144, v148, v152 bitop3:0x80
  v_bitop3_b32 v40, v40, v156, 1 bitop3:0x80
  v_cmp_eq_u32 vcc, 0, v40
  s_nop 1
  s_cbranch_vccz L_tagok3
  s_sub_u32 s84, s84, 1
  s_cmp_lg_u32 s84, 0
  s_cbranch_scc1 L_tg3
  s_branch L_tagok3
L_tag0:
  s_mov_b32 s84, 0x40000
L_tg0:
  v_and_b32 v40, 1, v164
  v_cmp_eq_u32 s[16:17], 0, v40
  v_and_b32 v40, 1, v168
  v_cmp_eq_u32 s[18:19], 0, v40
  v_and_b32 v40, 1, v172
  v_cmp_eq_u32 s[20:21], 0, v40
  s_add_u32 s100, s9, 12288
  s_mov_b64 exec, s[16:17]
  s_cbranch_execz L_ts0_0
  buffer_load_dwordx4 v[164:167], v37, s[4:7], s100 offen offset:0 sc1
  L_ts0_0:
  s_add_u32 s100, s11, 13312
  s_mov_b64 exec, s[18:19]
  s_cbranch_execz L_ts0_1
  buffer_load_dwordx4 v[168:171], v37, s[4:7], s100 offen offset:0 sc1
  L_ts0_1:
  s_add_u32 s100, s13, 14336
  s_mov_b64 exec, s[20:21]
  s_cbranch_execz L_ts0_2
  buffer_load_dwordx4 v[172:175], v37, s[4:7], s100 offen offset:0 sc1
  L_ts0_2:
  s_mov_b64 exec, -1
  s_waitcnt vmcnt(0)
  v_bitop3_b32 v40, v164, v168, v172 bitop3:0x80
  v_and_b32 v40, 1, v40
  v_cmp_eq_u32 vcc, 0, v40
  s_nop 1
  s_cbranch_vccz L_tagok0
  s_sub_u32 s84, s84, 1
  s_cmp_lg_u32 s84, 0
  s_cbranch_scc1 L_tg0
  s_branch L_tagok0
L_tag2:
  s_mov_b32 s84, 0x40000
L_tg2:
  v_and_b32 v40, 1, v228
  v_cmp_eq_u32 s[16:17], 0, v40
  v_and_b32 v40, 1, v232
  v_cmp_eq_u32 s[18:19], 0, v40
  v_and_b32 v40, 1, v236
  v_cmp_eq_u32 s[20:21], 0, v40
  s_add_u32 s100, s9, 15360
  s_mov_b64 exec, s[16:17]
  s_cbranch_execz L_ts2_0
  buffer_load_dwordx4 v[228:231], v37, s[4:7], s100 offen offset:0 sc1
  L_ts2_0:
  s_add_u32 s100, s11, 16384
  s_mov_b64 exec, s[18:19]
  s_cbranch_execz L_ts2_1
  buffer_load_dwordx4 v[232:235], v37, s[4:7], s100 offen offset:0 sc1
  L_ts2_1:
  s_add_u32 s100, s13, 17408
  s_mov_b64 exec, s[20:21]
  s_cbranch_execz L_ts2_2
  buffer_load_dwordx4 v[236:239], v37, s[4:7], s100 offen offset:0 sc1
  L_ts2_2:
  s_mov_b64 exec, -1
  s_waitcnt vmcnt(0)
  v_bitop3_b32 v40, v228, v232, v236 bitop3:0x80
  v_and_b32 v40, 1, v40
  v_cmp_eq_u32 vcc, 0, v40
  s_nop 1
  s_cbranch_vccz L_tagok2
  s_sub_u32 s84, s84, 1
  s_cmp_lg_u32 s84, 0
  s_cbranch_scc1 L_tg2
  s_branch L_tagok2
L_spin0:
  s_mov_b32 s84, 0x40000
L_sp0:
  buffer_load_dword v40, v39, s[4:7], s3 offen offset:0 sc1
  s_waitcnt vmcnt(0)
  v_subrev_u32 v40, s40, v40
  v_cmp_lt_u32 vcc, 7, v40
  s_nop 1
  s_cbranch_vccz L_ret0
  s_sub_u32 s84, s84, 1
  s_cmp_lg_u32 s84, 0
  s_cbranch_scc1 L_sp0
  s_branch L_ret0
L_spin1:
  s_mov_b32 s84, 0x40000
L_sp1:
  buffer_load_dword v40, v14, s[4:7], s78 offen offset:0 sc1
  s_waitcnt vmcnt(0)
  v_subrev_u32 v40, s43, v40
  v_cmp_lt_u32 vcc, 7, v40
  s_nop 1
  s_cbranch_vccz L_ret1
  s_sub_u32 s84, s84, 1
  s_cmp_lg_u32 s84, 0
  s_cbranch_scc1 L_sp1
  s_branch L_ret1
L_spin2:
  s_mov_b32 s84, 0x40000
L_sp2:
  buffer_load_dword v40, v39, s[4:7], s79 offen offset:0 sc1
  s_waitcnt vmcnt(0)
  v_subrev_u32 v40, s43, v40
  v_cmp_lt_u32 vcc, 7, v40
  s_nop 1
  s_cbranch_vccz L_ret2
  s_sub_u32 s84, s84, 1
  s_cmp_lg_u32 s84, 0
  s_cbranch_scc1 L_sp2
  s_branch L_ret2
L_exact:
  s_waitcnt vmcnt(0) lgkmcnt(0)
  s_nop 15
  s_nop 15
  s_mov_b32 s82, m0
  s_mul_i32 s100, s47, 786432
  s_add_u32 s100, s100, 589824
  s_lshl_b32 s101, s72, 10
  s_add_u32 s101, s101, 159744
  v_bfe_u32 v151, v37, 4, 4
  v_mul_u32_u24 v148, 384, v151
  v_lshrrev_b32 v151, 8, v37
  v_lshl_add_u32 v148, v151, 4, v148
  v_add_u32 v148, s100, v148
  v_lshrrev_b32 v151, 5, v37
  v_mul_u32_u24 v149, 384, v151
  v_and_b32 v151, 16, v37
  v_add_u32 v149, v149, v151
  v_add_u32 v149, s100, v149
  v_lshrrev_b32 v151, 1, v37
  v_add_u32 v150, s101, v151
  s_mov_b32 m0, s101
  v_mov_b32 v144, 0xff800000
  v_mov_b32 v44, 0
  v_mov_b32 v145, 0xff800000
  v_mov_b32 v45, 0
  v_mov_b32 v146, 0xff800000
  v_mov_b32 v46, 0
  v_mov_b32 v147, 0xff800000
  v_mov_b32 v47, 0
  s_mov_b32 s83, 0
L_ex1:
  s_add_u32 s84, s83, 0
  buffer_load_dwordx4 a[208:211], v148, s[16:19], s84 offen offset:0
  buffer_load_dwordx4 a[212:215], v148, s[16:19], s84 offen offset:64
  buffer_load_dwordx4 a[216:219], v148, s[16:19], s84 offen offset:128
  buffer_load_dwordx4 a[220:223], v148, s[16:19], s84 offen offset:192
  buffer_load_dwordx4 a[224:227], v148, s[16:19], s84 offen offset:256
  buffer_load_dwordx4 a[228:231], v148, s[16:19], s84 offen offset:320
  s_waitcnt vmcnt(5)
  v_mfma_f32_16x16x32_bf16 v[160:163], a[208:211], v[48:51], 0
  s_waitcnt vmcnt(4)
  v_mfma_f32_16x16x32_bf16 v[160:163], a[212:215], v[64:67], v[160:163]
  s_waitcnt vmcnt(3)
  v_mfma_f32_16x16x32_bf16 v[160:163], a[216:219], v[80:83], v[160:163]
  s_waitcnt vmcnt(2)
  v_mfma_f32_16x16x32_bf16 v[160:163], a[220:223], v[96:99], v[160:163]
  s_waitcnt vmcnt(1)
  v_mfma_f32_16x16x32_bf16 v[160:163], a[224:227], v[112:115], v[160:163]
  s_waitcnt vmcnt(0)
  v_mfma_f32_16x16x32_bf16 v[160:163], a[228:231], v[128:131], v[160:163]
  v_mfma_f32_16x16x32_bf16 v[164:167], a[208:211], v[52:55], 0
  v_mfma_f32_16x16x32_bf16 v[164:167], a[212:215], v[68:71], v[164:167]
  v_mfma_f32_16x16x32_bf16 v[164:167], a[216:219], v[84:87], v[164:167]
  v_mfma_f32_16x16x32_bf16 v[164:167], a[220:223], v[100:103], v[164:167]
  v_mfma_f32_16x16x32_bf16 v[164:167], a[224:227], v[116:119], v[164:167]
  v_mfma_f32_16x16x32_bf16 v[164:167], a[228:231], v[132:135], v[164:167]
  v_mfma_f32_16x16x32_bf16 v[168:171], a[208:211], v[56:59], 0
  v_mfma_f32_16x16x32_bf16 v[168:171], a[212:215], v[72:75], v[168:171]
  v_mfma_f32_16x16x32_bf16 v[168:171], a[216:219], v[88:91], v[168:171]
  v_mfma_f32_16x16x32_bf16 v[168:171], a[220:223], v[104:107], v[168:171]
  v_mfma_f32_16x16x32_bf16 v[168:171], a[224:227], v[120:123], v[168:171]
  v_mfma_f32_16x16x32_bf16 v[168:171], a[228:231], v[136:139], v[168:171]
  v_mfma_f32_16x16x32_bf16 v[172:175], a[208:211], v[60:63], 0
  v_mfma_f32_16x16x32_bf16 v[172:175], a[212:215], v[76:79], v[172:175]
  v_mfma_f32_16x16x32_bf16 v[172:175], a[216:219], v[92:95], v[172:175]
  v_mfma_f32_16x16x32_bf16 v[172:175], a[220:223], v[108:111], v[172:175]
  v_mfma_f32_16x16x32_bf16 v[172:175], a[224:227], v[124:127], v[172:175]
  v_mfma_f32_16x16x32_bf16 v[172:175], a[228:231], v[140:143], v[172:175]
  s_nop 7
  s_add_u32 s84, s83, 6144
  buffer_load_dwordx4 a[208:211], v148, s[16:19], s84 offen offset:0
  buffer_load_dwordx4 a[212:215], v148, s[16:19], s84 offen offset:64
  buffer_load_dwordx4 a[216:219], v148, s[16:19], s84 offen offset:128
  buffer_load_dwordx4 a[220:223], v148, s[16:19], s84 offen offset:192
  buffer_load_dwordx4 a[224:227], v148, s[16:19], s84 offen offset:256
  buffer_load_dwordx4 a[228:231], v148, s[16:19], s84 offen offset:320
  s_waitcnt vmcnt(5)
  v_mfma_f32_16x16x32_bf16 v[176:179], a[208:211], v[48:51], 0
  s_waitcnt vmcnt(4)
  v_mfma_f32_16x16x32_bf16 v[176:179], a[212:215], v[64:67], v[176:179]
  s_waitcnt vmcnt(3)
  v_mfma_f32_16x16x32_bf16 v[176:179], a[216:219], v[80:83], v[176:179]
  s_waitcnt vmcnt(2)
  v_mfma_f32_16x16x32_bf16 v[176:179], a[220:223], v[96:99], v[176:179]
  s_waitcnt vmcnt(1)
  v_mfma_f32_16x16x32_bf16 v[176:179], a[224:227], v[112:115], v[176:179]
  s_waitcnt vmcnt(0)
  v_mfma_f32_16x16x32_bf16 v[176:179], a[228:231], v[128:131], v[176:179]
  v_mfma_f32_16x16x32_bf16 v[180:183], a[208:211], v[52:55], 0
  v_mfma_f32_16x16x32_bf16 v[180:183], a[212:215], v[68:71], v[180:183]
  v_mfma_f32_16x16x32_bf16 v[180:183], a[216:219], v[84:87], v[180:183]
  v_mfma_f32_16x16x32_bf16 v[180:183], a[220:223], v[100:103], v[180:183]
  v_mfma_f32_16x16x32_bf16 v[180:183], a[224:227], v[116:119], v[180:183]
  v_mfma_f32_16x16x32_bf16 v[180:183], a[228:231], v[132:135], v[180:183]
  v_mfma_f32_16x16x32_bf16 v[184:187], a[208:211], v[56:59], 0
  v_mfma_f32_16x16x32_bf16 v[184:187], a[212:215], v[72:75], v[184:187]
  v_mfma_f32_16x16x32_bf16 v[184:187], a[216:219], v[88:91], v[184:187]
  v_mfma_f32_16x16x32_bf16 v[184:187], a[220:223], v[104:107], v[184:187]
  v_mfma_f32_16x16x32_bf16 v[184:187], a[224:227], v[120:123], v[184:187]
  v_mfma_f32_16x16x32_bf16 v[184:187], a[228:231], v[136:139], v[184:187]
  v_mfma_f32_16x16x32_bf16 v[188:191], a[208:211], v[60:63], 0
  v_mfma_f32_16x16x32_bf16 v[188:191], a[212:215], v[76:79], v[188:191]
  v_mfma_f32_16x16x32_bf16 v[188:191], a[216:219], v[92:95], v[188:191]
  v_mfma_f32_16x16x32_bf16 v[188:191], a[220:223], v[108:111], v[188:191]
  v_mfma_f32_16x16x32_bf16 v[188:191], a[224:227], v[124:127], v[188:191]
  v_mfma_f32_16x16x32_bf16 v[188:191], a[228:231], v[140:143], v[188:191]
  s_nop 7
  v_max3_f32 v144, v160, v161, v144
  v_max3_f32 v144, v162, v163, v144
  v_max3_f32 v144, v176, v177, v144
  v_max3_f32 v144, v178, v179, v144
  v_max3_f32 v145, v164, v165, v145
  v_max3_f32 v145, v166, v167, v145
  v_max3_f32 v145, v180, v181, v145
  v_max3_f32 v145, v182, v183, v145
  v_max3_f32 v146, v168, v169, v146
  v_max3_f32 v146, v170, v171, v146
  v_max3_f32 v146, v184, v185, v146
  v_max3_f32 v146, v186, v187, v146
  v_max3_f32 v147, v172, v173, v147
  v_max3_f32 v147, v174, v175, v147
  v_max3_f32 v147, v188, v189, v147
  v_max3_f32 v147, v190, v191, v147
  s_waitcnt vmcnt(0) lgkmcnt(0)
  s_nop 15
  s_nop 15
  s_add_u32 s83, s83, 12288
  s_cmp_lt_u32 s83, 196608
  s_cbranch_scc1 L_ex1
  v_mov_b32 v151, v144
  s_nop 1
  v_permlane32_swap_b32 v151, v144
  v_max_f32 v144, v151, v144
  v_mov_b32 v151, v144
  s_nop 1
  v_permlane16_swap_b32 v151, v144
  v_max_f32 v144, v151, v144
  v_mov_b32 v151, v145
  s_nop 1
  v_permlane32_swap_b32 v151, v145
  v_max_f32 v145, v151, v145
  v_mov_b32 v151, v145
  s_nop 1
  v_permlane16_swap_b32 v151, v145
  v_max_f32 v145, v151, v145
  v_mov_b32 v151, v146
  s_nop 1
  v_permlane32_swap_b32 v151, v146
  v_max_f32 v146, v151, v146
  v_mov_b32 v151, v146
  s_nop 1
  v_permlane16_swap_b32 v151, v146
  v_max_f32 v146, v151, v146
  v_mov_b32 v151, v147
  s_nop 1
  v_permlane32_swap_b32 v151, v147
  v_max_f32 v147, v151, v147
  v_mov_b32 v151, v147
  s_nop 1
  v_permlane16_swap_b32 v151, v147
  v_max_f32 v147, v151, v147
  v_mov_b32 v208, 0
  v_mov_b32 v209, 0
  v_mov_b32 v210, 0
  v_mov_b32 v211, 0
  v_mov_b32 v212, 0
  v_mov_b32 v213, 0
  v_mov_b32 v214, 0
  v_mov_b32 v215, 0
  v_mov_b32 v216, 0
  v_mov_b32 v217, 0
  v_mov_b32 v218, 0
  v_mov_b32 v219, 0
  v_mov_b32 v220, 0
  v_mov_b32 v221, 0
  v_mov_b32 v222, 0
  v_mov_b32 v223, 0
  v_mov_b32 v224, 0
  v_mov_b32 v225, 0
  v_mov_b32 v226, 0
  v_mov_b32 v227, 0
  v_mov_b32 v228, 0
  v_mov_b32 v229, 0
  v_mov_b32 v230, 0
  v_mov_b32 v231, 0
  v_mov_b32 v232, 0
  v_mov_b32 v233, 0
  v_mov_b32 v234, 0
  v_mov_b32 v235, 0
  v_mov_b32 v236, 0
  v_mov_b32 v237, 0
  v_mov_b32 v238, 0
  v_mov_b32 v239, 0
  v_mov_b32 v240, 0
  v_mov_b32 v241, 0
  v_mov_b32 v242, 0
  v_mov_b32 v243, 0
  v_mov_b32 v244, 0
  v_mov_b32 v245, 0
  v_mov_b32 v246, 0
  v_mov_b32 v247, 0
  v_mov_b32 v248, 0
  v_mov_b32 v249, 0
  v_mov_b32 v250, 0
  v_mov_b32 v251, 0
  v_mov_b32 v252, 0
  v_mov_b32 v253, 0
  v_mov_b32 v254, 0
  v_mov_b32 v255, 0
  v_accvgpr_write_b32 a232, 0
  v_accvgpr_write_b32 a233, 0
  v_accvgpr_write_b32 a234, 0
  v_accvgpr_write_b32 a235, 0
  v_accvgpr_write_b32 a236, 0
  v_accvgpr_write_b32 a237, 0
  v_accvgpr_write_b32 a238, 0
  v_accvgpr_write_b32 a239, 0
  v_accvgpr_write_b32 a240, 0
  v_accvgpr_write_b32 a241, 0
  v_accvgpr_write_b32 a242, 0
  v_accvgpr_write_b32 a243, 0
  v_accvgpr_write_b32 a244, 0
  v_accvgpr_write_b32 a245, 0
  v_accvgpr_write_b32 a246, 0
  v_accvgpr_write_b32 a247, 0
  v_accvgpr_write_b32 a0, 0
  v_accvgpr_write_b32 a1, 0
  v_accvgpr_write_b32 a2, 0
  v_accvgpr_write_b32 a3, 0
  v_accvgpr_write_b32 a4, 0
  v_accvgpr_write_b32 a5, 0
  v_accvgpr_write_b32 a6, 0
  v_accvgpr_write_b32 a7, 0
  v_accvgpr_write_b32 a8, 0
  v_accvgpr_write_b32 a9, 0
  v_accvgpr_write_b32 a10, 0
  v_accvgpr_write_b32 a11, 0
  v_accvgpr_write_b32 a12, 0
  v_accvgpr_write_b32 a13, 0
  v_accvgpr_write_b32 a14, 0
  v_accvgpr_write_b32 a15, 0
  v_accvgpr_write_b32 a16, 0
  v_accvgpr_write_b32 a17, 0
  v_accvgpr_write_b32 a18, 0
  v_accvgpr_write_b32 a19, 0
  v_accvgpr_write_b32 a20, 0
  v_accvgpr_write_b32 a21, 0
  v_accvgpr_write_b32 a22, 0
  v_accvgpr_write_b32 a23, 0
  v_accvgpr_write_b32 a24, 0
  v_accvgpr_write_b32 a25, 0
  v_accvgpr_write_b32 a26, 0
  v_accvgpr_write_b32 a27, 0
  v_accvgpr_write_b32 a28, 0
  v_accvgpr_write_b32 a29, 0
  v_accvgpr_write_b32 a30, 0
  v_accvgpr_write_b32 a31, 0
  v_accvgpr_write_b32 a32, 0
  v_accvgpr_write_b32 a33, 0
  v_accvgpr_write_b32 a34, 0
  v_accvgpr_write_b32 a35, 0
  v_accvgpr_write_b32 a36, 0
  v_accvgpr_write_b32 a37, 0
  v_accvgpr_write_b32 a38, 0
  v_accvgpr_write_b32 a39, 0
  v_accvgpr_write_b32 a40, 0
  v_accvgpr_write_b32 a41, 0
  v_accvgpr_write_b32 a42, 0
  v_accvgpr_write_b32 a43, 0
  v_accvgpr_write_b32 a44, 0
  v_accvgpr_write_b32 a45, 0
  v_accvgpr_write_b32 a46, 0
  v_accvgpr_write_b32 a47, 0
  v_accvgpr_write_b32 a48, 0
  v_accvgpr_write_b32 a49, 0
  v_accvgpr_write_b32 a50, 0
  v_accvgpr_write_b32 a51, 0
  v_accvgpr_write_b32 a52, 0
  v_accvgpr_write_b32 a53, 0
  v_accvgpr_write_b32 a54, 0
  v_accvgpr_write_b32 a55, 0
  v_accvgpr_write_b32 a56, 0
  v_accvgpr_write_b32 a57, 0
  v_accvgpr_write_b32 a58, 0
  v_accvgpr_write_b32 a59, 0
  v_accvgpr_write_b32 a60, 0
  v_accvgpr_write_b32 a61, 0
  v_accvgpr_write_b32 a62, 0
  v_accvgpr_write_b32 a63, 0
  v_accvgpr_write_b32 a64, 0
  v_accvgpr_write_b32 a65, 0
  v_accvgpr_write_b32 a66, 0
  v_accvgpr_write_b32 a67, 0
  v_accvgpr_write_b32 a68, 0
  v_accvgpr_write_b32 a69, 0
  v_accvgpr_write_b32 a70, 0
  v_accvgpr_write_b32 a71, 0
  v_accvgpr_write_b32 a72, 0
  v_accvgpr_write_b32 a73, 0
  v_accvgpr_write_b32 a74, 0
  v_accvgpr_write_b32 a75, 0
  v_accvgpr_write_b32 a76, 0
  v_accvgpr_write_b32 a77, 0
  v_accvgpr_write_b32 a78, 0
  v_accvgpr_write_b32 a79, 0
  v_accvgpr_write_b32 a80, 0
  v_accvgpr_write_b32 a81, 0
  v_accvgpr_write_b32 a82, 0
  v_accvgpr_write_b32 a83, 0
  v_accvgpr_write_b32 a84, 0
  v_accvgpr_write_b32 a85, 0
  v_accvgpr_write_b32 a86, 0
  v_accvgpr_write_b32 a87, 0
  v_accvgpr_write_b32 a88, 0
  v_accvgpr_write_b32 a89, 0
  v_accvgpr_write_b32 a90, 0
  v_accvgpr_write_b32 a91, 0
  v_accvgpr_write_b32 a92, 0
  v_accvgpr_write_b32 a93, 0
  v_accvgpr_write_b32 a94, 0
  v_accvgpr_write_b32 a95, 0
  v_accvgpr_write_b32 a96, 0
  v_accvgpr_write_b32 a97, 0
  v_accvgpr_write_b32 a98, 0
  v_accvgpr_write_b32 a99, 0
  v_accvgpr_write_b32 a100, 0
  v_accvgpr_write_b32 a101, 0
  v_accvgpr_write_b32 a102, 0
  v_accvgpr_write_b32 a103, 0
  v_accvgpr_write_b32 a104, 0
  v_accvgpr_write_b32 a105, 0
  v_accvgpr_write_b32 a106, 0
  v_accvgpr_write_b32 a107, 0
  v_accvgpr_write_b32 a108, 0
  v_accvgpr_write_b32 a109, 0
  v_accvgpr_write_b32 a110, 0
  v_accvgpr_write_b32 a111, 0
  v_accvgpr_write_b32 a112, 0
  v_accvgpr_write_b32 a113, 0
  v_accvgpr_write_b32 a114, 0
  v_accvgpr_write_b32 a115, 0
  v_accvgpr_write_b32 a116, 0
  v_accvgpr_write_b32 a117, 0
  v_accvgpr_write_b32 a118, 0
  v_accvgpr_write_b32 a119, 0
  v_accvgpr_write_b32 a120, 0
  v_accvgpr_write_b32 a121, 0
  v_accvgpr_write_b32 a122, 0
  v_accvgpr_write_b32 a123, 0
  v_accvgpr_write_b32 a124, 0
  v_accvgpr_write_b32 a125, 0
  v_accvgpr_write_b32 a126, 0
  v_accvgpr_write_b32 a127, 0
  s_nop 3
  s_mov_b32 s83, 0
L_ex2:
  s_add_u32 s84, s83, 0
  buffer_load_dwordx4 a[208:211], v148, s[16:19], s84 offen offset:0
  buffer_load_dwordx4 a[212:215], v148, s[16:19], s84 offen offset:64
  buffer_load_dwordx4 a[216:219], v148, s[16:19], s84 offen offset:128
  buffer_load_dwordx4 a[220:223], v148, s[16:19], s84 offen offset:192
  buffer_load_dwordx4 a[224:227], v148, s[16:19], s84 offen offset:256
  buffer_load_dwordx4 a[228:231], v148, s[16:19], s84 offen offset:320
  s_waitcnt vmcnt(5)
  v_mfma_f32_16x16x32_bf16 v[160:163], a[208:211], v[48:51], 0
  s_waitcnt vmcnt(4)
  v_mfma_f32_16x16x32_bf16 v[160:163], a[212:215], v[64:67], v[160:163]
  s_waitcnt vmcnt(3)
  v_mfma_f32_16x16x32_bf16 v[160:163], a[216:219], v[80:83], v[160:163]
  s_waitcnt vmcnt(2)
  v_mfma_f32_16x16x32_bf16 v[160:163], a[220:223], v[96:99], v[160:163]
  s_waitcnt vmcnt(1)
  v_mfma_f32_16x16x32_bf16 v[160:163], a[224:227], v[112:115], v[160:163]
  s_waitcnt vmcnt(0)
  v_mfma_f32_16x16x32_bf16 v[160:163], a[228:231], v[128:131], v[160:163]
  v_mfma_f32_16x16x32_bf16 v[164:167], a[208:211], v[52:55], 0
  v_mfma_f32_16x16x32_bf16 v[164:167], a[212:215], v[68:71], v[164:167]
  v_mfma_f32_16x16x32_bf16 v[164:167], a[216:219], v[84:87], v[164:167]
  v_mfma_f32_16x16x32_bf16 v[164:167], a[220:223], v[100:103], v[164:167]
  v_mfma_f32_16x16x32_bf16 v[164:167], a[224:227], v[116:119], v[164:167]
  v_mfma_f32_16x16x32_bf16 v[164:167], a[228:231], v[132:135], v[164:167]
  v_mfma_f32_16x16x32_bf16 v[168:171], a[208:211], v[56:59], 0
  v_mfma_f32_16x16x32_bf16 v[168:171], a[212:215], v[72:75], v[168:171]
  v_mfma_f32_16x16x32_bf16 v[168:171], a[216:219], v[88:91], v[168:171]
  v_mfma_f32_16x16x32_bf16 v[168:171], a[220:223], v[104:107], v[168:171]
  v_mfma_f32_16x16x32_bf16 v[168:171], a[224:227], v[120:123], v[168:171]
  v_mfma_f32_16x16x32_bf16 v[168:171], a[228:231], v[136:139], v[168:171]
  v_mfma_f32_16x16x32_bf16 v[172:175], a[208:211], v[60:63], 0
  v_mfma_f32_16x16x32_bf16 v[172:175], a[212:215], v[76:79], v[172:175]
  v_mfma_f32_16x16x32_bf16 v[172:175], a[216:219], v[92:95], v[172:175]
  v_mfma_f32_16x16x32_bf16 v[172:175], a[220:223], v[108:111], v[172:175]
  v_mfma_f32_16x16x32_bf16 v[172:175], a[224:227], v[124:127], v[172:175]
  v_mfma_f32_16x16x32_bf16 v[172:175], a[228:231], v[140:143], v[172:175]
  s_nop 7
  s_add_u32 s84, s83, 6144
  buffer_load_dwordx4 a[208:211], v148, s[16:19], s84 offen offset:0
  buffer_load_dwordx4 a[212:215], v148, s[16:19], s84 offen offset:64
  buffer_load_dwordx4 a[216:219], v148, s[16:19], s84 offen offset:128
  buffer_load_dwordx4 a[220:223], v148, s[16:19], s84 offen offset:192
  buffer_load_dwordx4 a[224:227], v148, s[16:19], s84 offen offset:256
  buffer_load_dwordx4 a[228:231], v148, s[16:19], s84 offen offset:320
  s_waitcnt vmcnt(5)
  v_mfma_f32_16x16x32_bf16 v[176:179], a[208:211], v[48:51], 0
  s_waitcnt vmcnt(4)
  v_mfma_f32_16x16x32_bf16 v[176:179], a[212:215], v[64:67], v[176:179]
  s_waitcnt vmcnt(3)
  v_mfma_f32_16x16x32_bf16 v[176:179], a[216:219], v[80:83], v[176:179]
  s_waitcnt vmcnt(2)
  v_mfma_f32_16x16x32_bf16 v[176:179], a[220:223], v[96:99], v[176:179]
  s_waitcnt vmcnt(1)
  v_mfma_f32_16x16x32_bf16 v[176:179], a[224:227], v[112:115], v[176:179]
  s_waitcnt vmcnt(0)
  v_mfma_f32_16x16x32_bf16 v[176:179], a[228:231], v[128:131], v[176:179]
  v_mfma_f32_16x16x32_bf16 v[180:183], a[208:211], v[52:55], 0
  v_mfma_f32_16x16x32_bf16 v[180:183], a[212:215], v[68:71], v[180:183]
  v_mfma_f32_16x16x32_bf16 v[180:183], a[216:219], v[84:87], v[180:183]
  v_mfma_f32_16x16x32_bf16 v[180:183], a[220:223], v[100:103], v[180:183]
  v_mfma_f32_16x16x32_bf16 v[180:183], a[224:227], v[116:119], v[180:183]
  v_mfma_f32_16x16x32_bf16 v[180:183], a[228:231], v[132:135], v[180:183]
  v_mfma_f32_16x16x32_bf16 v[184:187], a[208:211], v[56:59], 0
  v_mfma_f32_16x16x32_bf16 v[184:187], a[212:215], v[72:75], v[184:187]
  v_mfma_f32_16x16x32_bf16 v[184:187], a[216:219], v[88:91], v[184:187]
  v_mfma_f32_16x16x32_bf16 v[184:187], a[220:223], v[104:107], v[184:187]
  v_mfma_f32_16x16x32_bf16 v[184:187], a[224:227], v[120:123], v[184:187]
  v_mfma_f32_16x16x32_bf16 v[184:187], a[228:231], v[136:139], v[184:187]
  v_mfma_f32_16x16x32_bf16 v[188:191], a[208:211], v[60:63], 0
  v_mfma_f32_16x16x32_bf16 v[188:191], a[212:215], v[76:79], v[188:191]
  v_mfma_f32_16x16x32_bf16 v[188:191], a[216:219], v[92:95], v[188:191]
  v_mfma_f32_16x16x32_bf16 v[188:191], a[220:223], v[108:111], v[188:191]
  v_mfma_f32_16x16x32_bf16 v[188:191], a[224:227], v[124:127], v[188:191]
  v_mfma_f32_16x16x32_bf16 v[188:191], a[228:231], v[140:143], v[188:191]
  s_nop 7
  v_sub_f32 v160, v160, v144
  v_exp_f32 v160, v160
  s_nop 0
  v_add_f32 v44, v44, v160
  v_sub_f32 v161, v161, v144
  v_exp_f32 v161, v161
  s_nop 0
  v_add_f32 v44, v44, v161
  v_sub_f32 v162, v162, v144
  v_exp_f32 v162, v162
  s_nop 0
  v_add_f32 v44, v44, v162
  v_sub_f32 v163, v163, v144
  v_exp_f32 v163, v163
  s_nop 0
  v_add_f32 v44, v44, v163
  v_cvt_pk_bf16_f32 v160, v160, v161
  v_cvt_pk_bf16_f32 v161, v162, v163
  v_sub_f32 v164, v164, v145
  v_exp_f32 v164, v164
  s_nop 0
  v_add_f32 v45, v45, v164
  v_sub_f32 v165, v165, v145
  v_exp_f32 v165, v165
  s_nop 0
  v_add_f32 v45, v45, v165
  v_sub_f32 v166, v166, v145
  v_exp_f32 v166, v166
  s_nop 0
  v_add_f32 v45, v45, v166
  v_sub_f32 v167, v167, v145
  v_exp_f32 v167, v167
  s_nop 0
  v_add_f32 v45, v45, v167
  v_cvt_pk_bf16_f32 v164, v164, v165
  v_cvt_pk_bf16_f32 v165, v166, v167
  v_sub_f32 v168, v168, v146
  v_exp_f32 v168, v168
  s_nop 0
  v_add_f32 v46, v46, v168
  v_sub_f32 v169, v169, v146
  v_exp_f32 v169, v169
  s_nop 0
  v_add_f32 v46, v46, v169
  v_sub_f32 v170, v170, v146
  v_exp_f32 v170, v170
  s_nop 0
  v_add_f32 v46, v46, v170
  v_sub_f32 v171, v171, v146
  v_exp_f32 v171, v171
  s_nop 0
  v_add_f32 v46, v46, v171
  v_cvt_pk_bf16_f32 v168, v168, v169
  v_cvt_pk_bf16_f32 v169, v170, v171
  v_sub_f32 v172, v172, v147
  v_exp_f32 v172, v172
  s_nop 0
  v_add_f32 v47, v47, v172
  v_sub_f32 v173, v173, v147
  v_exp_f32 v173, v173
  s_nop 0
  v_add_f32 v47, v47, v173
  v_sub_f32 v174, v174, v147
  v_exp_f32 v174, v174
  s_nop 0
  v_add_f32 v47, v47, v174
  v_sub_f32 v175, v175, v147
  v_exp_f32 v175, v175
  s_nop 0
  v_add_f32 v47, v47, v175
  v_cvt_pk_bf16_f32 v172, v172, v173
  v_cvt_pk_bf16_f32 v173, v174, v175
  v_sub_f32 v176, v176, v144
  v_exp_f32 v176, v176
  s_nop 0
  v_add_f32 v44, v44, v176
  v_sub_f32 v177, v177, v144
  v_exp_f32 v177, v177
  s_nop 0
  v_add_f32 v44, v44, v177
  v_sub_f32 v178, v178, v144
  v_exp_f32 v178, v178
  s_nop 0
  v_add_f32 v44, v44, v178
  v_sub_f32 v179, v179, v144
  v_exp_f32 v179, v179
  s_nop 0
  v_add_f32 v44, v44, v179
  v_cvt_pk_bf16_f32 v162, v176, v177
  v_cvt_pk_bf16_f32 v163, v178, v179
  v_sub_f32 v180, v180, v145
  v_exp_f32 v180, v180
  s_nop 0
  v_add_f32 v45, v45, v180
  v_sub_f32 v181, v181, v145
  v_exp_f32 v181, v181
  s_nop 0
  v_add_f32 v45, v45, v181
  v_sub_f32 v182, v182, v145
  v_exp_f32 v182, v182
  s_nop 0
  v_add_f32 v45, v45, v182
  v_sub_f32 v183, v183, v145
  v_exp_f32 v183, v183
  s_nop 0
  v_add_f32 v45, v45, v183
  v_cvt_pk_bf16_f32 v166, v180, v181
  v_cvt_pk_bf16_f32 v167, v182, v183
  v_sub_f32 v184, v184, v146
  v_exp_f32 v184, v184
  s_nop 0
  v_add_f32 v46, v46, v184
  v_sub_f32 v185, v185, v146
  v_exp_f32 v185, v185
  s_nop 0
  v_add_f32 v46, v46, v185
  v_sub_f32 v186, v186, v146
  v_exp_f32 v186, v186
  s_nop 0
  v_add_f32 v46, v46, v186
  v_sub_f32 v187, v187, v146
  v_exp_f32 v187, v187
  s_nop 0
  v_add_f32 v46, v46, v187
  v_cvt_pk_bf16_f32 v170, v184, v185
  v_cvt_pk_bf16_f32 v171, v186, v187
  v_sub_f32 v188, v188, v147
  v_exp_f32 v188, v188
  s_nop 0
  v_add_f32 v47, v47, v188
  v_sub_f32 v189, v189, v147
  v_exp_f32 v189, v189
  s_nop 0
  v_add_f32 v47, v47, v189
  v_sub_f32 v190, v190, v147
  v_exp_f32 v190, v190
  s_nop 0
  v_add_f32 v47, v47, v190
  v_sub_f32 v191, v191, v147
  v_exp_f32 v191, v191
  s_nop 0
  v_add_f32 v47, v47, v191
  v_cvt_pk_bf16_f32 v174, v188, v189
  v_cvt_pk_bf16_f32 v175, v190, v191
  s_add_u32 s84, s83, 0
  buffer_load_dwordx4 v149, s[20:23], s84 offen lds
  s_waitcnt vmcnt(0)
  ds_read_b64_tr_b16 a[208:209], v150 offset:0
  ds_read_b64_tr_b16 a[210:211], v150 offset:512
  s_waitcnt lgkmcnt(0)
  v_mfma_f32_16x16x32_bf16 v[208:211], a[208:211], v[160:163], v[208:211]
  v_mfma_f32_16x16x32_bf16 v[212:215], a[208:211], v[164:167], v[212:215]
  v_mfma_f32_16x16x32_bf16 v[216:219], a[208:211], v[168:171], v[216:219]
  v_mfma_f32_16x16x32_bf16 v[220:223], a[208:211], v[172:175], v[220:223]
  s_add_u32 s84, s83, 32
  buffer_load_dwordx4 v149, s[20:23], s84 offen lds
  s_waitcnt vmcnt(0)
  ds_read_b64_tr_b16 a[212:213], v150 offset:0
  ds_read_b64_tr_b16 a[214:215], v150 offset:512
  s_waitcnt lgkmcnt(0)
  v_mfma_f32_16x16x32_bf16 v[224:227], a[212:215], v[160:163], v[224:227]
  v_mfma_f32_16x16x32_bf16 v[228:231], a[212:215], v[164:167], v[228:231]
  v_mfma_f32_16x16x32_bf16 v[232:235], a[212:215], v[168:171], v[232:235]
  v_mfma_f32_16x16x32_bf16 v[236:239], a[212:215], v[172:175], v[236:239]
  s_add_u32 s84, s83, 64
  buffer_load_dwordx4 v149, s[20:23], s84 offen lds
  s_waitcnt vmcnt(0)
  ds_read_b64_tr_b16 a[216:217], v150 offset:0
  ds_read_b64_tr_b16 a[218:219], v150 offset:512
  s_waitcnt lgkmcnt(0)
  v_mfma_f32_16x16x32_bf16 v[240:243], a[216:219], v[160:163], v[240:243]
  v_mfma_f32_16x16x32_bf16 v[244:247], a[216:219], v[164:167], v[244:247]
  v_mfma_f32_16x16x32_bf16 v[248:251], a[216:219], v[168:171], v[248:251]
  v_mfma_f32_16x16x32_bf16 v[252:255], a[216:219], v[172:175], v[252:255]
  s_add_u32 s84, s83, 96
  buffer_load_dwordx4 v149, s[20:23], s84 offen lds
  s_waitcnt vmcnt(0)
  ds_read_b64_tr_b16 a[220:221], v150 offset:0
  ds_read_b64_tr_b16 a[222:223], v150 offset:512
  s_waitcnt lgkmcnt(0)
  v_mfma_f32_16x16x32_bf16 a[232:235], a[220:223], v[160:163], a[232:235]
  v_mfma_f32_16x16x32_bf16 a[236:239], a[220:223], v[164:167], a[236:239]
  v_mfma_f32_16x16x32_bf16 a[240:243], a[220:223], v[168:171], a[240:243]
  v_mfma_f32_16x16x32_bf16 a[244:247], a[220:223], v[172:175], a[244:247]
  s_add_u32 s84, s83, 128
  buffer_load_dwordx4 v149, s[20:23], s84 offen lds
  s_waitcnt vmcnt(0)
  ds_read_b64_tr_b16 a[224:225], v150 offset:0
  ds_read_b64_tr_b16 a[226:227], v150 offset:512
  s_waitcnt lgkmcnt(0)
  v_mfma_f32_16x16x32_bf16 a[0:3], a[224:227], v[160:163], a[0:3]
  v_mfma_f32_16x16x32_bf16 a[4:7], a[224:227], v[164:167], a[4:7]
  v_mfma_f32_16x16x32_bf16 a[8:11], a[224:227], v[168:171], a[8:11]
  v_mfma_f32_16x16x32_bf16 a[12:15], a[224:227], v[172:175], a[12:15]
  s_add_u32 s84, s83, 160
  buffer_load_dwordx4 v149, s[20:23], s84 offen lds
  s_waitcnt vmcnt(0)
  ds_read_b64_tr_b16 a[228:229], v150 offset:0
  ds_read_b64_tr_b16 a[230:231], v150 offset:512
  s_waitcnt lgkmcnt(0)
  v_mfma_f32_16x16x32_bf16 a[16:19], a[228:231], v[160:163], a[16:19]
  v_mfma_f32_16x16x32_bf16 a[20:23], a[228:231], v[164:167], a[20:23]
  v_mfma_f32_16x16x32_bf16 a[24:27], a[228:231], v[168:171], a[24:27]
  v_mfma_f32_16x16x32_bf16 a[28:31], a[228:231], v[172:175], a[28:31]
  s_add_u32 s84, s83, 192
  buffer_load_dwordx4 v149, s[20:23], s84 offen lds
  s_waitcnt vmcnt(0)
  ds_read_b64_tr_b16 a[208:209], v150 offset:0
  ds_read_b64_tr_b16 a[210:211], v150 offset:512
  s_waitcnt lgkmcnt(0)
  v_mfma_f32_16x16x32_bf16 a[32:35], a[208:211], v[160:163], a[32:35]
  v_mfma_f32_16x16x32_bf16 a[36:39], a[208:211], v[164:167], a[36:39]
  v_mfma_f32_16x16x32_bf16 a[40:43], a[208:211], v[168:171], a[40:43]
  v_mfma_f32_16x16x32_bf16 a[44:47], a[208:211], v[172:175], a[44:47]
  s_add_u32 s84, s83, 224
  buffer_load_dwordx4 v149, s[20:23], s84 offen lds
  s_waitcnt vmcnt(0)
  ds_read_b64_tr_b16 a[212:213], v150 offset:0
  ds_read_b64_tr_b16 a[214:215], v150 offset:512
  s_waitcnt lgkmcnt(0)
  v_mfma_f32_16x16x32_bf16 a[48:51], a[212:215], v[160:163], a[48:51]
  v_mfma_f32_16x16x32_bf16 a[52:55], a[212:215], v[164:167], a[52:55]
  v_mfma_f32_16x16x32_bf16 a[56:59], a[212:215], v[168:171], a[56:59]
  v_mfma_f32_16x16x32_bf16 a[60:63], a[212:215], v[172:175], a[60:63]
  s_add_u32 s84, s83, 256
  buffer_load_dwordx4 v149, s[20:23], s84 offen lds
  s_waitcnt vmcnt(0)
  ds_read_b64_tr_b16 a[216:217], v150 offset:0
  ds_read_b64_tr_b16 a[218:219], v150 offset:512
  s_waitcnt lgkmcnt(0)
  v_mfma_f32_16x16x32_bf16 a[64:67], a[216:219], v[160:163], a[64:67]
  v_mfma_f32_16x16x32_bf16 a[68:71], a[216:219], v[164:167], a[68:71]
  v_mfma_f32_16x16x32_bf16 a[72:75], a[216:219], v[168:171], a[72:75]
  v_mfma_f32_16x16x32_bf16 a[76:79], a[216:219], v[172:175], a[76:79]
  s_add_u32 s84, s83, 288
  buffer_load_dwordx4 v149, s[20:23], s84 offen lds
  s_waitcnt vmcnt(0)
  ds_read_b64_tr_b16 a[220:221], v150 offset:0
  ds_read_b64_tr_b16 a[222:223], v150 offset:512
  s_waitcnt lgkmcnt(0)
  v_mfma_f32_16x16x32_bf16 a[80:83], a[220:223], v[160:163], a[80:83]
  v_mfma_f32_16x16x32_bf16 a[84:87], a[220:223], v[164:167], a[84:87]
  v_mfma_f32_16x16x32_bf16 a[88:91], a[220:223], v[168:171], a[88:91]
  v_mfma_f32_16x16x32_bf16 a[92:95], a[220:223], v[172:175], a[92:95]
  s_add_u32 s84, s83, 320
  buffer_load_dwordx4 v149, s[20:23], s84 offen lds
  s_waitcnt vmcnt(0)
  ds_read_b64_tr_b16 a[224:225], v150 offset:0
  ds_read_b64_tr_b16 a[226:227], v150 offset:512
  s_waitcnt lgkmcnt(0)
  v_mfma_f32_16x16x32_bf16 a[96:99], a[224:227], v[160:163], a[96:99]
  v_mfma_f32_16x16x32_bf16 a[100:103], a[224:227], v[164:167], a[100:103]
  v_mfma_f32_16x16x32_bf16 a[104:107], a[224:227], v[168:171], a[104:107]
  v_mfma_f32_16x16x32_bf16 a[108:111], a[224:227], v[172:175], a[108:111]
  s_add_u32 s84, s83, 352
  buffer_load_dwordx4 v149, s[20:23], s84 offen lds
  s_waitcnt vmcnt(0)
  ds_read_b64_tr_b16 a[228:229], v150 offset:0
  ds_read_b64_tr_b16 a[230:231], v150 offset:512
  s_waitcnt lgkmcnt(0)
  v_mfma_f32_16x16x32_bf16 a[112:115], a[228:231], v[160:163], a[112:115]
  v_mfma_f32_16x16x32_bf16 a[116:119], a[228:231], v[164:167], a[116:119]
  v_mfma_f32_16x16x32_bf16 a[120:123], a[228:231], v[168:171], a[120:123]
  v_mfma_f32_16x16x32_bf16 a[124:127], a[228:231], v[172:175], a[124:127]
  s_waitcnt vmcnt(0) lgkmcnt(0)
  s_nop 15
  s_nop 15
  s_add_u32 s83, s83, 12288
  s_cmp_lt_u32 s83, 196608
  s_cbranch_scc1 L_ex2
  v_permlane32_swap_b32 v44, v45
  v_add_f32 v44, v44, v45
  v_permlane32_swap_b32 v46, v47
  v_add_f32 v46, v46, v47
  s_nop 1
  v_permlane16_swap_b32 v44, v46
  v_add_f32 v44, v44, v46
  v_mov_b32 v160, 0
  v_mov_b32 v161, 0
  v_mov_b32 v162, 0
  v_mov_b32 v163, 0
  v_mov_b32 v164, 0
  v_mov_b32 v165, 0
  v_mov_b32 v166, 0
  v_mov_b32 v167, 0
  v_mov_b32 v168, 0
  v_mov_b32 v169, 0
  v_mov_b32 v170, 0
  v_mov_b32 v171, 0
  v_mov_b32 v172, 0
  v_mov_b32 v173, 0
  v_mov_b32 v174, 0
  v_mov_b32 v175, 0
  v_mov_b32 v144, 0
  v_mov_b32 v145, 0
  v_mov_b32 v146, 0
  v_mov_b32 v147, 0
  v_mov_b32 v148, 0
  v_mov_b32 v149, 0
  v_mov_b32 v150, 0
  v_mov_b32 v151, 0
  v_mov_b32 v152, 0
  v_mov_b32 v153, 0
  v_mov_b32 v154, 0
  v_mov_b32 v155, 0
  v_mov_b32 v156, 0
  v_mov_b32 v157, 0
  v_mov_b32 v158, 0
  v_mov_b32 v159, 0
  v_mov_b32 v192, 0
  v_mov_b32 v193, 0
  v_mov_b32 v194, 0
  v_mov_b32 v195, 0
  v_mov_b32 v196, 0
  v_mov_b32 v197, 0
  v_mov_b32 v198, 0
  v_mov_b32 v199, 0
  v_mov_b32 v200, 0
  v_mov_b32 v201, 0
  v_mov_b32 v202, 0
  v_mov_b32 v203, 0
  v_mov_b32 v204, 0
  v_mov_b32 v205, 0
  v_mov_b32 v206, 0
  v_mov_b32 v207, 0
  s_mov_b32 m0, s82
  s_waitcnt vmcnt(0) lgkmcnt(0)
  s_nop 15
  s_nop 15
  s_branch L_exact_ret
L_slow2:
  s_waitcnt vmcnt(0)
  buffer_wbl2 sc1
  s_waitcnt vmcnt(0)
  buffer_store_dword v41, v0, s[4:7], s41 offen sc1
  s_branch L_fast2
L_slow3:
  s_waitcnt vmcnt(0)
  buffer_wbl2 sc1
  s_waitcnt vmcnt(0)
  buffer_store_dword v41, v0, s[4:7], s41 offen sc1
  s_branch L_fast3
L_spin3:
  s_mov_b32 s84, 0x40000
L_sp3:
  buffer_load_dword v40, v14, s[4:7], s78 offen offset:0 sc1
  s_waitcnt vmcnt(0)
  v_subrev_u32 v40, s43, v40
  v_cmp_lt_u32 vcc, 7, v40
  s_nop 1
  s_cbranch_vccz L_ret3
  s_sub_u32 s84, s84, 1
  s_cmp_lg_u32 s84, 0
  s_cbranch_scc1 L_sp3
  s_branch L_ret3
L_slow4:
  s_waitcnt vmcnt(0)
  buffer_wbl2 sc1
  s_waitcnt vmcnt(0)
  buffer_store_dword v41, v0, s[4:7], s41 offen sc1
  s_branch L_fast4
L_spin4:
  s_mov_b32 s84, 0x40000
L_sp4:
  buffer_load_dword v40, v14, s[4:7], s78 offen offset:0 sc1
  s_waitcnt vmcnt(0)
  v_subrev_u32 v40, s43, v40
  v_cmp_lt_u32 vcc, 7, v40
  s_nop 1
  s_cbranch_vccz L_ret4
  s_sub_u32 s84, s84, 1
  s_cmp_lg_u32 s84, 0
  s_cbranch_scc1 L_sp4
  s_branch L_ret4
L_slow5:
  s_waitcnt vmcnt(0)
  buffer_wbl2 sc1
  s_waitcnt vmcnt(0)
  buffer_store_dword v41, v0, s[4:7], s41 offen sc1
  s_branch L_fast5
L_spin5:
  s_mov_b32 s84, 0x40000
L_sp5:
  buffer_load_dword v40, v14, s[4:7], s78 offen offset:0 sc1
  s_waitcnt vmcnt(0)
  v_subrev_u32 v40, s43, v40
  v_cmp_lt_u32 vcc, 7, v40
  s_nop 1
  s_cbranch_vccz L_ret5
  s_sub_u32 s84, s84, 1
  s_cmp_lg_u32 s84, 0
  s_cbranch_scc1 L_sp5
  s_branch L_ret5
L_slow6:
  s_waitcnt vmcnt(0)
  buffer_wbl2 sc1
  s_waitcnt vmcnt(0)
  buffer_store_dword v41, v0, s[4:7], s41 offen sc1
  s_branch L_fast6
L_spin6:
  s_mov_b32 s84, 0x40000
L_sp6:
  buffer_load_dword v40, v14, s[4:7], s78 offen offset:0 sc1
  s_waitcnt vmcnt(0)
  v_subrev_u32 v40, s43, v40
  v_cmp_lt_u32 vcc, 7, v40
  s_nop 1
  s_cbranch_vccz L_ret6
  s_sub_u32 s84, s84, 1
  s_cmp_lg_u32 s84, 0
  s_cbranch_scc1 L_sp6
  s_branch L_ret6
L_slow7:
  s_waitcnt vmcnt(0)
  buffer_wbl2 sc1
  s_waitcnt vmcnt(0)
  buffer_store_dword v41, v0, s[4:7], s41 offen sc1
  s_branch L_fast7
L_spin7:
  s_mov_b32 s84, 0x40000
L_sp7:
  buffer_load_dword v40, v14, s[4:7], s78 offen offset:0 sc1
  s_waitcnt vmcnt(0)
  v_subrev_u32 v40, s43, v40
  v_cmp_lt_u32 vcc, 7, v40
  s_nop 1
  s_cbranch_vccz L_ret7
  s_sub_u32 s84, s84, 1
  s_cmp_lg_u32 s84, 0
  s_cbranch_scc1 L_sp7
  s_branch L_ret7
L_spin8:
  s_mov_b32 s84, 0x40000
L_sp8:
  buffer_load_dword v40, v39, s[4:7], s79 offen offset:0 sc1
  s_waitcnt vmcnt(0)
  v_subrev_u32 v40, s43, v40
  v_cmp_lt_u32 vcc, 7, v40
  s_nop 1
  s_cbranch_vccz L_ret8
  s_sub_u32 s84, s84, 1
  s_cmp_lg_u32 s84, 0
  s_cbranch_scc1 L_sp8
  s_branch L_ret8
L_spin9:
  s_mov_b32 s84, 0x40000
L_sp9:
  buffer_load_dword v40, v14, s[4:7], s78 offen offset:0 sc1
  s_waitcnt vmcnt(0)
  v_subrev_u32 v40, s43, v40
  v_cmp_lt_u32 vcc, 7, v40
  s_nop 1
  s_cbranch_vccz L_ret9
  s_sub_u32 s84, s84, 1
  s_cmp_lg_u32 s84, 0
  s_cbranch_scc1 L_sp9
  s_branch L_ret9
L_pad:
.fill (recurrent_scan__sliding_block_cached__swiglu_ffn__prompt_kernel + 106752 - L_pad) / 4, 4, 0xBF810000
.section .rodata,"a"
.p2align 6
.amdhsa_kernel recurrent_scan__sliding_block_cached__swiglu_ffn__prompt_kernel
  .amdhsa_next_free_vgpr 512
  .amdhsa_next_free_sgpr 102
  .amdhsa_accum_offset 256
  .amdhsa_group_segment_fixed_size 0
  .amdhsa_kernarg_size 96
  .amdhsa_user_sgpr_count 2
  .amdhsa_user_sgpr_kernarg_segment_ptr 1
  .amdhsa_system_sgpr_workgroup_id_x 1
.end_amdhsa_kernel
```
